```python
import torch

def _softmax(x, axis=-1):
    return torch.softmax(x, dim=axis)
def _gelu(x):
    return torch.nn.functional.gelu(x, approximate="tanh")
def _silu(x):
    return torch.nn.functional.silu(x)
def _sigmoid(x):
    return torch.sigmoid(x)
def _layernorm(x, axis=-1, eps=1e-5):
    m = x.mean(dim=axis, keepdim=True)
    v = x.var(dim=axis, keepdim=True, unbiased=False)
    return (x - m) / torch.sqrt(v + eps)
def _scatter_add(tgt, idx, src, axis=0):
    return tgt.clone().index_add_(axis, idx, src)
def _segment_sum(src, seg, n):
    out = torch.zeros((n,) + src.shape[1:], dtype=src.dtype)
    return out.index_add_(0, seg, src)
def _pad(x, pw):
    flat = tuple(v for pair in reversed(pw) for v in pair)
    return torch.nn.functional.pad(x, flat)

kernel_name = 'concat_heads__gqa_block_cached__gqa_block_cached__near_ridge'

def setup_inputs():

    _w = (lambda a: (lambda t: t.to(torch.bfloat16) if t.is_floating_point() else t)(torch.as_tensor(a)))
    def _A_setup():
        B, Sq, D = 8, 240, 640
        Hq, Hkv, Sk, Dh = 32, 32, 1024, 192
        assert Hq % Hkv == 0, (Hq, Hkv)
        return {
            "x": _w((lambda *s: torch.randn(*s, dtype=torch.bfloat16) * 0.8)(B, Sq, D)),
            "k_cache": _w((lambda *s: torch.randn(*s, dtype=torch.bfloat16) * 0.8)(B, Hkv, Sk, Dh)),
            "v_cache": _w((lambda *s: torch.randn(*s, dtype=torch.bfloat16) * 0.05)(B, Hkv, Sk, Dh)),
            "wq": _w((lambda *s: torch.randn(*s, dtype=torch.bfloat16) * 0.8)(D, Hq * Dh) * (D ** -0.5)),
            "wo": _w((lambda *s: torch.randn(*s, dtype=torch.bfloat16) * 0.05)(Hq * Dh, D) * ((Hq * Dh) ** -0.5)),
        }
    _A_in = _A_setup()

    def _B_setup():
        B, Sq, D = 8, 240, 640
        Hq, Hkv, Sk, Dh = 32, 32, 1024, 192
        assert Hq % Hkv == 0, (Hq, Hkv)
        return {
            "x": _w((lambda *s: torch.randn(*s, dtype=torch.bfloat16) * 0.8)(B, Sq, D)),
            "k_cache": _w((lambda *s: torch.randn(*s, dtype=torch.bfloat16) * 0.8)(B, Hkv, Sk, Dh)),
            "v_cache": _w((lambda *s: torch.randn(*s, dtype=torch.bfloat16) * 0.05)(B, Hkv, Sk, Dh)),
            "wq": _w((lambda *s: torch.randn(*s, dtype=torch.bfloat16) * 0.8)(D, Hq * Dh) * (D ** -0.5)),
            "wo": _w((lambda *s: torch.randn(*s, dtype=torch.bfloat16) * 0.05)(Hq * Dh, D) * ((Hq * Dh) ** -0.5)),
        }
    _B_in = _B_setup()

    return {
        "A_x": _A_in["x"],
        "A_k_cache": _A_in["k_cache"],
        "A_v_cache": _A_in["v_cache"],
        "A_wq": _A_in["wq"],
        "A_wo": _A_in["wo"],
        "B_x": _B_in["x"],
        "B_k_cache": _B_in["k_cache"],
        "B_v_cache": _B_in["v_cache"],
        "B_wq": _B_in["wq"],
        "B_wo": _B_in["wo"],
    }

def reference(A_x, A_k_cache, A_v_cache, A_wq, A_wo, B_x, B_k_cache, B_v_cache, B_wq, B_wo):
    def _A_ref(x, k_cache, v_cache, wq, wo):
        B, Sq, D = x.shape
        Hq, Dh = 32, 192
        Hkv = k_cache.shape[1]
        rep = Hq // Hkv
        q = (lambda x, *d: x.permute(*d))((x @ wq).reshape(B, Sq, Hq, Dh), 0, 2, 1, 3)
        k = (lambda x, n, axis: torch.repeat_interleave(x, n, dim=axis))(k_cache, rep, axis=1)
        v = (lambda x, n, axis: torch.repeat_interleave(x, n, dim=axis))(v_cache, rep, axis=1)
        scores = torch.einsum("bhqd,bhkd->bhqk", q, k) * (Dh ** -0.5)
        p = _softmax(scores, axis=-1)
        o = torch.einsum("bhqk,bhkd->bhqd", p, v)
        return (lambda x, *d: x.permute(*d))(o, 0, 2, 1, 3).reshape(B, Sq, Hq * Dh) @ wo

    def _B_ref(x, k_cache, v_cache, wq, wo):
        B, Sq, D = x.shape
        Hq, Dh = 32, 192
        Hkv = k_cache.shape[1]
        rep = Hq // Hkv
        q = (lambda x, *d: x.permute(*d))((x @ wq).reshape(B, Sq, Hq, Dh), 0, 2, 1, 3)
        k = (lambda x, n, axis: torch.repeat_interleave(x, n, dim=axis))(k_cache, rep, axis=1)
        v = (lambda x, n, axis: torch.repeat_interleave(x, n, dim=axis))(v_cache, rep, axis=1)
        scores = torch.einsum("bhqd,bhkd->bhqk", q, k) * (Dh ** -0.5)
        p = _softmax(scores, axis=-1)
        o = torch.einsum("bhqk,bhkd->bhqd", p, v)
        return (lambda x, *d: x.permute(*d))(o, 0, 2, 1, 3).reshape(B, Sq, Hq * Dh) @ wo

    a = _A_ref(A_x, A_k_cache, A_v_cache, A_wq, A_wo)
    b = _B_ref(B_x, B_k_cache, B_v_cache, B_wq, B_wo)
    return torch.concatenate([a, b], axis=-1)
```

```asm
; @launch grid=(256,1,1) block=(256,1,1) lds=163840
.amdgcn_target "amdgcn-amd-amdhsa--gfx950"
.text
.globl concat_heads__gqa_block_cached__gqa_block_cached__near_ridge_kernel
.p2align 8
.type concat_heads__gqa_block_cached__gqa_block_cached__near_ridge_kernel,@function
concat_heads__gqa_block_cached__gqa_block_cached__near_ridge_kernel:
s_cmp_ge_u32 s2, 256
s_cbranch_scc1 K1_END
s_load_dwordx16 s[4:19], s[0:1], 0
s_load_dwordx8 s[20:27], s[0:1], 64
s_load_dwordx2 s[68:69], s[0:1], 96
v_lshrrev_b32 v32, 6, v0
v_and_b32 v0, 63, v0
s_mov_b32 s53, s2
v_readfirstlane_b32 s52, v32
s_mov_b64 s[58:59], s[0:1]
s_mov_b32 s48, 0
s_mov_b32 s70, 0
K1_PRO:
s_lshr_b32 s82, s53, 6
s_and_b32 s83, s53, 2
s_lshl1_add_u32 s81, s83, s82
s_mul_i32 s82, s81, 307200
s_lshl_b32 s41, s52, 13
s_lshl_b32 s86, s52, 6
v_lshrrev_b32 v32, 3, v0
v_and_b32 v33, 7, v0
v_and_b32 v34, 6, v32
v_xor_b32 v33, v33, v34
v_add_u32 v34, s86, v32
v_mul_u32_u24 v21, 1280, v34
v_lshl_add_u32 v21, v33, 4, v21
s_bfe_u32 s55, s53, 0x10002
s_waitcnt lgkmcnt(0)
s_cselect_b64 s[92:93], s[16:17], s[6:7]
s_cselect_b64 s[4:5], s[14:15], s[4:5]
s_add_u32 s4, s4, s82
s_addc_u32 s5, s5, 0
s_mov_b32 s6, 307200
s_mov_b32 s7, 0x20000
s_add_u32 m0, s41, 0
s_mov_b32 s46, 0
buffer_load_dwordx4 v21, s[4:7], s46 offen offset:0 lds
s_mov_b32 s46, 9216
buffer_load_dwordx4 v21, s[4:7], s46 offen offset:1024 lds
s_mov_b32 s46, 18432
buffer_load_dwordx4 v21, s[4:7], s46 offen offset:2048 lds
s_mov_b32 s46, 27648
buffer_load_dwordx4 v21, s[4:7], s46 offen offset:3072 lds
s_add_u32 m0, s41, 4096
s_mov_b32 s46, 40960
buffer_load_dwordx4 v21, s[4:7], s46 offen offset:0 lds
s_mov_b32 s46, 50176
buffer_load_dwordx4 v21, s[4:7], s46 offen offset:1024 lds
s_mov_b32 s46, 59392
buffer_load_dwordx4 v21, s[4:7], s46 offen offset:2048 lds
s_mov_b32 s46, 68608
buffer_load_dwordx4 v21, s[4:7], s46 offen offset:3072 lds
s_getpc_b64 s[90:91]
K1_PC:
s_lshr_b32 s86, s53, 3
s_lshl2_add_u32 s86, s86, s52
s_lshl_b32 s86, s86, 10
v_lshl_add_u32 v28, v0, 4, s86
v_min_u32 v28, (K_CODE_END-K1_PC-32)&0xfffffff0, v28
s_and_b32 s90, s90, 0xfffffff0
v_mov_b32 v29, s91
v_add_co_u32 v28, vcc, s90, v28
s_mov_b32 s78, 0
s_nop 0
v_addc_co_u32 v29, vcc, 0, v29, vcc
global_load_dword v30, v[28:29], off
s_cmp_eq_u32 s55, 0
s_cselect_b64 s[94:95], s[8:9], s[18:19]
s_cselect_b64 s[96:97], s[10:11], s[20:21]
s_cselect_b64 s[64:65], s[12:13], s[22:23]
s_mov_b64 s[66:67], s[24:25]
s_mov_b64 s[72:73], s[26:27]
s_lshr_b32 s91, s53, 3
s_and_b32 s88, s53, 1
s_and_b32 s89, s91, 7
s_lshl3_add_u32 s80, s88, s89
s_mul_i32 s84, s80, 384
s_mul_i32 s40, s52, 6144
v_mul_u32_u24 v19, 384, v32
v_lshl_add_u32 v19, v33, 4, v19
v_add_u32 v19, s40, v19
v_and_b32 v34, 4, v33
v_and_b32 v35, 1, v33
v_lshl_or_b32 v34, v35, 1, v34
v_bfe_u32 v35, v33, 1, 1
v_or_b32 v33, v34, v35
v_and_b32 v34, 3, v32
v_lshrrev_b32 v35, 2, v32
v_lshl_add_u32 v34, v35, 3, v34
s_lshr_b32 s86, s52, 1
s_lshl_b32 s86, s86, 5
s_and_b32 s87, s52, 1
s_lshl2_add_u32 s86, s87, s86
v_add_u32 v34, s86, v34
v_mul_u32_u24 v20, 12288, v34
v_lshl_add_u32 v20, v33, 4, v20
v_add_u32 v18, 193536, v20
s_add_u32 s8, s96, s84
s_addc_u32 s9, s97, 0
s_sub_u32 s10, 7864320, s84
s_mov_b32 s11, 0x20000
s_mov_b32 s54, 0
s_add_u32 m0, s40, 32768
s_nop 0
buffer_load_dwordx4 v20, s[8:11], s54 offen offset:0 lds
buffer_load_dwordx4 v18, s[8:11], s54 offen offset:3072 lds
s_add_u32 m0, s40, 33664
s_nop 0
buffer_load_dwordx4 v20, s[8:11], s54 offen offset:128 lds
s_lshl_b32 s83, s81, 5
s_add_u32 s83, s83, s80
s_mul_i32 s83, s83, 393216
s_lshl_b32 s85, s55, 5
s_lshl_b32 s86, s88, 4
s_add_u32 s85, s85, s86
s_add_u32 s85, s85, s89
s_and_b32 s86, s89, 4
s_add_u32 s85, s85, s86
s_mul_i32 s85, s85, 720
s_mul_i32 s86, s81, 15
s_add_u32 s85, s85, s86
buffer_load_dwordx4 v18, s[8:11], s54 offen offset:3200 lds
s_lshl_b32 s85, s85, 10
s_and_b32 s88, s53, 3
s_lshl_b32 s89, s91, 2
s_add_u32 s88, s88, s89
s_add_u32 s20, s92, s83
s_addc_u32 s21, s93, 0
s_add_u32 s22, s94, s83
s_addc_u32 s23, s95, 0
s_mov_b32 s74, 256
s_mov_b32 s75, 0x20000
s_bfe_u32 s76, s53, 0x20001
s_lshl_b32 s76, s76, 6
s_add_u32 m0, s40, 34560
s_nop 0
buffer_load_dwordx4 v20, s[8:11], s54 offen offset:256 lds
s_cmp_eq_u32 s70, 0
s_cselect_b32 s77, 629760, 0
s_add_u32 s24, s8, 6144
s_addc_u32 s25, s9, 0
s_sub_u32 s26, s10, 6144
s_lshr_b32 s86, s88, 1
s_and_b32 s87, s88, 1
s_lshl_b32 s87, s87, 6
s_add_u32 s86, s86, s87
s_mul_i32 s86, s86, 30720
s_add_u32 s98, s64, s86
s_addc_u32 s99, s65, 0
buffer_load_dwordx4 v18, s[8:11], s54 offen offset:3328 lds
s_mul_i32 s86, s88, 49152
s_add_u32 s86, s86, 1579008
s_add_u32 s60, s96, s86
s_addc_u32 s61, s97, 0
s_mov_b32 s62, 43008
s_mov_b32 s63, 0x20000
s_mov_b32 s55, 4096
s_add_u32 s16, s68, s85
s_addc_u32 s17, s69, 0
s_sub_u32 s16, s16, 2949120
s_subb_u32 s17, s17, 0
s_mov_b32 s18, 0
s_mov_b32 s54, 786432
s_add_u32 m0, s40, 57344
s_nop 0
buffer_load_dwordx4 v20, s[8:11], s54 offen offset:0 lds
s_mov_b32 s19, 0x20000
s_lshl_b32 s86, s53, 7
s_add_u32 s86, s86, 48234496
s_add_u32 s12, s68, s86
s_addc_u32 s13, s69, 0
s_cmp_eq_u32 s48, 0
s_cselect_b32 s14, 128, 0
s_mov_b32 s15, 0x20000
s_mov_b32 s47, 0
s_mov_b32 s49, 0
s_mov_b32 s1, 63
s_mov_b32 s3, 0
buffer_load_dwordx4 v18, s[8:11], s54 offen offset:3072 lds
s_lshr_b32 s80, s53, 4
s_mul_i32 s84, s80, 52
s_lshr_b32 s84, s84, 8
s_mul_i32 s85, s84, 5
s_sub_u32 s85, s80, s85
s_and_b32 s81, s53, 1
s_bfe_u32 s89, s53, 0x10003
s_lshl1_add_u32 s89, s81, s89
s_and_b32 s82, s52, 1
s_lshr_b32 s83, s52, 1
s_xor_b32 s86, s81, s82
s_xor_b32 s86, s86, 1
s_add_u32 m0, s40, 58240
s_nop 0
buffer_load_dwordx4 v20, s[8:11], s54 offen offset:128 lds
s_lshl_b32 s86, s86, 7
s_lshl_b32 s87, s85, 8
s_add_u32 s86, s86, s87
s_mul_i32 s87, s83, 81920
s_add_u32 s86, s86, s87
s_mul_i32 s87, s89, 983040
s_add_u32 s86, s86, s87
s_add_u32 s64, s64, s86
s_addc_u32 s65, s65, 0
s_sub_u32 s79, 7864320, s86
s_cmp_lt_u32 s80, 15
s_cselect_b32 s79, s79, 0
buffer_load_dwordx4 v18, s[8:11], s54 offen offset:3200 lds
s_bfe_u32 s86, s53, 0x10001
s_mul_i32 s86, s86, 60
s_mul_i32 s87, s84, 20
s_add_u32 s86, s86, s87
s_mul_i32 s87, s52, 5
s_add_u32 s86, s86, s87
s_bfe_u32 s87, s53, 0x10002
s_lshl2_add_u32 s88, s87, s89
s_mul_i32 s88, s88, 5760
s_add_u32 s88, s88, s86
s_lshl_b32 s88, s88, 10
s_add_u32 s100, s68, s88
s_addc_u32 s101, s69, 0
s_add_u32 m0, s40, 59136
s_nop 0
buffer_load_dwordx4 v20, s[8:11], s54 offen offset:256 lds
s_mul_i32 s88, s86, 40960
s_mul_i32 s87, s87, 1280
s_add_u32 s88, s88, s87
s_lshl_b32 s87, s85, 8
s_add_u32 s88, s88, s87
s_lshl_b32 s87, s89, 6
s_add_u32 s88, s88, s87
s_add_u32 s66, s66, s88
s_addc_u32 s67, s67, 0
s_mov_b32 s50, 0x3dd53b95
s_mov_b32 s51, 0x3dd53b95
s_mov_b32 s56, 0x5d800000
buffer_load_dwordx4 v18, s[8:11], s54 offen offset:3328 lds
s_mov_b32 s42, 0
s_mov_b32 s43, 122880
s_mov_b32 s44, 245760
s_mov_b32 s45, 368640
s_mov_b32 s37, 491520
s_mov_b32 s38, 614400
v_and_b32 v32, 15, v0
v_lshrrev_b32 v33, 4, v0
v_and_b32 v34, 6, v32
v_xor_b32 v35, v34, v33
v_lshlrev_b32 v35, 4, v35
v_lshl_add_u32 v13, v32, 7, v35
s_add_u32 m0, s41, 131072
s_mov_b32 s46, 128
buffer_load_dwordx4 v21, s[4:7], s46 offen offset:0 lds
v_add_u32 v13, s41, v13
v_xor_b32 v14, 64, v13
v_add_u32 v15, 131072, v13
v_add_u32 v16, 131072, v14
v_lshrrev_b32 v34, 3, v32
v_mul_u32_u24 v1, 3072, v34
v_and_b32 v34, 7, v32
v_lshl_add_u32 v1, v34, 7, v1
v_add_u32 v1, v1, v35
v_xor_b32 v2, 64, v1
v_add_u32 v3, 65536, v1
v_add_u32 v4, 65536, v2
s_mov_b32 s46, 9344
buffer_load_dwordx4 v21, s[4:7], s46 offen offset:1024 lds
v_lshrrev_b32 v34, 5, v0
v_mul_u32_u24 v5, 3072, v34
v_bfe_u32 v34, v0, 2, 3
v_lshl_add_u32 v5, v34, 7, v5
v_and_b32 v34, 6, v34
v_bfe_u32 v35, v0, 1, 1
v_xor_b32 v34, v34, v35
v_lshl_add_u32 v5, v34, 4, v5
v_and_b32 v34, 1, v0
v_lshl_add_u32 v5, v34, 3, v5
v_add_u32 v5, 32768, v5
v_xor_b32 v6, 32, v5
s_mov_b32 s46, 18560
buffer_load_dwordx4 v21, s[4:7], s46 offen offset:2048 lds
v_xor_b32 v7, 64, v5
v_xor_b32 v8, 96, v5
v_add_u32 v9, 65536, v5
v_add_u32 v10, 65536, v6
v_add_u32 v11, 65536, v7
v_add_u32 v12, 65536, v8
v_bfe_i32 v34, v0, 2, 1
v_and_b32 v34, 0xaaaaaaaa, v34
v_or_b32 v17, 0x44444444, v34
s_lshl_b32 s86, s52, 12
v_lshlrev_b32 v22, 4, v0
v_add_u32 v22, s86, v22
s_mov_b32 s46, 27776
buffer_load_dwordx4 v21, s[4:7], s46 offen offset:3072 lds
s_cmp_eq_u32 s52, 3
s_cselect_b32 s86, 0x80000000, 0
v_add_u32 v23, s86, v22
v_mov_b32 v24, 0
v_mov_b32 v25, 0
v_mov_b32 v26, 0
v_mov_b32 v27, 0
s_waitcnt vmcnt(10)
ds_read_b128 a[0:3], v13 offset:0
ds_read_b128 a[16:19], v14 offset:0
ds_read_b128 a[4:7], v13 offset:2048
ds_read_b128 a[20:23], v14 offset:2048
ds_read_b128 a[8:11], v13 offset:4096
ds_read_b128 a[24:27], v14 offset:4096
ds_read_b128 a[12:15], v13 offset:6144
ds_read_b128 a[28:31], v14 offset:6144
s_barrier
ds_read_b64_tr_b16 a[192:193], v5 offset:0
ds_read_b64_tr_b16 a[194:195], v5 offset:6144
ds_read_b64_tr_b16 a[196:197], v5 offset:12288
ds_read_b64_tr_b16 a[198:199], v5 offset:18432
ds_read_b64_tr_b16 a[200:201], v6 offset:0
ds_read_b64_tr_b16 a[202:203], v6 offset:6144
ds_read_b64_tr_b16 a[204:205], v6 offset:12288
ds_read_b64_tr_b16 a[206:207], v6 offset:18432
ds_read_b64_tr_b16 a[208:209], v7 offset:0
ds_read_b64_tr_b16 a[210:211], v7 offset:6144
s_waitcnt lgkmcnt(6)
v_mfma_f32_16x16x32_bf16 v[160:163], a[192:195], a[0:3], 0
ds_read_b64_tr_b16 a[212:213], v7 offset:12288
v_mfma_f32_16x16x32_bf16 v[160:163], a[196:199], a[16:19], v[160:163]
ds_read_b64_tr_b16 a[214:215], v7 offset:18432
s_add_u32 m0, s41, 135168
v_mfma_f32_16x16x32_bf16 v[184:187], a[192:195], a[4:7], 0
ds_read_b64_tr_b16 a[216:217], v8 offset:0
s_mov_b32 s46, 41088
v_mfma_f32_16x16x32_bf16 v[184:187], a[196:199], a[20:23], v[184:187]
buffer_load_dwordx4 v21, s[4:7], s46 offen offset:0 lds
v_mfma_f32_16x16x32_bf16 v[208:211], a[192:195], a[8:11], 0
ds_read_b64_tr_b16 a[218:219], v8 offset:6144
s_mov_b32 s46, 50304
v_mfma_f32_16x16x32_bf16 v[208:211], a[196:199], a[24:27], v[208:211]
ds_read_b64_tr_b16 a[220:221], v8 offset:12288
s_waitcnt lgkmcnt(7)
v_mfma_f32_16x16x32_bf16 v[232:235], a[192:195], a[12:15], 0
buffer_load_dwordx4 v21, s[4:7], s46 offen offset:1024 lds
v_mfma_f32_16x16x32_bf16 v[232:235], a[196:199], a[28:31], v[232:235]
ds_read_b64_tr_b16 a[222:223], v8 offset:18432
s_mov_b32 s46, 59520
v_mfma_f32_16x16x32_bf16 v[64:67], a[200:203], a[0:3], 0
v_mfma_f32_16x16x32_bf16 v[64:67], a[204:207], a[16:19], v[64:67]
ds_read_b64_tr_b16 a[224:225], v5 offset:1024
v_mfma_f32_16x16x32_bf16 v[88:91], a[200:203], a[4:7], 0
buffer_load_dwordx4 v21, s[4:7], s46 offen offset:2048 lds
v_mfma_f32_16x16x32_bf16 v[88:91], a[204:207], a[20:23], v[88:91]
ds_read_b64_tr_b16 a[226:227], v5 offset:7168
s_mov_b32 s46, 68736
v_mfma_f32_16x16x32_bf16 v[112:115], a[200:203], a[8:11], 0
ds_read_b64_tr_b16 a[228:229], v5 offset:13312
v_mfma_f32_16x16x32_bf16 v[112:115], a[204:207], a[24:27], v[112:115]
buffer_load_dwordx4 v21, s[4:7], s46 offen offset:3072 lds
v_mfma_f32_16x16x32_bf16 v[136:139], a[200:203], a[12:15], 0
ds_read_b64_tr_b16 a[230:231], v5 offset:19456
s_waitcnt lgkmcnt(8)
v_mfma_f32_16x16x32_bf16 v[136:139], a[204:207], a[28:31], v[136:139]
v_mfma_f32_16x16x32_bf16 v[164:167], a[208:211], a[0:3], 0
ds_read_b64_tr_b16 a[232:233], v6 offset:1024
s_mov_b32 s54, 1572864
v_mfma_f32_16x16x32_bf16 v[164:167], a[212:215], a[16:19], v[164:167]
v_mfma_f32_16x16x32_bf16 v[188:191], a[208:211], a[4:7], 0
ds_read_b64_tr_b16 a[234:235], v6 offset:7168
s_add_u32 m0, s40, 81920
v_mfma_f32_16x16x32_bf16 v[188:191], a[212:215], a[20:23], v[188:191]
buffer_load_dwordx4 v20, s[8:11], s54 offen offset:0 lds
v_mfma_f32_16x16x32_bf16 v[212:215], a[208:211], a[8:11], 0
ds_read_b64_tr_b16 a[236:237], v6 offset:13312
v_mfma_f32_16x16x32_bf16 v[212:215], a[212:215], a[24:27], v[212:215]
buffer_load_dwordx4 v18, s[8:11], s54 offen offset:3072 lds
v_mfma_f32_16x16x32_bf16 v[236:239], a[208:211], a[12:15], 0
ds_read_b64_tr_b16 a[238:239], v6 offset:19456
s_waitcnt lgkmcnt(8)
v_mfma_f32_16x16x32_bf16 v[236:239], a[212:215], a[28:31], v[236:239]
ds_read_b64_tr_b16 a[240:241], v7 offset:1024
s_add_u32 m0, s40, 82816
v_mfma_f32_16x16x32_bf16 v[68:71], a[216:219], a[0:3], 0
v_mfma_f32_16x16x32_bf16 v[68:71], a[220:223], a[16:19], v[68:71]
buffer_load_dwordx4 v20, s[8:11], s54 offen offset:128 lds
v_mfma_f32_16x16x32_bf16 v[92:95], a[216:219], a[4:7], 0
ds_read_b64_tr_b16 a[242:243], v7 offset:7168
v_mfma_f32_16x16x32_bf16 v[92:95], a[220:223], a[20:23], v[92:95]
ds_read_b64_tr_b16 a[244:245], v7 offset:13312
v_mfma_f32_16x16x32_bf16 v[116:119], a[216:219], a[8:11], 0
buffer_load_dwordx4 v18, s[8:11], s54 offen offset:3200 lds
v_mfma_f32_16x16x32_bf16 v[116:119], a[220:223], a[24:27], v[116:119]
ds_read_b64_tr_b16 a[246:247], v7 offset:19456
s_waitcnt lgkmcnt(8)
v_mfma_f32_16x16x32_bf16 v[140:143], a[216:219], a[12:15], 0
v_mfma_f32_16x16x32_bf16 v[140:143], a[220:223], a[28:31], v[140:143]
ds_read_b64_tr_b16 a[248:249], v8 offset:1024
s_add_u32 m0, s40, 83712
v_mfma_f32_16x16x32_bf16 v[168:171], a[224:227], a[0:3], 0
buffer_load_dwordx4 v20, s[8:11], s54 offen offset:256 lds
v_mfma_f32_16x16x32_bf16 v[168:171], a[228:231], a[16:19], v[168:171]
ds_read_b64_tr_b16 a[250:251], v8 offset:7168
v_mfma_f32_16x16x32_bf16 v[192:195], a[224:227], a[4:7], 0
buffer_load_dwordx4 v18, s[8:11], s54 offen offset:3328 lds
v_mfma_f32_16x16x32_bf16 v[192:195], a[228:231], a[20:23], v[192:195]
ds_read_b64_tr_b16 a[252:253], v8 offset:13312
s_add_u32 m0, s41, 0
v_mfma_f32_16x16x32_bf16 v[216:219], a[224:227], a[8:11], 0
ds_read_b64_tr_b16 a[254:255], v8 offset:19456
s_mov_b32 s46, 256
v_mfma_f32_16x16x32_bf16 v[216:219], a[228:231], a[24:27], v[216:219]
s_waitcnt lgkmcnt(8)
ds_read_b64_tr_b16 a[192:193], v5 offset:2048
v_mfma_f32_16x16x32_bf16 v[240:243], a[224:227], a[12:15], 0
v_mfma_f32_16x16x32_bf16 v[240:243], a[228:231], a[28:31], v[240:243]
v_mfma_f32_16x16x32_bf16 v[72:75], a[232:235], a[0:3], 0
buffer_load_dwordx4 v21, s[4:7], s46 offen offset:0 lds
v_mfma_f32_16x16x32_bf16 v[72:75], a[236:239], a[16:19], v[72:75]
ds_read_b64_tr_b16 a[194:195], v5 offset:8192
s_mov_b32 s46, 9472
v_mfma_f32_16x16x32_bf16 v[96:99], a[232:235], a[4:7], 0
ds_read_b64_tr_b16 a[196:197], v5 offset:14336
v_mfma_f32_16x16x32_bf16 v[96:99], a[236:239], a[20:23], v[96:99]
v_mfma_f32_16x16x32_bf16 v[120:123], a[232:235], a[8:11], 0
ds_read_b64_tr_b16 a[198:199], v5 offset:20480
v_mfma_f32_16x16x32_bf16 v[120:123], a[236:239], a[24:27], v[120:123]
buffer_load_dwordx4 v21, s[4:7], s46 offen offset:1024 lds
v_mfma_f32_16x16x32_bf16 v[144:147], a[232:235], a[12:15], 0
ds_read_b64_tr_b16 a[200:201], v6 offset:2048
s_waitcnt lgkmcnt(9)
v_mfma_f32_16x16x32_bf16 v[144:147], a[236:239], a[28:31], v[144:147]
ds_read_b64_tr_b16 a[202:203], v6 offset:8192
s_mov_b32 s46, 18688
v_mfma_f32_16x16x32_bf16 v[172:175], a[240:243], a[0:3], 0
buffer_load_dwordx4 v21, s[4:7], s46 offen offset:2048 lds
v_mfma_f32_16x16x32_bf16 v[172:175], a[244:247], a[16:19], v[172:175]
ds_read_b64_tr_b16 a[204:205], v6 offset:14336
s_mov_b32 s46, 27904
v_mfma_f32_16x16x32_bf16 v[196:199], a[240:243], a[4:7], 0
v_mfma_f32_16x16x32_bf16 v[196:199], a[244:247], a[20:23], v[196:199]
ds_read_b64_tr_b16 a[206:207], v6 offset:20480
v_mfma_f32_16x16x32_bf16 v[220:223], a[240:243], a[8:11], 0
buffer_load_dwordx4 v21, s[4:7], s46 offen offset:3072 lds
v_mfma_f32_16x16x32_bf16 v[220:223], a[244:247], a[24:27], v[220:223]
ds_read_b64_tr_b16 a[208:209], v7 offset:2048
s_waitcnt lgkmcnt(9)
v_mfma_f32_16x16x32_bf16 v[244:247], a[240:243], a[12:15], 0
v_mfma_f32_16x16x32_bf16 v[244:247], a[244:247], a[28:31], v[244:247]
ds_read_b64_tr_b16 a[210:211], v7 offset:8192
s_add_u32 m0, s41, 4096
v_mfma_f32_16x16x32_bf16 v[76:79], a[248:251], a[0:3], 0
ds_read_b64_tr_b16 a[212:213], v7 offset:14336
s_waitcnt vmcnt(16)
v_mfma_f32_16x16x32_bf16 v[76:79], a[252:255], a[16:19], v[76:79]
ds_read_b128 a[32:35], v15 offset:0
s_mov_b32 s46, 41216
v_mfma_f32_16x16x32_bf16 v[100:103], a[248:251], a[4:7], 0
buffer_load_dwordx4 v21, s[4:7], s46 offen offset:0 lds
v_mfma_f32_16x16x32_bf16 v[100:103], a[252:255], a[20:23], v[100:103]
ds_read_b64_tr_b16 a[214:215], v7 offset:20480
s_mov_b32 s46, 50432
v_mfma_f32_16x16x32_bf16 v[124:127], a[248:251], a[8:11], 0
ds_read_b128 a[48:51], v16 offset:0
s_waitcnt vmcnt(15)
v_mfma_f32_16x16x32_bf16 v[124:127], a[252:255], a[24:27], v[124:127]
ds_read_b64_tr_b16 a[216:217], v8 offset:2048
s_waitcnt lgkmcnt(11)
v_mfma_f32_16x16x32_bf16 v[148:151], a[248:251], a[12:15], 0
buffer_load_dwordx4 v21, s[4:7], s46 offen offset:1024 lds
v_mfma_f32_16x16x32_bf16 v[148:151], a[252:255], a[28:31], v[148:151]
ds_read_b64_tr_b16 a[218:219], v8 offset:8192
s_mov_b32 s46, 59648
v_mfma_f32_16x16x32_bf16 v[176:179], a[192:195], a[0:3], 0
ds_read_b128 a[36:39], v15 offset:2048
v_mfma_f32_16x16x32_bf16 v[176:179], a[196:199], a[16:19], v[176:179]
ds_read_b64_tr_b16 a[220:221], v8 offset:14336
v_mfma_f32_16x16x32_bf16 v[200:203], a[192:195], a[4:7], 0
buffer_load_dwordx4 v21, s[4:7], s46 offen offset:2048 lds
v_mfma_f32_16x16x32_bf16 v[200:203], a[196:199], a[20:23], v[200:203]
ds_read_b64_tr_b16 a[222:223], v8 offset:20480
s_mov_b32 s46, 68864
v_mfma_f32_16x16x32_bf16 v[224:227], a[192:195], a[8:11], 0
ds_read_b128 a[52:55], v16 offset:2048
v_mfma_f32_16x16x32_bf16 v[224:227], a[196:199], a[24:27], v[224:227]
buffer_load_dwordx4 v21, s[4:7], s46 offen offset:3072 lds
v_mfma_f32_16x16x32_bf16 v[248:251], a[192:195], a[12:15], 0
s_waitcnt lgkmcnt(12)
v_mfma_f32_16x16x32_bf16 v[248:251], a[196:199], a[28:31], v[248:251]
v_mfma_f32_16x16x32_bf16 v[80:83], a[200:203], a[0:3], 0
v_mfma_f32_16x16x32_bf16 v[80:83], a[204:207], a[16:19], v[80:83]
v_mfma_f32_16x16x32_bf16 v[104:107], a[200:203], a[4:7], 0
v_mfma_f32_16x16x32_bf16 v[104:107], a[204:207], a[20:23], v[104:107]
s_mov_b32 s54, 2359296
s_add_u32 m0, s40, 106496
v_mfma_f32_16x16x32_bf16 v[128:131], a[200:203], a[8:11], 0
s_waitcnt vmcnt(22) lgkmcnt(0)
s_barrier
v_mfma_f32_16x16x32_bf16 v[128:131], a[204:207], a[24:27], v[128:131]
ds_read_b64_tr_b16 a[224:225], v5 offset:24576
s_waitcnt vmcnt(16)
v_mfma_f32_16x16x32_bf16 v[152:155], a[200:203], a[12:15], 0
buffer_load_dwordx4 v20, s[8:11], s54 offen offset:0 lds
v_mfma_f32_16x16x32_bf16 v[152:155], a[204:207], a[28:31], v[152:155]
ds_read_b64_tr_b16 a[226:227], v5 offset:30720
v_mfma_f32_16x16x32_bf16 v[180:183], a[208:211], a[0:3], 0
ds_read_b128 a[40:43], v15 offset:4096
v_mfma_f32_16x16x32_bf16 v[180:183], a[212:215], a[16:19], v[180:183]
ds_read_b64_tr_b16 a[228:229], v5 offset:36864
v_mfma_f32_16x16x32_bf16 v[204:207], a[208:211], a[4:7], 0
ds_read_b128 a[56:59], v16 offset:4096
s_waitcnt vmcnt(15)
v_mfma_f32_16x16x32_bf16 v[204:207], a[212:215], a[20:23], v[204:207]
ds_read_b64_tr_b16 a[230:231], v5 offset:43008
v_mfma_f32_16x16x32_bf16 v[228:231], a[208:211], a[8:11], 0
buffer_load_dwordx4 v18, s[8:11], s54 offen offset:3072 lds
v_mfma_f32_16x16x32_bf16 v[228:231], a[212:215], a[24:27], v[228:231]
ds_read_b64_tr_b16 a[232:233], v6 offset:24576
v_mfma_f32_16x16x32_bf16 v[252:255], a[208:211], a[12:15], 0
ds_read_b128 a[44:47], v15 offset:6144
v_mfma_f32_16x16x32_bf16 v[252:255], a[212:215], a[28:31], v[252:255]
ds_read_b64_tr_b16 a[234:235], v6 offset:30720
v_mfma_f32_16x16x32_bf16 v[84:87], a[216:219], a[0:3], 0
ds_read_b128 a[60:63], v16 offset:6144
v_mfma_f32_16x16x32_bf16 v[84:87], a[220:223], a[16:19], v[84:87]
ds_read_b64_tr_b16 a[236:237], v6 offset:36864
v_mfma_f32_16x16x32_bf16 v[108:111], a[216:219], a[4:7], 0
buffer_store_dwordx4 v[24:27], v22, s[12:15], 0 offen sc1
v_mfma_f32_16x16x32_bf16 v[108:111], a[220:223], a[20:23], v[108:111]
ds_read_b64_tr_b16 a[238:239], v6 offset:43008
v_mfma_f32_16x16x32_bf16 v[132:135], a[216:219], a[8:11], 0
ds_read_b64_tr_b16 a[240:241], v7 offset:24576
v_mfma_f32_16x16x32_bf16 v[132:135], a[220:223], a[24:27], v[132:135]
ds_read_b64_tr_b16 a[242:243], v7 offset:30720
v_mfma_f32_16x16x32_bf16 v[156:159], a[216:219], a[12:15], 0
s_waitcnt lgkmcnt(4)
v_mfma_f32_16x16x32_bf16 v[156:159], a[220:223], a[28:31], v[156:159]
K1_W1:
v_mfma_f32_16x16x32_bf16 v[160:163], a[224:227], a[32:35], v[160:163]
ds_read_b64_tr_b16 a[244:245], v7 offset:36864
v_accvgpr_read_b32 v56, a64
v_mfma_f32_16x16x32_bf16 v[160:163], a[228:231], a[48:51], v[160:163]
ds_read_b64_tr_b16 a[246:247], v7 offset:43008
s_add_u32 m0, s40, 107392
v_mfma_f32_16x16x32_bf16 v[184:187], a[224:227], a[36:39], v[184:187]
buffer_load_dwordx4 v20, s[8:11], s54 offen offset:128 lds
v_mfma_f32_16x16x32_bf16 v[184:187], a[228:231], a[52:55], v[184:187]
ds_read_b64_tr_b16 a[248:249], v8 offset:24576
v_accvgpr_read_b32 v57, a65
v_mfma_f32_16x16x32_bf16 v[208:211], a[224:227], a[40:43], v[208:211]
ds_read_b64_tr_b16 a[250:251], v8 offset:30720
v_accvgpr_read_b32 v58, a66
v_mfma_f32_16x16x32_bf16 v[208:211], a[228:231], a[56:59], v[208:211]
buffer_load_dwordx4 v18, s[8:11], s54 offen offset:3200 lds
v_mfma_f32_16x16x32_bf16 v[232:235], a[224:227], a[44:47], v[232:235]
ds_read_b64_tr_b16 a[252:253], v8 offset:36864
s_waitcnt lgkmcnt(7)
v_mfma_f32_16x16x32_bf16 v[232:235], a[228:231], a[60:63], v[232:235]
ds_read_b64_tr_b16 a[254:255], v8 offset:43008
v_accvgpr_read_b32 v59, a67
v_mfma_f32_16x16x32_bf16 v[64:67], a[232:235], a[32:35], v[64:67]
v_mul_f32 v56, v56, v48
v_mul_f32 v57, v57, v48
v_mfma_f32_16x16x32_bf16 v[64:67], a[236:239], a[48:51], v[64:67]
ds_read_b64_tr_b16 a[192:193], v5 offset:25600
v_mul_f32 v58, v58, v48
v_mfma_f32_16x16x32_bf16 v[88:91], a[232:235], a[36:39], v[88:91]
ds_read_b64_tr_b16 a[194:195], v5 offset:31744
v_mul_f32 v59, v59, v48
v_mfma_f32_16x16x32_bf16 v[88:91], a[236:239], a[52:55], v[88:91]
s_add_u32 m0, s40, 108288
v_cvt_pk_bf16_f32 v56, v56, v57
v_mfma_f32_16x16x32_bf16 v[112:115], a[232:235], a[40:43], v[112:115]
buffer_load_dwordx4 v20, s[8:11], s54 offen offset:256 lds
v_mfma_f32_16x16x32_bf16 v[112:115], a[236:239], a[56:59], v[112:115]
ds_read_b64_tr_b16 a[196:197], v5 offset:37888
v_cvt_pk_bf16_f32 v57, v58, v59
v_mfma_f32_16x16x32_bf16 v[136:139], a[232:235], a[44:47], v[136:139]
buffer_load_dwordx4 v18, s[8:11], s54 offen offset:3328 lds
v_mfma_f32_16x16x32_bf16 v[136:139], a[236:239], a[60:63], v[136:139]
s_waitcnt lgkmcnt(7)
v_accvgpr_read_b32 v60, a80
v_mfma_f32_16x16x32_bf16 v[164:167], a[240:243], a[32:35], v[164:167]
ds_read_b64_tr_b16 a[198:199], v5 offset:44032
v_accvgpr_read_b32 v61, a81
v_mfma_f32_16x16x32_bf16 v[164:167], a[244:247], a[48:51], v[164:167]
ds_read_b64_tr_b16 a[200:201], v6 offset:25600
v_accvgpr_read_b32 v62, a82
v_mfma_f32_16x16x32_bf16 v[188:191], a[240:243], a[36:39], v[188:191]
ds_read_b64_tr_b16 a[202:203], v6 offset:31744
v_accvgpr_read_b32 v63, a83
v_mfma_f32_16x16x32_bf16 v[188:191], a[244:247], a[52:55], v[188:191]
ds_read_b64_tr_b16 a[204:205], v6 offset:37888
v_mul_f32 v60, v60, v48
v_mfma_f32_16x16x32_bf16 v[212:215], a[240:243], a[40:43], v[212:215]
s_add_u32 m0, s41, 131072
v_mul_f32 v61, v61, v48
v_mfma_f32_16x16x32_bf16 v[212:215], a[244:247], a[56:59], v[212:215]
ds_read_b64_tr_b16 a[206:207], v6 offset:44032
v_mul_f32 v62, v62, v48
v_mfma_f32_16x16x32_bf16 v[236:239], a[240:243], a[44:47], v[236:239]
s_waitcnt lgkmcnt(8)
s_mov_b32 s46, 384
v_mfma_f32_16x16x32_bf16 v[236:239], a[244:247], a[60:63], v[236:239]
buffer_load_dwordx4 v21, s[4:7], s46 offen offset:0 lds
v_mfma_f32_16x16x32_bf16 v[68:71], a[248:251], a[32:35], v[68:71]
ds_read_b64_tr_b16 a[208:209], v7 offset:25600
v_mul_f32 v63, v63, v48
v_mfma_f32_16x16x32_bf16 v[68:71], a[252:255], a[48:51], v[68:71]
ds_read_b64_tr_b16 a[210:211], v7 offset:31744
v_cvt_pk_bf16_f32 v58, v60, v61
v_mfma_f32_16x16x32_bf16 v[92:95], a[248:251], a[36:39], v[92:95]
v_cvt_pk_bf16_f32 v59, v62, v63
v_accvgpr_read_b32 v32, a68
v_mfma_f32_16x16x32_bf16 v[92:95], a[252:255], a[52:55], v[92:95]
ds_read_b64_tr_b16 a[212:213], v7 offset:37888
s_mov_b32 s46, 9600
v_mfma_f32_16x16x32_bf16 v[116:119], a[248:251], a[40:43], v[116:119]
buffer_load_dwordx4 v21, s[4:7], s46 offen offset:1024 lds
v_mfma_f32_16x16x32_bf16 v[116:119], a[252:255], a[56:59], v[116:119]
ds_read_b64_tr_b16 a[214:215], v7 offset:44032
v_accvgpr_read_b32 v33, a69
v_mfma_f32_16x16x32_bf16 v[140:143], a[248:251], a[44:47], v[140:143]
v_accvgpr_read_b32 v34, a70
s_waitcnt lgkmcnt(8)
v_mfma_f32_16x16x32_bf16 v[140:143], a[252:255], a[60:63], v[140:143]
ds_read_b64_tr_b16 a[216:217], v8 offset:25600
v_accvgpr_read_b32 v35, a71
v_mfma_f32_16x16x32_bf16 v[168:171], a[192:195], a[32:35], v[168:171]
ds_read_b64_tr_b16 a[218:219], v8 offset:31744
v_mul_f32 v32, v32, v50
v_mfma_f32_16x16x32_bf16 v[168:171], a[196:199], a[48:51], v[168:171]
s_mov_b32 s46, 18816
v_mul_f32 v33, v33, v50
v_mfma_f32_16x16x32_bf16 v[192:195], a[192:195], a[36:39], v[192:195]
buffer_load_dwordx4 v21, s[4:7], s46 offen offset:2048 lds
v_mfma_f32_16x16x32_bf16 v[192:195], a[196:199], a[52:55], v[192:195]
ds_read_b64_tr_b16 a[220:221], v8 offset:37888
v_mul_f32 v34, v34, v50
v_mfma_f32_16x16x32_bf16 v[216:219], a[192:195], a[40:43], v[216:219]
ds_read_b64_tr_b16 a[222:223], v8 offset:44032
v_mul_f32 v35, v35, v50
v_mfma_f32_16x16x32_bf16 v[216:219], a[196:199], a[56:59], v[216:219]
v_cvt_pk_bf16_f32 v32, v32, v33
s_waitcnt lgkmcnt(8)
v_mfma_f32_16x16x32_bf16 v[240:243], a[192:195], a[44:47], v[240:243]
ds_read_b64_tr_b16 a[224:225], v5 offset:26624
v_cvt_pk_bf16_f32 v33, v34, v35
v_mfma_f32_16x16x32_bf16 v[240:243], a[196:199], a[60:63], v[240:243]
s_mov_b32 s46, 28032
ds_read_b64_tr_b16 a[226:227], v5 offset:32768
v_mfma_f32_16x16x32_bf16 v[72:75], a[200:203], a[32:35], v[72:75]
buffer_load_dwordx4 v21, s[4:7], s46 offen offset:3072 lds
v_mfma_f32_16x16x32_bf16 v[72:75], a[204:207], a[48:51], v[72:75]
v_accvgpr_read_b32 v36, a84
v_accvgpr_read_b32 v37, a85
v_mfma_f32_16x16x32_bf16 v[96:99], a[200:203], a[36:39], v[96:99]
ds_read_b64_tr_b16 a[228:229], v5 offset:38912
v_accvgpr_read_b32 v38, a86
v_mfma_f32_16x16x32_bf16 v[96:99], a[204:207], a[52:55], v[96:99]
v_mfma_f32_16x16x32_bf16 v[120:123], a[200:203], a[40:43], v[120:123]
ds_read_b64_tr_b16 a[230:231], v5 offset:45056
v_accvgpr_read_b32 v39, a87
v_mfma_f32_16x16x32_bf16 v[120:123], a[204:207], a[56:59], v[120:123]
ds_read_b64_tr_b16 a[232:233], v6 offset:26624
s_add_u32 m0, s41, 135168
v_mfma_f32_16x16x32_bf16 v[144:147], a[200:203], a[44:47], v[144:147]
v_mul_f32 v36, v36, v50
s_waitcnt lgkmcnt(9)
v_mfma_f32_16x16x32_bf16 v[144:147], a[204:207], a[60:63], v[144:147]
ds_read_b64_tr_b16 a[234:235], v6 offset:32768
s_waitcnt vmcnt(15)
v_mfma_f32_16x16x32_bf16 v[172:175], a[208:211], a[32:35], v[172:175]
ds_read_b128 a[0:3], v13 offset:0
s_mov_b32 s46, 41344
v_mfma_f32_16x16x32_bf16 v[172:175], a[212:215], a[48:51], v[172:175]
buffer_load_dwordx4 v21, s[4:7], s46 offen offset:0 lds
v_mfma_f32_16x16x32_bf16 v[196:199], a[208:211], a[36:39], v[196:199]
ds_read_b128 a[16:19], v14 offset:0
v_mul_f32 v37, v37, v50
v_mfma_f32_16x16x32_bf16 v[196:199], a[212:215], a[52:55], v[196:199]
ds_read_b64_tr_b16 a[236:237], v6 offset:38912
v_mul_f32 v38, v38, v50
v_mfma_f32_16x16x32_bf16 v[220:223], a[208:211], a[40:43], v[220:223]
ds_read_b64_tr_b16 a[238:239], v6 offset:45056
v_mul_f32 v39, v39, v50
v_mfma_f32_16x16x32_bf16 v[220:223], a[212:215], a[56:59], v[220:223]
ds_read_b128 a[4:7], v13 offset:2048
v_cvt_pk_bf16_f32 v34, v36, v37
v_mfma_f32_16x16x32_bf16 v[244:247], a[208:211], a[44:47], v[244:247]
ds_read_b64_tr_b16 a[240:241], v7 offset:26624
s_waitcnt lgkmcnt(12)
v_mfma_f32_16x16x32_bf16 v[244:247], a[212:215], a[60:63], v[244:247]
ds_read_b128 a[20:23], v14 offset:2048
v_cvt_pk_bf16_f32 v35, v38, v39
v_mfma_f32_16x16x32_bf16 v[76:79], a[216:219], a[32:35], v[76:79]
ds_read_b64_tr_b16 a[242:243], v7 offset:32768
s_mov_b32 s46, 50560
v_mfma_f32_16x16x32_bf16 v[76:79], a[220:223], a[48:51], v[76:79]
buffer_load_dwordx4 v21, s[4:7], s46 offen offset:1024 lds
v_mfma_f32_16x16x32_bf16 v[100:103], a[216:219], a[36:39], v[100:103]
ds_read_b64_tr_b16 a[244:245], v7 offset:38912
v_accvgpr_read_b32 v40, a72
v_mfma_f32_16x16x32_bf16 v[100:103], a[220:223], a[52:55], v[100:103]
ds_read_b64_tr_b16 a[246:247], v7 offset:45056
v_accvgpr_read_b32 v41, a73
v_mfma_f32_16x16x32_bf16 v[124:127], a[216:219], a[40:43], v[124:127]
ds_read_b64_tr_b16 a[248:249], v8 offset:26624
v_accvgpr_read_b32 v42, a74
v_mfma_f32_16x16x32_bf16 v[124:127], a[220:223], a[56:59], v[124:127]
s_mov_b32 s46, 59776
v_accvgpr_read_b32 v43, a75
v_mfma_f32_16x16x32_bf16 v[148:151], a[216:219], a[44:47], v[148:151]
buffer_load_dwordx4 v21, s[4:7], s46 offen offset:2048 lds
v_mfma_f32_16x16x32_bf16 v[148:151], a[220:223], a[60:63], v[148:151]
s_waitcnt lgkmcnt(13)
s_waitcnt vmcnt(14)
v_mfma_f32_16x16x32_bf16 v[176:179], a[224:227], a[32:35], v[176:179]
ds_read_b64_tr_b16 a[250:251], v8 offset:32768
v_mul_f32 v40, v40, v52
v_mfma_f32_16x16x32_bf16 v[176:179], a[228:231], a[48:51], v[176:179]
ds_read_b64_tr_b16 a[252:253], v8 offset:38912
v_mul_f32 v41, v41, v52
v_mfma_f32_16x16x32_bf16 v[200:203], a[224:227], a[36:39], v[200:203]
ds_read_b128 a[8:11], v13 offset:4096
v_mul_f32 v42, v42, v52
v_mfma_f32_16x16x32_bf16 v[200:203], a[228:231], a[52:55], v[200:203]
ds_read_b128 a[24:27], v14 offset:4096
v_mul_f32 v43, v43, v52
v_mfma_f32_16x16x32_bf16 v[224:227], a[224:227], a[40:43], v[224:227]
ds_read_b128 a[12:15], v13 offset:6144
s_mov_b32 s46, 68992
v_mfma_f32_16x16x32_bf16 v[224:227], a[228:231], a[56:59], v[224:227]
buffer_load_dwordx4 v21, s[4:7], s46 offen offset:3072 lds
v_mfma_f32_16x16x32_bf16 v[248:251], a[224:227], a[44:47], v[248:251]
ds_read_b128 a[28:31], v14 offset:6144
s_waitcnt lgkmcnt(13)
v_mfma_f32_16x16x32_bf16 v[248:251], a[228:231], a[60:63], v[248:251]
ds_read_b64_tr_b16 a[254:255], v8 offset:45056
v_cvt_pk_bf16_f32 v40, v40, v41
v_mfma_f32_16x16x32_bf16 v[80:83], a[232:235], a[32:35], v[80:83]
v_cvt_pk_bf16_f32 v41, v42, v43
v_accvgpr_read_b32 v44, a88
v_mfma_f32_16x16x32_bf16 v[80:83], a[236:239], a[48:51], v[80:83]
v_accvgpr_read_b32 v45, a89
v_accvgpr_read_b32 v46, a90
v_mfma_f32_16x16x32_bf16 v[104:107], a[232:235], a[36:39], v[104:107]
buffer_store_dwordx4 v[56:59], v22, s[16:19], s44 offen offset:0 sc1
v_mfma_f32_16x16x32_bf16 v[104:107], a[236:239], a[52:55], v[104:107]
v_accvgpr_read_b32 v47, a91
v_mul_f32 v44, v44, v52
v_mfma_f32_16x16x32_bf16 v[128:131], a[232:235], a[40:43], v[128:131]
s_waitcnt vmcnt(24) lgkmcnt(0)
s_barrier
v_mfma_f32_16x16x32_bf16 v[128:131], a[236:239], a[56:59], v[128:131]
ds_read_b64_tr_b16 a[192:193], v5 offset:49152
s_mov_b32 s54, 3145728
v_mfma_f32_16x16x32_bf16 v[152:155], a[232:235], a[44:47], v[152:155]
ds_read_b64_tr_b16 a[194:195], v5 offset:55296
s_add_u32 m0, s40, 32768
v_mfma_f32_16x16x32_bf16 v[152:155], a[236:239], a[60:63], v[152:155]
buffer_load_dwordx4 v20, s[8:11], s54 offen offset:0 lds
v_mfma_f32_16x16x32_bf16 v[180:183], a[240:243], a[32:35], v[180:183]
ds_read_b64_tr_b16 a[196:197], v5 offset:61440
v_mfma_f32_16x16x32_bf16 v[180:183], a[244:247], a[48:51], v[180:183]
buffer_store_dwordx4 v[32:35], v22, s[16:19], s44 offen offset:1024 sc1
v_mfma_f32_16x16x32_bf16 v[204:207], a[240:243], a[36:39], v[204:207]
ds_read_b64_tr_b16 a[198:199], v9 offset:2048
v_mfma_f32_16x16x32_bf16 v[204:207], a[244:247], a[52:55], v[204:207]
ds_read_b64_tr_b16 a[200:201], v6 offset:49152
v_mfma_f32_16x16x32_bf16 v[228:231], a[240:243], a[40:43], v[228:231]
ds_read_b64_tr_b16 a[202:203], v6 offset:55296
v_mfma_f32_16x16x32_bf16 v[228:231], a[244:247], a[56:59], v[228:231]
ds_read_b64_tr_b16 a[204:205], v6 offset:61440
v_mul_f32 v45, v45, v52
v_mfma_f32_16x16x32_bf16 v[252:255], a[240:243], a[44:47], v[252:255]
ds_read_b64_tr_b16 a[206:207], v10 offset:2048
v_mul_f32 v46, v46, v52
v_mfma_f32_16x16x32_bf16 v[252:255], a[244:247], a[60:63], v[252:255]
buffer_load_dwordx4 v18, s[8:11], s54 offen offset:3072 lds
v_mfma_f32_16x16x32_bf16 v[84:87], a[248:251], a[32:35], v[84:87]
v_mul_f32 v47, v47, v52
v_cvt_pk_bf16_f32 v42, v44, v45
v_mfma_f32_16x16x32_bf16 v[84:87], a[252:255], a[48:51], v[84:87]
ds_read_b64_tr_b16 a[208:209], v7 offset:49152
v_cvt_pk_bf16_f32 v43, v46, v47
v_mfma_f32_16x16x32_bf16 v[108:111], a[248:251], a[36:39], v[108:111]
buffer_store_dwordx4 v[40:43], v22, s[16:19], s44 offen offset:2048 sc1
v_mfma_f32_16x16x32_bf16 v[108:111], a[252:255], a[52:55], v[108:111]
ds_read_b64_tr_b16 a[210:211], v7 offset:55296
v_mfma_f32_16x16x32_bf16 v[132:135], a[248:251], a[40:43], v[132:135]
v_mfma_f32_16x16x32_bf16 v[132:135], a[252:255], a[56:59], v[132:135]
v_mfma_f32_16x16x32_bf16 v[156:159], a[248:251], a[44:47], v[156:159]
s_waitcnt lgkmcnt(6)
v_mfma_f32_16x16x32_bf16 v[156:159], a[252:255], a[60:63], v[156:159]
v_mfma_f32_16x16x32_bf16 v[160:163], a[192:195], a[0:3], v[160:163]
ds_read_b64_tr_b16 a[212:213], v7 offset:61440
v_accvgpr_read_b32 v56, a76
v_mfma_f32_16x16x32_bf16 v[160:163], a[196:199], a[16:19], v[160:163]
ds_read_b64_tr_b16 a[214:215], v11 offset:2048
s_add_u32 m0, s40, 33664
v_mfma_f32_16x16x32_bf16 v[184:187], a[192:195], a[4:7], v[184:187]
buffer_load_dwordx4 v20, s[8:11], s54 offen offset:128 lds
v_mfma_f32_16x16x32_bf16 v[184:187], a[196:199], a[20:23], v[184:187]
ds_read_b64_tr_b16 a[216:217], v8 offset:49152
v_accvgpr_read_b32 v57, a77
v_mfma_f32_16x16x32_bf16 v[208:211], a[192:195], a[8:11], v[208:211]
ds_read_b64_tr_b16 a[218:219], v8 offset:55296
v_accvgpr_read_b32 v58, a78
v_mfma_f32_16x16x32_bf16 v[208:211], a[196:199], a[24:27], v[208:211]
buffer_load_dwordx4 v18, s[8:11], s54 offen offset:3200 lds
v_mfma_f32_16x16x32_bf16 v[232:235], a[192:195], a[12:15], v[232:235]
ds_read_b64_tr_b16 a[220:221], v8 offset:61440
s_waitcnt lgkmcnt(7)
v_mfma_f32_16x16x32_bf16 v[232:235], a[196:199], a[28:31], v[232:235]
ds_read_b64_tr_b16 a[222:223], v12 offset:2048
v_accvgpr_read_b32 v59, a79
v_mfma_f32_16x16x32_bf16 v[64:67], a[200:203], a[0:3], v[64:67]
v_mul_f32 v56, v56, v54
v_mul_f32 v57, v57, v54
v_mfma_f32_16x16x32_bf16 v[64:67], a[204:207], a[16:19], v[64:67]
ds_read_b64_tr_b16 a[224:225], v5 offset:50176
v_mul_f32 v58, v58, v54
v_mfma_f32_16x16x32_bf16 v[88:91], a[200:203], a[4:7], v[88:91]
ds_read_b64_tr_b16 a[226:227], v5 offset:56320
v_mul_f32 v59, v59, v54
v_mfma_f32_16x16x32_bf16 v[88:91], a[204:207], a[20:23], v[88:91]
s_add_u32 m0, s40, 34560
v_cvt_pk_bf16_f32 v56, v56, v57
v_mfma_f32_16x16x32_bf16 v[112:115], a[200:203], a[8:11], v[112:115]
buffer_load_dwordx4 v20, s[8:11], s54 offen offset:256 lds
v_mfma_f32_16x16x32_bf16 v[112:115], a[204:207], a[24:27], v[112:115]
ds_read_b64_tr_b16 a[228:229], v5 offset:62464
v_cvt_pk_bf16_f32 v57, v58, v59
v_mfma_f32_16x16x32_bf16 v[136:139], a[200:203], a[12:15], v[136:139]
buffer_load_dwordx4 v18, s[8:11], s54 offen offset:3328 lds
v_mfma_f32_16x16x32_bf16 v[136:139], a[204:207], a[28:31], v[136:139]
s_waitcnt lgkmcnt(7)
v_accvgpr_read_b32 v60, a92
v_mfma_f32_16x16x32_bf16 v[164:167], a[208:211], a[0:3], v[164:167]
ds_read_b64_tr_b16 a[230:231], v9 offset:3072
v_accvgpr_read_b32 v61, a93
v_mfma_f32_16x16x32_bf16 v[164:167], a[212:215], a[16:19], v[164:167]
ds_read_b64_tr_b16 a[232:233], v6 offset:50176
v_accvgpr_read_b32 v62, a94
v_mfma_f32_16x16x32_bf16 v[188:191], a[208:211], a[4:7], v[188:191]
ds_read_b64_tr_b16 a[234:235], v6 offset:56320
v_accvgpr_read_b32 v63, a95
v_mfma_f32_16x16x32_bf16 v[188:191], a[212:215], a[20:23], v[188:191]
ds_read_b64_tr_b16 a[236:237], v6 offset:62464
v_mul_f32 v60, v60, v54
v_mfma_f32_16x16x32_bf16 v[212:215], a[208:211], a[8:11], v[212:215]
s_add_u32 m0, s41, 0
v_mul_f32 v61, v61, v54
v_mfma_f32_16x16x32_bf16 v[212:215], a[212:215], a[24:27], v[212:215]
ds_read_b64_tr_b16 a[238:239], v10 offset:3072
v_mul_f32 v62, v62, v54
v_mfma_f32_16x16x32_bf16 v[236:239], a[208:211], a[12:15], v[236:239]
s_waitcnt lgkmcnt(8)
s_mov_b32 s46, 512
v_mfma_f32_16x16x32_bf16 v[236:239], a[212:215], a[28:31], v[236:239]
buffer_load_dwordx4 v21, s[4:7], s46 offen offset:0 lds
v_mfma_f32_16x16x32_bf16 v[68:71], a[216:219], a[0:3], v[68:71]
ds_read_b64_tr_b16 a[240:241], v7 offset:50176
v_mul_f32 v63, v63, v54
v_mfma_f32_16x16x32_bf16 v[68:71], a[220:223], a[16:19], v[68:71]
ds_read_b64_tr_b16 a[242:243], v7 offset:56320
v_cvt_pk_bf16_f32 v58, v60, v61
v_mfma_f32_16x16x32_bf16 v[92:95], a[216:219], a[4:7], v[92:95]
v_cvt_pk_bf16_f32 v59, v62, v63
v_accvgpr_read_b32 v32, a96
v_mfma_f32_16x16x32_bf16 v[92:95], a[220:223], a[20:23], v[92:95]
ds_read_b64_tr_b16 a[244:245], v7 offset:62464
s_mov_b32 s46, 9728
v_mfma_f32_16x16x32_bf16 v[116:119], a[216:219], a[8:11], v[116:119]
buffer_load_dwordx4 v21, s[4:7], s46 offen offset:1024 lds
v_mfma_f32_16x16x32_bf16 v[116:119], a[220:223], a[24:27], v[116:119]
ds_read_b64_tr_b16 a[246:247], v11 offset:3072
v_accvgpr_read_b32 v33, a97
v_mfma_f32_16x16x32_bf16 v[140:143], a[216:219], a[12:15], v[140:143]
v_accvgpr_read_b32 v34, a98
s_waitcnt lgkmcnt(8)
v_mfma_f32_16x16x32_bf16 v[140:143], a[220:223], a[28:31], v[140:143]
ds_read_b64_tr_b16 a[248:249], v8 offset:50176
v_accvgpr_read_b32 v35, a99
v_mfma_f32_16x16x32_bf16 v[168:171], a[224:227], a[0:3], v[168:171]
ds_read_b64_tr_b16 a[250:251], v8 offset:56320
v_mul_f32 v32, v32, v48
v_mfma_f32_16x16x32_bf16 v[168:171], a[228:231], a[16:19], v[168:171]
s_mov_b32 s46, 18944
v_mul_f32 v33, v33, v48
v_mfma_f32_16x16x32_bf16 v[192:195], a[224:227], a[4:7], v[192:195]
buffer_load_dwordx4 v21, s[4:7], s46 offen offset:2048 lds
v_mfma_f32_16x16x32_bf16 v[192:195], a[228:231], a[20:23], v[192:195]
ds_read_b64_tr_b16 a[252:253], v8 offset:62464
v_mul_f32 v34, v34, v48
v_mfma_f32_16x16x32_bf16 v[216:219], a[224:227], a[8:11], v[216:219]
ds_read_b64_tr_b16 a[254:255], v12 offset:3072
v_mul_f32 v35, v35, v48
v_mfma_f32_16x16x32_bf16 v[216:219], a[228:231], a[24:27], v[216:219]
v_cvt_pk_bf16_f32 v32, v32, v33
s_waitcnt lgkmcnt(8)
v_mfma_f32_16x16x32_bf16 v[240:243], a[224:227], a[12:15], v[240:243]
ds_read_b64_tr_b16 a[192:193], v5 offset:51200
v_cvt_pk_bf16_f32 v33, v34, v35
v_mfma_f32_16x16x32_bf16 v[240:243], a[228:231], a[28:31], v[240:243]
s_mov_b32 s46, 28160
ds_read_b64_tr_b16 a[194:195], v5 offset:57344
v_mfma_f32_16x16x32_bf16 v[72:75], a[232:235], a[0:3], v[72:75]
buffer_load_dwordx4 v21, s[4:7], s46 offen offset:3072 lds
v_mfma_f32_16x16x32_bf16 v[72:75], a[236:239], a[16:19], v[72:75]
v_accvgpr_read_b32 v36, a112
v_accvgpr_read_b32 v37, a113
v_mfma_f32_16x16x32_bf16 v[96:99], a[232:235], a[4:7], v[96:99]
ds_read_b64_tr_b16 a[196:197], v5 offset:63488
v_accvgpr_read_b32 v38, a114
v_mfma_f32_16x16x32_bf16 v[96:99], a[236:239], a[20:23], v[96:99]
v_mfma_f32_16x16x32_bf16 v[120:123], a[232:235], a[8:11], v[120:123]
ds_read_b64_tr_b16 a[198:199], v9 offset:4096
v_accvgpr_read_b32 v39, a115
v_mfma_f32_16x16x32_bf16 v[120:123], a[236:239], a[24:27], v[120:123]
ds_read_b64_tr_b16 a[200:201], v6 offset:51200
s_add_u32 m0, s41, 4096
v_mfma_f32_16x16x32_bf16 v[144:147], a[232:235], a[12:15], v[144:147]
v_mul_f32 v36, v36, v48
s_waitcnt lgkmcnt(9)
v_mfma_f32_16x16x32_bf16 v[144:147], a[236:239], a[28:31], v[144:147]
ds_read_b64_tr_b16 a[202:203], v6 offset:57344
s_waitcnt vmcnt(17)
v_mfma_f32_16x16x32_bf16 v[172:175], a[240:243], a[0:3], v[172:175]
ds_read_b128 a[32:35], v15 offset:0
s_mov_b32 s46, 41472
v_mfma_f32_16x16x32_bf16 v[172:175], a[244:247], a[16:19], v[172:175]
buffer_load_dwordx4 v21, s[4:7], s46 offen offset:0 lds
v_mfma_f32_16x16x32_bf16 v[196:199], a[240:243], a[4:7], v[196:199]
ds_read_b128 a[48:51], v16 offset:0
v_mul_f32 v37, v37, v48
v_mfma_f32_16x16x32_bf16 v[196:199], a[244:247], a[20:23], v[196:199]
ds_read_b64_tr_b16 a[204:205], v6 offset:63488
v_mul_f32 v38, v38, v48
v_mfma_f32_16x16x32_bf16 v[220:223], a[240:243], a[8:11], v[220:223]
ds_read_b64_tr_b16 a[206:207], v10 offset:4096
v_mul_f32 v39, v39, v48
v_mfma_f32_16x16x32_bf16 v[220:223], a[244:247], a[24:27], v[220:223]
ds_read_b128 a[36:39], v15 offset:2048
v_cvt_pk_bf16_f32 v34, v36, v37
v_mfma_f32_16x16x32_bf16 v[244:247], a[240:243], a[12:15], v[244:247]
ds_read_b64_tr_b16 a[208:209], v7 offset:51200
s_waitcnt lgkmcnt(12)
v_mfma_f32_16x16x32_bf16 v[244:247], a[244:247], a[28:31], v[244:247]
ds_read_b128 a[52:55], v16 offset:2048
v_cvt_pk_bf16_f32 v35, v38, v39
v_mfma_f32_16x16x32_bf16 v[76:79], a[248:251], a[0:3], v[76:79]
ds_read_b64_tr_b16 a[210:211], v7 offset:57344
s_mov_b32 s46, 50688
v_mfma_f32_16x16x32_bf16 v[76:79], a[252:255], a[16:19], v[76:79]
buffer_load_dwordx4 v21, s[4:7], s46 offen offset:1024 lds
v_mfma_f32_16x16x32_bf16 v[100:103], a[248:251], a[4:7], v[100:103]
ds_read_b64_tr_b16 a[212:213], v7 offset:63488
v_accvgpr_read_b32 v40, a100
v_mfma_f32_16x16x32_bf16 v[100:103], a[252:255], a[20:23], v[100:103]
ds_read_b64_tr_b16 a[214:215], v11 offset:4096
v_accvgpr_read_b32 v41, a101
v_mfma_f32_16x16x32_bf16 v[124:127], a[248:251], a[8:11], v[124:127]
ds_read_b64_tr_b16 a[216:217], v8 offset:51200
v_accvgpr_read_b32 v42, a102
v_mfma_f32_16x16x32_bf16 v[124:127], a[252:255], a[24:27], v[124:127]
s_mov_b32 s46, 59904
v_accvgpr_read_b32 v43, a103
v_mfma_f32_16x16x32_bf16 v[148:151], a[248:251], a[12:15], v[148:151]
buffer_load_dwordx4 v21, s[4:7], s46 offen offset:2048 lds
v_mfma_f32_16x16x32_bf16 v[148:151], a[252:255], a[28:31], v[148:151]
s_waitcnt lgkmcnt(13)
s_waitcnt vmcnt(16)
v_mfma_f32_16x16x32_bf16 v[176:179], a[192:195], a[0:3], v[176:179]
ds_read_b64_tr_b16 a[218:219], v8 offset:57344
v_mul_f32 v40, v40, v50
v_mfma_f32_16x16x32_bf16 v[176:179], a[196:199], a[16:19], v[176:179]
ds_read_b64_tr_b16 a[220:221], v8 offset:63488
v_mul_f32 v41, v41, v50
v_mfma_f32_16x16x32_bf16 v[200:203], a[192:195], a[4:7], v[200:203]
ds_read_b128 a[40:43], v15 offset:4096
v_mul_f32 v42, v42, v50
v_mfma_f32_16x16x32_bf16 v[200:203], a[196:199], a[20:23], v[200:203]
ds_read_b128 a[56:59], v16 offset:4096
v_mul_f32 v43, v43, v50
v_mfma_f32_16x16x32_bf16 v[224:227], a[192:195], a[8:11], v[224:227]
ds_read_b128 a[44:47], v15 offset:6144
s_mov_b32 s46, 69120
v_mfma_f32_16x16x32_bf16 v[224:227], a[196:199], a[24:27], v[224:227]
buffer_load_dwordx4 v21, s[4:7], s46 offen offset:3072 lds
v_mfma_f32_16x16x32_bf16 v[248:251], a[192:195], a[12:15], v[248:251]
ds_read_b128 a[60:63], v16 offset:6144
s_waitcnt lgkmcnt(13)
v_mfma_f32_16x16x32_bf16 v[248:251], a[196:199], a[28:31], v[248:251]
ds_read_b64_tr_b16 a[222:223], v12 offset:4096
v_cvt_pk_bf16_f32 v40, v40, v41
v_mfma_f32_16x16x32_bf16 v[80:83], a[200:203], a[0:3], v[80:83]
v_cvt_pk_bf16_f32 v41, v42, v43
v_accvgpr_read_b32 v44, a116
v_mfma_f32_16x16x32_bf16 v[80:83], a[204:207], a[16:19], v[80:83]
v_accvgpr_read_b32 v45, a117
v_accvgpr_read_b32 v46, a118
v_mfma_f32_16x16x32_bf16 v[104:107], a[200:203], a[4:7], v[104:107]
buffer_store_dwordx4 v[56:59], v23, s[16:19], s44 offen offset:3072 sc1
v_mfma_f32_16x16x32_bf16 v[104:107], a[204:207], a[20:23], v[104:107]
v_accvgpr_read_b32 v47, a119
v_mul_f32 v44, v44, v50
v_mfma_f32_16x16x32_bf16 v[128:131], a[200:203], a[8:11], v[128:131]
s_waitcnt vmcnt(26) lgkmcnt(0)
s_barrier
v_mfma_f32_16x16x32_bf16 v[128:131], a[204:207], a[24:27], v[128:131]
ds_read_b64_tr_b16 a[224:225], v9 offset:8192
s_mov_b32 s54, 3932160
v_mfma_f32_16x16x32_bf16 v[152:155], a[200:203], a[12:15], v[152:155]
ds_read_b64_tr_b16 a[226:227], v9 offset:14336
s_add_u32 m0, s40, 57344
v_mfma_f32_16x16x32_bf16 v[152:155], a[204:207], a[28:31], v[152:155]
buffer_load_dwordx4 v20, s[8:11], s54 offen offset:0 lds
v_mfma_f32_16x16x32_bf16 v[180:183], a[208:211], a[0:3], v[180:183]
ds_read_b64_tr_b16 a[228:229], v9 offset:20480
v_mfma_f32_16x16x32_bf16 v[180:183], a[212:215], a[16:19], v[180:183]
buffer_store_dwordx4 v[32:35], v22, s[16:19], s45 offen offset:0 sc1
v_mfma_f32_16x16x32_bf16 v[204:207], a[208:211], a[4:7], v[204:207]
ds_read_b64_tr_b16 a[230:231], v9 offset:26624
v_mfma_f32_16x16x32_bf16 v[204:207], a[212:215], a[20:23], v[204:207]
ds_read_b64_tr_b16 a[232:233], v10 offset:8192
v_mfma_f32_16x16x32_bf16 v[228:231], a[208:211], a[8:11], v[228:231]
ds_read_b64_tr_b16 a[234:235], v10 offset:14336
v_mfma_f32_16x16x32_bf16 v[228:231], a[212:215], a[24:27], v[228:231]
ds_read_b64_tr_b16 a[236:237], v10 offset:20480
v_mul_f32 v45, v45, v50
v_mfma_f32_16x16x32_bf16 v[252:255], a[208:211], a[12:15], v[252:255]
ds_read_b64_tr_b16 a[238:239], v10 offset:26624
v_mul_f32 v46, v46, v50
v_mfma_f32_16x16x32_bf16 v[252:255], a[212:215], a[28:31], v[252:255]
buffer_load_dwordx4 v18, s[8:11], s54 offen offset:3072 lds
v_mfma_f32_16x16x32_bf16 v[84:87], a[216:219], a[0:3], v[84:87]
v_mul_f32 v47, v47, v50
v_cvt_pk_bf16_f32 v42, v44, v45
v_mfma_f32_16x16x32_bf16 v[84:87], a[220:223], a[16:19], v[84:87]
ds_read_b64_tr_b16 a[240:241], v11 offset:8192
v_cvt_pk_bf16_f32 v43, v46, v47
v_mfma_f32_16x16x32_bf16 v[108:111], a[216:219], a[4:7], v[108:111]
buffer_store_dwordx4 v[40:43], v22, s[16:19], s45 offen offset:1024 sc1
v_mfma_f32_16x16x32_bf16 v[108:111], a[220:223], a[20:23], v[108:111]
ds_read_b64_tr_b16 a[242:243], v11 offset:14336
v_mfma_f32_16x16x32_bf16 v[132:135], a[216:219], a[8:11], v[132:135]
v_mfma_f32_16x16x32_bf16 v[132:135], a[220:223], a[24:27], v[132:135]
v_mfma_f32_16x16x32_bf16 v[156:159], a[216:219], a[12:15], v[156:159]
s_waitcnt lgkmcnt(6)
v_mfma_f32_16x16x32_bf16 v[156:159], a[220:223], a[28:31], v[156:159]
v_mfma_f32_16x16x32_bf16 v[160:163], a[224:227], a[32:35], v[160:163]
ds_read_b64_tr_b16 a[244:245], v11 offset:20480
v_accvgpr_read_b32 v56, a104
v_mfma_f32_16x16x32_bf16 v[160:163], a[228:231], a[48:51], v[160:163]
ds_read_b64_tr_b16 a[246:247], v11 offset:26624
s_add_u32 m0, s40, 58240
v_mfma_f32_16x16x32_bf16 v[184:187], a[224:227], a[36:39], v[184:187]
buffer_load_dwordx4 v20, s[8:11], s54 offen offset:128 lds
v_mfma_f32_16x16x32_bf16 v[184:187], a[228:231], a[52:55], v[184:187]
ds_read_b64_tr_b16 a[248:249], v12 offset:8192
v_accvgpr_read_b32 v57, a105
v_mfma_f32_16x16x32_bf16 v[208:211], a[224:227], a[40:43], v[208:211]
ds_read_b64_tr_b16 a[250:251], v12 offset:14336
v_accvgpr_read_b32 v58, a106
v_mfma_f32_16x16x32_bf16 v[208:211], a[228:231], a[56:59], v[208:211]
s_waitcnt lgkmcnt(6)
ds_read_b64_tr_b16 a[252:253], v12 offset:20480
v_mfma_f32_16x16x32_bf16 v[232:235], a[224:227], a[44:47], v[232:235]
buffer_load_dwordx4 v18, s[8:11], s54 offen offset:3200 lds
v_mfma_f32_16x16x32_bf16 v[232:235], a[228:231], a[60:63], v[232:235]
ds_read_b64_tr_b16 a[254:255], v12 offset:26624
v_accvgpr_read_b32 v59, a107
v_mfma_f32_16x16x32_bf16 v[64:67], a[232:235], a[32:35], v[64:67]
ds_read_b64_tr_b16 a[192:193], v9 offset:9216
v_mul_f32 v56, v56, v52
v_mfma_f32_16x16x32_bf16 v[64:67], a[236:239], a[48:51], v[64:67]
v_mfma_f32_16x16x32_bf16 v[88:91], a[232:235], a[36:39], v[88:91]
s_add_u32 m0, s40, 59136
v_mul_f32 v57, v57, v52
v_mfma_f32_16x16x32_bf16 v[88:91], a[236:239], a[52:55], v[88:91]
buffer_load_dwordx4 v20, s[8:11], s54 offen offset:256 lds
v_mfma_f32_16x16x32_bf16 v[112:115], a[232:235], a[40:43], v[112:115]
ds_read_b64_tr_b16 a[194:195], v9 offset:15360
v_mul_f32 v58, v58, v52
v_mfma_f32_16x16x32_bf16 v[112:115], a[236:239], a[56:59], v[112:115]
s_waitcnt lgkmcnt(6)
ds_read_b64_tr_b16 a[196:197], v9 offset:21504
v_mfma_f32_16x16x32_bf16 v[136:139], a[232:235], a[44:47], v[136:139]
ds_read_b64_tr_b16 a[198:199], v9 offset:27648
v_mul_f32 v59, v59, v52
v_mfma_f32_16x16x32_bf16 v[136:139], a[236:239], a[60:63], v[136:139]
buffer_load_dwordx4 v18, s[8:11], s54 offen offset:3328 lds
v_mfma_f32_16x16x32_bf16 v[164:167], a[240:243], a[32:35], v[164:167]
ds_read_b64_tr_b16 a[200:201], v10 offset:9216
v_cvt_pk_bf16_f32 v56, v56, v57
v_mfma_f32_16x16x32_bf16 v[164:167], a[244:247], a[48:51], v[164:167]
v_mfma_f32_16x16x32_bf16 v[188:191], a[240:243], a[36:39], v[188:191]
ds_read_b64_tr_b16 a[202:203], v10 offset:15360
v_cvt_pk_bf16_f32 v57, v58, v59
v_mfma_f32_16x16x32_bf16 v[188:191], a[244:247], a[52:55], v[188:191]
s_add_u32 m0, s41, 131072
ds_read_b64_tr_b16 a[204:205], v10 offset:21504
v_mfma_f32_16x16x32_bf16 v[212:215], a[240:243], a[40:43], v[212:215]
s_mov_b32 s46, 640
v_accvgpr_read_b32 v60, a120
v_mfma_f32_16x16x32_bf16 v[212:215], a[244:247], a[56:59], v[212:215]
s_waitcnt lgkmcnt(7)
ds_read_b64_tr_b16 a[206:207], v10 offset:27648
v_mfma_f32_16x16x32_bf16 v[236:239], a[240:243], a[44:47], v[236:239]
buffer_load_dwordx4 v21, s[4:7], s46 offen offset:0 lds
v_mfma_f32_16x16x32_bf16 v[236:239], a[244:247], a[60:63], v[236:239]
ds_read_b64_tr_b16 a[208:209], v11 offset:9216
v_accvgpr_read_b32 v61, a121
v_mfma_f32_16x16x32_bf16 v[68:71], a[248:251], a[32:35], v[68:71]
ds_read_b64_tr_b16 a[210:211], v11 offset:15360
v_accvgpr_read_b32 v62, a122
v_mfma_f32_16x16x32_bf16 v[68:71], a[252:255], a[48:51], v[68:71]
v_mfma_f32_16x16x32_bf16 v[92:95], a[248:251], a[36:39], v[92:95]
s_mov_b32 s46, 9856
v_accvgpr_read_b32 v63, a123
v_mfma_f32_16x16x32_bf16 v[92:95], a[252:255], a[52:55], v[92:95]
v_mfma_f32_16x16x32_bf16 v[116:119], a[248:251], a[40:43], v[116:119]
buffer_load_dwordx4 v21, s[4:7], s46 offen offset:1024 lds
v_mfma_f32_16x16x32_bf16 v[116:119], a[252:255], a[56:59], v[116:119]
ds_read_b64_tr_b16 a[212:213], v11 offset:21504
v_mul_f32 v60, v60, v52
v_mfma_f32_16x16x32_bf16 v[140:143], a[248:251], a[44:47], v[140:143]
s_waitcnt lgkmcnt(7)
v_mul_f32 v61, v61, v52
v_mfma_f32_16x16x32_bf16 v[140:143], a[252:255], a[60:63], v[140:143]
ds_read_b64_tr_b16 a[214:215], v11 offset:27648
s_mov_b32 s46, 19072
v_mfma_f32_16x16x32_bf16 v[168:171], a[192:195], a[32:35], v[168:171]
ds_read_b64_tr_b16 a[216:217], v12 offset:9216
v_mul_f32 v62, v62, v52
v_mfma_f32_16x16x32_bf16 v[168:171], a[196:199], a[48:51], v[168:171]
buffer_load_dwordx4 v21, s[4:7], s46 offen offset:2048 lds
v_mfma_f32_16x16x32_bf16 v[192:195], a[192:195], a[36:39], v[192:195]
ds_read_b64_tr_b16 a[218:219], v12 offset:15360
v_mul_f32 v63, v63, v52
v_mfma_f32_16x16x32_bf16 v[192:195], a[196:199], a[52:55], v[192:195]
v_mfma_f32_16x16x32_bf16 v[216:219], a[192:195], a[40:43], v[216:219]
ds_read_b64_tr_b16 a[220:221], v12 offset:21504
v_cvt_pk_bf16_f32 v58, v60, v61
v_mfma_f32_16x16x32_bf16 v[216:219], a[196:199], a[56:59], v[216:219]
s_mov_b32 s46, 28288
s_waitcnt lgkmcnt(7)
v_mfma_f32_16x16x32_bf16 v[240:243], a[192:195], a[44:47], v[240:243]
ds_read_b64_tr_b16 a[222:223], v12 offset:27648
v_cvt_pk_bf16_f32 v59, v62, v63
v_mfma_f32_16x16x32_bf16 v[240:243], a[196:199], a[60:63], v[240:243]
buffer_load_dwordx4 v21, s[4:7], s46 offen offset:3072 lds
v_mfma_f32_16x16x32_bf16 v[72:75], a[200:203], a[32:35], v[72:75]
ds_read_b64_tr_b16 a[224:225], v9 offset:10240
v_accvgpr_read_b32 v32, a108
v_mfma_f32_16x16x32_bf16 v[72:75], a[204:207], a[48:51], v[72:75]
v_mfma_f32_16x16x32_bf16 v[96:99], a[200:203], a[36:39], v[96:99]
ds_read_b64_tr_b16 a[226:227], v9 offset:16384
v_accvgpr_read_b32 v33, a109
v_mfma_f32_16x16x32_bf16 v[96:99], a[204:207], a[52:55], v[96:99]
s_add_u32 m0, s41, 135168
ds_read_b64_tr_b16 a[228:229], v9 offset:22528
v_mfma_f32_16x16x32_bf16 v[120:123], a[200:203], a[40:43], v[120:123]
s_mov_b32 s46, 41600
v_accvgpr_read_b32 v34, a110
v_mfma_f32_16x16x32_bf16 v[120:123], a[204:207], a[56:59], v[120:123]
s_waitcnt lgkmcnt(7)
ds_read_b64_tr_b16 a[230:231], v9 offset:28672
v_mfma_f32_16x16x32_bf16 v[144:147], a[200:203], a[44:47], v[144:147]
buffer_load_dwordx4 v21, s[4:7], s46 offen offset:0 lds
v_mfma_f32_16x16x32_bf16 v[144:147], a[204:207], a[60:63], v[144:147]
ds_read_b64_tr_b16 a[232:233], v10 offset:10240
s_waitcnt vmcnt(18)
v_mfma_f32_16x16x32_bf16 v[172:175], a[208:211], a[32:35], v[172:175]
ds_read_b64_tr_b16 a[234:235], v10 offset:16384
v_accvgpr_read_b32 v35, a111
v_mfma_f32_16x16x32_bf16 v[172:175], a[212:215], a[48:51], v[172:175]
ds_read_b128 a[0:3], v13 offset:0
v_mul_f32 v32, v32, v54
v_mfma_f32_16x16x32_bf16 v[196:199], a[208:211], a[36:39], v[196:199]
ds_read_b128 a[16:19], v14 offset:0
s_mov_b32 s46, 50816
v_mfma_f32_16x16x32_bf16 v[196:199], a[212:215], a[52:55], v[196:199]
ds_read_b64_tr_b16 a[236:237], v10 offset:22528
v_mul_f32 v33, v33, v54
v_mfma_f32_16x16x32_bf16 v[220:223], a[208:211], a[40:43], v[220:223]
buffer_load_dwordx4 v21, s[4:7], s46 offen offset:1024 lds
v_mfma_f32_16x16x32_bf16 v[220:223], a[212:215], a[56:59], v[220:223]
ds_read_b64_tr_b16 a[238:239], v10 offset:28672
v_mul_f32 v34, v34, v54
v_mfma_f32_16x16x32_bf16 v[244:247], a[208:211], a[44:47], v[244:247]
ds_read_b128 a[4:7], v13 offset:2048
s_waitcnt lgkmcnt(11)
v_mfma_f32_16x16x32_bf16 v[244:247], a[212:215], a[60:63], v[244:247]
ds_read_b64_tr_b16 a[240:241], v11 offset:10240
v_mul_f32 v35, v35, v54
v_mfma_f32_16x16x32_bf16 v[76:79], a[216:219], a[32:35], v[76:79]
ds_read_b128 a[20:23], v14 offset:2048
s_mov_b32 s46, 60032
v_mfma_f32_16x16x32_bf16 v[76:79], a[220:223], a[48:51], v[76:79]
ds_read_b64_tr_b16 a[242:243], v11 offset:16384
v_cvt_pk_bf16_f32 v32, v32, v33
v_mfma_f32_16x16x32_bf16 v[100:103], a[216:219], a[36:39], v[100:103]
buffer_load_dwordx4 v21, s[4:7], s46 offen offset:2048 lds
v_mfma_f32_16x16x32_bf16 v[100:103], a[220:223], a[52:55], v[100:103]
ds_read_b64_tr_b16 a[244:245], v11 offset:22528
s_waitcnt vmcnt(16)
v_mfma_f32_16x16x32_bf16 v[124:127], a[216:219], a[40:43], v[124:127]
ds_read_b64_tr_b16 a[246:247], v11 offset:28672
v_cvt_pk_bf16_f32 v33, v34, v35
v_mfma_f32_16x16x32_bf16 v[124:127], a[220:223], a[56:59], v[124:127]
ds_read_b128 a[8:11], v13 offset:4096
v_accvgpr_read_b32 v36, a124
v_mfma_f32_16x16x32_bf16 v[148:151], a[216:219], a[44:47], v[148:151]
ds_read_b64_tr_b16 a[248:249], v12 offset:10240
s_waitcnt lgkmcnt(14)
v_mfma_f32_16x16x32_bf16 v[148:151], a[220:223], a[60:63], v[148:151]
ds_read_b64_tr_b16 a[250:251], v12 offset:16384
s_mov_b32 s46, 69248
v_mfma_f32_16x16x32_bf16 v[176:179], a[224:227], a[32:35], v[176:179]
ds_read_b64_tr_b16 a[252:253], v12 offset:22528
v_accvgpr_read_b32 v37, a125
v_mfma_f32_16x16x32_bf16 v[176:179], a[228:231], a[48:51], v[176:179]
buffer_load_dwordx4 v21, s[4:7], s46 offen offset:3072 lds
v_mfma_f32_16x16x32_bf16 v[200:203], a[224:227], a[36:39], v[200:203]
ds_read_b64_tr_b16 a[254:255], v12 offset:28672
v_accvgpr_read_b32 v38, a126
v_mfma_f32_16x16x32_bf16 v[200:203], a[228:231], a[52:55], v[200:203]
ds_read_b128 a[24:27], v14 offset:4096
v_accvgpr_read_b32 v39, a127
v_mfma_f32_16x16x32_bf16 v[224:227], a[224:227], a[40:43], v[224:227]
global_load_dword v30, v[28:29], off
v_mfma_f32_16x16x32_bf16 v[224:227], a[228:231], a[56:59], v[224:227]
ds_read_b128 a[12:15], v13 offset:6144
v_mul_f32 v36, v36, v54
v_mfma_f32_16x16x32_bf16 v[248:251], a[224:227], a[44:47], v[248:251]
ds_read_b128 a[28:31], v14 offset:6144
s_waitcnt lgkmcnt(14)
v_mfma_f32_16x16x32_bf16 v[248:251], a[228:231], a[60:63], v[248:251]
v_mul_f32 v37, v37, v54
v_mul_f32 v38, v38, v54
v_mfma_f32_16x16x32_bf16 v[80:83], a[232:235], a[32:35], v[80:83]
buffer_store_dwordx4 v[56:59], v22, s[16:19], s45 offen offset:2048 sc1
v_mfma_f32_16x16x32_bf16 v[80:83], a[236:239], a[48:51], v[80:83]
v_mfma_f32_16x16x32_bf16 v[104:107], a[232:235], a[36:39], v[104:107]
s_mov_b32 s54, 4718592
v_mul_f32 v39, v39, v54
v_mfma_f32_16x16x32_bf16 v[104:107], a[236:239], a[52:55], v[104:107]
s_add_u32 m0, s40, 81920
v_mfma_f32_16x16x32_bf16 v[128:131], a[232:235], a[40:43], v[128:131]
s_waitcnt vmcnt(27) lgkmcnt(0)
s_barrier
v_mfma_f32_16x16x32_bf16 v[128:131], a[236:239], a[56:59], v[128:131]
ds_read_b64_tr_b16 a[192:193], v5 offset:0
v_mfma_f32_16x16x32_bf16 v[152:155], a[232:235], a[44:47], v[152:155]
buffer_load_dwordx4 v20, s[8:11], s54 offen offset:0 lds
v_mfma_f32_16x16x32_bf16 v[152:155], a[236:239], a[60:63], v[152:155]
ds_read_b64_tr_b16 a[194:195], v5 offset:6144
v_mfma_f32_16x16x32_bf16 v[180:183], a[240:243], a[32:35], v[180:183]
ds_read_b64_tr_b16 a[196:197], v5 offset:12288
v_mfma_f32_16x16x32_bf16 v[180:183], a[244:247], a[48:51], v[180:183]
v_mfma_f32_16x16x32_bf16 v[204:207], a[240:243], a[36:39], v[204:207]
ds_read_b64_tr_b16 a[198:199], v5 offset:18432
v_mfma_f32_16x16x32_bf16 v[204:207], a[244:247], a[52:55], v[204:207]
v_mfma_f32_16x16x32_bf16 v[228:231], a[240:243], a[40:43], v[228:231]
ds_read_b64_tr_b16 a[200:201], v6 offset:0
v_mfma_f32_16x16x32_bf16 v[228:231], a[244:247], a[56:59], v[228:231]
ds_read_b64_tr_b16 a[202:203], v6 offset:6144
v_cvt_pk_bf16_f32 v34, v36, v37
v_mfma_f32_16x16x32_bf16 v[252:255], a[240:243], a[44:47], v[252:255]
buffer_load_dwordx4 v18, s[8:11], s54 offen offset:3072 lds
v_mfma_f32_16x16x32_bf16 v[252:255], a[244:247], a[60:63], v[252:255]
ds_read_b64_tr_b16 a[204:205], v6 offset:12288
v_cvt_pk_bf16_f32 v35, v38, v39
v_mfma_f32_16x16x32_bf16 v[84:87], a[248:251], a[32:35], v[84:87]
buffer_store_dwordx4 v[32:35], v23, s[16:19], s45 offen offset:3072 sc1
v_mfma_f32_16x16x32_bf16 v[84:87], a[252:255], a[48:51], v[84:87]
ds_read_b64_tr_b16 a[206:207], v6 offset:18432
v_mfma_f32_16x16x32_bf16 v[108:111], a[248:251], a[36:39], v[108:111]
v_mfma_f32_16x16x32_bf16 v[108:111], a[252:255], a[52:55], v[108:111]
ds_read_b64_tr_b16 a[208:209], v7 offset:0
v_mfma_f32_16x16x32_bf16 v[132:135], a[248:251], a[40:43], v[132:135]
v_mfma_f32_16x16x32_bf16 v[132:135], a[252:255], a[56:59], v[132:135]
ds_read_b64_tr_b16 a[210:211], v7 offset:6144
v_mfma_f32_16x16x32_bf16 v[156:159], a[248:251], a[44:47], v[156:159]
s_waitcnt lgkmcnt(6)
v_mfma_f32_16x16x32_bf16 v[156:159], a[252:255], a[60:63], v[156:159]
v_mfma_f32_16x16x32_bf16 v[160:163], a[192:195], a[0:3], v[160:163]
ds_read_b64_tr_b16 a[212:213], v7 offset:12288
v_accvgpr_read_b32 v40, a128
v_mfma_f32_16x16x32_bf16 v[160:163], a[196:199], a[16:19], v[160:163]
ds_read_b64_tr_b16 a[214:215], v7 offset:18432
s_add_u32 m0, s40, 82816
v_mfma_f32_16x16x32_bf16 v[184:187], a[192:195], a[4:7], v[184:187]
buffer_load_dwordx4 v20, s[8:11], s54 offen offset:128 lds
v_mfma_f32_16x16x32_bf16 v[184:187], a[196:199], a[20:23], v[184:187]
ds_read_b64_tr_b16 a[216:217], v8 offset:0
v_accvgpr_read_b32 v41, a129
v_mfma_f32_16x16x32_bf16 v[208:211], a[192:195], a[8:11], v[208:211]
ds_read_b64_tr_b16 a[218:219], v8 offset:6144
v_accvgpr_read_b32 v42, a130
v_mfma_f32_16x16x32_bf16 v[208:211], a[196:199], a[24:27], v[208:211]
buffer_load_dwordx4 v18, s[8:11], s54 offen offset:3200 lds
v_mfma_f32_16x16x32_bf16 v[232:235], a[192:195], a[12:15], v[232:235]
ds_read_b64_tr_b16 a[220:221], v8 offset:12288
s_waitcnt lgkmcnt(7)
v_mfma_f32_16x16x32_bf16 v[232:235], a[196:199], a[28:31], v[232:235]
ds_read_b64_tr_b16 a[222:223], v8 offset:18432
v_accvgpr_read_b32 v43, a131
v_mfma_f32_16x16x32_bf16 v[64:67], a[200:203], a[0:3], v[64:67]
ds_read_b64_tr_b16 a[224:225], v5 offset:1024
v_mul_f32 v40, v40, v48
v_mfma_f32_16x16x32_bf16 v[64:67], a[204:207], a[16:19], v[64:67]
v_mfma_f32_16x16x32_bf16 v[88:91], a[200:203], a[4:7], v[88:91]
s_add_u32 m0, s40, 83712
v_mul_f32 v41, v41, v48
v_mfma_f32_16x16x32_bf16 v[88:91], a[204:207], a[20:23], v[88:91]
buffer_load_dwordx4 v20, s[8:11], s54 offen offset:256 lds
v_mfma_f32_16x16x32_bf16 v[112:115], a[200:203], a[8:11], v[112:115]
ds_read_b64_tr_b16 a[226:227], v5 offset:7168
v_mul_f32 v42, v42, v48
v_mfma_f32_16x16x32_bf16 v[112:115], a[204:207], a[24:27], v[112:115]
ds_read_b64_tr_b16 a[228:229], v5 offset:13312
s_waitcnt lgkmcnt(7)
v_mfma_f32_16x16x32_bf16 v[136:139], a[200:203], a[12:15], v[136:139]
ds_read_b64_tr_b16 a[230:231], v5 offset:19456
v_mul_f32 v43, v43, v48
v_mfma_f32_16x16x32_bf16 v[136:139], a[204:207], a[28:31], v[136:139]
buffer_load_dwordx4 v18, s[8:11], s54 offen offset:3328 lds
v_mfma_f32_16x16x32_bf16 v[164:167], a[208:211], a[0:3], v[164:167]
ds_read_b64_tr_b16 a[232:233], v6 offset:1024
v_cvt_pk_bf16_f32 v40, v40, v41
v_mfma_f32_16x16x32_bf16 v[164:167], a[212:215], a[16:19], v[164:167]
v_mfma_f32_16x16x32_bf16 v[188:191], a[208:211], a[4:7], v[188:191]
ds_read_b64_tr_b16 a[234:235], v6 offset:7168
v_cvt_pk_bf16_f32 v41, v42, v43
v_mfma_f32_16x16x32_bf16 v[188:191], a[212:215], a[20:23], v[188:191]
v_mfma_f32_16x16x32_bf16 v[212:215], a[208:211], a[8:11], v[212:215]
s_add_u32 m0, s41, 0
v_accvgpr_read_b32 v44, a144
v_mfma_f32_16x16x32_bf16 v[212:215], a[212:215], a[24:27], v[212:215]
ds_read_b64_tr_b16 a[236:237], v6 offset:13312
s_waitcnt lgkmcnt(7)
v_mfma_f32_16x16x32_bf16 v[236:239], a[208:211], a[12:15], v[236:239]
ds_read_b64_tr_b16 a[238:239], v6 offset:19456
s_mov_b32 s46, 768
v_mfma_f32_16x16x32_bf16 v[236:239], a[212:215], a[28:31], v[236:239]
buffer_load_dwordx4 v21, s[4:7], s46 offen offset:0 lds
v_mfma_f32_16x16x32_bf16 v[68:71], a[216:219], a[0:3], v[68:71]
ds_read_b64_tr_b16 a[240:241], v7 offset:1024
v_accvgpr_read_b32 v45, a145
v_mfma_f32_16x16x32_bf16 v[68:71], a[220:223], a[16:19], v[68:71]
ds_read_b64_tr_b16 a[242:243], v7 offset:7168
v_accvgpr_read_b32 v46, a146
v_mfma_f32_16x16x32_bf16 v[92:95], a[216:219], a[4:7], v[92:95]
ds_read_b64_tr_b16 a[244:245], v7 offset:13312
v_accvgpr_read_b32 v47, a147
v_mfma_f32_16x16x32_bf16 v[92:95], a[220:223], a[20:23], v[92:95]
s_mov_b32 s46, 9984
ds_read_b64_tr_b16 a[246:247], v7 offset:19456
v_mfma_f32_16x16x32_bf16 v[116:119], a[216:219], a[8:11], v[116:119]
buffer_load_dwordx4 v21, s[4:7], s46 offen offset:1024 lds
v_mfma_f32_16x16x32_bf16 v[116:119], a[220:223], a[24:27], v[116:119]
v_mul_f32 v44, v44, v48
s_waitcnt lgkmcnt(8)
v_mfma_f32_16x16x32_bf16 v[140:143], a[216:219], a[12:15], v[140:143]
ds_read_b64_tr_b16 a[248:249], v8 offset:1024
v_mul_f32 v45, v45, v48
v_mfma_f32_16x16x32_bf16 v[140:143], a[220:223], a[28:31], v[140:143]
v_mfma_f32_16x16x32_bf16 v[168:171], a[224:227], a[0:3], v[168:171]
ds_read_b64_tr_b16 a[250:251], v8 offset:7168
v_mul_f32 v46, v46, v48
v_mfma_f32_16x16x32_bf16 v[168:171], a[228:231], a[16:19], v[168:171]
s_mov_b32 s46, 19200
ds_read_b64_tr_b16 a[252:253], v8 offset:13312
v_mfma_f32_16x16x32_bf16 v[192:195], a[224:227], a[4:7], v[192:195]
buffer_load_dwordx4 v21, s[4:7], s46 offen offset:2048 lds
v_mfma_f32_16x16x32_bf16 v[192:195], a[228:231], a[20:23], v[192:195]
ds_read_b64_tr_b16 a[254:255], v8 offset:19456
v_mul_f32 v47, v47, v48
v_mfma_f32_16x16x32_bf16 v[216:219], a[224:227], a[8:11], v[216:219]
ds_read_b64_tr_b16 a[192:193], v5 offset:2048
v_cvt_pk_bf16_f32 v42, v44, v45
v_mfma_f32_16x16x32_bf16 v[216:219], a[228:231], a[24:27], v[216:219]
s_waitcnt lgkmcnt(9)
v_cvt_pk_bf16_f32 v43, v46, v47
v_mfma_f32_16x16x32_bf16 v[240:243], a[224:227], a[12:15], v[240:243]
v_mfma_f32_16x16x32_bf16 v[240:243], a[228:231], a[28:31], v[240:243]
s_mov_b32 s46, 28416
ds_read_b64_tr_b16 a[194:195], v5 offset:8192
v_mfma_f32_16x16x32_bf16 v[72:75], a[232:235], a[0:3], v[72:75]
buffer_load_dwordx4 v21, s[4:7], s46 offen offset:3072 lds
v_mfma_f32_16x16x32_bf16 v[72:75], a[236:239], a[16:19], v[72:75]
ds_read_b64_tr_b16 a[196:197], v5 offset:14336
v_accvgpr_read_b32 v56, a132
v_mfma_f32_16x16x32_bf16 v[96:99], a[232:235], a[4:7], v[96:99]
ds_read_b64_tr_b16 a[198:199], v5 offset:20480
v_accvgpr_read_b32 v57, a133
v_mfma_f32_16x16x32_bf16 v[96:99], a[236:239], a[20:23], v[96:99]
v_mfma_f32_16x16x32_bf16 v[120:123], a[232:235], a[8:11], v[120:123]
ds_read_b64_tr_b16 a[200:201], v6 offset:2048
v_accvgpr_read_b32 v58, a134
v_mfma_f32_16x16x32_bf16 v[120:123], a[236:239], a[24:27], v[120:123]
s_add_u32 m0, s41, 4096
s_waitcnt lgkmcnt(9)
v_mfma_f32_16x16x32_bf16 v[144:147], a[232:235], a[12:15], v[144:147]
s_waitcnt vmcnt(17)
v_accvgpr_read_b32 v59, a135
v_mfma_f32_16x16x32_bf16 v[144:147], a[236:239], a[28:31], v[144:147]
ds_read_b128 a[32:35], v15 offset:0
s_mov_b32 s46, 41728
v_mfma_f32_16x16x32_bf16 v[172:175], a[240:243], a[0:3], v[172:175]
buffer_load_dwordx4 v21, s[4:7], s46 offen offset:0 lds
v_mfma_f32_16x16x32_bf16 v[172:175], a[244:247], a[16:19], v[172:175]
ds_read_b64_tr_b16 a[202:203], v6 offset:8192
v_mul_f32 v56, v56, v50
v_mfma_f32_16x16x32_bf16 v[196:199], a[240:243], a[4:7], v[196:199]
ds_read_b128 a[48:51], v16 offset:0
v_mul_f32 v57, v57, v50
v_mfma_f32_16x16x32_bf16 v[196:199], a[244:247], a[20:23], v[196:199]
ds_read_b64_tr_b16 a[204:205], v6 offset:14336
v_mul_f32 v58, v58, v50
v_mfma_f32_16x16x32_bf16 v[220:223], a[240:243], a[8:11], v[220:223]
ds_read_b64_tr_b16 a[206:207], v6 offset:20480
s_mov_b32 s46, 50944
v_mfma_f32_16x16x32_bf16 v[220:223], a[244:247], a[24:27], v[220:223]
ds_read_b128 a[36:39], v15 offset:2048
s_waitcnt lgkmcnt(11)
v_mfma_f32_16x16x32_bf16 v[244:247], a[240:243], a[12:15], v[244:247]
buffer_load_dwordx4 v21, s[4:7], s46 offen offset:1024 lds
v_mfma_f32_16x16x32_bf16 v[244:247], a[244:247], a[28:31], v[244:247]
ds_read_b64_tr_b16 a[208:209], v7 offset:2048
v_mul_f32 v59, v59, v50
v_mfma_f32_16x16x32_bf16 v[76:79], a[248:251], a[0:3], v[76:79]
ds_read_b128 a[52:55], v16 offset:2048
v_cvt_pk_bf16_f32 v56, v56, v57
v_mfma_f32_16x16x32_bf16 v[76:79], a[252:255], a[16:19], v[76:79]
ds_read_b64_tr_b16 a[210:211], v7 offset:8192
s_mov_b32 s46, 60160
v_mfma_f32_16x16x32_bf16 v[100:103], a[248:251], a[4:7], v[100:103]
ds_read_b64_tr_b16 a[212:213], v7 offset:14336
s_waitcnt vmcnt(15)
v_mfma_f32_16x16x32_bf16 v[100:103], a[252:255], a[20:23], v[100:103]
buffer_load_dwordx4 v21, s[4:7], s46 offen offset:2048 lds
v_mfma_f32_16x16x32_bf16 v[124:127], a[248:251], a[8:11], v[124:127]
ds_read_b64_tr_b16 a[214:215], v7 offset:20480
v_cvt_pk_bf16_f32 v57, v58, v59
v_mfma_f32_16x16x32_bf16 v[124:127], a[252:255], a[24:27], v[124:127]
ds_read_b128 a[40:43], v15 offset:4096
v_accvgpr_read_b32 v60, a148
v_mfma_f32_16x16x32_bf16 v[148:151], a[248:251], a[12:15], v[148:151]
ds_read_b64_tr_b16 a[216:217], v8 offset:2048
s_waitcnt lgkmcnt(14)
v_mfma_f32_16x16x32_bf16 v[148:151], a[252:255], a[28:31], v[148:151]
ds_read_b128 a[56:59], v16 offset:4096
v_accvgpr_read_b32 v61, a149
v_mfma_f32_16x16x32_bf16 v[176:179], a[192:195], a[0:3], v[176:179]
ds_read_b64_tr_b16 a[218:219], v8 offset:8192
s_mov_b32 s46, 69376
v_mfma_f32_16x16x32_bf16 v[176:179], a[196:199], a[16:19], v[176:179]
ds_read_b128 a[44:47], v15 offset:6144
v_accvgpr_read_b32 v62, a150
v_mfma_f32_16x16x32_bf16 v[200:203], a[192:195], a[4:7], v[200:203]
buffer_load_dwordx4 v21, s[4:7], s46 offen offset:3072 lds
v_mfma_f32_16x16x32_bf16 v[200:203], a[196:199], a[20:23], v[200:203]
ds_read_b64_tr_b16 a[220:221], v8 offset:14336
v_accvgpr_read_b32 v63, a151
v_mfma_f32_16x16x32_bf16 v[224:227], a[192:195], a[8:11], v[224:227]
ds_read_b64_tr_b16 a[222:223], v8 offset:20480
v_mul_f32 v60, v60, v50
v_mfma_f32_16x16x32_bf16 v[224:227], a[196:199], a[24:27], v[224:227]
ds_read_b128 a[60:63], v16 offset:6144
s_waitcnt lgkmcnt(14)
v_mfma_f32_16x16x32_bf16 v[248:251], a[192:195], a[12:15], v[248:251]
v_mul_f32 v61, v61, v50
v_mul_f32 v62, v62, v50
v_mfma_f32_16x16x32_bf16 v[248:251], a[196:199], a[28:31], v[248:251]
v_mfma_f32_16x16x32_bf16 v[80:83], a[200:203], a[0:3], v[80:83]
buffer_store_dwordx4 v[40:43], v22, s[16:19], s37 offen offset:0 sc1
v_mfma_f32_16x16x32_bf16 v[80:83], a[204:207], a[16:19], v[80:83]
v_mfma_f32_16x16x32_bf16 v[104:107], a[200:203], a[4:7], v[104:107]
s_mov_b32 s54, 5505024
v_mul_f32 v63, v63, v50
v_mfma_f32_16x16x32_bf16 v[104:107], a[204:207], a[20:23], v[104:107]
s_add_u32 m0, s40, 106496
v_mfma_f32_16x16x32_bf16 v[128:131], a[200:203], a[8:11], v[128:131]
s_waitcnt vmcnt(26) lgkmcnt(0)
s_barrier
v_mfma_f32_16x16x32_bf16 v[128:131], a[204:207], a[24:27], v[128:131]
ds_read_b64_tr_b16 a[224:225], v5 offset:24576
v_mfma_f32_16x16x32_bf16 v[152:155], a[200:203], a[12:15], v[152:155]
buffer_load_dwordx4 v20, s[8:11], s54 offen offset:0 lds
v_mfma_f32_16x16x32_bf16 v[152:155], a[204:207], a[28:31], v[152:155]
ds_read_b64_tr_b16 a[226:227], v5 offset:30720
v_mfma_f32_16x16x32_bf16 v[180:183], a[208:211], a[0:3], v[180:183]
ds_read_b64_tr_b16 a[228:229], v5 offset:36864
v_mfma_f32_16x16x32_bf16 v[180:183], a[212:215], a[16:19], v[180:183]
ds_read_b64_tr_b16 a[230:231], v5 offset:43008
v_mfma_f32_16x16x32_bf16 v[204:207], a[208:211], a[4:7], v[204:207]
v_mfma_f32_16x16x32_bf16 v[204:207], a[212:215], a[20:23], v[204:207]
ds_read_b64_tr_b16 a[232:233], v6 offset:24576
v_mfma_f32_16x16x32_bf16 v[228:231], a[208:211], a[8:11], v[228:231]
ds_read_b64_tr_b16 a[234:235], v6 offset:30720
v_mfma_f32_16x16x32_bf16 v[228:231], a[212:215], a[24:27], v[228:231]
buffer_load_dwordx4 v18, s[8:11], s54 offen offset:3072 lds
v_mfma_f32_16x16x32_bf16 v[252:255], a[208:211], a[12:15], v[252:255]
ds_read_b64_tr_b16 a[236:237], v6 offset:36864
v_cvt_pk_bf16_f32 v58, v60, v61
v_mfma_f32_16x16x32_bf16 v[252:255], a[212:215], a[28:31], v[252:255]
ds_read_b64_tr_b16 a[238:239], v6 offset:43008
v_cvt_pk_bf16_f32 v59, v62, v63
v_mfma_f32_16x16x32_bf16 v[84:87], a[216:219], a[0:3], v[84:87]
buffer_store_dwordx4 v[56:59], v22, s[16:19], s37 offen offset:1024 sc1
v_mfma_f32_16x16x32_bf16 v[84:87], a[220:223], a[16:19], v[84:87]
v_mfma_f32_16x16x32_bf16 v[108:111], a[216:219], a[4:7], v[108:111]
ds_read_b64_tr_b16 a[240:241], v7 offset:24576
v_mfma_f32_16x16x32_bf16 v[108:111], a[220:223], a[20:23], v[108:111]
v_mfma_f32_16x16x32_bf16 v[132:135], a[216:219], a[8:11], v[132:135]
ds_read_b64_tr_b16 a[242:243], v7 offset:30720
v_mfma_f32_16x16x32_bf16 v[132:135], a[220:223], a[24:27], v[132:135]
v_mfma_f32_16x16x32_bf16 v[156:159], a[216:219], a[12:15], v[156:159]
s_waitcnt lgkmcnt(6)
v_mfma_f32_16x16x32_bf16 v[156:159], a[220:223], a[28:31], v[156:159]
v_mfma_f32_16x16x32_bf16 v[160:163], a[224:227], a[32:35], v[160:163]
ds_read_b64_tr_b16 a[244:245], v7 offset:36864
v_accvgpr_read_b32 v32, a136
v_mfma_f32_16x16x32_bf16 v[160:163], a[228:231], a[48:51], v[160:163]
ds_read_b64_tr_b16 a[246:247], v7 offset:43008
s_add_u32 m0, s40, 107392
v_mfma_f32_16x16x32_bf16 v[184:187], a[224:227], a[36:39], v[184:187]
buffer_load_dwordx4 v20, s[8:11], s54 offen offset:128 lds
v_mfma_f32_16x16x32_bf16 v[184:187], a[228:231], a[52:55], v[184:187]
ds_read_b64_tr_b16 a[248:249], v8 offset:24576
v_accvgpr_read_b32 v33, a137
v_mfma_f32_16x16x32_bf16 v[208:211], a[224:227], a[40:43], v[208:211]
ds_read_b64_tr_b16 a[250:251], v8 offset:30720
v_accvgpr_read_b32 v34, a138
v_mfma_f32_16x16x32_bf16 v[208:211], a[228:231], a[56:59], v[208:211]
buffer_load_dwordx4 v18, s[8:11], s54 offen offset:3200 lds
v_mfma_f32_16x16x32_bf16 v[232:235], a[224:227], a[44:47], v[232:235]
ds_read_b64_tr_b16 a[252:253], v8 offset:36864
s_waitcnt lgkmcnt(7)
v_mfma_f32_16x16x32_bf16 v[232:235], a[228:231], a[60:63], v[232:235]
ds_read_b64_tr_b16 a[254:255], v8 offset:43008
v_accvgpr_read_b32 v35, a139
v_mfma_f32_16x16x32_bf16 v[64:67], a[232:235], a[32:35], v[64:67]
ds_read_b64_tr_b16 a[192:193], v5 offset:25600
v_mul_f32 v32, v32, v52
v_mfma_f32_16x16x32_bf16 v[64:67], a[236:239], a[48:51], v[64:67]
v_mfma_f32_16x16x32_bf16 v[88:91], a[232:235], a[36:39], v[88:91]
s_add_u32 m0, s40, 108288
v_mul_f32 v33, v33, v52
v_mfma_f32_16x16x32_bf16 v[88:91], a[236:239], a[52:55], v[88:91]
buffer_load_dwordx4 v20, s[8:11], s54 offen offset:256 lds
v_mfma_f32_16x16x32_bf16 v[112:115], a[232:235], a[40:43], v[112:115]
ds_read_b64_tr_b16 a[194:195], v5 offset:31744
v_mul_f32 v34, v34, v52
v_mfma_f32_16x16x32_bf16 v[112:115], a[236:239], a[56:59], v[112:115]
ds_read_b64_tr_b16 a[196:197], v5 offset:37888
s_waitcnt lgkmcnt(7)
v_mfma_f32_16x16x32_bf16 v[136:139], a[232:235], a[44:47], v[136:139]
ds_read_b64_tr_b16 a[198:199], v5 offset:44032
v_mul_f32 v35, v35, v52
v_mfma_f32_16x16x32_bf16 v[136:139], a[236:239], a[60:63], v[136:139]
buffer_load_dwordx4 v18, s[8:11], s54 offen offset:3328 lds
v_mfma_f32_16x16x32_bf16 v[164:167], a[240:243], a[32:35], v[164:167]
ds_read_b64_tr_b16 a[200:201], v6 offset:25600
v_cvt_pk_bf16_f32 v32, v32, v33
v_mfma_f32_16x16x32_bf16 v[164:167], a[244:247], a[48:51], v[164:167]
v_mfma_f32_16x16x32_bf16 v[188:191], a[240:243], a[36:39], v[188:191]
ds_read_b64_tr_b16 a[202:203], v6 offset:31744
v_cvt_pk_bf16_f32 v33, v34, v35
v_mfma_f32_16x16x32_bf16 v[188:191], a[244:247], a[52:55], v[188:191]
v_mfma_f32_16x16x32_bf16 v[212:215], a[240:243], a[40:43], v[212:215]
s_add_u32 m0, s41, 131072
v_accvgpr_read_b32 v36, a152
v_mfma_f32_16x16x32_bf16 v[212:215], a[244:247], a[56:59], v[212:215]
ds_read_b64_tr_b16 a[204:205], v6 offset:37888
s_waitcnt lgkmcnt(7)
v_mfma_f32_16x16x32_bf16 v[236:239], a[240:243], a[44:47], v[236:239]
ds_read_b64_tr_b16 a[206:207], v6 offset:44032
s_mov_b32 s46, 896
v_mfma_f32_16x16x32_bf16 v[236:239], a[244:247], a[60:63], v[236:239]
buffer_load_dwordx4 v21, s[4:7], s46 offen offset:0 lds
v_mfma_f32_16x16x32_bf16 v[68:71], a[248:251], a[32:35], v[68:71]
ds_read_b64_tr_b16 a[208:209], v7 offset:25600
v_accvgpr_read_b32 v37, a153
v_mfma_f32_16x16x32_bf16 v[68:71], a[252:255], a[48:51], v[68:71]
ds_read_b64_tr_b16 a[210:211], v7 offset:31744
v_accvgpr_read_b32 v38, a154
v_mfma_f32_16x16x32_bf16 v[92:95], a[248:251], a[36:39], v[92:95]
ds_read_b64_tr_b16 a[212:213], v7 offset:37888
v_accvgpr_read_b32 v39, a155
v_mfma_f32_16x16x32_bf16 v[92:95], a[252:255], a[52:55], v[92:95]
s_mov_b32 s46, 10112
ds_read_b64_tr_b16 a[214:215], v7 offset:44032
v_mfma_f32_16x16x32_bf16 v[116:119], a[248:251], a[40:43], v[116:119]
buffer_load_dwordx4 v21, s[4:7], s46 offen offset:1024 lds
v_mfma_f32_16x16x32_bf16 v[116:119], a[252:255], a[56:59], v[116:119]
v_mul_f32 v36, v36, v52
s_waitcnt lgkmcnt(8)
v_mfma_f32_16x16x32_bf16 v[140:143], a[248:251], a[44:47], v[140:143]
ds_read_b64_tr_b16 a[216:217], v8 offset:25600
v_mul_f32 v37, v37, v52
v_mfma_f32_16x16x32_bf16 v[140:143], a[252:255], a[60:63], v[140:143]
v_mfma_f32_16x16x32_bf16 v[168:171], a[192:195], a[32:35], v[168:171]
ds_read_b64_tr_b16 a[218:219], v8 offset:31744
v_mul_f32 v38, v38, v52
v_mfma_f32_16x16x32_bf16 v[168:171], a[196:199], a[48:51], v[168:171]
s_mov_b32 s46, 19328
ds_read_b64_tr_b16 a[220:221], v8 offset:37888
v_mfma_f32_16x16x32_bf16 v[192:195], a[192:195], a[36:39], v[192:195]
buffer_load_dwordx4 v21, s[4:7], s46 offen offset:2048 lds
v_mfma_f32_16x16x32_bf16 v[192:195], a[196:199], a[52:55], v[192:195]
ds_read_b64_tr_b16 a[222:223], v8 offset:44032
v_mul_f32 v39, v39, v52
v_mfma_f32_16x16x32_bf16 v[216:219], a[192:195], a[40:43], v[216:219]
ds_read_b64_tr_b16 a[224:225], v5 offset:26624
v_cvt_pk_bf16_f32 v34, v36, v37
v_mfma_f32_16x16x32_bf16 v[216:219], a[196:199], a[56:59], v[216:219]
s_waitcnt lgkmcnt(9)
v_cvt_pk_bf16_f32 v35, v38, v39
v_mfma_f32_16x16x32_bf16 v[240:243], a[192:195], a[44:47], v[240:243]
v_mfma_f32_16x16x32_bf16 v[240:243], a[196:199], a[60:63], v[240:243]
s_mov_b32 s46, 28544
ds_read_b64_tr_b16 a[226:227], v5 offset:32768
v_mfma_f32_16x16x32_bf16 v[72:75], a[200:203], a[32:35], v[72:75]
buffer_load_dwordx4 v21, s[4:7], s46 offen offset:3072 lds
v_mfma_f32_16x16x32_bf16 v[72:75], a[204:207], a[48:51], v[72:75]
ds_read_b64_tr_b16 a[228:229], v5 offset:38912
v_accvgpr_read_b32 v40, a140
v_mfma_f32_16x16x32_bf16 v[96:99], a[200:203], a[36:39], v[96:99]
ds_read_b64_tr_b16 a[230:231], v5 offset:45056
v_accvgpr_read_b32 v41, a141
v_mfma_f32_16x16x32_bf16 v[96:99], a[204:207], a[52:55], v[96:99]
v_mfma_f32_16x16x32_bf16 v[120:123], a[200:203], a[40:43], v[120:123]
ds_read_b64_tr_b16 a[232:233], v6 offset:26624
v_accvgpr_read_b32 v42, a142
v_mfma_f32_16x16x32_bf16 v[120:123], a[204:207], a[56:59], v[120:123]
s_add_u32 m0, s41, 135168
s_waitcnt lgkmcnt(9)
v_mfma_f32_16x16x32_bf16 v[144:147], a[200:203], a[44:47], v[144:147]
s_waitcnt vmcnt(16)
v_accvgpr_read_b32 v43, a143
v_mfma_f32_16x16x32_bf16 v[144:147], a[204:207], a[60:63], v[144:147]
ds_read_b128 a[0:3], v13 offset:0
s_mov_b32 s46, 41856
v_mfma_f32_16x16x32_bf16 v[172:175], a[208:211], a[32:35], v[172:175]
buffer_load_dwordx4 v21, s[4:7], s46 offen offset:0 lds
v_mfma_f32_16x16x32_bf16 v[172:175], a[212:215], a[48:51], v[172:175]
ds_read_b64_tr_b16 a[234:235], v6 offset:32768
v_mul_f32 v40, v40, v54
v_mfma_f32_16x16x32_bf16 v[196:199], a[208:211], a[36:39], v[196:199]
ds_read_b128 a[16:19], v14 offset:0
v_mul_f32 v41, v41, v54
v_mfma_f32_16x16x32_bf16 v[196:199], a[212:215], a[52:55], v[196:199]
ds_read_b64_tr_b16 a[236:237], v6 offset:38912
v_mul_f32 v42, v42, v54
v_mfma_f32_16x16x32_bf16 v[220:223], a[208:211], a[40:43], v[220:223]
ds_read_b64_tr_b16 a[238:239], v6 offset:45056
s_mov_b32 s46, 51072
v_mfma_f32_16x16x32_bf16 v[220:223], a[212:215], a[56:59], v[220:223]
ds_read_b128 a[4:7], v13 offset:2048
s_waitcnt lgkmcnt(11)
v_mfma_f32_16x16x32_bf16 v[244:247], a[208:211], a[44:47], v[244:247]
buffer_load_dwordx4 v21, s[4:7], s46 offen offset:1024 lds
v_mfma_f32_16x16x32_bf16 v[244:247], a[212:215], a[60:63], v[244:247]
ds_read_b64_tr_b16 a[240:241], v7 offset:26624
v_mul_f32 v43, v43, v54
v_mfma_f32_16x16x32_bf16 v[76:79], a[216:219], a[32:35], v[76:79]
ds_read_b128 a[20:23], v14 offset:2048
v_cvt_pk_bf16_f32 v40, v40, v41
v_mfma_f32_16x16x32_bf16 v[76:79], a[220:223], a[48:51], v[76:79]
ds_read_b64_tr_b16 a[242:243], v7 offset:32768
s_mov_b32 s46, 60288
v_mfma_f32_16x16x32_bf16 v[100:103], a[216:219], a[36:39], v[100:103]
ds_read_b64_tr_b16 a[244:245], v7 offset:38912
s_waitcnt vmcnt(14)
v_mfma_f32_16x16x32_bf16 v[100:103], a[220:223], a[52:55], v[100:103]
buffer_load_dwordx4 v21, s[4:7], s46 offen offset:2048 lds
v_mfma_f32_16x16x32_bf16 v[124:127], a[216:219], a[40:43], v[124:127]
ds_read_b64_tr_b16 a[246:247], v7 offset:45056
v_cvt_pk_bf16_f32 v41, v42, v43
v_mfma_f32_16x16x32_bf16 v[124:127], a[220:223], a[56:59], v[124:127]
ds_read_b128 a[8:11], v13 offset:4096
v_accvgpr_read_b32 v44, a156
v_mfma_f32_16x16x32_bf16 v[148:151], a[216:219], a[44:47], v[148:151]
ds_read_b64_tr_b16 a[248:249], v8 offset:26624
s_waitcnt lgkmcnt(14)
v_mfma_f32_16x16x32_bf16 v[148:151], a[220:223], a[60:63], v[148:151]
ds_read_b128 a[24:27], v14 offset:4096
v_accvgpr_read_b32 v45, a157
v_mfma_f32_16x16x32_bf16 v[176:179], a[224:227], a[32:35], v[176:179]
ds_read_b64_tr_b16 a[250:251], v8 offset:32768
s_mov_b32 s46, 69504
v_mfma_f32_16x16x32_bf16 v[176:179], a[228:231], a[48:51], v[176:179]
ds_read_b128 a[12:15], v13 offset:6144
v_accvgpr_read_b32 v46, a158
v_mfma_f32_16x16x32_bf16 v[200:203], a[224:227], a[36:39], v[200:203]
buffer_load_dwordx4 v21, s[4:7], s46 offen offset:3072 lds
v_mfma_f32_16x16x32_bf16 v[200:203], a[228:231], a[52:55], v[200:203]
ds_read_b64_tr_b16 a[252:253], v8 offset:38912
v_accvgpr_read_b32 v47, a159
v_mfma_f32_16x16x32_bf16 v[224:227], a[224:227], a[40:43], v[224:227]
ds_read_b64_tr_b16 a[254:255], v8 offset:45056
v_mul_f32 v44, v44, v54
v_mfma_f32_16x16x32_bf16 v[224:227], a[228:231], a[56:59], v[224:227]
ds_read_b128 a[28:31], v14 offset:6144
s_waitcnt lgkmcnt(14)
v_mfma_f32_16x16x32_bf16 v[248:251], a[224:227], a[44:47], v[248:251]
v_mul_f32 v45, v45, v54
v_mul_f32 v46, v46, v54
v_mfma_f32_16x16x32_bf16 v[248:251], a[228:231], a[60:63], v[248:251]
v_mfma_f32_16x16x32_bf16 v[80:83], a[232:235], a[32:35], v[80:83]
buffer_store_dwordx4 v[32:35], v22, s[16:19], s37 offen offset:2048 sc1
v_mfma_f32_16x16x32_bf16 v[80:83], a[236:239], a[48:51], v[80:83]
v_mfma_f32_16x16x32_bf16 v[104:107], a[232:235], a[36:39], v[104:107]
s_mov_b32 s54, 6291456
v_mul_f32 v47, v47, v54
v_mfma_f32_16x16x32_bf16 v[104:107], a[236:239], a[52:55], v[104:107]
s_add_u32 m0, s40, 32768
v_mfma_f32_16x16x32_bf16 v[128:131], a[232:235], a[40:43], v[128:131]
s_waitcnt vmcnt(25) lgkmcnt(0)
s_barrier
v_mfma_f32_16x16x32_bf16 v[128:131], a[236:239], a[56:59], v[128:131]
ds_read_b64_tr_b16 a[192:193], v5 offset:49152
v_mfma_f32_16x16x32_bf16 v[152:155], a[232:235], a[44:47], v[152:155]
buffer_load_dwordx4 v20, s[8:11], s54 offen offset:0 lds
v_mfma_f32_16x16x32_bf16 v[152:155], a[236:239], a[60:63], v[152:155]
ds_read_b64_tr_b16 a[194:195], v5 offset:55296
v_mfma_f32_16x16x32_bf16 v[180:183], a[240:243], a[32:35], v[180:183]
ds_read_b64_tr_b16 a[196:197], v5 offset:61440
v_mfma_f32_16x16x32_bf16 v[180:183], a[244:247], a[48:51], v[180:183]
ds_read_b64_tr_b16 a[198:199], v9 offset:2048
v_mfma_f32_16x16x32_bf16 v[204:207], a[240:243], a[36:39], v[204:207]
v_mfma_f32_16x16x32_bf16 v[204:207], a[244:247], a[52:55], v[204:207]
ds_read_b64_tr_b16 a[200:201], v6 offset:49152
v_mfma_f32_16x16x32_bf16 v[228:231], a[240:243], a[40:43], v[228:231]
ds_read_b64_tr_b16 a[202:203], v6 offset:55296
v_mfma_f32_16x16x32_bf16 v[228:231], a[244:247], a[56:59], v[228:231]
buffer_load_dwordx4 v18, s[8:11], s54 offen offset:3072 lds
v_mfma_f32_16x16x32_bf16 v[252:255], a[240:243], a[44:47], v[252:255]
ds_read_b64_tr_b16 a[204:205], v6 offset:61440
v_cvt_pk_bf16_f32 v42, v44, v45
v_mfma_f32_16x16x32_bf16 v[252:255], a[244:247], a[60:63], v[252:255]
ds_read_b64_tr_b16 a[206:207], v10 offset:2048
v_cvt_pk_bf16_f32 v43, v46, v47
v_mfma_f32_16x16x32_bf16 v[84:87], a[248:251], a[32:35], v[84:87]
buffer_store_dwordx4 v[40:43], v23, s[16:19], s37 offen offset:3072 sc1
v_mfma_f32_16x16x32_bf16 v[84:87], a[252:255], a[48:51], v[84:87]
v_mfma_f32_16x16x32_bf16 v[108:111], a[248:251], a[36:39], v[108:111]
ds_read_b64_tr_b16 a[208:209], v7 offset:49152
v_mfma_f32_16x16x32_bf16 v[108:111], a[252:255], a[52:55], v[108:111]
v_mfma_f32_16x16x32_bf16 v[132:135], a[248:251], a[40:43], v[132:135]
ds_read_b64_tr_b16 a[210:211], v7 offset:55296
v_mfma_f32_16x16x32_bf16 v[132:135], a[252:255], a[56:59], v[132:135]
v_mfma_f32_16x16x32_bf16 v[156:159], a[248:251], a[44:47], v[156:159]
s_waitcnt lgkmcnt(6)
v_mfma_f32_16x16x32_bf16 v[156:159], a[252:255], a[60:63], v[156:159]
v_mfma_f32_16x16x32_bf16 v[160:163], a[192:195], a[0:3], v[160:163]
ds_read_b64_tr_b16 a[212:213], v7 offset:61440
v_accvgpr_read_b32 v56, a160
v_mfma_f32_16x16x32_bf16 v[160:163], a[196:199], a[16:19], v[160:163]
ds_read_b64_tr_b16 a[214:215], v11 offset:2048
s_add_u32 m0, s40, 33664
v_mfma_f32_16x16x32_bf16 v[184:187], a[192:195], a[4:7], v[184:187]
buffer_load_dwordx4 v20, s[8:11], s54 offen offset:128 lds
v_mfma_f32_16x16x32_bf16 v[184:187], a[196:199], a[20:23], v[184:187]
ds_read_b64_tr_b16 a[216:217], v8 offset:49152
v_accvgpr_read_b32 v57, a161
v_mfma_f32_16x16x32_bf16 v[208:211], a[192:195], a[8:11], v[208:211]
ds_read_b64_tr_b16 a[218:219], v8 offset:55296
v_accvgpr_read_b32 v58, a162
v_mfma_f32_16x16x32_bf16 v[208:211], a[196:199], a[24:27], v[208:211]
buffer_load_dwordx4 v18, s[8:11], s54 offen offset:3200 lds
v_mfma_f32_16x16x32_bf16 v[232:235], a[192:195], a[12:15], v[232:235]
ds_read_b64_tr_b16 a[220:221], v8 offset:61440
s_waitcnt lgkmcnt(7)
v_mfma_f32_16x16x32_bf16 v[232:235], a[196:199], a[28:31], v[232:235]
ds_read_b64_tr_b16 a[222:223], v12 offset:2048
v_accvgpr_read_b32 v59, a163
v_mfma_f32_16x16x32_bf16 v[64:67], a[200:203], a[0:3], v[64:67]
ds_read_b64_tr_b16 a[224:225], v5 offset:50176
v_mul_f32 v56, v56, v48
v_mfma_f32_16x16x32_bf16 v[64:67], a[204:207], a[16:19], v[64:67]
v_mfma_f32_16x16x32_bf16 v[88:91], a[200:203], a[4:7], v[88:91]
s_add_u32 m0, s40, 34560
v_mul_f32 v57, v57, v48
v_mfma_f32_16x16x32_bf16 v[88:91], a[204:207], a[20:23], v[88:91]
buffer_load_dwordx4 v20, s[8:11], s54 offen offset:256 lds
v_mfma_f32_16x16x32_bf16 v[112:115], a[200:203], a[8:11], v[112:115]
ds_read_b64_tr_b16 a[226:227], v5 offset:56320
v_mul_f32 v58, v58, v48
v_mfma_f32_16x16x32_bf16 v[112:115], a[204:207], a[24:27], v[112:115]
ds_read_b64_tr_b16 a[228:229], v5 offset:62464
s_waitcnt lgkmcnt(7)
v_mfma_f32_16x16x32_bf16 v[136:139], a[200:203], a[12:15], v[136:139]
ds_read_b64_tr_b16 a[230:231], v9 offset:3072
v_mul_f32 v59, v59, v48
v_mfma_f32_16x16x32_bf16 v[136:139], a[204:207], a[28:31], v[136:139]
buffer_load_dwordx4 v18, s[8:11], s54 offen offset:3328 lds
v_mfma_f32_16x16x32_bf16 v[164:167], a[208:211], a[0:3], v[164:167]
ds_read_b64_tr_b16 a[232:233], v6 offset:50176
v_cvt_pk_bf16_f32 v56, v56, v57
v_mfma_f32_16x16x32_bf16 v[164:167], a[212:215], a[16:19], v[164:167]
v_mfma_f32_16x16x32_bf16 v[188:191], a[208:211], a[4:7], v[188:191]
ds_read_b64_tr_b16 a[234:235], v6 offset:56320
v_cvt_pk_bf16_f32 v57, v58, v59
v_mfma_f32_16x16x32_bf16 v[188:191], a[212:215], a[20:23], v[188:191]
v_mfma_f32_16x16x32_bf16 v[212:215], a[208:211], a[8:11], v[212:215]
s_add_u32 m0, s41, 0
v_accvgpr_read_b32 v60, a176
v_mfma_f32_16x16x32_bf16 v[212:215], a[212:215], a[24:27], v[212:215]
ds_read_b64_tr_b16 a[236:237], v6 offset:62464
s_waitcnt lgkmcnt(7)
v_mfma_f32_16x16x32_bf16 v[236:239], a[208:211], a[12:15], v[236:239]
ds_read_b64_tr_b16 a[238:239], v10 offset:3072
s_mov_b32 s46, 1024
v_mfma_f32_16x16x32_bf16 v[236:239], a[212:215], a[28:31], v[236:239]
buffer_load_dwordx4 v21, s[4:7], s46 offen offset:0 lds
v_mfma_f32_16x16x32_bf16 v[68:71], a[216:219], a[0:3], v[68:71]
ds_read_b64_tr_b16 a[240:241], v7 offset:50176
v_accvgpr_read_b32 v61, a177
v_mfma_f32_16x16x32_bf16 v[68:71], a[220:223], a[16:19], v[68:71]
ds_read_b64_tr_b16 a[242:243], v7 offset:56320
v_accvgpr_read_b32 v62, a178
v_mfma_f32_16x16x32_bf16 v[92:95], a[216:219], a[4:7], v[92:95]
ds_read_b64_tr_b16 a[244:245], v7 offset:62464
v_accvgpr_read_b32 v63, a179
v_mfma_f32_16x16x32_bf16 v[92:95], a[220:223], a[20:23], v[92:95]
s_mov_b32 s46, 10240
ds_read_b64_tr_b16 a[246:247], v11 offset:3072
v_mfma_f32_16x16x32_bf16 v[116:119], a[216:219], a[8:11], v[116:119]
buffer_load_dwordx4 v21, s[4:7], s46 offen offset:1024 lds
v_mfma_f32_16x16x32_bf16 v[116:119], a[220:223], a[24:27], v[116:119]
v_mul_f32 v60, v60, v48
s_waitcnt lgkmcnt(8)
v_mfma_f32_16x16x32_bf16 v[140:143], a[216:219], a[12:15], v[140:143]
ds_read_b64_tr_b16 a[248:249], v8 offset:50176
v_mul_f32 v61, v61, v48
v_mfma_f32_16x16x32_bf16 v[140:143], a[220:223], a[28:31], v[140:143]
v_mfma_f32_16x16x32_bf16 v[168:171], a[224:227], a[0:3], v[168:171]
ds_read_b64_tr_b16 a[250:251], v8 offset:56320
v_mul_f32 v62, v62, v48
v_mfma_f32_16x16x32_bf16 v[168:171], a[228:231], a[16:19], v[168:171]
s_mov_b32 s46, 19456
ds_read_b64_tr_b16 a[252:253], v8 offset:62464
v_mfma_f32_16x16x32_bf16 v[192:195], a[224:227], a[4:7], v[192:195]
buffer_load_dwordx4 v21, s[4:7], s46 offen offset:2048 lds
v_mfma_f32_16x16x32_bf16 v[192:195], a[228:231], a[20:23], v[192:195]
ds_read_b64_tr_b16 a[254:255], v12 offset:3072
v_mul_f32 v63, v63, v48
v_mfma_f32_16x16x32_bf16 v[216:219], a[224:227], a[8:11], v[216:219]
ds_read_b64_tr_b16 a[192:193], v5 offset:51200
v_cvt_pk_bf16_f32 v58, v60, v61
v_mfma_f32_16x16x32_bf16 v[216:219], a[228:231], a[24:27], v[216:219]
s_waitcnt lgkmcnt(9)
v_cvt_pk_bf16_f32 v59, v62, v63
v_mfma_f32_16x16x32_bf16 v[240:243], a[224:227], a[12:15], v[240:243]
v_mfma_f32_16x16x32_bf16 v[240:243], a[228:231], a[28:31], v[240:243]
s_mov_b32 s46, 28672
ds_read_b64_tr_b16 a[194:195], v5 offset:57344
v_mfma_f32_16x16x32_bf16 v[72:75], a[232:235], a[0:3], v[72:75]
buffer_load_dwordx4 v21, s[4:7], s46 offen offset:3072 lds
v_mfma_f32_16x16x32_bf16 v[72:75], a[236:239], a[16:19], v[72:75]
ds_read_b64_tr_b16 a[196:197], v5 offset:63488
v_accvgpr_read_b32 v32, a164
v_mfma_f32_16x16x32_bf16 v[96:99], a[232:235], a[4:7], v[96:99]
ds_read_b64_tr_b16 a[198:199], v9 offset:4096
v_accvgpr_read_b32 v33, a165
v_mfma_f32_16x16x32_bf16 v[96:99], a[236:239], a[20:23], v[96:99]
v_mfma_f32_16x16x32_bf16 v[120:123], a[232:235], a[8:11], v[120:123]
ds_read_b64_tr_b16 a[200:201], v6 offset:51200
v_accvgpr_read_b32 v34, a166
v_mfma_f32_16x16x32_bf16 v[120:123], a[236:239], a[24:27], v[120:123]
s_add_u32 m0, s41, 4096
s_waitcnt lgkmcnt(9)
v_mfma_f32_16x16x32_bf16 v[144:147], a[232:235], a[12:15], v[144:147]
s_waitcnt vmcnt(16)
v_accvgpr_read_b32 v35, a167
v_mfma_f32_16x16x32_bf16 v[144:147], a[236:239], a[28:31], v[144:147]
ds_read_b128 a[32:35], v15 offset:0
s_mov_b32 s46, 41984
v_mfma_f32_16x16x32_bf16 v[172:175], a[240:243], a[0:3], v[172:175]
buffer_load_dwordx4 v21, s[4:7], s46 offen offset:0 lds
v_mfma_f32_16x16x32_bf16 v[172:175], a[244:247], a[16:19], v[172:175]
ds_read_b64_tr_b16 a[202:203], v6 offset:57344
v_mul_f32 v32, v32, v50
v_mfma_f32_16x16x32_bf16 v[196:199], a[240:243], a[4:7], v[196:199]
ds_read_b128 a[48:51], v16 offset:0
v_mul_f32 v33, v33, v50
v_mfma_f32_16x16x32_bf16 v[196:199], a[244:247], a[20:23], v[196:199]
ds_read_b64_tr_b16 a[204:205], v6 offset:63488
v_mul_f32 v34, v34, v50
v_mfma_f32_16x16x32_bf16 v[220:223], a[240:243], a[8:11], v[220:223]
ds_read_b64_tr_b16 a[206:207], v10 offset:4096
s_mov_b32 s46, 51200
v_mfma_f32_16x16x32_bf16 v[220:223], a[244:247], a[24:27], v[220:223]
ds_read_b128 a[36:39], v15 offset:2048
s_waitcnt lgkmcnt(11)
v_mfma_f32_16x16x32_bf16 v[244:247], a[240:243], a[12:15], v[244:247]
buffer_load_dwordx4 v21, s[4:7], s46 offen offset:1024 lds
v_mfma_f32_16x16x32_bf16 v[244:247], a[244:247], a[28:31], v[244:247]
ds_read_b64_tr_b16 a[208:209], v7 offset:51200
v_mul_f32 v35, v35, v50
v_mfma_f32_16x16x32_bf16 v[76:79], a[248:251], a[0:3], v[76:79]
ds_read_b128 a[52:55], v16 offset:2048
v_cvt_pk_bf16_f32 v32, v32, v33
v_mfma_f32_16x16x32_bf16 v[76:79], a[252:255], a[16:19], v[76:79]
ds_read_b64_tr_b16 a[210:211], v7 offset:57344
s_mov_b32 s46, 60416
v_mfma_f32_16x16x32_bf16 v[100:103], a[248:251], a[4:7], v[100:103]
ds_read_b64_tr_b16 a[212:213], v7 offset:63488
s_waitcnt vmcnt(14)
v_mfma_f32_16x16x32_bf16 v[100:103], a[252:255], a[20:23], v[100:103]
buffer_load_dwordx4 v21, s[4:7], s46 offen offset:2048 lds
v_mfma_f32_16x16x32_bf16 v[124:127], a[248:251], a[8:11], v[124:127]
ds_read_b64_tr_b16 a[214:215], v11 offset:4096
v_cvt_pk_bf16_f32 v33, v34, v35
v_mfma_f32_16x16x32_bf16 v[124:127], a[252:255], a[24:27], v[124:127]
ds_read_b128 a[40:43], v15 offset:4096
v_accvgpr_read_b32 v36, a180
v_mfma_f32_16x16x32_bf16 v[148:151], a[248:251], a[12:15], v[148:151]
ds_read_b64_tr_b16 a[216:217], v8 offset:51200
s_waitcnt lgkmcnt(14)
v_mfma_f32_16x16x32_bf16 v[148:151], a[252:255], a[28:31], v[148:151]
ds_read_b128 a[56:59], v16 offset:4096
v_accvgpr_read_b32 v37, a181
v_mfma_f32_16x16x32_bf16 v[176:179], a[192:195], a[0:3], v[176:179]
ds_read_b64_tr_b16 a[218:219], v8 offset:57344
s_mov_b32 s46, 69632
v_mfma_f32_16x16x32_bf16 v[176:179], a[196:199], a[16:19], v[176:179]
ds_read_b128 a[44:47], v15 offset:6144
v_accvgpr_read_b32 v38, a182
v_mfma_f32_16x16x32_bf16 v[200:203], a[192:195], a[4:7], v[200:203]
buffer_load_dwordx4 v21, s[4:7], s46 offen offset:3072 lds
v_mfma_f32_16x16x32_bf16 v[200:203], a[196:199], a[20:23], v[200:203]
ds_read_b64_tr_b16 a[220:221], v8 offset:63488
v_accvgpr_read_b32 v39, a183
v_mfma_f32_16x16x32_bf16 v[224:227], a[192:195], a[8:11], v[224:227]
ds_read_b64_tr_b16 a[222:223], v12 offset:4096
v_mul_f32 v36, v36, v50
v_mfma_f32_16x16x32_bf16 v[224:227], a[196:199], a[24:27], v[224:227]
ds_read_b128 a[60:63], v16 offset:6144
s_waitcnt lgkmcnt(14)
v_mfma_f32_16x16x32_bf16 v[248:251], a[192:195], a[12:15], v[248:251]
v_mul_f32 v37, v37, v50
v_mul_f32 v38, v38, v50
v_mfma_f32_16x16x32_bf16 v[248:251], a[196:199], a[28:31], v[248:251]
v_mfma_f32_16x16x32_bf16 v[80:83], a[200:203], a[0:3], v[80:83]
buffer_store_dwordx4 v[56:59], v22, s[16:19], s38 offen offset:0 sc1
v_mfma_f32_16x16x32_bf16 v[80:83], a[204:207], a[16:19], v[80:83]
v_mfma_f32_16x16x32_bf16 v[104:107], a[200:203], a[4:7], v[104:107]
s_mov_b32 s54, 7077888
v_mul_f32 v39, v39, v50
v_mfma_f32_16x16x32_bf16 v[104:107], a[204:207], a[20:23], v[104:107]
s_add_u32 m0, s40, 57344
v_mfma_f32_16x16x32_bf16 v[128:131], a[200:203], a[8:11], v[128:131]
s_waitcnt vmcnt(25) lgkmcnt(0)
s_barrier
v_mfma_f32_16x16x32_bf16 v[128:131], a[204:207], a[24:27], v[128:131]
ds_read_b64_tr_b16 a[224:225], v9 offset:8192
v_mfma_f32_16x16x32_bf16 v[152:155], a[200:203], a[12:15], v[152:155]
buffer_load_dwordx4 v20, s[8:11], s54 offen offset:0 lds
v_mfma_f32_16x16x32_bf16 v[152:155], a[204:207], a[28:31], v[152:155]
ds_read_b64_tr_b16 a[226:227], v9 offset:14336
v_mfma_f32_16x16x32_bf16 v[180:183], a[208:211], a[0:3], v[180:183]
ds_read_b64_tr_b16 a[228:229], v9 offset:20480
v_mfma_f32_16x16x32_bf16 v[180:183], a[212:215], a[16:19], v[180:183]
ds_read_b64_tr_b16 a[230:231], v9 offset:26624
v_mfma_f32_16x16x32_bf16 v[204:207], a[208:211], a[4:7], v[204:207]
v_mfma_f32_16x16x32_bf16 v[204:207], a[212:215], a[20:23], v[204:207]
ds_read_b64_tr_b16 a[232:233], v10 offset:8192
v_mfma_f32_16x16x32_bf16 v[228:231], a[208:211], a[8:11], v[228:231]
ds_read_b64_tr_b16 a[234:235], v10 offset:14336
v_mfma_f32_16x16x32_bf16 v[228:231], a[212:215], a[24:27], v[228:231]
buffer_load_dwordx4 v18, s[8:11], s54 offen offset:3072 lds
v_mfma_f32_16x16x32_bf16 v[252:255], a[208:211], a[12:15], v[252:255]
ds_read_b64_tr_b16 a[236:237], v10 offset:20480
v_cvt_pk_bf16_f32 v34, v36, v37
v_mfma_f32_16x16x32_bf16 v[252:255], a[212:215], a[28:31], v[252:255]
ds_read_b64_tr_b16 a[238:239], v10 offset:26624
v_cvt_pk_bf16_f32 v35, v38, v39
v_mfma_f32_16x16x32_bf16 v[84:87], a[216:219], a[0:3], v[84:87]
buffer_store_dwordx4 v[32:35], v22, s[16:19], s38 offen offset:1024 sc1
v_mfma_f32_16x16x32_bf16 v[84:87], a[220:223], a[16:19], v[84:87]
v_mfma_f32_16x16x32_bf16 v[108:111], a[216:219], a[4:7], v[108:111]
ds_read_b64_tr_b16 a[240:241], v11 offset:8192
v_mfma_f32_16x16x32_bf16 v[108:111], a[220:223], a[20:23], v[108:111]
v_mfma_f32_16x16x32_bf16 v[132:135], a[216:219], a[8:11], v[132:135]
ds_read_b64_tr_b16 a[242:243], v11 offset:14336
v_mfma_f32_16x16x32_bf16 v[132:135], a[220:223], a[24:27], v[132:135]
v_mfma_f32_16x16x32_bf16 v[156:159], a[216:219], a[12:15], v[156:159]
s_waitcnt lgkmcnt(6)
v_mfma_f32_16x16x32_bf16 v[156:159], a[220:223], a[28:31], v[156:159]
v_mfma_f32_16x16x32_bf16 v[160:163], a[224:227], a[32:35], v[160:163]
ds_read_b64_tr_b16 a[244:245], v11 offset:20480
v_accvgpr_read_b32 v40, a168
v_mfma_f32_16x16x32_bf16 v[160:163], a[228:231], a[48:51], v[160:163]
ds_read_b64_tr_b16 a[246:247], v11 offset:26624
s_add_u32 m0, s40, 58240
v_mfma_f32_16x16x32_bf16 v[184:187], a[224:227], a[36:39], v[184:187]
buffer_load_dwordx4 v20, s[8:11], s54 offen offset:128 lds
v_mfma_f32_16x16x32_bf16 v[184:187], a[228:231], a[52:55], v[184:187]
ds_read_b64_tr_b16 a[248:249], v12 offset:8192
v_accvgpr_read_b32 v41, a169
v_mfma_f32_16x16x32_bf16 v[208:211], a[224:227], a[40:43], v[208:211]
ds_read_b64_tr_b16 a[250:251], v12 offset:14336
v_accvgpr_read_b32 v42, a170
v_mfma_f32_16x16x32_bf16 v[208:211], a[228:231], a[56:59], v[208:211]
buffer_load_dwordx4 v18, s[8:11], s54 offen offset:3200 lds
v_mfma_f32_16x16x32_bf16 v[232:235], a[224:227], a[44:47], v[232:235]
ds_read_b64_tr_b16 a[252:253], v12 offset:20480
s_waitcnt lgkmcnt(7)
v_mfma_f32_16x16x32_bf16 v[232:235], a[228:231], a[60:63], v[232:235]
ds_read_b64_tr_b16 a[254:255], v12 offset:26624
v_accvgpr_read_b32 v43, a171
v_mfma_f32_16x16x32_bf16 v[64:67], a[232:235], a[32:35], v[64:67]
ds_read_b64_tr_b16 a[192:193], v9 offset:9216
v_mul_f32 v40, v40, v52
v_mfma_f32_16x16x32_bf16 v[64:67], a[236:239], a[48:51], v[64:67]
s_add_u32 m0, s40, 59136
ds_read_b64_tr_b16 a[194:195], v9 offset:15360
v_mfma_f32_16x16x32_bf16 v[88:91], a[232:235], a[36:39], v[88:91]
buffer_load_dwordx4 v20, s[8:11], s54 offen offset:256 lds
v_mfma_f32_16x16x32_bf16 v[88:91], a[236:239], a[52:55], v[88:91]
ds_read_b64_tr_b16 a[196:197], v9 offset:21504
v_mul_f32 v41, v41, v52
v_mfma_f32_16x16x32_bf16 v[112:115], a[232:235], a[40:43], v[112:115]
buffer_load_dwordx4 v18, s[8:11], s54 offen offset:3328 lds
v_mfma_f32_16x16x32_bf16 v[112:115], a[236:239], a[56:59], v[112:115]
v_mul_f32 v42, v42, v52
s_waitcnt lgkmcnt(7)
v_mfma_f32_16x16x32_bf16 v[136:139], a[232:235], a[44:47], v[136:139]
ds_read_b64_tr_b16 a[198:199], v9 offset:27648
v_mul_f32 v43, v43, v52
v_mfma_f32_16x16x32_bf16 v[136:139], a[236:239], a[60:63], v[136:139]
v_mfma_f32_16x16x32_bf16 v[164:167], a[240:243], a[32:35], v[164:167]
ds_read_b64_tr_b16 a[200:201], v10 offset:9216
v_cvt_pk_bf16_f32 v40, v40, v41
v_mfma_f32_16x16x32_bf16 v[164:167], a[244:247], a[48:51], v[164:167]
s_mov_b64 s[8:9], s[20:21]
ds_read_b64_tr_b16 a[202:203], v10 offset:15360
v_mfma_f32_16x16x32_bf16 v[188:191], a[240:243], a[36:39], v[188:191]
ds_read_b64_tr_b16 a[204:205], v10 offset:21504
v_cvt_pk_bf16_f32 v41, v42, v43
v_mfma_f32_16x16x32_bf16 v[188:191], a[244:247], a[52:55], v[188:191]
s_mov_b32 s10, 393216
ds_read_b64_tr_b16 a[206:207], v10 offset:27648
v_mfma_f32_16x16x32_bf16 v[212:215], a[240:243], a[40:43], v[212:215]
s_mov_b64 s[12:13], s[22:23]
v_accvgpr_read_b32 v44, a184
v_mfma_f32_16x16x32_bf16 v[212:215], a[244:247], a[56:59], v[212:215]
s_waitcnt lgkmcnt(8)
ds_read_b64_tr_b16 a[208:209], v11 offset:9216
v_mfma_f32_16x16x32_bf16 v[236:239], a[240:243], a[44:47], v[236:239]
s_mov_b32 s14, 393216
v_accvgpr_read_b32 v45, a185
v_mfma_f32_16x16x32_bf16 v[236:239], a[244:247], a[60:63], v[236:239]
s_add_u32 m0, s41, 131072
ds_read_b64_tr_b16 a[210:211], v11 offset:15360
v_mfma_f32_16x16x32_bf16 v[68:71], a[248:251], a[32:35], v[68:71]
ds_read_b64_tr_b16 a[212:213], v11 offset:21504
v_accvgpr_read_b32 v46, a186
v_mfma_f32_16x16x32_bf16 v[68:71], a[252:255], a[48:51], v[68:71]
s_mov_b32 s46, 1152
v_accvgpr_read_b32 v47, a187
v_mfma_f32_16x16x32_bf16 v[92:95], a[248:251], a[36:39], v[92:95]
buffer_load_dwordx4 v21, s[4:7], s46 offen offset:0 lds
v_mfma_f32_16x16x32_bf16 v[92:95], a[252:255], a[52:55], v[92:95]
v_mfma_f32_16x16x32_bf16 v[116:119], a[248:251], a[40:43], v[116:119]
ds_read_b64_tr_b16 a[214:215], v11 offset:27648
v_mul_f32 v44, v44, v52
v_mfma_f32_16x16x32_bf16 v[116:119], a[252:255], a[56:59], v[116:119]
s_waitcnt lgkmcnt(8)
ds_read_b64_tr_b16 a[216:217], v12 offset:9216
v_mfma_f32_16x16x32_bf16 v[140:143], a[248:251], a[44:47], v[140:143]
s_mov_b32 s46, 10368
v_mul_f32 v45, v45, v52
v_mfma_f32_16x16x32_bf16 v[140:143], a[252:255], a[60:63], v[140:143]
buffer_load_dwordx4 v21, s[4:7], s46 offen offset:1024 lds
v_mfma_f32_16x16x32_bf16 v[168:171], a[192:195], a[32:35], v[168:171]
ds_read_b64_tr_b16 a[218:219], v12 offset:15360
v_mul_f32 v46, v46, v52
v_mfma_f32_16x16x32_bf16 v[168:171], a[196:199], a[48:51], v[168:171]
v_mfma_f32_16x16x32_bf16 v[192:195], a[192:195], a[36:39], v[192:195]
ds_read_b64_tr_b16 a[220:221], v12 offset:21504
v_mul_f32 v47, v47, v52
v_mfma_f32_16x16x32_bf16 v[192:195], a[196:199], a[52:55], v[192:195]
s_mov_b32 s46, 19584
ds_read_b64_tr_b16 a[222:223], v12 offset:27648
v_mfma_f32_16x16x32_bf16 v[216:219], a[192:195], a[40:43], v[216:219]
buffer_load_dwordx4 v21, s[4:7], s46 offen offset:2048 lds
v_mfma_f32_16x16x32_bf16 v[216:219], a[196:199], a[56:59], v[216:219]
v_cvt_pk_bf16_f32 v42, v44, v45
s_waitcnt lgkmcnt(8)
v_mfma_f32_16x16x32_bf16 v[240:243], a[192:195], a[44:47], v[240:243]
ds_read_b64_tr_b16 a[224:225], v9 offset:10240
v_cvt_pk_bf16_f32 v43, v46, v47
v_mfma_f32_16x16x32_bf16 v[240:243], a[196:199], a[60:63], v[240:243]
v_mfma_f32_16x16x32_bf16 v[72:75], a[200:203], a[32:35], v[72:75]
ds_read_b64_tr_b16 a[226:227], v9 offset:16384
s_mov_b32 s46, 28800
v_mfma_f32_16x16x32_bf16 v[72:75], a[204:207], a[48:51], v[72:75]
buffer_load_dwordx4 v21, s[4:7], s46 offen offset:3072 lds
v_mfma_f32_16x16x32_bf16 v[96:99], a[200:203], a[36:39], v[96:99]
ds_read_b64_tr_b16 a[228:229], v9 offset:22528
v_accvgpr_read_b32 v56, a172
v_mfma_f32_16x16x32_bf16 v[96:99], a[204:207], a[52:55], v[96:99]
ds_read_b64_tr_b16 a[230:231], v9 offset:28672
v_accvgpr_read_b32 v57, a173
v_mfma_f32_16x16x32_bf16 v[120:123], a[200:203], a[40:43], v[120:123]
ds_read_b64_tr_b16 a[232:233], v10 offset:10240
v_accvgpr_read_b32 v58, a174
v_mfma_f32_16x16x32_bf16 v[120:123], a[204:207], a[56:59], v[120:123]
s_add_u32 m0, s41, 135168
s_waitcnt lgkmcnt(9)
v_mfma_f32_16x16x32_bf16 v[144:147], a[200:203], a[44:47], v[144:147]
s_waitcnt vmcnt(16)
v_accvgpr_read_b32 v59, a175
v_mfma_f32_16x16x32_bf16 v[144:147], a[204:207], a[60:63], v[144:147]
ds_read_b128 a[0:3], v13 offset:0
s_mov_b32 s46, 42112
v_mfma_f32_16x16x32_bf16 v[172:175], a[208:211], a[32:35], v[172:175]
buffer_load_dwordx4 v21, s[4:7], s46 offen offset:0 lds
v_mfma_f32_16x16x32_bf16 v[172:175], a[212:215], a[48:51], v[172:175]
ds_read_b64_tr_b16 a[234:235], v10 offset:16384
v_mul_f32 v56, v56, v54
v_mfma_f32_16x16x32_bf16 v[196:199], a[208:211], a[36:39], v[196:199]
ds_read_b128 a[16:19], v14 offset:0
v_mul_f32 v57, v57, v54
v_mfma_f32_16x16x32_bf16 v[196:199], a[212:215], a[52:55], v[196:199]
ds_read_b64_tr_b16 a[236:237], v10 offset:22528
s_mov_b32 s46, 51328
v_mfma_f32_16x16x32_bf16 v[220:223], a[208:211], a[40:43], v[220:223]
ds_read_b64_tr_b16 a[238:239], v10 offset:28672
v_mul_f32 v58, v58, v54
v_mfma_f32_16x16x32_bf16 v[220:223], a[212:215], a[56:59], v[220:223]
ds_read_b128 a[4:7], v13 offset:2048
s_waitcnt lgkmcnt(11)
v_mfma_f32_16x16x32_bf16 v[244:247], a[208:211], a[44:47], v[244:247]
buffer_load_dwordx4 v21, s[4:7], s46 offen offset:1024 lds
v_mfma_f32_16x16x32_bf16 v[244:247], a[212:215], a[60:63], v[244:247]
ds_read_b64_tr_b16 a[240:241], v11 offset:10240
v_mul_f32 v59, v59, v54
v_mfma_f32_16x16x32_bf16 v[76:79], a[216:219], a[32:35], v[76:79]
ds_read_b128 a[20:23], v14 offset:2048
v_cvt_pk_bf16_f32 v56, v56, v57
v_mfma_f32_16x16x32_bf16 v[76:79], a[220:223], a[48:51], v[76:79]
ds_read_b64_tr_b16 a[242:243], v11 offset:16384
s_mov_b32 s46, 60544
v_mfma_f32_16x16x32_bf16 v[100:103], a[216:219], a[36:39], v[100:103]
buffer_load_dwordx4 v21, s[4:7], s46 offen offset:2048 lds
v_mfma_f32_16x16x32_bf16 v[100:103], a[220:223], a[52:55], v[100:103]
ds_read_b64_tr_b16 a[244:245], v11 offset:22528
s_waitcnt vmcnt(15)
v_mfma_f32_16x16x32_bf16 v[124:127], a[216:219], a[40:43], v[124:127]
ds_read_b64_tr_b16 a[246:247], v11 offset:28672
v_cvt_pk_bf16_f32 v57, v58, v59
v_mfma_f32_16x16x32_bf16 v[124:127], a[220:223], a[56:59], v[124:127]
ds_read_b128 a[8:11], v13 offset:4096
v_accvgpr_read_b32 v60, a188
v_mfma_f32_16x16x32_bf16 v[148:151], a[216:219], a[44:47], v[148:151]
ds_read_b64_tr_b16 a[248:249], v12 offset:10240
s_waitcnt lgkmcnt(14)
v_mfma_f32_16x16x32_bf16 v[148:151], a[220:223], a[60:63], v[148:151]
ds_read_b64_tr_b16 a[250:251], v12 offset:16384
s_mov_b32 s46, 69760
v_mfma_f32_16x16x32_bf16 v[176:179], a[224:227], a[32:35], v[176:179]
ds_read_b64_tr_b16 a[252:253], v12 offset:22528
v_accvgpr_read_b32 v61, a189
v_mfma_f32_16x16x32_bf16 v[176:179], a[228:231], a[48:51], v[176:179]
buffer_load_dwordx4 v21, s[4:7], s46 offen offset:3072 lds
v_mfma_f32_16x16x32_bf16 v[200:203], a[224:227], a[36:39], v[200:203]
ds_read_b64_tr_b16 a[254:255], v12 offset:28672
v_accvgpr_read_b32 v62, a190
v_mfma_f32_16x16x32_bf16 v[200:203], a[228:231], a[52:55], v[200:203]
ds_read_b128 a[24:27], v14 offset:4096
v_accvgpr_read_b32 v63, a191
v_mfma_f32_16x16x32_bf16 v[224:227], a[224:227], a[40:43], v[224:227]
global_load_dword v30, v[28:29], off
v_mfma_f32_16x16x32_bf16 v[224:227], a[228:231], a[56:59], v[224:227]
ds_read_b128 a[12:15], v13 offset:6144
v_mul_f32 v60, v60, v54
v_mfma_f32_16x16x32_bf16 v[248:251], a[224:227], a[44:47], v[248:251]
ds_read_b128 a[28:31], v14 offset:6144
s_waitcnt lgkmcnt(14)
v_mfma_f32_16x16x32_bf16 v[248:251], a[228:231], a[60:63], v[248:251]
v_mul_f32 v61, v61, v54
v_mul_f32 v62, v62, v54
v_mfma_f32_16x16x32_bf16 v[80:83], a[232:235], a[32:35], v[80:83]
buffer_store_dwordx4 v[40:43], v22, s[16:19], s38 offen offset:2048 sc1
v_mfma_f32_16x16x32_bf16 v[80:83], a[236:239], a[48:51], v[80:83]
v_mfma_f32_16x16x32_bf16 v[104:107], a[232:235], a[36:39], v[104:107]
s_mov_b32 s54, 0
v_mul_f32 v63, v63, v54
v_mfma_f32_16x16x32_bf16 v[104:107], a[236:239], a[52:55], v[104:107]
s_add_u32 m0, s40, 0
v_mfma_f32_16x16x32_bf16 v[128:131], a[232:235], a[40:43], v[128:131]
s_waitcnt vmcnt(26) lgkmcnt(0)
s_barrier
v_mfma_f32_16x16x32_bf16 v[128:131], a[236:239], a[56:59], v[128:131]
ds_read_b64_tr_b16 a[192:193], v5 offset:0
v_mfma_f32_16x16x32_bf16 v[152:155], a[232:235], a[44:47], v[152:155]
buffer_load_dwordx4 v19, s[8:11], s54 offen offset:0 nt lds
v_mfma_f32_16x16x32_bf16 v[152:155], a[236:239], a[60:63], v[152:155]
ds_read_b64_tr_b16 a[194:195], v5 offset:6144
v_mfma_f32_16x16x32_bf16 v[180:183], a[240:243], a[32:35], v[180:183]
ds_read_b64_tr_b16 a[196:197], v5 offset:12288
v_mfma_f32_16x16x32_bf16 v[180:183], a[244:247], a[48:51], v[180:183]
ds_read_b64_tr_b16 a[198:199], v5 offset:18432
v_mfma_f32_16x16x32_bf16 v[204:207], a[240:243], a[36:39], v[204:207]
ds_read_b64_tr_b16 a[200:201], v6 offset:0
v_mfma_f32_16x16x32_bf16 v[204:207], a[244:247], a[52:55], v[204:207]
ds_read_b64_tr_b16 a[202:203], v6 offset:6144
v_mfma_f32_16x16x32_bf16 v[228:231], a[240:243], a[40:43], v[228:231]
buffer_load_dwordx4 v19, s[8:11], s54 offen offset:3072 nt lds
v_mfma_f32_16x16x32_bf16 v[228:231], a[244:247], a[56:59], v[228:231]
ds_read_b64_tr_b16 a[204:205], v6 offset:12288
v_cvt_pk_bf16_f32 v58, v60, v61
v_mfma_f32_16x16x32_bf16 v[252:255], a[240:243], a[44:47], v[252:255]
v_mfma_f32_16x16x32_bf16 v[252:255], a[244:247], a[60:63], v[252:255]
ds_read_b64_tr_b16 a[206:207], v6 offset:18432
v_cvt_pk_bf16_f32 v59, v62, v63
v_mfma_f32_16x16x32_bf16 v[84:87], a[248:251], a[32:35], v[84:87]
buffer_store_dwordx4 v[56:59], v23, s[16:19], s38 offen offset:3072 sc1
v_mfma_f32_16x16x32_bf16 v[84:87], a[252:255], a[48:51], v[84:87]
ds_read_b64_tr_b16 a[208:209], v7 offset:0
v_mfma_f32_16x16x32_bf16 v[108:111], a[248:251], a[36:39], v[108:111]
v_mfma_f32_16x16x32_bf16 v[108:111], a[252:255], a[52:55], v[108:111]
ds_read_b64_tr_b16 a[210:211], v7 offset:6144
v_mfma_f32_16x16x32_bf16 v[132:135], a[248:251], a[40:43], v[132:135]
v_mfma_f32_16x16x32_bf16 v[132:135], a[252:255], a[56:59], v[132:135]
v_mfma_f32_16x16x32_bf16 v[156:159], a[248:251], a[44:47], v[156:159]
s_waitcnt lgkmcnt(6)
v_mfma_f32_16x16x32_bf16 v[156:159], a[252:255], a[60:63], v[156:159]
v_mfma_f32_16x16x32_bf16 v[160:163], a[192:195], a[0:3], v[160:163]
ds_read_b64_tr_b16 a[212:213], v7 offset:12288
v_mfma_f32_16x16x32_bf16 v[160:163], a[196:199], a[16:19], v[160:163]
ds_read_b64_tr_b16 a[214:215], v7 offset:18432
s_add_u32 m0, s40, 896
v_mfma_f32_16x16x32_bf16 v[184:187], a[192:195], a[4:7], v[184:187]
ds_read_b64_tr_b16 a[216:217], v8 offset:0
v_mfma_f32_16x16x32_bf16 v[184:187], a[196:199], a[20:23], v[184:187]
buffer_load_dwordx4 v19, s[8:11], s54 offen offset:128 nt lds
v_mfma_f32_16x16x32_bf16 v[208:211], a[192:195], a[8:11], v[208:211]
ds_read_b64_tr_b16 a[218:219], v8 offset:6144
v_mfma_f32_16x16x32_bf16 v[208:211], a[196:199], a[24:27], v[208:211]
s_waitcnt lgkmcnt(6)
ds_read_b64_tr_b16 a[220:221], v8 offset:12288
v_mfma_f32_16x16x32_bf16 v[232:235], a[192:195], a[12:15], v[232:235]
v_mfma_f32_16x16x32_bf16 v[232:235], a[196:199], a[28:31], v[232:235]
v_mfma_f32_16x16x32_bf16 v[64:67], a[200:203], a[0:3], v[64:67]
ds_read_b64_tr_b16 a[222:223], v8 offset:18432
v_mfma_f32_16x16x32_bf16 v[64:67], a[204:207], a[16:19], v[64:67]
buffer_load_dwordx4 v19, s[8:11], s54 offen offset:3200 nt lds
v_mfma_f32_16x16x32_bf16 v[88:91], a[200:203], a[4:7], v[88:91]
ds_read_b64_tr_b16 a[224:225], v5 offset:1024
s_add_u32 m0, s40, 1792
v_mfma_f32_16x16x32_bf16 v[88:91], a[204:207], a[20:23], v[88:91]
ds_read_b64_tr_b16 a[226:227], v5 offset:7168
v_mfma_f32_16x16x32_bf16 v[112:115], a[200:203], a[8:11], v[112:115]
v_mfma_f32_16x16x32_bf16 v[112:115], a[204:207], a[24:27], v[112:115]
ds_read_b64_tr_b16 a[228:229], v5 offset:13312
s_waitcnt lgkmcnt(7)
v_mfma_f32_16x16x32_bf16 v[136:139], a[200:203], a[12:15], v[136:139]
v_mfma_f32_16x16x32_bf16 v[136:139], a[204:207], a[28:31], v[136:139]
ds_read_b64_tr_b16 a[230:231], v5 offset:19456
v_mfma_f32_16x16x32_bf16 v[164:167], a[208:211], a[0:3], v[164:167]
v_mfma_f32_16x16x32_bf16 v[164:167], a[212:215], a[16:19], v[164:167]
ds_read_b64_tr_b16 a[232:233], v6 offset:1024
v_mfma_f32_16x16x32_bf16 v[188:191], a[208:211], a[4:7], v[188:191]
v_mfma_f32_16x16x32_bf16 v[188:191], a[212:215], a[20:23], v[188:191]
ds_read_b64_tr_b16 a[234:235], v6 offset:7168
v_mfma_f32_16x16x32_bf16 v[212:215], a[208:211], a[8:11], v[212:215]
buffer_load_dwordx4 v19, s[8:11], s54 offen offset:256 nt lds
v_mfma_f32_16x16x32_bf16 v[212:215], a[212:215], a[24:27], v[212:215]
ds_read_b64_tr_b16 a[236:237], v6 offset:13312
s_waitcnt lgkmcnt(7)
v_mfma_f32_16x16x32_bf16 v[236:239], a[208:211], a[12:15], v[236:239]
ds_read_b64_tr_b16 a[238:239], v6 offset:19456
v_mfma_f32_16x16x32_bf16 v[236:239], a[212:215], a[28:31], v[236:239]
v_mfma_f32_16x16x32_bf16 v[68:71], a[216:219], a[0:3], v[68:71]
ds_read_b64_tr_b16 a[240:241], v7 offset:1024
v_mfma_f32_16x16x32_bf16 v[68:71], a[220:223], a[16:19], v[68:71]
v_mfma_f32_16x16x32_bf16 v[92:95], a[216:219], a[4:7], v[92:95]
buffer_load_dwordx4 v19, s[8:11], s54 offen offset:3328 nt lds
v_mfma_f32_16x16x32_bf16 v[92:95], a[220:223], a[20:23], v[92:95]
ds_read_b64_tr_b16 a[242:243], v7 offset:7168
s_mov_b32 s54, 24576
v_mfma_f32_16x16x32_bf16 v[116:119], a[216:219], a[8:11], v[116:119]
ds_read_b64_tr_b16 a[244:245], v7 offset:13312
v_mfma_f32_16x16x32_bf16 v[116:119], a[220:223], a[24:27], v[116:119]
s_waitcnt lgkmcnt(7)
ds_read_b64_tr_b16 a[246:247], v7 offset:19456
v_mfma_f32_16x16x32_bf16 v[140:143], a[216:219], a[12:15], v[140:143]
v_mfma_f32_16x16x32_bf16 v[140:143], a[220:223], a[28:31], v[140:143]
v_mfma_f32_16x16x32_bf16 v[168:171], a[224:227], a[0:3], v[168:171]
ds_read_b64_tr_b16 a[248:249], v8 offset:1024
s_add_u32 m0, s40, 81920
v_mfma_f32_16x16x32_bf16 v[168:171], a[228:231], a[16:19], v[168:171]
ds_read_b64_tr_b16 a[250:251], v8 offset:7168
v_mfma_f32_16x16x32_bf16 v[192:195], a[224:227], a[4:7], v[192:195]
v_mfma_f32_16x16x32_bf16 v[192:195], a[228:231], a[20:23], v[192:195]
ds_read_b64_tr_b16 a[252:253], v8 offset:13312
v_mfma_f32_16x16x32_bf16 v[216:219], a[224:227], a[8:11], v[216:219]
v_mfma_f32_16x16x32_bf16 v[216:219], a[228:231], a[24:27], v[216:219]
ds_read_b64_tr_b16 a[254:255], v8 offset:19456
s_waitcnt lgkmcnt(8)
v_mfma_f32_16x16x32_bf16 v[240:243], a[224:227], a[12:15], v[240:243]
v_mfma_f32_16x16x32_bf16 v[240:243], a[228:231], a[28:31], v[240:243]
buffer_load_dwordx4 v19, s[8:11], s54 offen offset:0 nt lds
v_mfma_f32_16x16x32_bf16 v[72:75], a[232:235], a[0:3], v[72:75]
ds_read_b64_tr_b16 a[192:193], v5 offset:2048
v_mfma_f32_16x16x32_bf16 v[72:75], a[236:239], a[16:19], v[72:75]
ds_read_b64_tr_b16 a[194:195], v5 offset:8192
v_mfma_f32_16x16x32_bf16 v[96:99], a[232:235], a[4:7], v[96:99]
v_mfma_f32_16x16x32_bf16 v[96:99], a[236:239], a[20:23], v[96:99]
ds_read_b64_tr_b16 a[196:197], v5 offset:14336
v_mfma_f32_16x16x32_bf16 v[120:123], a[232:235], a[8:11], v[120:123]
v_mfma_f32_16x16x32_bf16 v[120:123], a[236:239], a[24:27], v[120:123]
ds_read_b64_tr_b16 a[198:199], v5 offset:20480
s_waitcnt lgkmcnt(8)
v_mfma_f32_16x16x32_bf16 v[144:147], a[232:235], a[12:15], v[144:147]
buffer_load_dwordx4 v19, s[8:11], s54 offen offset:3072 nt lds
v_mfma_f32_16x16x32_bf16 v[144:147], a[236:239], a[28:31], v[144:147]
ds_read_b64_tr_b16 a[200:201], v6 offset:2048
s_waitcnt vmcnt(15)
v_mfma_f32_16x16x32_bf16 v[172:175], a[240:243], a[0:3], v[172:175]
ds_read_b128 a[32:35], v15 offset:0
s_add_u32 m0, s40, 82816
v_mfma_f32_16x16x32_bf16 v[172:175], a[244:247], a[16:19], v[172:175]
ds_read_b64_tr_b16 a[202:203], v6 offset:8192
v_mfma_f32_16x16x32_bf16 v[196:199], a[240:243], a[4:7], v[196:199]
ds_read_b128 a[48:51], v16 offset:0
v_mfma_f32_16x16x32_bf16 v[196:199], a[244:247], a[20:23], v[196:199]
ds_read_b64_tr_b16 a[204:205], v6 offset:14336
v_mfma_f32_16x16x32_bf16 v[220:223], a[240:243], a[8:11], v[220:223]
ds_read_b64_tr_b16 a[206:207], v6 offset:20480
v_mfma_f32_16x16x32_bf16 v[220:223], a[244:247], a[24:27], v[220:223]
ds_read_b128 a[36:39], v15 offset:2048
s_waitcnt lgkmcnt(11)
v_mfma_f32_16x16x32_bf16 v[244:247], a[240:243], a[12:15], v[244:247]
ds_read_b64_tr_b16 a[208:209], v7 offset:2048
v_mfma_f32_16x16x32_bf16 v[244:247], a[244:247], a[28:31], v[244:247]
ds_read_b128 a[52:55], v16 offset:2048
s_waitcnt vmcnt(11)
v_mfma_f32_16x16x32_bf16 v[76:79], a[248:251], a[0:3], v[76:79]
buffer_load_dwordx4 v19, s[8:11], s54 offen offset:128 nt lds
v_mfma_f32_16x16x32_bf16 v[76:79], a[252:255], a[16:19], v[76:79]
ds_read_b64_tr_b16 a[210:211], v7 offset:8192
v_mfma_f32_16x16x32_bf16 v[100:103], a[248:251], a[4:7], v[100:103]
ds_read_b64_tr_b16 a[212:213], v7 offset:14336
v_mfma_f32_16x16x32_bf16 v[100:103], a[252:255], a[20:23], v[100:103]
ds_read_b64_tr_b16 a[214:215], v7 offset:20480
v_mfma_f32_16x16x32_bf16 v[124:127], a[248:251], a[8:11], v[124:127]
ds_read_b128 a[40:43], v15 offset:4096
v_mfma_f32_16x16x32_bf16 v[124:127], a[252:255], a[24:27], v[124:127]
ds_read_b64_tr_b16 a[216:217], v8 offset:2048
s_waitcnt lgkmcnt(14)
v_mfma_f32_16x16x32_bf16 v[148:151], a[248:251], a[12:15], v[148:151]
buffer_load_dwordx4 v19, s[8:11], s54 offen offset:3200 nt lds
v_mfma_f32_16x16x32_bf16 v[148:151], a[252:255], a[28:31], v[148:151]
ds_read_b128 a[56:59], v16 offset:4096
v_mfma_f32_16x16x32_bf16 v[176:179], a[192:195], a[0:3], v[176:179]
ds_read_b64_tr_b16 a[218:219], v8 offset:8192
v_mfma_f32_16x16x32_bf16 v[176:179], a[196:199], a[16:19], v[176:179]
ds_read_b128 a[44:47], v15 offset:6144
v_mfma_f32_16x16x32_bf16 v[200:203], a[192:195], a[4:7], v[200:203]
ds_read_b64_tr_b16 a[220:221], v8 offset:14336
v_mfma_f32_16x16x32_bf16 v[200:203], a[196:199], a[20:23], v[200:203]
ds_read_b64_tr_b16 a[222:223], v8 offset:20480
v_mfma_f32_16x16x32_bf16 v[224:227], a[192:195], a[8:11], v[224:227]
ds_read_b128 a[60:63], v16 offset:6144
v_mfma_f32_16x16x32_bf16 v[224:227], a[196:199], a[24:27], v[224:227]
s_waitcnt lgkmcnt(14)
v_mfma_f32_16x16x32_bf16 v[248:251], a[192:195], a[12:15], v[248:251]
v_mfma_f32_16x16x32_bf16 v[248:251], a[196:199], a[28:31], v[248:251]
v_mfma_f32_16x16x32_bf16 v[80:83], a[200:203], a[0:3], v[80:83]
v_mfma_f32_16x16x32_bf16 v[80:83], a[204:207], a[16:19], v[80:83]
v_mfma_f32_16x16x32_bf16 v[104:107], a[200:203], a[4:7], v[104:107]
v_mfma_f32_16x16x32_bf16 v[104:107], a[204:207], a[20:23], v[104:107]
s_add_u32 m0, s40, 83712
v_mfma_f32_16x16x32_bf16 v[128:131], a[200:203], a[8:11], v[128:131]
s_waitcnt vmcnt(21) lgkmcnt(0)
s_barrier
v_mfma_f32_16x16x32_bf16 v[128:131], a[204:207], a[24:27], v[128:131]
ds_read_b64_tr_b16 a[224:225], v5 offset:24576
v_mfma_f32_16x16x32_bf16 v[152:155], a[200:203], a[12:15], v[152:155]
buffer_load_dwordx4 v19, s[8:11], s54 offen offset:256 nt lds
v_mfma_f32_16x16x32_bf16 v[152:155], a[204:207], a[28:31], v[152:155]
ds_read_b64_tr_b16 a[226:227], v5 offset:30720
v_mfma_f32_16x16x32_bf16 v[180:183], a[208:211], a[0:3], v[180:183]
ds_read_b64_tr_b16 a[228:229], v5 offset:36864
v_mfma_f32_16x16x32_bf16 v[180:183], a[212:215], a[16:19], v[180:183]
ds_read_b64_tr_b16 a[230:231], v5 offset:43008
v_mfma_f32_16x16x32_bf16 v[204:207], a[208:211], a[4:7], v[204:207]
v_mfma_f32_16x16x32_bf16 v[204:207], a[212:215], a[20:23], v[204:207]
ds_read_b64_tr_b16 a[232:233], v6 offset:24576
v_mfma_f32_16x16x32_bf16 v[228:231], a[208:211], a[8:11], v[228:231]
ds_read_b64_tr_b16 a[234:235], v6 offset:30720
v_mfma_f32_16x16x32_bf16 v[228:231], a[212:215], a[24:27], v[228:231]
buffer_load_dwordx4 v19, s[8:11], s54 offen offset:3328 nt lds
v_mfma_f32_16x16x32_bf16 v[252:255], a[208:211], a[12:15], v[252:255]
ds_read_b64_tr_b16 a[236:237], v6 offset:36864
s_mov_b32 s83, 0xff800000
v_mfma_f32_16x16x32_bf16 v[252:255], a[212:215], a[28:31], v[252:255]
v_mfma_f32_16x16x32_bf16 v[84:87], a[216:219], a[0:3], v[84:87]
ds_read_b64_tr_b16 a[238:239], v6 offset:43008
s_cmp_eq_u32 s52, 3
v_mfma_f32_16x16x32_bf16 v[84:87], a[220:223], a[16:19], v[84:87]
s_cselect_b32 s82, 0x71000000, s83
v_mov_b32 v40, s83
v_mfma_f32_16x16x32_bf16 v[108:111], a[216:219], a[4:7], v[108:111]
ds_read_b64_tr_b16 a[240:241], v7 offset:24576
v_mov_b32 v41, s83
v_mfma_f32_16x16x32_bf16 v[108:111], a[220:223], a[20:23], v[108:111]
v_mov_b32 v42, s83
v_mov_b32 v43, s82
v_mfma_f32_16x16x32_bf16 v[132:135], a[216:219], a[8:11], v[132:135]
ds_read_b64_tr_b16 a[242:243], v7 offset:30720
v_mfma_f32_16x16x32_bf16 v[132:135], a[220:223], a[24:27], v[132:135]
v_mfma_f32_16x16x32_bf16 v[156:159], a[216:219], a[12:15], v[156:159]
s_waitcnt lgkmcnt(6)
v_mfma_f32_16x16x32_bf16 v[156:159], a[220:223], a[28:31], v[156:159]
v_mfma_f32_16x16x32_bf16 v[160:163], a[224:227], a[32:35], v[160:163]
ds_read_b64_tr_b16 a[244:245], v7 offset:36864
v_mfma_f32_16x16x32_bf16 v[160:163], a[228:231], a[48:51], v[160:163]
ds_read_b64_tr_b16 a[246:247], v7 offset:43008
s_mov_b32 s54, 0
v_mfma_f32_16x16x32_bf16 v[184:187], a[224:227], a[36:39], v[184:187]
ds_read_b64_tr_b16 a[248:249], v8 offset:24576
s_add_u32 m0, s40, 106496
v_mfma_f32_16x16x32_bf16 v[184:187], a[228:231], a[52:55], v[184:187]
ds_read_b64_tr_b16 a[250:251], v8 offset:30720
v_mfma_f32_16x16x32_bf16 v[208:211], a[224:227], a[40:43], v[208:211]
v_mfma_f32_16x16x32_bf16 v[208:211], a[228:231], a[56:59], v[208:211]
ds_read_b64_tr_b16 a[252:253], v8 offset:36864
s_waitcnt lgkmcnt(7)
v_mfma_f32_16x16x32_bf16 v[232:235], a[224:227], a[44:47], v[232:235]
v_mfma_f32_16x16x32_bf16 v[232:235], a[228:231], a[60:63], v[232:235]
ds_read_b64_tr_b16 a[254:255], v8 offset:43008
v_mfma_f32_16x16x32_bf16 v[64:67], a[232:235], a[32:35], v[64:67]
v_mfma_f32_16x16x32_bf16 v[64:67], a[236:239], a[48:51], v[64:67]
ds_read_b64_tr_b16 a[192:193], v5 offset:25600
v_mfma_f32_16x16x32_bf16 v[88:91], a[232:235], a[36:39], v[88:91]
ds_read_b64_tr_b16 a[194:195], v5 offset:31744
v_mfma_f32_16x16x32_bf16 v[88:91], a[236:239], a[52:55], v[88:91]
buffer_load_dwordx4 v19, s[12:15], s54 offen offset:0 nt lds
v_mfma_f32_16x16x32_bf16 v[112:115], a[232:235], a[40:43], v[112:115]
ds_read_b64_tr_b16 a[196:197], v5 offset:37888
v_mfma_f32_16x16x32_bf16 v[112:115], a[236:239], a[56:59], v[112:115]
s_waitcnt lgkmcnt(7)
ds_read_b64_tr_b16 a[198:199], v5 offset:44032
v_mfma_f32_16x16x32_bf16 v[136:139], a[232:235], a[44:47], v[136:139]
v_mfma_f32_16x16x32_bf16 v[136:139], a[236:239], a[60:63], v[136:139]
v_mfma_f32_16x16x32_bf16 v[164:167], a[240:243], a[32:35], v[164:167]
ds_read_b64_tr_b16 a[200:201], v6 offset:25600
v_mfma_f32_16x16x32_bf16 v[164:167], a[244:247], a[48:51], v[164:167]
v_mul_f32 v160, s50, v160
v_mul_f32 v161, s50, v161
v_mfma_f32_16x16x32_bf16 v[188:191], a[240:243], a[36:39], v[188:191]
ds_read_b64_tr_b16 a[202:203], v6 offset:31744
v_mul_f32 v162, s50, v162
v_mfma_f32_16x16x32_bf16 v[188:191], a[244:247], a[52:55], v[188:191]
ds_read_b64_tr_b16 a[204:205], v6 offset:37888
v_mul_f32 v163, s50, v163
v_mfma_f32_16x16x32_bf16 v[212:215], a[240:243], a[40:43], v[212:215]
v_mul_f32 v64, s50, v64
v_mul_f32 v65, s50, v65
v_mfma_f32_16x16x32_bf16 v[212:215], a[244:247], a[56:59], v[212:215]
ds_read_b64_tr_b16 a[206:207], v6 offset:44032
v_mul_f32 v66, s50, v66
v_mfma_f32_16x16x32_bf16 v[236:239], a[240:243], a[44:47], v[236:239]
s_waitcnt lgkmcnt(8)
v_mul_f32 v67, s50, v67
v_mfma_f32_16x16x32_bf16 v[236:239], a[244:247], a[60:63], v[236:239]
ds_read_b64_tr_b16 a[208:209], v7 offset:25600
v_cvt_pk_bf16_f32 v160, v160, v161
v_mfma_f32_16x16x32_bf16 v[68:71], a[248:251], a[32:35], v[68:71]
buffer_load_dwordx4 v19, s[12:15], s54 offen offset:3072 nt lds
v_mfma_f32_16x16x32_bf16 v[68:71], a[252:255], a[48:51], v[68:71]
ds_read_b64_tr_b16 a[210:211], v7 offset:31744
v_cvt_pk_bf16_f32 v161, v162, v163
v_mfma_f32_16x16x32_bf16 v[92:95], a[248:251], a[36:39], v[92:95]
v_cvt_pk_bf16_f32 v162, v64, v65
v_cvt_pk_bf16_f32 v163, v66, v67
v_mfma_f32_16x16x32_bf16 v[92:95], a[252:255], a[52:55], v[92:95]
ds_read_b64_tr_b16 a[212:213], v7 offset:37888
v_mul_f32 v184, s50, v184
v_mfma_f32_16x16x32_bf16 v[116:119], a[248:251], a[40:43], v[116:119]
v_mul_f32 v185, s50, v185
v_permlane16_swap_b32 v160, v162
v_mfma_f32_16x16x32_bf16 v[116:119], a[252:255], a[56:59], v[116:119]
ds_read_b64_tr_b16 a[214:215], v7 offset:44032
v_permlane16_swap_b32 v161, v163
v_mfma_f32_16x16x32_bf16 v[140:143], a[248:251], a[44:47], v[140:143]
v_mul_f32 v186, s50, v186
s_waitcnt lgkmcnt(8)
v_mfma_f32_16x16x32_bf16 v[140:143], a[252:255], a[60:63], v[140:143]
ds_read_b64_tr_b16 a[216:217], v8 offset:25600
v_mul_f32 v187, s50, v187
v_mfma_f32_16x16x32_bf16 v[168:171], a[192:195], a[32:35], v[168:171]
ds_read_b64_tr_b16 a[218:219], v8 offset:31744
v_mul_f32 v88, s50, v88
v_mfma_f32_16x16x32_bf16 v[168:171], a[196:199], a[48:51], v[168:171]
v_mul_f32 v89, s50, v89
v_mul_f32 v90, s50, v90
v_mfma_f32_16x16x32_bf16 v[192:195], a[192:195], a[36:39], v[192:195]
ds_read_b64_tr_b16 a[220:221], v8 offset:37888
v_mul_f32 v91, s50, v91
v_mfma_f32_16x16x32_bf16 v[192:195], a[196:199], a[52:55], v[192:195]
v_cvt_pk_bf16_f32 v184, v184, v185
v_cvt_pk_bf16_f32 v185, v186, v187
v_mfma_f32_16x16x32_bf16 v[216:219], a[192:195], a[40:43], v[216:219]
ds_read_b64_tr_b16 a[222:223], v8 offset:44032
v_cvt_pk_bf16_f32 v186, v88, v89
v_mfma_f32_16x16x32_bf16 v[216:219], a[196:199], a[56:59], v[216:219]
v_cvt_pk_bf16_f32 v187, v90, v91
v_mul_f32 v208, s50, v208
v_mfma_f32_16x16x32_bf16 v[240:243], a[192:195], a[44:47], v[240:243]
ds_read_b64_tr_b16 a[224:225], v5 offset:26624
s_waitcnt lgkmcnt(9)
v_mfma_f32_16x16x32_bf16 v[240:243], a[196:199], a[60:63], v[240:243]
v_mul_f32 v209, s50, v209
v_permlane16_swap_b32 v184, v186
v_mfma_f32_16x16x32_bf16 v[72:75], a[200:203], a[32:35], v[72:75]
ds_read_b64_tr_b16 a[226:227], v5 offset:32768
v_permlane16_swap_b32 v185, v187
v_mfma_f32_16x16x32_bf16 v[72:75], a[204:207], a[48:51], v[72:75]
v_mul_f32 v210, s50, v210
v_mul_f32 v211, s50, v211
v_mfma_f32_16x16x32_bf16 v[96:99], a[200:203], a[36:39], v[96:99]
ds_read_b64_tr_b16 a[228:229], v5 offset:38912
s_add_u32 m0, s40, 107392
v_mfma_f32_16x16x32_bf16 v[96:99], a[204:207], a[52:55], v[96:99]
buffer_load_dwordx4 v19, s[12:15], s54 offen offset:128 nt lds
v_mfma_f32_16x16x32_bf16 v[120:123], a[200:203], a[40:43], v[120:123]
ds_read_b64_tr_b16 a[230:231], v5 offset:45056
v_mul_f32 v112, s50, v112
v_mfma_f32_16x16x32_bf16 v[120:123], a[204:207], a[56:59], v[120:123]
ds_read_b64_tr_b16 a[232:233], v6 offset:26624
v_mul_f32 v113, s50, v113
v_mfma_f32_16x16x32_bf16 v[144:147], a[200:203], a[44:47], v[144:147]
v_mul_f32 v114, s50, v114
s_waitcnt lgkmcnt(9)
v_mfma_f32_16x16x32_bf16 v[144:147], a[204:207], a[60:63], v[144:147]
ds_read_b64_tr_b16 a[234:235], v6 offset:32768
v_mul_f32 v115, s50, v115
v_mfma_f32_16x16x32_bf16 v[172:175], a[208:211], a[32:35], v[172:175]
v_cvt_pk_bf16_f32 v208, v208, v209
v_cvt_pk_bf16_f32 v209, v210, v211
v_mfma_f32_16x16x32_bf16 v[172:175], a[212:215], a[48:51], v[172:175]
ds_read_b64_tr_b16 a[236:237], v6 offset:38912
v_cvt_pk_bf16_f32 v210, v112, v113
v_mfma_f32_16x16x32_bf16 v[196:199], a[208:211], a[36:39], v[196:199]
v_cvt_pk_bf16_f32 v211, v114, v115
v_mul_f32 v232, s50, v232
v_mfma_f32_16x16x32_bf16 v[196:199], a[212:215], a[52:55], v[196:199]
ds_read_b64_tr_b16 a[238:239], v6 offset:45056
v_mul_f32 v233, s50, v233
v_mfma_f32_16x16x32_bf16 v[220:223], a[208:211], a[40:43], v[220:223]
v_permlane16_swap_b32 v208, v210
v_permlane16_swap_b32 v209, v211
v_mfma_f32_16x16x32_bf16 v[220:223], a[212:215], a[56:59], v[220:223]
ds_read_b64_tr_b16 a[240:241], v7 offset:26624
v_mul_f32 v234, s50, v234
v_mfma_f32_16x16x32_bf16 v[244:247], a[208:211], a[44:47], v[244:247]
v_mul_f32 v235, s50, v235
s_waitcnt lgkmcnt(9)
v_mfma_f32_16x16x32_bf16 v[244:247], a[212:215], a[60:63], v[244:247]
ds_read_b64_tr_b16 a[242:243], v7 offset:32768
v_mul_f32 v136, s50, v136
v_mfma_f32_16x16x32_bf16 v[76:79], a[216:219], a[32:35], v[76:79]
buffer_load_dwordx4 v19, s[12:15], s54 offen offset:3200 nt lds
v_mfma_f32_16x16x32_bf16 v[76:79], a[220:223], a[48:51], v[76:79]
ds_read_b64_tr_b16 a[244:245], v7 offset:38912
v_mul_f32 v137, s50, v137
v_mfma_f32_16x16x32_bf16 v[100:103], a[216:219], a[36:39], v[100:103]
ds_read_b64_tr_b16 a[246:247], v7 offset:45056
v_mul_f32 v138, s50, v138
v_mfma_f32_16x16x32_bf16 v[100:103], a[220:223], a[52:55], v[100:103]
ds_read_b64_tr_b16 a[248:249], v8 offset:26624
v_mul_f32 v139, s50, v139
v_mfma_f32_16x16x32_bf16 v[124:127], a[216:219], a[40:43], v[124:127]
ds_read_b64_tr_b16 a[250:251], v8 offset:32768
v_cvt_pk_bf16_f32 v232, v232, v233
v_mfma_f32_16x16x32_bf16 v[124:127], a[220:223], a[56:59], v[124:127]
v_cvt_pk_bf16_f32 v233, v234, v235
v_cvt_pk_bf16_f32 v234, v136, v137
v_mfma_f32_16x16x32_bf16 v[148:151], a[216:219], a[44:47], v[148:151]
ds_read_b64_tr_b16 a[252:253], v8 offset:38912
s_waitcnt lgkmcnt(11)
v_mfma_f32_16x16x32_bf16 v[148:151], a[220:223], a[60:63], v[148:151]
v_cvt_pk_bf16_f32 v235, v138, v139
v_mul_f32 v164, s50, v164
v_mfma_f32_16x16x32_bf16 v[176:179], a[224:227], a[32:35], v[176:179]
ds_read_b64_tr_b16 a[254:255], v8 offset:45056
v_mul_f32 v165, s50, v165
v_mfma_f32_16x16x32_bf16 v[176:179], a[228:231], a[48:51], v[176:179]
v_permlane16_swap_b32 v232, v234
v_permlane16_swap_b32 v233, v235
v_mfma_f32_16x16x32_bf16 v[200:203], a[224:227], a[36:39], v[200:203]
v_mul_f32 v166, s50, v166
v_mul_f32 v167, s50, v167
v_mfma_f32_16x16x32_bf16 v[200:203], a[228:231], a[52:55], v[200:203]
v_mul_f32 v68, s50, v68
v_mul_f32 v69, s50, v69
v_mfma_f32_16x16x32_bf16 v[224:227], a[224:227], a[40:43], v[224:227]
v_mul_f32 v70, s50, v70
v_mul_f32 v71, s50, v71
v_mfma_f32_16x16x32_bf16 v[224:227], a[228:231], a[56:59], v[224:227]
v_cvt_pk_bf16_f32 v164, v164, v165
v_cvt_pk_bf16_f32 v165, v166, v167
v_mfma_f32_16x16x32_bf16 v[248:251], a[224:227], a[44:47], v[248:251]
v_cvt_pk_bf16_f32 v166, v68, v69
s_waitcnt lgkmcnt(8)
v_mfma_f32_16x16x32_bf16 v[248:251], a[228:231], a[60:63], v[248:251]
v_cvt_pk_bf16_f32 v167, v70, v71
v_mul_f32 v188, s50, v188
v_mfma_f32_16x16x32_bf16 v[80:83], a[232:235], a[32:35], v[80:83]
v_mul_f32 v189, s50, v189
v_mul_f32 v190, s50, v190
v_mfma_f32_16x16x32_bf16 v[80:83], a[236:239], a[48:51], v[80:83]
v_permlane16_swap_b32 v164, v166
v_permlane16_swap_b32 v165, v167
v_mfma_f32_16x16x32_bf16 v[104:107], a[232:235], a[36:39], v[104:107]
v_mul_f32 v191, s50, v191
v_mul_f32 v92, s50, v92
v_mfma_f32_16x16x32_bf16 v[104:107], a[236:239], a[52:55], v[104:107]
v_mul_f32 v93, s50, v93
v_mul_f32 v94, s50, v94
v_mfma_f32_16x16x32_bf16 v[128:131], a[232:235], a[40:43], v[128:131]
s_waitcnt vmcnt(10) lgkmcnt(0)
s_barrier
v_mfma_f32_16x16x32_bf16 v[128:131], a[236:239], a[56:59], v[128:131]
ds_read_b128 a[192:195], v1 offset:0
s_add_u32 m0, s40, 108288
v_mfma_f32_16x16x32_bf16 v[152:155], a[232:235], a[44:47], v[152:155]
buffer_load_dwordx4 v19, s[12:15], s54 offen offset:256 nt lds
v_mfma_f32_16x16x32_bf16 v[152:155], a[236:239], a[60:63], v[152:155]
ds_read_b128 a[196:199], v2 offset:0
v_mfma_f32_16x16x32_bf16 v[180:183], a[240:243], a[32:35], v[180:183]
ds_read_b128 a[200:203], v1 offset:1024
v_mfma_f32_16x16x32_bf16 v[180:183], a[244:247], a[48:51], v[180:183]
ds_read_b128 a[204:207], v2 offset:1024
v_mfma_f32_16x16x32_bf16 v[204:207], a[240:243], a[36:39], v[204:207]
ds_read_b128 a[208:211], v1 offset:2048
v_mfma_f32_16x16x32_bf16 v[204:207], a[244:247], a[52:55], v[204:207]
ds_read_b128 a[212:215], v2 offset:2048
v_mfma_f32_16x16x32_bf16 v[228:231], a[240:243], a[40:43], v[228:231]
buffer_load_dwordx4 v19, s[12:15], s54 offen offset:3328 nt lds
v_mfma_f32_16x16x32_bf16 v[228:231], a[244:247], a[56:59], v[228:231]
v_mul_f32 v95, s50, v95
v_cvt_pk_bf16_f32 v188, v188, v189
v_mfma_f32_16x16x32_bf16 v[252:255], a[240:243], a[44:47], v[252:255]
v_cvt_pk_bf16_f32 v189, v190, v191
v_cvt_pk_bf16_f32 v190, v92, v93
v_mfma_f32_16x16x32_bf16 v[252:255], a[244:247], a[60:63], v[252:255]
v_cvt_pk_bf16_f32 v191, v94, v95
v_mul_f32 v212, s50, v212
v_mfma_f32_16x16x32_bf16 v[84:87], a[248:251], a[32:35], v[84:87]
v_mul_f32 v213, s50, v213
v_mul_f32 v214, s50, v214
v_mfma_f32_16x16x32_bf16 v[84:87], a[252:255], a[48:51], v[84:87]
v_permlane16_swap_b32 v188, v190
v_permlane16_swap_b32 v189, v191
v_mfma_f32_16x16x32_bf16 v[108:111], a[248:251], a[36:39], v[108:111]
v_mul_f32 v215, s50, v215
v_mul_f32 v116, s50, v116
v_mfma_f32_16x16x32_bf16 v[108:111], a[252:255], a[52:55], v[108:111]
v_mul_f32 v117, s50, v117
v_mul_f32 v118, s50, v118
v_mul_f32 v119, s50, v119
v_cvt_pk_bf16_f32 v212, v212, v213
v_cvt_pk_bf16_f32 v213, v214, v215
v_cvt_pk_bf16_f32 v214, v116, v117
v_cvt_pk_bf16_f32 v215, v118, v119
v_mfma_f32_16x16x32_bf16 v[132:135], a[248:251], a[40:43], v[132:135]
v_mfma_f32_16x16x32_bf16 v[132:135], a[252:255], a[56:59], v[132:135]
v_permlane16_swap_b32 v212, v214
v_permlane16_swap_b32 v213, v215
v_mfma_f32_16x16x32_bf16 v[156:159], a[248:251], a[44:47], v[156:159]
s_waitcnt lgkmcnt(0)
v_mfma_f32_16x16x32_bf16 v[156:159], a[252:255], a[60:63], v[156:159]
.p2align 3
v_pk_mul_f32 v[236:237], v[236:237], s[50:51]
v_pk_mul_f32 v[238:239], v[238:239], s[50:51]
v_pk_mul_f32 v[140:141], v[140:141], s[50:51]
v_pk_mul_f32 v[142:143], v[142:143], s[50:51]
v_cvt_pk_bf16_f32 v236, v236, v237
v_cvt_pk_bf16_f32 v237, v238, v239
v_cvt_pk_bf16_f32 v238, v140, v141
v_cvt_pk_bf16_f32 v239, v142, v143
v_pk_mul_f32 v[168:169], v[168:169], s[50:51]
v_pk_mul_f32 v[170:171], v[170:171], s[50:51]
v_pk_mul_f32 v[72:73], v[72:73], s[50:51]
v_pk_mul_f32 v[74:75], v[74:75], s[50:51]
v_permlane16_swap_b32 v236, v238
v_permlane16_swap_b32 v237, v239
v_cvt_pk_bf16_f32 v168, v168, v169
v_cvt_pk_bf16_f32 v169, v170, v171
v_cvt_pk_bf16_f32 v170, v72, v73
v_cvt_pk_bf16_f32 v171, v74, v75
v_pk_mul_f32 v[192:193], v[192:193], s[50:51]
v_pk_mul_f32 v[194:195], v[194:195], s[50:51]
v_pk_mul_f32 v[96:97], v[96:97], s[50:51]
v_pk_mul_f32 v[98:99], v[98:99], s[50:51]
v_permlane16_swap_b32 v168, v170
v_permlane16_swap_b32 v169, v171
v_cvt_pk_bf16_f32 v192, v192, v193
v_cvt_pk_bf16_f32 v193, v194, v195
v_cvt_pk_bf16_f32 v194, v96, v97
v_cvt_pk_bf16_f32 v195, v98, v99
v_pk_mul_f32 v[216:217], v[216:217], s[50:51]
v_pk_mul_f32 v[218:219], v[218:219], s[50:51]
v_pk_mul_f32 v[120:121], v[120:121], s[50:51]
v_pk_mul_f32 v[122:123], v[122:123], s[50:51]
v_permlane16_swap_b32 v192, v194
v_permlane16_swap_b32 v193, v195
v_cvt_pk_bf16_f32 v216, v216, v217
v_cvt_pk_bf16_f32 v217, v218, v219
v_cvt_pk_bf16_f32 v218, v120, v121
v_cvt_pk_bf16_f32 v219, v122, v123
v_pk_mul_f32 v[240:241], v[240:241], s[50:51]
v_pk_mul_f32 v[242:243], v[242:243], s[50:51]
v_pk_mul_f32 v[144:145], v[144:145], s[50:51]
v_pk_mul_f32 v[146:147], v[146:147], s[50:51]
v_permlane16_swap_b32 v216, v218
v_permlane16_swap_b32 v217, v219
v_cvt_pk_bf16_f32 v240, v240, v241
v_cvt_pk_bf16_f32 v241, v242, v243
v_cvt_pk_bf16_f32 v242, v144, v145
v_cvt_pk_bf16_f32 v243, v146, v147
v_pk_mul_f32 v[172:173], v[172:173], s[50:51]
v_pk_mul_f32 v[174:175], v[174:175], s[50:51]
v_pk_mul_f32 v[76:77], v[76:77], s[50:51]
v_pk_mul_f32 v[78:79], v[78:79], s[50:51]
v_permlane16_swap_b32 v240, v242
v_permlane16_swap_b32 v241, v243
v_cvt_pk_bf16_f32 v172, v172, v173
v_cvt_pk_bf16_f32 v173, v174, v175
v_cvt_pk_bf16_f32 v174, v76, v77
v_cvt_pk_bf16_f32 v175, v78, v79
v_pk_mul_f32 v[196:197], v[196:197], s[50:51]
v_pk_mul_f32 v[198:199], v[198:199], s[50:51]
v_pk_mul_f32 v[100:101], v[100:101], s[50:51]
v_pk_mul_f32 v[102:103], v[102:103], s[50:51]
v_permlane16_swap_b32 v172, v174
v_permlane16_swap_b32 v173, v175
v_cvt_pk_bf16_f32 v196, v196, v197
v_cvt_pk_bf16_f32 v197, v198, v199
v_cvt_pk_bf16_f32 v198, v100, v101
v_cvt_pk_bf16_f32 v199, v102, v103
v_pk_mul_f32 v[220:221], v[220:221], s[50:51]
v_pk_mul_f32 v[222:223], v[222:223], s[50:51]
v_pk_mul_f32 v[124:125], v[124:125], s[50:51]
v_pk_mul_f32 v[126:127], v[126:127], s[50:51]
v_permlane16_swap_b32 v196, v198
v_permlane16_swap_b32 v197, v199
v_cvt_pk_bf16_f32 v220, v220, v221
v_cvt_pk_bf16_f32 v221, v222, v223
v_cvt_pk_bf16_f32 v222, v124, v125
v_cvt_pk_bf16_f32 v223, v126, v127
v_pk_mul_f32 v[244:245], v[244:245], s[50:51]
v_pk_mul_f32 v[246:247], v[246:247], s[50:51]
v_pk_mul_f32 v[148:149], v[148:149], s[50:51]
v_pk_mul_f32 v[150:151], v[150:151], s[50:51]
v_permlane16_swap_b32 v220, v222
v_permlane16_swap_b32 v221, v223
v_cvt_pk_bf16_f32 v244, v244, v245
v_cvt_pk_bf16_f32 v245, v246, v247
v_cvt_pk_bf16_f32 v246, v148, v149
v_cvt_pk_bf16_f32 v247, v150, v151
v_pk_mul_f32 v[176:177], v[176:177], s[50:51]
v_pk_mul_f32 v[178:179], v[178:179], s[50:51]
v_pk_mul_f32 v[80:81], v[80:81], s[50:51]
v_pk_mul_f32 v[82:83], v[82:83], s[50:51]
v_permlane16_swap_b32 v244, v246
v_permlane16_swap_b32 v245, v247
v_cvt_pk_bf16_f32 v176, v176, v177
v_cvt_pk_bf16_f32 v177, v178, v179
v_cvt_pk_bf16_f32 v178, v80, v81
v_cvt_pk_bf16_f32 v179, v82, v83
v_pk_mul_f32 v[200:201], v[200:201], s[50:51]
v_pk_mul_f32 v[202:203], v[202:203], s[50:51]
v_pk_mul_f32 v[104:105], v[104:105], s[50:51]
v_pk_mul_f32 v[106:107], v[106:107], s[50:51]
v_permlane16_swap_b32 v176, v178
v_permlane16_swap_b32 v177, v179
v_cvt_pk_bf16_f32 v200, v200, v201
v_cvt_pk_bf16_f32 v201, v202, v203
v_cvt_pk_bf16_f32 v202, v104, v105
v_cvt_pk_bf16_f32 v203, v106, v107
v_pk_mul_f32 v[224:225], v[224:225], s[50:51]
v_pk_mul_f32 v[226:227], v[226:227], s[50:51]
v_pk_mul_f32 v[128:129], v[128:129], s[50:51]
v_pk_mul_f32 v[130:131], v[130:131], s[50:51]
v_permlane16_swap_b32 v200, v202
v_permlane16_swap_b32 v201, v203
v_cvt_pk_bf16_f32 v224, v224, v225
v_cvt_pk_bf16_f32 v225, v226, v227
v_cvt_pk_bf16_f32 v226, v128, v129
v_cvt_pk_bf16_f32 v227, v130, v131
v_pk_mul_f32 v[248:249], v[248:249], s[50:51]
v_pk_mul_f32 v[250:251], v[250:251], s[50:51]
v_pk_mul_f32 v[152:153], v[152:153], s[50:51]
v_pk_mul_f32 v[154:155], v[154:155], s[50:51]
v_permlane16_swap_b32 v224, v226
v_permlane16_swap_b32 v225, v227
v_cvt_pk_bf16_f32 v248, v248, v249
v_cvt_pk_bf16_f32 v249, v250, v251
v_cvt_pk_bf16_f32 v250, v152, v153
v_cvt_pk_bf16_f32 v251, v154, v155
v_pk_mul_f32 v[180:181], v[180:181], s[50:51]
v_pk_mul_f32 v[182:183], v[182:183], s[50:51]
v_pk_mul_f32 v[84:85], v[84:85], s[50:51]
v_pk_mul_f32 v[86:87], v[86:87], s[50:51]
v_permlane16_swap_b32 v248, v250
v_permlane16_swap_b32 v249, v251
v_cvt_pk_bf16_f32 v180, v180, v181
v_cvt_pk_bf16_f32 v181, v182, v183
v_cvt_pk_bf16_f32 v182, v84, v85
v_cvt_pk_bf16_f32 v183, v86, v87
v_pk_mul_f32 v[204:205], v[204:205], s[50:51]
v_pk_mul_f32 v[206:207], v[206:207], s[50:51]
v_pk_mul_f32 v[108:109], v[108:109], s[50:51]
v_pk_mul_f32 v[110:111], v[110:111], s[50:51]
v_permlane16_swap_b32 v180, v182
v_permlane16_swap_b32 v181, v183
v_cvt_pk_bf16_f32 v204, v204, v205
v_cvt_pk_bf16_f32 v205, v206, v207
v_cvt_pk_bf16_f32 v206, v108, v109
v_cvt_pk_bf16_f32 v207, v110, v111
v_pk_mul_f32 v[228:229], v[228:229], s[50:51]
v_pk_mul_f32 v[230:231], v[230:231], s[50:51]
v_pk_mul_f32 v[132:133], v[132:133], s[50:51]
v_pk_mul_f32 v[134:135], v[134:135], s[50:51]
v_permlane16_swap_b32 v204, v206
v_permlane16_swap_b32 v205, v207
v_cvt_pk_bf16_f32 v228, v228, v229
v_cvt_pk_bf16_f32 v229, v230, v231
v_cvt_pk_bf16_f32 v230, v132, v133
v_cvt_pk_bf16_f32 v231, v134, v135
v_pk_mul_f32 v[252:253], v[252:253], s[50:51]
v_pk_mul_f32 v[254:255], v[254:255], s[50:51]
v_pk_mul_f32 v[156:157], v[156:157], s[50:51]
v_pk_mul_f32 v[158:159], v[158:159], s[50:51]
v_permlane16_swap_b32 v228, v230
v_permlane16_swap_b32 v229, v231
v_cvt_pk_bf16_f32 v252, v252, v253
v_cvt_pk_bf16_f32 v253, v254, v255
v_cvt_pk_bf16_f32 v254, v156, v157
v_cvt_pk_bf16_f32 v255, v158, v159
s_cmp_lg_u32 s48, 0
s_nop 0
v_permlane16_swap_b32 v252, v254
v_permlane16_swap_b32 v253, v255
s_cbranch_scc1 K1_MAXPASS
K1_MAXRET:
s_nop 0
v_mfma_f32_16x16x32_bf16 v[64:67], a[192:195], v[160:163], 0
v_mfma_f32_16x16x32_bf16 v[64:67], a[196:199], v[164:167], v[64:67]
ds_read_b128 a[216:219], v1 offset:6144
s_mov_b32 s34, 73728
v_mfma_f32_16x16x32_bf16 v[64:67], a[200:203], v[168:171], v[64:67]
v_mfma_f32_16x16x32_bf16 v[64:67], a[204:207], v[172:175], v[64:67]
ds_read_b128 a[220:223], v2 offset:6144
s_mov_b32 s35, 49152
v_mfma_f32_16x16x32_bf16 v[64:67], a[208:211], v[176:179], v[64:67]
v_mfma_f32_16x16x32_bf16 v[64:67], a[212:215], v[180:183], v[64:67]
v_mfma_f32_16x16x32_bf16 v[72:75], a[212:215], v[204:207], 0
ds_read_b128 a[224:227], v1 offset:7168
s_mov_b32 s39, 0
v_mfma_f32_16x16x32_bf16 v[72:75], a[208:211], v[200:203], v[72:75]
v_mfma_f32_16x16x32_bf16 v[72:75], a[204:207], v[196:199], v[72:75]
ds_read_b128 a[228:231], v2 offset:7168
s_add_u32 s16, s16, 2949120
v_mfma_f32_16x16x32_bf16 v[72:75], a[200:203], v[192:195], v[72:75]
v_mfma_f32_16x16x32_bf16 v[72:75], a[196:199], v[188:191], v[72:75]
v_mfma_f32_16x16x32_bf16 v[72:75], a[192:195], v[184:187], v[72:75]
ds_read_b128 a[232:235], v1 offset:8192
s_addc_u32 s17, s17, 0
v_mfma_f32_16x16x32_bf16 v[80:83], a[192:195], v[208:211], 0
v_mfma_f32_16x16x32_bf16 v[80:83], a[196:199], v[212:215], v[80:83]
ds_read_b128 a[236:239], v2 offset:8192
v_max3_f32 v32, v64, v65, v66
v_mfma_f32_16x16x32_bf16 v[80:83], a[200:203], v[216:219], v[80:83]
v_max3_f32 v32, v32, v67, v40
v_mov_b32 v33, v32
v_mfma_f32_16x16x32_bf16 v[80:83], a[204:207], v[220:223], v[80:83]
s_mov_b32 s18, s77
s_mov_b32 s77, 629760
v_mfma_f32_16x16x32_bf16 v[80:83], a[208:211], v[224:227], v[80:83]
v_permlane16_swap_b32 v32, v33
v_max_f32 v32, v32, v33
v_mfma_f32_16x16x32_bf16 v[80:83], a[212:215], v[228:231], v[80:83]
s_mov_b32 s54, 49152
v_mov_b32 v33, v32
v_mfma_f32_16x16x32_bf16 v[88:91], a[212:215], v[252:255], 0
v_mfma_f32_16x16x32_bf16 v[88:91], a[208:211], v[248:251], v[88:91]
v_permlane32_swap_b32 v32, v33
v_max_f32 v32, v32, v33
v_mfma_f32_16x16x32_bf16 v[88:91], a[204:207], v[244:247], v[88:91]
v_sub_f32 v48, 0, v32
v_sub_f32 v49, 0, v32
v_mfma_f32_16x16x32_bf16 v[88:91], a[200:203], v[240:243], v[88:91]
v_sub_f32 v50, 0, v32
v_sub_f32 v51, 0, v32
v_mfma_f32_16x16x32_bf16 v[88:91], a[196:199], v[236:239], v[88:91]
v_max3_f32 v34, v72, v73, v74
s_waitcnt lgkmcnt(0)
v_mfma_f32_16x16x32_bf16 v[88:91], a[192:195], v[232:235], v[88:91]
ds_read_b128 a[240:243], v1 offset:12288
v_max3_f32 v34, v34, v75, v41
v_mfma_f32_16x16x32_bf16 v[128:131], a[216:219], v[160:163], 0
s_add_u32 m0, s40, 32768
v_mov_b32 v35, v34
v_mfma_f32_16x16x32_bf16 v[128:131], a[220:223], v[164:167], v[128:131]
v_max3_f32 v36, v80, v81, v82
v_add_f32 v64, v64, v48
v_mfma_f32_16x16x32_bf16 v[128:131], a[224:227], v[168:171], v[128:131]
ds_read_b128 a[244:247], v2 offset:12288
v_permlane16_swap_b32 v34, v35
v_mfma_f32_16x16x32_bf16 v[128:131], a[228:231], v[172:175], v[128:131]
v_max_f32 v34, v34, v35
v_mov_b32 v35, v34
v_mfma_f32_16x16x32_bf16 v[128:131], a[232:235], v[176:179], v[128:131]
ds_read_b128 a[248:251], v1 offset:13312
v_max3_f32 v36, v36, v83, v42
v_mfma_f32_16x16x32_bf16 v[128:131], a[236:239], v[180:183], v[128:131]
v_permlane32_swap_b32 v34, v35
v_max_f32 v34, v34, v35
v_mfma_f32_16x16x32_bf16 v[132:135], a[236:239], v[204:207], 0
ds_read_b128 a[252:255], v2 offset:13312
v_sub_f32 v52, 0, v34
v_mfma_f32_16x16x32_bf16 v[132:135], a[232:235], v[200:203], v[132:135]
v_sub_f32 v53, 0, v34
v_sub_f32 v54, 0, v34
v_mfma_f32_16x16x32_bf16 v[132:135], a[228:231], v[196:199], v[132:135]
v_sub_f32 v55, 0, v34
v_mov_b32 v37, v36
v_mfma_f32_16x16x32_bf16 v[132:135], a[224:227], v[192:195], v[132:135]
ds_read_b128 a[192:195], v1 offset:14336
v_add_f32 v65, v65, v48
v_mfma_f32_16x16x32_bf16 v[132:135], a[220:223], v[188:191], v[132:135]
v_permlane16_swap_b32 v36, v37
v_max_f32 v36, v36, v37
v_mfma_f32_16x16x32_bf16 v[132:135], a[216:219], v[184:187], v[132:135]
ds_read_b128 a[196:199], v2 offset:14336
v_mov_b32 v37, v36
v_mfma_f32_16x16x32_bf16 v[136:139], a[216:219], v[208:211], 0
v_max3_f32 v38, v88, v89, v90
v_max3_f32 v38, v38, v91, v43
v_mfma_f32_16x16x32_bf16 v[136:139], a[220:223], v[212:215], v[136:139]
v_permlane32_swap_b32 v36, v37
v_max_f32 v36, v36, v37
v_mfma_f32_16x16x32_bf16 v[136:139], a[224:227], v[216:219], v[136:139]
v_sub_f32 v56, 0, v36
v_sub_f32 v57, 0, v36
v_mfma_f32_16x16x32_bf16 v[136:139], a[228:231], v[220:223], v[136:139]
v_sub_f32 v58, 0, v36
v_sub_f32 v59, 0, v36
v_mfma_f32_16x16x32_bf16 v[136:139], a[232:235], v[224:227], v[136:139]
v_mov_b32 v39, v38
v_add_f32 v66, v66, v48
v_mfma_f32_16x16x32_bf16 v[136:139], a[236:239], v[228:231], v[136:139]
v_add_f32 v67, v67, v48
v_add_f32 v128, v128, v48
v_mfma_f32_16x16x32_bf16 v[140:143], a[236:239], v[252:255], 0
v_permlane16_swap_b32 v38, v39
v_max_f32 v38, v38, v39
v_mfma_f32_16x16x32_bf16 v[140:143], a[232:235], v[248:251], v[140:143]
v_mov_b32 v39, v38
v_add_f32 v129, v129, v48
v_mfma_f32_16x16x32_bf16 v[140:143], a[228:231], v[244:247], v[140:143]
buffer_load_dwordx4 v19, s[8:11], s54 offen offset:0 nt lds
v_mfma_f32_16x16x32_bf16 v[140:143], a[224:227], v[240:243], v[140:143]
v_permlane32_swap_b32 v38, v39
v_max_f32 v38, v38, v39
v_mfma_f32_16x16x32_bf16 v[140:143], a[220:223], v[236:239], v[140:143]
v_sub_f32 v60, 0, v38
s_waitcnt lgkmcnt(0)
v_mfma_f32_16x16x32_bf16 v[140:143], a[216:219], v[232:235], v[140:143]
ds_read_b128 a[200:203], v1 offset:18432
v_sub_f32 v61, 0, v38
v_mfma_f32_16x16x32_bf16 v[68:71], a[240:243], v[160:163], v[48:51]
v_sub_f32 v62, 0, v38
v_sub_f32 v63, 0, v38
v_mfma_f32_16x16x32_bf16 v[68:71], a[244:247], v[164:167], v[68:71]
ds_read_b128 a[204:207], v2 offset:18432
v_add_f32 v130, v130, v48
v_mfma_f32_16x16x32_bf16 v[68:71], a[248:251], v[168:171], v[68:71]
v_exp_f32 v64, v64
v_mfma_f32_16x16x32_bf16 v[68:71], a[252:255], v[172:175], v[68:71]
ds_read_b128 a[208:211], v1 offset:19456
v_add_f32 v131, v131, v48
v_mfma_f32_16x16x32_bf16 v[68:71], a[192:195], v[176:179], v[68:71]
v_exp_f32 v65, v65
v_mfma_f32_16x16x32_bf16 v[68:71], a[196:199], v[180:183], v[68:71]
v_cvt_pk_bf16_f32 v64, v64, v65
v_add_f32 v72, v72, v52
v_mfma_f32_16x16x32_bf16 v[76:79], a[196:199], v[204:207], v[52:55]
buffer_load_dwordx4 v19, s[8:11], s54 offen offset:3072 nt lds
v_mfma_f32_16x16x32_bf16 v[76:79], a[192:195], v[200:203], v[76:79]
ds_read_b128 a[212:215], v2 offset:19456
s_add_u32 m0, s40, 33664
v_mfma_f32_16x16x32_bf16 v[76:79], a[252:255], v[196:199], v[76:79]
v_exp_f32 v66, v66
v_mfma_f32_16x16x32_bf16 v[76:79], a[248:251], v[192:195], v[76:79]
v_exp_f32 v67, v67
v_mfma_f32_16x16x32_bf16 v[76:79], a[244:247], v[188:191], v[76:79]
ds_read_b128 a[216:219], v1 offset:20480
v_cvt_pk_bf16_f32 v65, v66, v67
v_mfma_f32_16x16x32_bf16 v[76:79], a[240:243], v[184:187], v[76:79]
ds_read_b128 a[220:223], v2 offset:20480
v_add_f32 v73, v73, v52
v_mfma_f32_16x16x32_bf16 v[84:87], a[240:243], v[208:211], v[56:59]
v_exp_f32 v128, v128
v_mfma_f32_16x16x32_bf16 v[84:87], a[244:247], v[212:215], v[84:87]
buffer_load_dwordx4 v19, s[8:11], s54 offen offset:128 nt lds
v_mfma_f32_16x16x32_bf16 v[84:87], a[248:251], v[216:219], v[84:87]
v_add_f32 v74, v74, v52
v_add_f32 v75, v75, v52
v_mfma_f32_16x16x32_bf16 v[84:87], a[252:255], v[220:223], v[84:87]
v_exp_f32 v129, v129
v_mfma_f32_16x16x32_bf16 v[84:87], a[192:195], v[224:227], v[84:87]
v_cvt_pk_bf16_f32 v66, v128, v129
v_add_f32 v132, v132, v52
v_mfma_f32_16x16x32_bf16 v[84:87], a[196:199], v[228:231], v[84:87]
buffer_load_dwordx4 v19, s[8:11], s54 offen offset:3200 nt lds
v_mfma_f32_16x16x32_bf16 v[92:95], a[196:199], v[252:255], v[60:63]
s_add_u32 m0, s40, 34560
v_add_f32 v133, v133, v52
v_mfma_f32_16x16x32_bf16 v[92:95], a[192:195], v[248:251], v[92:95]
v_exp_f32 v130, v130
v_mfma_f32_16x16x32_bf16 v[92:95], a[252:255], v[244:247], v[92:95]
buffer_load_dwordx4 v19, s[8:11], s54 offen offset:256 nt lds
v_mfma_f32_16x16x32_bf16 v[92:95], a[248:251], v[240:243], v[92:95]
buffer_load_dwordx4 v19, s[8:11], s54 offen offset:3328 nt lds
v_mfma_f32_16x16x32_bf16 v[92:95], a[244:247], v[236:239], v[92:95]
v_exp_f32 v131, v131
v_mfma_f32_16x16x32_bf16 v[92:95], a[240:243], v[232:235], v[92:95]
s_waitcnt lgkmcnt(0)
v_cvt_pk_bf16_f32 v67, v130, v131
v_mfma_f32_16x16x32_bf16 v[144:147], a[200:203], v[160:163], v[48:51]
v_exp_f32 v72, v72
v_mfma_f32_16x16x32_bf16 v[144:147], a[204:207], v[164:167], v[144:147]
v_exp_f32 v73, v73
v_mfma_f32_16x16x32_bf16 v[144:147], a[208:211], v[168:171], v[144:147]
s_mov_b32 s54, 24576
v_cvt_pk_bf16_f32 v72, v72, v73
v_mfma_f32_16x16x32_bf16 v[144:147], a[212:215], v[172:175], v[144:147]
v_exp_f32 v74, v74
v_mfma_f32_16x16x32_bf16 v[144:147], a[216:219], v[176:179], v[144:147]
s_waitcnt vmcnt(12) lgkmcnt(0)
s_barrier
v_mfma_f32_16x16x32_bf16 v[144:147], a[220:223], v[180:183], v[144:147]
ds_read_b128 a[224:227], v3 offset:16384
s_add_u32 m0, s40, 57344
v_mfma_f32_16x16x32_bf16 v[148:151], a[220:223], v[204:207], v[52:55]
buffer_load_dwordx4 v19, s[12:15], s54 offen offset:0 nt lds
v_mfma_f32_16x16x32_bf16 v[148:151], a[216:219], v[200:203], v[148:151]
ds_read_b128 a[228:231], v4 offset:16384
v_mfma_f32_16x16x32_bf16 v[148:151], a[212:215], v[196:199], v[148:151]
ds_read_b128 a[232:235], v3 offset:17408
v_mfma_f32_16x16x32_bf16 v[148:151], a[208:211], v[192:195], v[148:151]
ds_read_b128 a[236:239], v4 offset:17408
v_mfma_f32_16x16x32_bf16 v[148:151], a[204:207], v[188:191], v[148:151]
v_mfma_f32_16x16x32_bf16 v[148:151], a[200:203], v[184:187], v[148:151]
ds_read_b128 a[240:243], v3 offset:18432
v_mfma_f32_16x16x32_bf16 v[152:155], a[200:203], v[208:211], v[56:59]
ds_read_b128 a[244:247], v4 offset:18432
v_mfma_f32_16x16x32_bf16 v[152:155], a[204:207], v[212:215], v[152:155]
v_add_f32 v134, v134, v52
v_add_f32 v135, v135, v52
v_mfma_f32_16x16x32_bf16 v[152:155], a[208:211], v[216:219], v[152:155]
v_exp_f32 v75, v75
v_mfma_f32_16x16x32_bf16 v[152:155], a[212:215], v[220:223], v[152:155]
v_cvt_pk_bf16_f32 v73, v74, v75
v_mfma_f32_16x16x32_bf16 v[152:155], a[216:219], v[224:227], v[152:155]
v_exp_f32 v132, v132
v_mfma_f32_16x16x32_bf16 v[152:155], a[220:223], v[228:231], v[152:155]
v_exp_f32 v133, v133
v_mfma_f32_16x16x32_bf16 v[156:159], a[220:223], v[252:255], v[60:63]
v_cvt_pk_bf16_f32 v74, v132, v133
v_mfma_f32_16x16x32_bf16 v[156:159], a[216:219], v[248:251], v[156:159]
v_exp_f32 v134, v134
v_mfma_f32_16x16x32_bf16 v[156:159], a[212:215], v[244:247], v[156:159]
buffer_load_dwordx4 v19, s[12:15], s54 offen offset:3072 nt lds
v_mfma_f32_16x16x32_bf16 v[156:159], a[208:211], v[240:243], v[156:159]
v_exp_f32 v135, v135
v_mfma_f32_16x16x32_bf16 v[156:159], a[204:207], v[236:239], v[156:159]
v_cvt_pk_bf16_f32 v75, v134, v135
s_waitcnt lgkmcnt(0)
v_mfma_f32_16x16x32_bf16 v[156:159], a[200:203], v[232:235], v[156:159]
v_mfma_f32_16x16x32_bf16 v[96:99], a[224:227], v[160:163], v[48:51]
ds_read_b128 a[248:251], v3 offset:22528
v_add_f32 v80, v80, v56
v_mfma_f32_16x16x32_bf16 v[96:99], a[228:231], v[164:167], v[96:99]
v_exp_f32 v80, v80
v_mfma_f32_16x16x32_bf16 v[96:99], a[232:235], v[168:171], v[96:99]
ds_read_b128 a[252:255], v4 offset:22528
v_add_f32 v81, v81, v56
v_mfma_f32_16x16x32_bf16 v[96:99], a[236:239], v[172:175], v[96:99]
v_exp_f32 v81, v81
v_mfma_f32_16x16x32_bf16 v[96:99], a[240:243], v[176:179], v[96:99]
ds_read_b128 a[192:195], v3 offset:23552
v_add_f32 v82, v82, v56
v_mfma_f32_16x16x32_bf16 v[96:99], a[244:247], v[180:183], v[96:99]
v_exp_f32 v82, v82
v_mfma_f32_16x16x32_bf16 v[104:107], a[244:247], v[204:207], v[52:55]
s_add_u32 m0, s40, 58240
v_add_f32 v83, v83, v56
v_mfma_f32_16x16x32_bf16 v[104:107], a[240:243], v[200:203], v[104:107]
v_exp_f32 v83, v83
v_mfma_f32_16x16x32_bf16 v[104:107], a[236:239], v[196:199], v[104:107]
buffer_load_dwordx4 v19, s[12:15], s54 offen offset:128 nt lds
v_mfma_f32_16x16x32_bf16 v[104:107], a[232:235], v[192:195], v[104:107]
ds_read_b128 a[196:199], v4 offset:23552
v_cvt_pk_bf16_f32 v80, v80, v81
v_mfma_f32_16x16x32_bf16 v[104:107], a[228:231], v[188:191], v[104:107]
ds_read_b128 a[200:203], v3 offset:24576
v_add_f32 v136, v136, v56
v_mfma_f32_16x16x32_bf16 v[104:107], a[224:227], v[184:187], v[104:107]
v_exp_f32 v136, v136
v_mfma_f32_16x16x32_bf16 v[112:115], a[224:227], v[208:211], v[56:59]
ds_read_b128 a[204:207], v4 offset:24576
v_add_f32 v137, v137, v56
v_mfma_f32_16x16x32_bf16 v[112:115], a[228:231], v[212:215], v[112:115]
v_exp_f32 v137, v137
v_mfma_f32_16x16x32_bf16 v[112:115], a[232:235], v[216:219], v[112:115]
v_cvt_pk_bf16_f32 v81, v82, v83
v_add_f32 v138, v138, v56
v_mfma_f32_16x16x32_bf16 v[112:115], a[236:239], v[220:223], v[112:115]
v_exp_f32 v138, v138
v_mfma_f32_16x16x32_bf16 v[112:115], a[240:243], v[224:227], v[112:115]
v_add_f32 v139, v139, v56
v_cvt_pk_bf16_f32 v82, v136, v137
v_mfma_f32_16x16x32_bf16 v[112:115], a[244:247], v[228:231], v[112:115]
v_exp_f32 v139, v139
v_mfma_f32_16x16x32_bf16 v[120:123], a[244:247], v[252:255], v[60:63]
v_add_f32 v88, v88, v60
v_add_f32 v89, v89, v60
v_mfma_f32_16x16x32_bf16 v[120:123], a[240:243], v[248:251], v[120:123]
v_exp_f32 v88, v88
v_mfma_f32_16x16x32_bf16 v[120:123], a[236:239], v[244:247], v[120:123]
v_exp_f32 v89, v89
v_mfma_f32_16x16x32_bf16 v[120:123], a[232:235], v[240:243], v[120:123]
buffer_load_dwordx4 v19, s[12:15], s54 offen offset:3200 nt lds
v_mfma_f32_16x16x32_bf16 v[120:123], a[228:231], v[236:239], v[120:123]
v_cvt_pk_bf16_f32 v83, v138, v139
s_waitcnt lgkmcnt(0)
v_mfma_f32_16x16x32_bf16 v[120:123], a[224:227], v[232:235], v[120:123]
ds_read_b128 a[208:211], v3 offset:28672
v_add_f32 v90, v90, v60
v_mfma_f32_16x16x32_bf16 v[128:131], a[248:251], v[160:163], v[48:51]
v_exp_f32 v90, v90
v_mfma_f32_16x16x32_bf16 v[128:131], a[252:255], v[164:167], v[128:131]
v_add_f32 v91, v91, v60
v_cvt_pk_bf16_f32 v88, v88, v89
v_mfma_f32_16x16x32_bf16 v[128:131], a[192:195], v[168:171], v[128:131]
v_exp_f32 v91, v91
v_mfma_f32_16x16x32_bf16 v[128:131], a[196:199], v[172:175], v[128:131]
ds_read_b128 a[212:215], v4 offset:28672
v_add_f32 v140, v140, v60
v_mfma_f32_16x16x32_bf16 v[128:131], a[200:203], v[176:179], v[128:131]
v_exp_f32 v140, v140
v_mfma_f32_16x16x32_bf16 v[128:131], a[204:207], v[180:183], v[128:131]
ds_read_b128 a[216:219], v3 offset:29696
v_add_f32 v141, v141, v60
v_mfma_f32_16x16x32_bf16 v[132:135], a[204:207], v[204:207], v[52:55]
v_exp_f32 v141, v141
v_mfma_f32_16x16x32_bf16 v[132:135], a[200:203], v[200:203], v[132:135]
ds_read_b128 a[220:223], v4 offset:29696
v_cvt_pk_bf16_f32 v89, v90, v91
v_mfma_f32_16x16x32_bf16 v[132:135], a[196:199], v[196:199], v[132:135]
v_add_f32 v142, v142, v60
v_add_f32 v143, v143, v60
v_mfma_f32_16x16x32_bf16 v[132:135], a[192:195], v[192:195], v[132:135]
v_exp_f32 v142, v142
v_mfma_f32_16x16x32_bf16 v[132:135], a[252:255], v[188:191], v[132:135]
v_exp_f32 v143, v143
v_mfma_f32_16x16x32_bf16 v[132:135], a[248:251], v[184:187], v[132:135]
ds_read_b128 a[224:227], v3 offset:30720
v_cvt_pk_bf16_f32 v90, v140, v141
v_mfma_f32_16x16x32_bf16 v[136:139], a[248:251], v[208:211], v[56:59]
v_exp_f32 v68, v68
v_mfma_f32_16x16x32_bf16 v[136:139], a[252:255], v[212:215], v[136:139]
v_exp_f32 v69, v69
v_mfma_f32_16x16x32_bf16 v[136:139], a[192:195], v[216:219], v[136:139]
ds_read_b128 a[228:231], v4 offset:30720
v_cvt_pk_bf16_f32 v91, v142, v143
v_mfma_f32_16x16x32_bf16 v[136:139], a[196:199], v[220:223], v[136:139]
v_exp_f32 v70, v70
v_mfma_f32_16x16x32_bf16 v[136:139], a[200:203], v[224:227], v[136:139]
v_exp_f32 v71, v71
v_mfma_f32_16x16x32_bf16 v[136:139], a[204:207], v[228:231], v[136:139]
v_cvt_pk_bf16_f32 v68, v68, v69
v_cvt_pk_bf16_f32 v69, v70, v71
v_mfma_f32_16x16x32_bf16 v[140:143], a[204:207], v[252:255], v[60:63]
v_exp_f32 v144, v144
v_mfma_f32_16x16x32_bf16 v[140:143], a[200:203], v[248:251], v[140:143]
v_exp_f32 v145, v145
v_mfma_f32_16x16x32_bf16 v[140:143], a[196:199], v[244:247], v[140:143]
v_exp_f32 v146, v146
v_mfma_f32_16x16x32_bf16 v[140:143], a[192:195], v[240:243], v[140:143]
v_exp_f32 v147, v147
v_mfma_f32_16x16x32_bf16 v[140:143], a[252:255], v[236:239], v[140:143]
v_exp_f32 v76, v76
v_mfma_f32_16x16x32_bf16 v[140:143], a[248:251], v[232:235], v[140:143]
s_waitcnt lgkmcnt(0)
v_cvt_pk_bf16_f32 v70, v144, v145
v_mfma_f32_16x16x32_bf16 v[100:103], a[208:211], v[160:163], v[48:51]
v_exp_f32 v77, v77
v_mfma_f32_16x16x32_bf16 v[100:103], a[212:215], v[164:167], v[100:103]
ds_read_b128 a[232:235], v3 offset:34816
s_add_u32 m0, s40, 59136
v_mfma_f32_16x16x32_bf16 v[100:103], a[216:219], v[168:171], v[100:103]
v_exp_f32 v78, v78
v_mfma_f32_16x16x32_bf16 v[100:103], a[220:223], v[172:175], v[100:103]
ds_read_b128 a[236:239], v4 offset:34816
v_cvt_pk_bf16_f32 v71, v146, v147
v_mfma_f32_16x16x32_bf16 v[100:103], a[224:227], v[176:179], v[100:103]
buffer_load_dwordx4 v19, s[12:15], s54 offen offset:256 nt lds
v_mfma_f32_16x16x32_bf16 v[100:103], a[228:231], v[180:183], v[100:103]
v_exp_f32 v79, v79
v_mfma_f32_16x16x32_bf16 v[108:111], a[228:231], v[204:207], v[52:55]
v_exp_f32 v148, v148
v_mfma_f32_16x16x32_bf16 v[108:111], a[224:227], v[200:203], v[108:111]
ds_read_b128 a[240:243], v3 offset:35840
v_cvt_pk_bf16_f32 v76, v76, v77
v_mfma_f32_16x16x32_bf16 v[108:111], a[220:223], v[196:199], v[108:111]
v_exp_f32 v149, v149
v_mfma_f32_16x16x32_bf16 v[108:111], a[216:219], v[192:195], v[108:111]
v_exp_f32 v150, v150
v_mfma_f32_16x16x32_bf16 v[108:111], a[212:215], v[188:191], v[108:111]
ds_read_b128 a[244:247], v4 offset:35840
v_cvt_pk_bf16_f32 v77, v78, v79
v_mfma_f32_16x16x32_bf16 v[108:111], a[208:211], v[184:187], v[108:111]
v_exp_f32 v151, v151
v_mfma_f32_16x16x32_bf16 v[116:119], a[208:211], v[208:211], v[56:59]
v_exp_f32 v84, v84
v_mfma_f32_16x16x32_bf16 v[116:119], a[212:215], v[212:215], v[116:119]
ds_read_b128 a[248:251], v3 offset:36864
v_cvt_pk_bf16_f32 v78, v148, v149
v_mfma_f32_16x16x32_bf16 v[116:119], a[216:219], v[216:219], v[116:119]
v_exp_f32 v85, v85
v_mfma_f32_16x16x32_bf16 v[116:119], a[220:223], v[220:223], v[116:119]
ds_read_b128 a[252:255], v4 offset:36864
v_cvt_pk_bf16_f32 v79, v150, v151
v_mfma_f32_16x16x32_bf16 v[116:119], a[224:227], v[224:227], v[116:119]
v_exp_f32 v86, v86
v_mfma_f32_16x16x32_bf16 v[116:119], a[228:231], v[228:231], v[116:119]
v_exp_f32 v87, v87
v_mfma_f32_16x16x32_bf16 v[124:127], a[228:231], v[252:255], v[60:63]
buffer_load_dwordx4 v19, s[12:15], s54 offen offset:3328 nt lds
v_mfma_f32_16x16x32_bf16 v[124:127], a[224:227], v[248:251], v[124:127]
v_exp_f32 v152, v152
v_mfma_f32_16x16x32_bf16 v[124:127], a[220:223], v[244:247], v[124:127]
v_cvt_pk_bf16_f32 v84, v84, v85
v_cvt_pk_bf16_f32 v85, v86, v87
v_mfma_f32_16x16x32_bf16 v[124:127], a[216:219], v[240:243], v[124:127]
v_exp_f32 v153, v153
v_mfma_f32_16x16x32_bf16 v[124:127], a[212:215], v[236:239], v[124:127]
v_exp_f32 v154, v154
v_mfma_f32_16x16x32_bf16 v[124:127], a[208:211], v[232:235], v[124:127]
s_waitcnt lgkmcnt(0)
v_cvt_pk_bf16_f32 v86, v152, v153
v_mfma_f32_16x16x32_bf16 v[144:147], a[232:235], v[160:163], v[48:51]
v_exp_f32 v155, v155
v_mfma_f32_16x16x32_bf16 v[144:147], a[236:239], v[164:167], v[144:147]
v_exp_f32 v92, v92
v_mfma_f32_16x16x32_bf16 v[144:147], a[240:243], v[168:171], v[144:147]
v_exp_f32 v93, v93
v_mfma_f32_16x16x32_bf16 v[144:147], a[244:247], v[172:175], v[144:147]
v_exp_f32 v94, v94
v_mfma_f32_16x16x32_bf16 v[144:147], a[248:251], v[176:179], v[144:147]
s_waitcnt vmcnt(12) lgkmcnt(0)
s_barrier
v_mfma_f32_16x16x32_bf16 v[144:147], a[252:255], v[180:183], v[144:147]
ds_read_b64_tr_b16 a[192:193], v9 offset:8192
s_add_u32 m0, s40, 81920
v_mfma_f32_16x16x32_bf16 v[148:151], a[252:255], v[204:207], v[52:55]
buffer_load_dwordx4 v19, s[8:11], s34 offen offset:0 nt lds
v_mfma_f32_16x16x32_bf16 v[148:151], a[248:251], v[200:203], v[148:151]
ds_read_b64_tr_b16 a[194:195], v9 offset:14336
v_mfma_f32_16x16x32_bf16 v[148:151], a[244:247], v[196:199], v[148:151]
ds_read_b64_tr_b16 a[196:197], v9 offset:20480
v_mfma_f32_16x16x32_bf16 v[148:151], a[240:243], v[192:195], v[148:151]
ds_read_b64_tr_b16 a[198:199], v9 offset:26624
v_mfma_f32_16x16x32_bf16 v[148:151], a[236:239], v[188:191], v[148:151]
v_mfma_f32_16x16x32_bf16 v[148:151], a[232:235], v[184:187], v[148:151]
ds_read_b64_tr_b16 a[200:201], v10 offset:8192
v_cvt_pk_bf16_f32 v87, v154, v155
v_mfma_f32_16x16x32_bf16 v[152:155], a[232:235], v[208:211], v[56:59]
ds_read_b64_tr_b16 a[202:203], v10 offset:14336
v_mfma_f32_16x16x32_bf16 v[152:155], a[236:239], v[212:215], v[152:155]
ds_read_b64_tr_b16 a[204:205], v10 offset:20480
v_cvt_pk_bf16_f32 v92, v92, v93
v_mfma_f32_16x16x32_bf16 v[152:155], a[240:243], v[216:219], v[152:155]
v_exp_f32 v95, v95
v_mfma_f32_16x16x32_bf16 v[152:155], a[244:247], v[220:223], v[152:155]
v_exp_f32 v156, v156
v_mfma_f32_16x16x32_bf16 v[152:155], a[248:251], v[224:227], v[152:155]
v_exp_f32 v157, v157
v_exp_f32 v158, v158
v_exp_f32 v159, v159
v_mfma_f32_16x16x32_bf16 v[152:155], a[252:255], v[228:231], v[152:155]
v_cvt_pk_bf16_f32 v93, v94, v95
v_cvt_pk_bf16_f32 v94, v156, v157
v_cvt_pk_bf16_f32 v95, v158, v159
v_mfma_f32_16x16x32_bf16 v[156:159], a[252:255], v[252:255], v[60:63]
buffer_load_dwordx4 v19, s[8:11], s34 offen offset:3072 nt lds
v_mfma_f32_16x16x32_bf16 v[156:159], a[248:251], v[248:251], v[156:159]
ds_read_b64_tr_b16 a[206:207], v10 offset:26624
v_mfma_f32_16x16x32_bf16 v[156:159], a[244:247], v[244:247], v[156:159]
ds_read_b64_tr_b16 a[208:209], v11 offset:8192
v_mfma_f32_16x16x32_bf16 v[156:159], a[240:243], v[240:243], v[156:159]
ds_read_b64_tr_b16 a[210:211], v11 offset:14336
v_mfma_f32_16x16x32_bf16 v[156:159], a[236:239], v[236:239], v[156:159]
s_waitcnt lgkmcnt(6)
v_mfma_f32_16x16x32_bf16 v[156:159], a[232:235], v[232:235], v[156:159]
v_mfma_f32_16x16x32_bf16 a[0:3], a[192:195], v[64:67], 0
ds_read_b64_tr_b16 a[212:213], v11 offset:20480
v_mfma_f32_16x16x32_bf16 a[0:3], a[196:199], v[68:71], a[0:3]
v_exp_f32 v96, v96
v_mfma_f32_16x16x32_bf16 a[4:7], a[192:195], v[72:75], 0
ds_read_b64_tr_b16 a[214:215], v11 offset:26624
s_waitcnt vmcnt(34)
v_mfma_f32_16x16x32_bf16 a[4:7], a[196:199], v[76:79], a[4:7]
v_exp_f32 v97, v97
v_mfma_f32_16x16x32_bf16 a[8:11], a[192:195], v[80:83], 0
ds_read_b64_tr_b16 a[216:217], v12 offset:8192
v_and_b32 v47, 3, v0
v_mfma_f32_16x16x32_bf16 a[8:11], a[196:199], v[84:87], a[8:11]
v_exp_f32 v98, v98
v_mfma_f32_16x16x32_bf16 a[12:15], a[192:195], v[88:91], 0
ds_read_b64_tr_b16 a[218:219], v12 offset:14336
s_waitcnt lgkmcnt(6)
v_mfma_f32_16x16x32_bf16 a[12:15], a[196:199], v[92:95], a[12:15]
ds_read_b64_tr_b16 a[220:221], v12 offset:20480
v_cvt_pk_bf16_f32 v96, v96, v97
v_mfma_f32_16x16x32_bf16 a[16:19], a[200:203], v[64:67], 0
v_exp_f32 v99, v99
v_mfma_f32_16x16x32_bf16 a[16:19], a[204:207], v[68:71], a[16:19]
ds_read_b64_tr_b16 a[222:223], v12 offset:26624
v_mov_b32 v30, 1
v_mfma_f32_16x16x32_bf16 a[20:23], a[200:203], v[72:75], 0
v_exp_f32 v128, v128
v_mfma_f32_16x16x32_bf16 a[20:23], a[204:207], v[76:79], a[20:23]
ds_read_b64_tr_b16 a[224:225], v9 offset:9216
v_mov_b32 v46, 0x3f803f80
v_mfma_f32_16x16x32_bf16 a[24:27], a[200:203], v[80:83], 0
ds_read_b64_tr_b16 a[226:227], v9 offset:15360
s_and_b32 s80, s53, 1
v_mfma_f32_16x16x32_bf16 a[24:27], a[204:207], v[84:87], a[24:27]
v_exp_f32 v129, v129
v_mfma_f32_16x16x32_bf16 a[28:31], a[200:203], v[88:91], 0
ds_read_b64_tr_b16 a[228:229], v9 offset:21504
s_waitcnt lgkmcnt(7)
v_mfma_f32_16x16x32_bf16 a[28:31], a[204:207], v[92:95], a[28:31]
v_cmp_eq_u32 s[86:87], 0, v47
v_cvt_pk_bf16_f32 v97, v98, v99
v_mfma_f32_16x16x32_bf16 a[32:35], a[208:211], v[64:67], 0
v_exp_f32 v130, v130
v_mfma_f32_16x16x32_bf16 a[32:35], a[212:215], v[68:71], a[32:35]
ds_read_b64_tr_b16 a[230:231], v9 offset:27648
s_lshl_b32 s80, s80, 2
v_mfma_f32_16x16x32_bf16 a[36:39], a[208:211], v[72:75], 0
ds_read_b64_tr_b16 a[232:233], v10 offset:9216
v_cndmask_b32 v32, 0, v46, s[86:87]
v_mfma_f32_16x16x32_bf16 a[36:39], a[212:215], v[76:79], a[36:39]
v_exp_f32 v131, v131
v_mfma_f32_16x16x32_bf16 a[40:43], a[208:211], v[80:83], 0
ds_read_b64_tr_b16 a[234:235], v10 offset:15360
s_add_u32 s80, s80, s76
v_mfma_f32_16x16x32_bf16 a[40:43], a[212:215], v[84:87], a[40:43]
v_exp_f32 v104, v104
v_mfma_f32_16x16x32_bf16 a[44:47], a[208:211], v[88:91], 0
ds_read_b64_tr_b16 a[236:237], v10 offset:21504
s_waitcnt lgkmcnt(7)
v_mfma_f32_16x16x32_bf16 a[44:47], a[212:215], v[92:95], a[44:47]
ds_read_b64_tr_b16 a[238:239], v10 offset:27648
v_mov_b32 v33, v32
v_mfma_f32_16x16x32_bf16 a[48:51], a[216:219], v[64:67], 0
ds_read_b64_tr_b16 a[240:241], v11 offset:9216
v_cvt_pk_bf16_f32 v98, v128, v129
v_mfma_f32_16x16x32_bf16 a[48:51], a[220:223], v[68:71], a[48:51]
ds_read_b64_tr_b16 a[242:243], v11 offset:15360
s_cmp_eq_u32 s36, 0
v_mfma_f32_16x16x32_bf16 a[52:55], a[216:219], v[72:75], 0
s_cselect_b32 s81, s47, 0
v_mov_b32 v34, v32
v_mfma_f32_16x16x32_bf16 a[52:55], a[220:223], v[76:79], a[52:55]
v_exp_f32 v105, v105
v_mfma_f32_16x16x32_bf16 a[56:59], a[216:219], v[80:83], 0
v_exp_f32 v106, v106
v_mfma_f32_16x16x32_bf16 a[56:59], a[220:223], v[84:87], a[56:59]
ds_read_b64_tr_b16 a[244:245], v11 offset:21504
v_cvt_pk_bf16_f32 v99, v130, v131
v_mfma_f32_16x16x32_bf16 a[60:63], a[216:219], v[88:91], 0
ds_read_b64_tr_b16 a[246:247], v11 offset:27648
s_waitcnt lgkmcnt(8)
v_mfma_f32_16x16x32_bf16 a[60:63], a[220:223], v[92:95], a[60:63]
ds_read_b64_tr_b16 a[248:249], v12 offset:9216
v_mov_b32 v35, v32
v_mfma_f32_16x16x32_bf16 a[64:67], a[224:227], v[64:67], 0
ds_read_b64_tr_b16 a[250:251], v12 offset:15360
s_cmp_lt_u32 s70, s81
v_mfma_f32_16x16x32_bf16 a[64:67], a[228:231], v[68:71], a[64:67]
s_cselect_b32 s80, s80, 0x1000
v_cmp_eq_u32 s[86:87], 1, v47
v_mfma_f32_16x16x32_bf16 a[68:71], a[224:227], v[72:75], 0
ds_read_b64_tr_b16 a[252:253], v12 offset:21504
v_cvt_pk_bf16_f32 v104, v104, v105
v_mfma_f32_16x16x32_bf16 a[68:71], a[228:231], v[76:79], a[68:71]
s_cselect_b32 s70, 1, s70
v_cndmask_b32 v36, 0, v46, s[86:87]
v_mfma_f32_16x16x32_bf16 a[72:75], a[224:227], v[80:83], 0
v_exp_f32 v107, v107
v_mfma_f32_16x16x32_bf16 a[72:75], a[228:231], v[84:87], a[72:75]
v_exp_f32 v132, v132
v_mfma_f32_16x16x32_bf16 a[76:79], a[224:227], v[88:91], 0
ds_read_b64_tr_b16 a[254:255], v12 offset:27648
s_waitcnt lgkmcnt(8)
v_mfma_f32_16x16x32_bf16 a[76:79], a[228:231], v[92:95], a[76:79]
ds_read_b64_tr_b16 a[192:193], v9 offset:10240
s_cmp_eq_u32 s52, 0
v_mfma_f32_16x16x32_bf16 a[80:83], a[232:235], v[64:67], 0
ds_read_b64_tr_b16 a[194:195], v9 offset:16384
v_mov_b32 v37, v36
v_mfma_f32_16x16x32_bf16 a[80:83], a[236:239], v[68:71], a[80:83]
s_cselect_b32 s80, s80, 0x1000
v_cvt_pk_bf16_f32 v105, v106, v107
v_mfma_f32_16x16x32_bf16 a[84:87], a[232:235], v[72:75], 0
ds_read_b64_tr_b16 a[196:197], v9 offset:22528
v_mov_b32 v38, v36
v_mfma_f32_16x16x32_bf16 a[84:87], a[236:239], v[76:79], a[84:87]
s_mov_b64 exec, 1
buffer_atomic_add v30, off, s[72:75], s80
s_mov_b64 exec, -1
v_mfma_f32_16x16x32_bf16 a[88:91], a[232:235], v[80:83], 0
v_exp_f32 v133, v133
v_mfma_f32_16x16x32_bf16 a[88:91], a[236:239], v[84:87], a[88:91]
ds_read_b64_tr_b16 a[198:199], v9 offset:28672
v_mov_b32 v39, v36
v_mfma_f32_16x16x32_bf16 a[92:95], a[232:235], v[88:91], 0
ds_read_b64_tr_b16 a[200:201], v10 offset:10240
s_waitcnt lgkmcnt(9)
v_mfma_f32_16x16x32_bf16 a[92:95], a[236:239], v[92:95], a[92:95]
ds_read_b64_tr_b16 a[202:203], v10 offset:16384
v_cvt_pk_bf16_f32 v106, v132, v133
v_mfma_f32_16x16x32_bf16 a[96:99], a[240:243], v[64:67], 0
s_add_u32 m0, s40, 82816
v_cmp_eq_u32 s[86:87], 2, v47
v_mfma_f32_16x16x32_bf16 a[96:99], a[244:247], v[68:71], a[96:99]
v_exp_f32 v134, v134
v_mfma_f32_16x16x32_bf16 a[100:103], a[240:243], v[72:75], 0
v_exp_f32 v135, v135
v_mfma_f32_16x16x32_bf16 a[100:103], a[244:247], v[76:79], a[100:103]
ds_read_b64_tr_b16 a[204:205], v10 offset:22528
v_cvt_pk_bf16_f32 v107, v134, v135
v_mfma_f32_16x16x32_bf16 a[104:107], a[240:243], v[80:83], 0
ds_read_b64_tr_b16 a[206:207], v10 offset:28672
v_cndmask_b32 v40, 0, v46, s[86:87]
v_mfma_f32_16x16x32_bf16 a[104:107], a[244:247], v[84:87], a[104:107]
buffer_load_dwordx4 v19, s[8:11], s34 offen offset:128 nt lds
v_mfma_f32_16x16x32_bf16 a[108:111], a[240:243], v[88:91], 0
ds_read_b64_tr_b16 a[208:209], v11 offset:10240
s_waitcnt lgkmcnt(9)
v_mfma_f32_16x16x32_bf16 a[108:111], a[244:247], v[92:95], a[108:111]
ds_read_b64_tr_b16 a[210:211], v11 offset:16384
v_mov_b32 v41, v40
v_mfma_f32_16x16x32_bf16 a[112:115], a[248:251], v[64:67], 0
v_exp_f32 v112, v112
v_mfma_f32_16x16x32_bf16 a[112:115], a[252:255], v[68:71], a[112:115]
ds_read_b64_tr_b16 a[212:213], v11 offset:22528
v_mov_b32 v42, v40
v_mfma_f32_16x16x32_bf16 a[116:119], a[248:251], v[72:75], 0
v_exp_f32 v113, v113
v_mfma_f32_16x16x32_bf16 a[116:119], a[252:255], v[76:79], a[116:119]
ds_read_b64_tr_b16 a[214:215], v11 offset:28672
v_cvt_pk_bf16_f32 v112, v112, v113
v_mfma_f32_16x16x32_bf16 a[120:123], a[248:251], v[80:83], 0
ds_read_b64_tr_b16 a[216:217], v12 offset:10240
v_mov_b32 v43, v40
v_mfma_f32_16x16x32_bf16 a[120:123], a[252:255], v[84:87], a[120:123]
buffer_load_dwordx4 v19, s[8:11], s34 offen offset:3200 nt lds
v_mfma_f32_16x16x32_bf16 a[124:127], a[248:251], v[88:91], 0
v_exp_f32 v114, v114
v_mfma_f32_16x16x32_bf16 a[124:127], a[252:255], v[92:95], a[124:127]
s_waitcnt lgkmcnt(9)
s_add_u32 m0, s40, 83712
v_mfma_f32_16x16x32_bf16 a[128:131], a[192:195], v[64:67], 0
ds_read_b64_tr_b16 a[218:219], v12 offset:16384
v_cmp_eq_u32 s[86:87], 3, v47
v_mfma_f32_16x16x32_bf16 a[128:131], a[196:199], v[68:71], a[128:131]
v_exp_f32 v115, v115
v_mfma_f32_16x16x32_bf16 a[132:135], a[192:195], v[72:75], 0
ds_read_b64_tr_b16 a[220:221], v12 offset:22528
v_cvt_pk_bf16_f32 v113, v114, v115
v_mfma_f32_16x16x32_bf16 a[132:135], a[196:199], v[76:79], a[132:135]
ds_read_b64_tr_b16 a[222:223], v12 offset:28672
v_cndmask_b32 v44, 0, v46, s[86:87]
v_mfma_f32_16x16x32_bf16 a[136:139], a[192:195], v[80:83], 0
v_exp_f32 v136, v136
v_mfma_f32_16x16x32_bf16 a[136:139], a[196:199], v[84:87], a[136:139]
v_exp_f32 v137, v137
v_mfma_f32_16x16x32_bf16 a[140:143], a[192:195], v[88:91], 0
buffer_load_dwordx4 v19, s[8:11], s34 offen offset:256 nt lds
v_mfma_f32_16x16x32_bf16 a[140:143], a[196:199], v[92:95], a[140:143]
buffer_load_dwordx4 v19, s[8:11], s34 offen offset:3328 nt lds
s_add_u32 s34, s34, 24576
s_waitcnt lgkmcnt(8)
v_mfma_f32_16x16x32_bf16 a[144:147], a[200:203], v[64:67], 0
v_cvt_pk_bf16_f32 v114, v136, v137
v_mov_b32 v45, v44
v_mfma_f32_16x16x32_bf16 a[144:147], a[204:207], v[68:71], a[144:147]
v_mov_b32 v46, v44
v_mov_b32 v47, v44
v_mfma_f32_16x16x32_bf16 a[148:151], a[200:203], v[72:75], 0
v_exp_f32 v138, v138
v_mfma_f32_16x16x32_bf16 a[148:151], a[204:207], v[76:79], a[148:151]
v_exp_f32 v139, v139
v_mfma_f32_16x16x32_bf16 a[152:155], a[200:203], v[80:83], 0
s_waitcnt vmcnt(13) lgkmcnt(0)
s_barrier
v_mfma_f32_16x16x32_bf16 a[152:155], a[204:207], v[84:87], a[152:155]
ds_read_b128 a[224:227], v1 offset:32768
s_add_u32 m0, s40, 106496
v_mfma_f32_16x16x32_bf16 a[156:159], a[200:203], v[88:91], 0
buffer_load_dwordx4 v19, s[12:15], s35 offen offset:0 nt lds
v_mfma_f32_16x16x32_bf16 a[156:159], a[204:207], v[92:95], a[156:159]
ds_read_b128 a[228:231], v2 offset:32768
v_mfma_f32_16x16x32_bf16 a[160:163], a[208:211], v[64:67], 0
ds_read_b128 a[232:235], v1 offset:33792
v_mfma_f32_16x16x32_bf16 a[160:163], a[212:215], v[68:71], a[160:163]
ds_read_b128 a[236:239], v2 offset:33792
v_mfma_f32_16x16x32_bf16 a[164:167], a[208:211], v[72:75], 0
ds_read_b128 a[240:243], v1 offset:34816
v_mfma_f32_16x16x32_bf16 a[164:167], a[212:215], v[76:79], a[164:167]
v_mfma_f32_16x16x32_bf16 a[168:171], a[208:211], v[80:83], 0
ds_read_b128 a[244:247], v2 offset:34816
v_mfma_f32_16x16x32_bf16 a[168:171], a[212:215], v[84:87], a[168:171]
v_cvt_pk_bf16_f32 v115, v138, v139
v_mov_b32 v24, 0
v_mfma_f32_16x16x32_bf16 a[172:175], a[208:211], v[88:91], 0
v_mov_b32 v25, 0
v_mov_b32 v26, 0
v_mfma_f32_16x16x32_bf16 a[172:175], a[212:215], v[92:95], a[172:175]
v_exp_f32 v120, v120
v_mfma_f32_16x16x32_bf16 a[176:179], a[216:219], v[64:67], 0
v_exp_f32 v121, v121
v_mfma_f32_16x16x32_bf16 a[176:179], a[220:223], v[68:71], a[176:179]
v_cvt_pk_bf16_f32 v120, v120, v121
v_mov_b32 v27, 0
v_mfma_f32_16x16x32_bf16 a[180:183], a[216:219], v[72:75], 0
v_exp_f32 v122, v122
v_mfma_f32_16x16x32_bf16 a[180:183], a[220:223], v[76:79], a[180:183]
v_exp_f32 v123, v123
v_mfma_f32_16x16x32_bf16 a[184:187], a[216:219], v[80:83], 0
v_cvt_pk_bf16_f32 v121, v122, v123
v_mfma_f32_16x16x32_bf16 a[184:187], a[220:223], v[84:87], a[184:187]
v_exp_f32 v140, v140
v_mfma_f32_16x16x32_bf16 a[188:191], a[216:219], v[88:91], 0
buffer_load_dwordx4 v19, s[12:15], s35 offen offset:3072 nt lds
v_mfma_f32_16x16x32_bf16 a[188:191], a[220:223], v[92:95], a[188:191]
v_exp_f32 v141, v141
v_smfmac_f32_16x16x64_bf16 v[24:27], v[32:35], v[64:71], v17
v_exp_f32 v142, v142
v_smfmac_f32_16x16x64_bf16 v[24:27], v[36:39], v[72:79], v17
v_exp_f32 v143, v143
v_smfmac_f32_16x16x64_bf16 v[24:27], v[40:43], v[80:87], v17
v_cvt_pk_bf16_f32 v122, v140, v141
s_waitcnt lgkmcnt(0)
v_smfmac_f32_16x16x64_bf16 v[24:27], v[44:47], v[88:95], v17
v_cvt_pk_bf16_f32 v123, v142, v143
s_bitcmp1_b32 s1, 0
s_cbranch_scc1 K1_LA
.p2align 6
K1_L:
v_mfma_f32_16x16x32_bf16 v[64:67], a[224:227], v[160:163], v[48:51]
v_exp_f32 v100, v100
v_mfma_f32_16x16x32_bf16 v[64:67], a[228:231], v[164:167], v[64:67]
ds_read_b128 a[248:251], v1 offset:38912
v_mfma_f32_16x16x32_bf16 v[64:67], a[232:235], v[168:171], v[64:67]
global_load_dword v30, v[28:29], off
v_mfma_f32_16x16x32_bf16 v[64:67], a[236:239], v[172:175], v[64:67]
v_exp_f32 v101, v101
v_mfma_f32_16x16x32_bf16 v[64:67], a[240:243], v[176:179], v[64:67]
ds_read_b128 a[252:255], v2 offset:38912
v_cvt_pk_bf16_f32 v100, v100, v101
v_mfma_f32_16x16x32_bf16 v[64:67], a[244:247], v[180:183], v[64:67]
v_exp_f32 v102, v102
v_mfma_f32_16x16x32_bf16 v[72:75], a[244:247], v[204:207], v[52:55]
ds_read_b128 a[192:195], v1 offset:39936
s_add_u32 m0, s40, 107392
v_mfma_f32_16x16x32_bf16 v[72:75], a[240:243], v[200:203], v[72:75]
v_exp_f32 v103, v103
v_mfma_f32_16x16x32_bf16 v[72:75], a[236:239], v[196:199], v[72:75]
ds_read_b128 a[196:199], v2 offset:39936
v_cvt_pk_bf16_f32 v101, v102, v103
v_mfma_f32_16x16x32_bf16 v[72:75], a[232:235], v[192:195], v[72:75]
v_exp_f32 v144, v144
v_mfma_f32_16x16x32_bf16 v[72:75], a[228:231], v[188:191], v[72:75]
ds_read_b128 a[200:203], v1 offset:40960
v_mfma_f32_16x16x32_bf16 v[72:75], a[224:227], v[184:187], v[72:75]
v_exp_f32 v145, v145
v_mfma_f32_16x16x32_bf16 v[80:83], a[224:227], v[208:211], v[56:59]
ds_read_b128 a[204:207], v2 offset:40960
v_cvt_pk_bf16_f32 v102, v144, v145
v_mfma_f32_16x16x32_bf16 v[80:83], a[228:231], v[212:215], v[80:83]
v_exp_f32 v146, v146
v_mfma_f32_16x16x32_bf16 v[80:83], a[232:235], v[216:219], v[80:83]
v_mfma_f32_16x16x32_bf16 v[80:83], a[236:239], v[220:223], v[80:83]
v_exp_f32 v147, v147
v_mfma_f32_16x16x32_bf16 v[80:83], a[240:243], v[224:227], v[80:83]
buffer_load_dwordx4 v19, s[12:15], s35 offen offset:128 nt lds
v_mfma_f32_16x16x32_bf16 v[80:83], a[244:247], v[228:231], v[80:83]
v_exp_f32 v108, v108
v_mfma_f32_16x16x32_bf16 v[88:91], a[244:247], v[252:255], v[60:63]
v_cvt_pk_bf16_f32 v103, v146, v147
v_mfma_f32_16x16x32_bf16 v[88:91], a[240:243], v[248:251], v[88:91]
v_exp_f32 v109, v109
v_mfma_f32_16x16x32_bf16 v[88:91], a[236:239], v[244:247], v[88:91]
v_mfma_f32_16x16x32_bf16 v[88:91], a[232:235], v[240:243], v[88:91]
v_cvt_pk_bf16_f32 v108, v108, v109
s_waitcnt lgkmcnt(0)
v_mfma_f32_16x16x32_bf16 v[88:91], a[228:231], v[236:239], v[88:91]
v_exp_f32 v110, v110
v_mfma_f32_16x16x32_bf16 v[88:91], a[224:227], v[232:235], v[88:91]
ds_read_b128 a[208:211], v1 offset:45056
v_mfma_f32_16x16x32_bf16 v[128:131], a[248:251], v[160:163], v[48:51]
v_exp_f32 v111, v111
v_mfma_f32_16x16x32_bf16 v[128:131], a[252:255], v[164:167], v[128:131]
v_mfma_f32_16x16x32_bf16 v[128:131], a[192:195], v[168:171], v[128:131]
ds_read_b128 a[212:215], v2 offset:45056
v_cvt_pk_bf16_f32 v109, v110, v111
v_mfma_f32_16x16x32_bf16 v[128:131], a[196:199], v[172:175], v[128:131]
v_exp_f32 v148, v148
v_mfma_f32_16x16x32_bf16 v[128:131], a[200:203], v[176:179], v[128:131]
buffer_load_dwordx4 v19, s[12:15], s35 offen offset:3200 nt lds
v_mfma_f32_16x16x32_bf16 v[128:131], a[204:207], v[180:183], v[128:131]
ds_read_b128 a[216:219], v1 offset:46080
v_mfma_f32_16x16x32_bf16 v[132:135], a[204:207], v[204:207], v[52:55]
v_exp_f32 v149, v149
v_mfma_f32_16x16x32_bf16 v[132:135], a[200:203], v[200:203], v[132:135]
v_exp_f32 v150, v150
v_mfma_f32_16x16x32_bf16 v[132:135], a[196:199], v[196:199], v[132:135]
ds_read_b128 a[220:223], v2 offset:46080
v_cvt_pk_bf16_f32 v110, v148, v149
v_mfma_f32_16x16x32_bf16 v[132:135], a[192:195], v[192:195], v[132:135]
v_exp_f32 v151, v151
v_mfma_f32_16x16x32_bf16 v[132:135], a[252:255], v[188:191], v[132:135]
ds_read_b128 a[224:227], v1 offset:47104
v_cvt_pk_bf16_f32 v111, v150, v151
v_mfma_f32_16x16x32_bf16 v[132:135], a[248:251], v[184:187], v[132:135]
v_exp_f32 v116, v116
v_mfma_f32_16x16x32_bf16 v[136:139], a[248:251], v[208:211], v[56:59]
ds_read_b128 a[228:231], v2 offset:47104
s_add_u32 m0, s40, 108288
v_mfma_f32_16x16x32_bf16 v[136:139], a[252:255], v[212:215], v[136:139]
v_mfma_f32_16x16x32_bf16 v[136:139], a[192:195], v[216:219], v[136:139]
v_exp_f32 v117, v117
v_mfma_f32_16x16x32_bf16 v[136:139], a[196:199], v[220:223], v[136:139]
v_mfma_f32_16x16x32_bf16 v[136:139], a[200:203], v[224:227], v[136:139]
v_exp_f32 v118, v118
v_mfma_f32_16x16x32_bf16 v[136:139], a[204:207], v[228:231], v[136:139]
v_cvt_pk_bf16_f32 v116, v116, v117
v_mfma_f32_16x16x32_bf16 v[140:143], a[204:207], v[252:255], v[60:63]
v_exp_f32 v119, v119
v_mfma_f32_16x16x32_bf16 v[140:143], a[200:203], v[248:251], v[140:143]
buffer_load_dwordx4 v19, s[12:15], s35 offen offset:256 nt lds
v_mfma_f32_16x16x32_bf16 v[140:143], a[196:199], v[244:247], v[140:143]
ds_read_b128 a[232:235], v1 offset:51200
v_cvt_pk_bf16_f32 v117, v118, v119
v_mfma_f32_16x16x32_bf16 v[140:143], a[192:195], v[240:243], v[140:143]
v_exp_f32 v152, v152
v_mfma_f32_16x16x32_bf16 v[140:143], a[252:255], v[236:239], v[140:143]
s_waitcnt lgkmcnt(1)
v_mfma_f32_16x16x32_bf16 v[140:143], a[248:251], v[232:235], v[140:143]
v_exp_f32 v153, v153
v_mfma_f32_16x16x32_bf16 v[68:71], a[208:211], v[160:163], v[48:51]
v_mfma_f32_16x16x32_bf16 v[68:71], a[212:215], v[164:167], v[68:71]
v_exp_f32 v154, v154
v_mfma_f32_16x16x32_bf16 v[68:71], a[216:219], v[168:171], v[68:71]
ds_read_b128 a[236:239], v2 offset:51200
v_cvt_pk_bf16_f32 v118, v152, v153
v_mfma_f32_16x16x32_bf16 v[68:71], a[220:223], v[172:175], v[68:71]
v_mfma_f32_16x16x32_bf16 v[68:71], a[224:227], v[176:179], v[68:71]
v_exp_f32 v155, v155
v_mfma_f32_16x16x32_bf16 v[68:71], a[228:231], v[180:183], v[68:71]
ds_read_b128 a[240:243], v1 offset:52224
v_cvt_pk_bf16_f32 v119, v154, v155
v_mfma_f32_16x16x32_bf16 v[76:79], a[228:231], v[204:207], v[52:55]
v_exp_f32 v124, v124
v_mfma_f32_16x16x32_bf16 v[76:79], a[224:227], v[200:203], v[76:79]
buffer_load_dwordx4 v19, s[12:15], s35 offen offset:3328 nt lds
v_mfma_f32_16x16x32_bf16 v[76:79], a[220:223], v[196:199], v[76:79]
ds_read_b128 a[244:247], v2 offset:52224
v_mfma_f32_16x16x32_bf16 v[76:79], a[216:219], v[192:195], v[76:79]
v_exp_f32 v125, v125
v_mfma_f32_16x16x32_bf16 v[76:79], a[212:215], v[188:191], v[76:79]
ds_read_b128 a[248:251], v1 offset:53248
v_cvt_pk_bf16_f32 v124, v124, v125
v_mfma_f32_16x16x32_bf16 v[76:79], a[208:211], v[184:187], v[76:79]
v_exp_f32 v126, v126
v_mfma_f32_16x16x32_bf16 v[84:87], a[208:211], v[208:211], v[56:59]
ds_read_b128 a[252:255], v2 offset:53248
s_add_u32 s35, s35, 24576
v_mfma_f32_16x16x32_bf16 v[84:87], a[212:215], v[212:215], v[84:87]
v_exp_f32 v127, v127
v_mfma_f32_16x16x32_bf16 v[84:87], a[216:219], v[216:219], v[84:87]
v_mfma_f32_16x16x32_bf16 v[84:87], a[220:223], v[220:223], v[84:87]
v_exp_f32 v156, v156
v_mfma_f32_16x16x32_bf16 v[84:87], a[224:227], v[224:227], v[84:87]
v_cvt_pk_bf16_f32 v125, v126, v127
v_mfma_f32_16x16x32_bf16 v[84:87], a[228:231], v[228:231], v[84:87]
v_mfma_f32_16x16x32_bf16 v[92:95], a[228:231], v[252:255], v[60:63]
v_exp_f32 v157, v157
v_mfma_f32_16x16x32_bf16 v[92:95], a[224:227], v[248:251], v[92:95]
v_mfma_f32_16x16x32_bf16 v[92:95], a[220:223], v[244:247], v[92:95]
v_exp_f32 v158, v158
v_mfma_f32_16x16x32_bf16 v[92:95], a[216:219], v[240:243], v[92:95]
v_cvt_pk_bf16_f32 v126, v156, v157
s_waitcnt lgkmcnt(0)
v_mfma_f32_16x16x32_bf16 v[92:95], a[212:215], v[236:239], v[92:95]
v_exp_f32 v159, v159
v_mfma_f32_16x16x32_bf16 v[92:95], a[208:211], v[232:235], v[92:95]
v_mfma_f32_16x16x32_bf16 v[144:147], a[232:235], v[160:163], v[48:51]
s_add_u32 m0, s40, 32768
v_cvt_pk_bf16_f32 v127, v158, v159
v_mfma_f32_16x16x32_bf16 v[144:147], a[236:239], v[164:167], v[144:147]
v_mfma_f32_16x16x32_bf16 v[144:147], a[240:243], v[168:171], v[144:147]
v_mfma_f32_16x16x32_bf16 v[144:147], a[244:247], v[172:175], v[144:147]
v_mfma_f32_16x16x32_bf16 v[144:147], a[248:251], v[176:179], v[144:147]
s_waitcnt vmcnt(13) lgkmcnt(0)
s_barrier
v_mfma_f32_16x16x32_bf16 v[144:147], a[252:255], v[180:183], v[144:147]
ds_read_b64_tr_b16 a[192:193], v5 offset:24576
v_mfma_f32_16x16x32_bf16 v[148:151], a[252:255], v[204:207], v[52:55]
buffer_load_dwordx4 v19, s[8:11], s34 offen offset:0 nt lds
v_mfma_f32_16x16x32_bf16 v[148:151], a[248:251], v[200:203], v[148:151]
ds_read_b64_tr_b16 a[194:195], v5 offset:30720
v_mfma_f32_16x16x32_bf16 v[148:151], a[244:247], v[196:199], v[148:151]
ds_read_b64_tr_b16 a[196:197], v5 offset:36864
v_mfma_f32_16x16x32_bf16 v[148:151], a[240:243], v[192:195], v[148:151]
ds_read_b64_tr_b16 a[198:199], v5 offset:43008
v_mfma_f32_16x16x32_bf16 v[148:151], a[236:239], v[188:191], v[148:151]
v_mfma_f32_16x16x32_bf16 v[148:151], a[232:235], v[184:187], v[148:151]
ds_read_b64_tr_b16 a[200:201], v6 offset:24576
v_mfma_f32_16x16x32_bf16 v[152:155], a[232:235], v[208:211], v[56:59]
ds_read_b64_tr_b16 a[202:203], v6 offset:30720
v_mfma_f32_16x16x32_bf16 v[152:155], a[236:239], v[212:215], v[152:155]
buffer_load_dwordx4 v19, s[8:11], s34 offen offset:3072 nt lds
v_mfma_f32_16x16x32_bf16 v[152:155], a[240:243], v[216:219], v[152:155]
ds_read_b64_tr_b16 a[204:205], v6 offset:36864
v_mfma_f32_16x16x32_bf16 v[152:155], a[244:247], v[220:223], v[152:155]
v_mfma_f32_16x16x32_bf16 v[152:155], a[248:251], v[224:227], v[152:155]
ds_read_b64_tr_b16 a[206:207], v6 offset:43008
v_mfma_f32_16x16x32_bf16 v[152:155], a[252:255], v[228:231], v[152:155]
v_mfma_f32_16x16x32_bf16 v[156:159], a[252:255], v[252:255], v[60:63]
ds_read_b64_tr_b16 a[208:209], v7 offset:24576
v_mfma_f32_16x16x32_bf16 v[156:159], a[248:251], v[248:251], v[156:159]
v_mfma_f32_16x16x32_bf16 v[156:159], a[244:247], v[244:247], v[156:159]
ds_read_b64_tr_b16 a[210:211], v7 offset:30720
v_mfma_f32_16x16x32_bf16 v[156:159], a[240:243], v[240:243], v[156:159]
v_mfma_f32_16x16x32_bf16 v[156:159], a[236:239], v[236:239], v[156:159]
s_waitcnt lgkmcnt(6)
v_mfma_f32_16x16x32_bf16 v[156:159], a[232:235], v[232:235], v[156:159]
v_mfma_f32_16x16x32_bf16 a[0:3], a[192:195], v[96:99], a[0:3]
ds_read_b64_tr_b16 a[212:213], v7 offset:36864
v_mfma_f32_16x16x32_bf16 a[0:3], a[196:199], v[100:103], a[0:3]
v_exp_f32 v64, v64
v_mfma_f32_16x16x32_bf16 a[4:7], a[192:195], v[104:107], a[4:7]
ds_read_b64_tr_b16 a[214:215], v7 offset:43008
s_add_u32 m0, s40, 33664
v_mfma_f32_16x16x32_bf16 a[4:7], a[196:199], v[108:111], a[4:7]
v_exp_f32 v65, v65
v_mfma_f32_16x16x32_bf16 a[8:11], a[192:195], v[112:115], a[8:11]
ds_read_b64_tr_b16 a[216:217], v8 offset:24576
v_cvt_pk_bf16_f32 v64, v64, v65
v_mfma_f32_16x16x32_bf16 a[8:11], a[196:199], v[116:119], a[8:11]
v_exp_f32 v66, v66
v_mfma_f32_16x16x32_bf16 a[12:15], a[192:195], v[120:123], a[12:15]
ds_read_b64_tr_b16 a[218:219], v8 offset:30720
s_waitcnt lgkmcnt(6)
v_mfma_f32_16x16x32_bf16 a[12:15], a[196:199], v[124:127], a[12:15]
ds_read_b64_tr_b16 a[220:221], v8 offset:36864
v_mfma_f32_16x16x32_bf16 a[16:19], a[200:203], v[96:99], a[16:19]
buffer_load_dwordx4 v19, s[8:11], s34 offen offset:128 nt lds
v_mfma_f32_16x16x32_bf16 a[16:19], a[204:207], v[100:103], a[16:19]
v_exp_f32 v67, v67
v_mfma_f32_16x16x32_bf16 a[20:23], a[200:203], v[104:107], a[20:23]
ds_read_b64_tr_b16 a[222:223], v8 offset:43008
v_cvt_pk_bf16_f32 v65, v66, v67
v_mfma_f32_16x16x32_bf16 a[20:23], a[204:207], v[108:111], a[20:23]
v_exp_f32 v128, v128
v_mfma_f32_16x16x32_bf16 a[24:27], a[200:203], v[112:115], a[24:27]
ds_read_b64_tr_b16 a[224:225], v5 offset:25600
v_mfma_f32_16x16x32_bf16 a[24:27], a[204:207], v[116:119], a[24:27]
ds_read_b64_tr_b16 a[226:227], v5 offset:31744
s_waitcnt lgkmcnt(6)
v_mfma_f32_16x16x32_bf16 a[28:31], a[200:203], v[120:123], a[28:31]
v_exp_f32 v129, v129
v_mfma_f32_16x16x32_bf16 a[28:31], a[204:207], v[124:127], a[28:31]
ds_read_b64_tr_b16 a[228:229], v5 offset:37888
v_cvt_pk_bf16_f32 v66, v128, v129
v_mfma_f32_16x16x32_bf16 a[32:35], a[208:211], v[96:99], a[32:35]
v_exp_f32 v130, v130
v_mfma_f32_16x16x32_bf16 a[32:35], a[212:215], v[100:103], a[32:35]
ds_read_b64_tr_b16 a[230:231], v5 offset:44032
v_mfma_f32_16x16x32_bf16 a[36:39], a[208:211], v[104:107], a[36:39]
ds_read_b64_tr_b16 a[232:233], v6 offset:25600
v_mfma_f32_16x16x32_bf16 a[36:39], a[212:215], v[108:111], a[36:39]
v_exp_f32 v131, v131
v_mfma_f32_16x16x32_bf16 a[40:43], a[208:211], v[112:115], a[40:43]
ds_read_b64_tr_b16 a[234:235], v6 offset:31744
v_cvt_pk_bf16_f32 v67, v130, v131
v_mfma_f32_16x16x32_bf16 a[40:43], a[212:215], v[116:119], a[40:43]
buffer_load_dwordx4 v19, s[8:11], s34 offen offset:3200 nt lds
v_mfma_f32_16x16x32_bf16 a[44:47], a[208:211], v[120:123], a[44:47]
v_exp_f32 v72, v72
v_mfma_f32_16x16x32_bf16 a[44:47], a[212:215], v[124:127], a[44:47]
s_waitcnt lgkmcnt(6)
ds_read_b64_tr_b16 a[236:237], v6 offset:37888
v_mfma_f32_16x16x32_bf16 a[48:51], a[216:219], v[96:99], a[48:51]
ds_read_b64_tr_b16 a[238:239], v6 offset:44032
v_mfma_f32_16x16x32_bf16 a[48:51], a[220:223], v[100:103], a[48:51]
v_exp_f32 v73, v73
v_mfma_f32_16x16x32_bf16 a[52:55], a[216:219], v[104:107], a[52:55]
ds_read_b64_tr_b16 a[240:241], v7 offset:25600
v_cvt_pk_bf16_f32 v72, v72, v73
v_mfma_f32_16x16x32_bf16 a[52:55], a[220:223], v[108:111], a[52:55]
v_exp_f32 v74, v74
v_mfma_f32_16x16x32_bf16 a[56:59], a[216:219], v[112:115], a[56:59]
ds_read_b64_tr_b16 a[242:243], v7 offset:31744
s_add_u32 m0, s40, 34560
v_mfma_f32_16x16x32_bf16 a[56:59], a[220:223], v[116:119], a[56:59]
ds_read_b64_tr_b16 a[244:245], v7 offset:37888
s_waitcnt lgkmcnt(7)
v_mfma_f32_16x16x32_bf16 a[60:63], a[216:219], v[120:123], a[60:63]
v_exp_f32 v75, v75
v_mfma_f32_16x16x32_bf16 a[60:63], a[220:223], v[124:127], a[60:63]
ds_read_b64_tr_b16 a[246:247], v7 offset:44032
v_cvt_pk_bf16_f32 v73, v74, v75
v_mfma_f32_16x16x32_bf16 a[64:67], a[224:227], v[96:99], a[64:67]
v_exp_f32 v132, v132
v_mfma_f32_16x16x32_bf16 a[64:67], a[228:231], v[100:103], a[64:67]
ds_read_b64_tr_b16 a[248:249], v8 offset:25600
v_mfma_f32_16x16x32_bf16 a[68:71], a[224:227], v[104:107], a[68:71]
ds_read_b64_tr_b16 a[250:251], v8 offset:31744
v_mfma_f32_16x16x32_bf16 a[68:71], a[228:231], v[108:111], a[68:71]
v_exp_f32 v133, v133
v_mfma_f32_16x16x32_bf16 a[72:75], a[224:227], v[112:115], a[72:75]
ds_read_b64_tr_b16 a[252:253], v8 offset:37888
v_cvt_pk_bf16_f32 v74, v132, v133
v_mfma_f32_16x16x32_bf16 a[72:75], a[228:231], v[116:119], a[72:75]
v_exp_f32 v134, v134
v_mfma_f32_16x16x32_bf16 a[76:79], a[224:227], v[120:123], a[76:79]
ds_read_b64_tr_b16 a[254:255], v8 offset:44032
s_waitcnt lgkmcnt(8)
v_mfma_f32_16x16x32_bf16 a[76:79], a[228:231], v[124:127], a[76:79]
buffer_load_dwordx4 v19, s[8:11], s34 offen offset:256 nt lds
v_mfma_f32_16x16x32_bf16 a[80:83], a[232:235], v[96:99], a[80:83]
ds_read_b64_tr_b16 a[192:193], v5 offset:26624
v_mfma_f32_16x16x32_bf16 a[80:83], a[236:239], v[100:103], a[80:83]
v_exp_f32 v135, v135
v_mfma_f32_16x16x32_bf16 a[84:87], a[232:235], v[104:107], a[84:87]
ds_read_b64_tr_b16 a[194:195], v5 offset:32768
v_cvt_pk_bf16_f32 v75, v134, v135
v_mfma_f32_16x16x32_bf16 a[84:87], a[236:239], v[108:111], a[84:87]
v_exp_f32 v80, v80
v_mfma_f32_16x16x32_bf16 a[88:91], a[232:235], v[112:115], a[88:91]
ds_read_b64_tr_b16 a[196:197], v5 offset:38912
v_mfma_f32_16x16x32_bf16 a[88:91], a[236:239], v[116:119], a[88:91]
ds_read_b64_tr_b16 a[198:199], v5 offset:45056
s_waitcnt lgkmcnt(8)
v_mfma_f32_16x16x32_bf16 a[92:95], a[232:235], v[120:123], a[92:95]
v_exp_f32 v81, v81
v_mfma_f32_16x16x32_bf16 a[92:95], a[236:239], v[124:127], a[92:95]
ds_read_b64_tr_b16 a[200:201], v6 offset:26624
v_cvt_pk_bf16_f32 v80, v80, v81
v_mfma_f32_16x16x32_bf16 a[96:99], a[240:243], v[96:99], a[96:99]
v_exp_f32 v82, v82
v_mfma_f32_16x16x32_bf16 a[96:99], a[244:247], v[100:103], a[96:99]
ds_read_b64_tr_b16 a[202:203], v6 offset:32768
v_mfma_f32_16x16x32_bf16 a[100:103], a[240:243], v[104:107], a[100:103]
ds_read_b64_tr_b16 a[204:205], v6 offset:38912
v_mfma_f32_16x16x32_bf16 a[100:103], a[244:247], v[108:111], a[100:103]
v_exp_f32 v83, v83
v_mfma_f32_16x16x32_bf16 a[104:107], a[240:243], v[112:115], a[104:107]
buffer_load_dwordx4 v19, s[8:11], s34 offen offset:3328 nt lds
v_mfma_f32_16x16x32_bf16 a[104:107], a[244:247], v[116:119], a[104:107]
ds_read_b64_tr_b16 a[206:207], v6 offset:45056
v_cvt_pk_bf16_f32 v81, v82, v83
v_mfma_f32_16x16x32_bf16 a[108:111], a[240:243], v[120:123], a[108:111]
v_exp_f32 v136, v136
v_mfma_f32_16x16x32_bf16 a[108:111], a[244:247], v[124:127], a[108:111]
s_waitcnt lgkmcnt(8)
ds_read_b64_tr_b16 a[208:209], v7 offset:26624
v_mfma_f32_16x16x32_bf16 a[112:115], a[248:251], v[96:99], a[112:115]
ds_read_b64_tr_b16 a[210:211], v7 offset:32768
v_mfma_f32_16x16x32_bf16 a[112:115], a[252:255], v[100:103], a[112:115]
v_exp_f32 v137, v137
v_mfma_f32_16x16x32_bf16 a[116:119], a[248:251], v[104:107], a[116:119]
ds_read_b64_tr_b16 a[212:213], v7 offset:38912
v_cvt_pk_bf16_f32 v82, v136, v137
v_mfma_f32_16x16x32_bf16 a[116:119], a[252:255], v[108:111], a[116:119]
v_exp_f32 v138, v138
v_mfma_f32_16x16x32_bf16 a[120:123], a[248:251], v[112:115], a[120:123]
ds_read_b64_tr_b16 a[214:215], v7 offset:45056
s_add_u32 s34, s34, 24576
v_mfma_f32_16x16x32_bf16 a[120:123], a[252:255], v[116:119], a[120:123]
ds_read_b64_tr_b16 a[216:217], v8 offset:26624
s_waitcnt lgkmcnt(9)
v_mfma_f32_16x16x32_bf16 a[124:127], a[248:251], v[120:123], a[124:127]
v_exp_f32 v139, v139
v_mfma_f32_16x16x32_bf16 a[124:127], a[252:255], v[124:127], a[124:127]
ds_read_b64_tr_b16 a[218:219], v8 offset:32768
v_cvt_pk_bf16_f32 v83, v138, v139
v_mfma_f32_16x16x32_bf16 a[128:131], a[192:195], v[96:99], a[128:131]
v_exp_f32 v88, v88
v_mfma_f32_16x16x32_bf16 a[128:131], a[196:199], v[100:103], a[128:131]
ds_read_b64_tr_b16 a[220:221], v8 offset:38912
v_mfma_f32_16x16x32_bf16 a[132:135], a[192:195], v[104:107], a[132:135]
v_mfma_f32_16x16x32_bf16 a[132:135], a[196:199], v[108:111], a[132:135]
ds_read_b64_tr_b16 a[222:223], v8 offset:45056
v_mfma_f32_16x16x32_bf16 a[136:139], a[192:195], v[112:115], a[136:139]
v_exp_f32 v89, v89
v_mfma_f32_16x16x32_bf16 a[136:139], a[196:199], v[116:119], a[136:139]
v_cvt_pk_bf16_f32 v88, v88, v89
s_waitcnt lgkmcnt(8)
v_mfma_f32_16x16x32_bf16 a[140:143], a[192:195], v[120:123], a[140:143]
v_exp_f32 v90, v90
v_mfma_f32_16x16x32_bf16 a[140:143], a[196:199], v[124:127], a[140:143]
v_mfma_f32_16x16x32_bf16 a[144:147], a[200:203], v[96:99], a[144:147]
v_mfma_f32_16x16x32_bf16 a[144:147], a[204:207], v[100:103], a[144:147]
v_exp_f32 v91, v91
v_mfma_f32_16x16x32_bf16 a[148:151], a[200:203], v[104:107], a[148:151]
v_mfma_f32_16x16x32_bf16 a[148:151], a[204:207], v[108:111], a[148:151]
s_add_u32 m0, s40, 57344
v_cvt_pk_bf16_f32 v89, v90, v91
v_mfma_f32_16x16x32_bf16 a[152:155], a[200:203], v[112:115], a[152:155]
s_waitcnt vmcnt(13) lgkmcnt(0)
s_barrier
v_mfma_f32_16x16x32_bf16 a[152:155], a[204:207], v[116:119], a[152:155]
ds_read_b128 a[224:227], v3 offset:16384
v_mfma_f32_16x16x32_bf16 a[156:159], a[200:203], v[120:123], a[156:159]
buffer_load_dwordx4 v19, s[12:15], s35 offen offset:0 nt lds
v_mfma_f32_16x16x32_bf16 a[156:159], a[204:207], v[124:127], a[156:159]
ds_read_b128 a[228:231], v4 offset:16384
v_mfma_f32_16x16x32_bf16 a[160:163], a[208:211], v[96:99], a[160:163]
ds_read_b128 a[232:235], v3 offset:17408
v_mfma_f32_16x16x32_bf16 a[160:163], a[212:215], v[100:103], a[160:163]
ds_read_b128 a[236:239], v4 offset:17408
v_mfma_f32_16x16x32_bf16 a[164:167], a[208:211], v[104:107], a[164:167]
ds_read_b128 a[240:243], v3 offset:18432
v_mfma_f32_16x16x32_bf16 a[164:167], a[212:215], v[108:111], a[164:167]
ds_read_b128 a[244:247], v4 offset:18432
v_mfma_f32_16x16x32_bf16 a[168:171], a[208:211], v[112:115], a[168:171]
v_mfma_f32_16x16x32_bf16 a[168:171], a[212:215], v[116:119], a[168:171]
v_exp_f32 v140, v140
v_mfma_f32_16x16x32_bf16 a[172:175], a[208:211], v[120:123], a[172:175]
v_mfma_f32_16x16x32_bf16 a[172:175], a[212:215], v[124:127], a[172:175]
buffer_load_dwordx4 v19, s[12:15], s35 offen offset:3072 nt lds
v_mfma_f32_16x16x32_bf16 a[176:179], a[216:219], v[96:99], a[176:179]
v_exp_f32 v141, v141
v_mfma_f32_16x16x32_bf16 a[176:179], a[220:223], v[100:103], a[176:179]
v_cvt_pk_bf16_f32 v90, v140, v141
v_mfma_f32_16x16x32_bf16 a[180:183], a[216:219], v[104:107], a[180:183]
v_exp_f32 v142, v142
v_mfma_f32_16x16x32_bf16 a[180:183], a[220:223], v[108:111], a[180:183]
v_mfma_f32_16x16x32_bf16 a[184:187], a[216:219], v[112:115], a[184:187]
v_mfma_f32_16x16x32_bf16 a[184:187], a[220:223], v[116:119], a[184:187]
v_exp_f32 v143, v143
v_mfma_f32_16x16x32_bf16 a[188:191], a[216:219], v[120:123], a[188:191]
v_mfma_f32_16x16x32_bf16 a[188:191], a[220:223], v[124:127], a[188:191]
v_cvt_pk_bf16_f32 v91, v142, v143
v_smfmac_f32_16x16x64_bf16 v[24:27], v[32:35], v[96:103], v17
v_smfmac_f32_16x16x64_bf16 v[24:27], v[36:39], v[104:111], v17
v_smfmac_f32_16x16x64_bf16 v[24:27], v[40:43], v[112:119], v17
s_waitcnt lgkmcnt(0)
v_smfmac_f32_16x16x64_bf16 v[24:27], v[44:47], v[120:127], v17
v_mfma_f32_16x16x32_bf16 v[96:99], a[224:227], v[160:163], v[48:51]
v_exp_f32 v68, v68
v_mfma_f32_16x16x32_bf16 v[96:99], a[228:231], v[164:167], v[96:99]
ds_read_b128 a[248:251], v3 offset:22528
s_add_u32 m0, s40, 58240
v_mfma_f32_16x16x32_bf16 v[96:99], a[232:235], v[168:171], v[96:99]
v_exp_f32 v69, v69
v_mfma_f32_16x16x32_bf16 v[96:99], a[236:239], v[172:175], v[96:99]
ds_read_b128 a[252:255], v4 offset:22528
v_cvt_pk_bf16_f32 v68, v68, v69
v_mfma_f32_16x16x32_bf16 v[96:99], a[240:243], v[176:179], v[96:99]
v_exp_f32 v70, v70
v_mfma_f32_16x16x32_bf16 v[96:99], a[244:247], v[180:183], v[96:99]
ds_read_b128 a[192:195], v3 offset:23552
v_mfma_f32_16x16x32_bf16 v[104:107], a[244:247], v[204:207], v[52:55]
v_exp_f32 v71, v71
v_mfma_f32_16x16x32_bf16 v[104:107], a[240:243], v[200:203], v[104:107]
buffer_load_dwordx4 v19, s[12:15], s35 offen offset:128 nt lds
v_mfma_f32_16x16x32_bf16 v[104:107], a[236:239], v[196:199], v[104:107]
ds_read_b128 a[196:199], v4 offset:23552
v_cvt_pk_bf16_f32 v69, v70, v71
v_mfma_f32_16x16x32_bf16 v[104:107], a[232:235], v[192:195], v[104:107]
v_exp_f32 v144, v144
v_mfma_f32_16x16x32_bf16 v[104:107], a[228:231], v[188:191], v[104:107]
ds_read_b128 a[200:203], v3 offset:24576
v_mfma_f32_16x16x32_bf16 v[104:107], a[224:227], v[184:187], v[104:107]
v_exp_f32 v145, v145
v_mfma_f32_16x16x32_bf16 v[112:115], a[224:227], v[208:211], v[56:59]
ds_read_b128 a[204:207], v4 offset:24576
v_cvt_pk_bf16_f32 v70, v144, v145
v_mfma_f32_16x16x32_bf16 v[112:115], a[228:231], v[212:215], v[112:115]
v_exp_f32 v146, v146
v_mfma_f32_16x16x32_bf16 v[112:115], a[232:235], v[216:219], v[112:115]
v_mfma_f32_16x16x32_bf16 v[112:115], a[236:239], v[220:223], v[112:115]
v_exp_f32 v147, v147
v_mfma_f32_16x16x32_bf16 v[112:115], a[240:243], v[224:227], v[112:115]
v_mfma_f32_16x16x32_bf16 v[112:115], a[244:247], v[228:231], v[112:115]
v_exp_f32 v76, v76
v_mfma_f32_16x16x32_bf16 v[120:123], a[244:247], v[252:255], v[60:63]
v_cvt_pk_bf16_f32 v71, v146, v147
v_mfma_f32_16x16x32_bf16 v[120:123], a[240:243], v[248:251], v[120:123]
buffer_load_dwordx4 v19, s[12:15], s35 offen offset:3200 nt lds
v_mfma_f32_16x16x32_bf16 v[120:123], a[236:239], v[244:247], v[120:123]
v_exp_f32 v77, v77
v_mfma_f32_16x16x32_bf16 v[120:123], a[232:235], v[240:243], v[120:123]
v_cvt_pk_bf16_f32 v76, v76, v77
s_waitcnt lgkmcnt(0)
v_mfma_f32_16x16x32_bf16 v[120:123], a[228:231], v[236:239], v[120:123]
v_exp_f32 v78, v78
v_mfma_f32_16x16x32_bf16 v[120:123], a[224:227], v[232:235], v[120:123]
ds_read_b128 a[208:211], v3 offset:28672
v_mfma_f32_16x16x32_bf16 v[128:131], a[248:251], v[160:163], v[48:51]
v_exp_f32 v79, v79
v_mfma_f32_16x16x32_bf16 v[128:131], a[252:255], v[164:167], v[128:131]
v_mfma_f32_16x16x32_bf16 v[128:131], a[192:195], v[168:171], v[128:131]
ds_read_b128 a[212:215], v4 offset:28672
v_cvt_pk_bf16_f32 v77, v78, v79
v_mfma_f32_16x16x32_bf16 v[128:131], a[196:199], v[172:175], v[128:131]
v_exp_f32 v148, v148
v_mfma_f32_16x16x32_bf16 v[128:131], a[200:203], v[176:179], v[128:131]
ds_read_b128 a[216:219], v3 offset:29696
s_add_u32 m0, s40, 59136
v_mfma_f32_16x16x32_bf16 v[128:131], a[204:207], v[180:183], v[128:131]
v_exp_f32 v149, v149
v_mfma_f32_16x16x32_bf16 v[132:135], a[204:207], v[204:207], v[52:55]
v_mfma_f32_16x16x32_bf16 v[132:135], a[200:203], v[200:203], v[132:135]
v_exp_f32 v150, v150
v_mfma_f32_16x16x32_bf16 v[132:135], a[196:199], v[196:199], v[132:135]
ds_read_b128 a[220:223], v4 offset:29696
v_cvt_pk_bf16_f32 v78, v148, v149
v_mfma_f32_16x16x32_bf16 v[132:135], a[192:195], v[192:195], v[132:135]
v_exp_f32 v151, v151
v_mfma_f32_16x16x32_bf16 v[132:135], a[252:255], v[188:191], v[132:135]
ds_read_b128 a[224:227], v3 offset:30720
v_cvt_pk_bf16_f32 v79, v150, v151
v_mfma_f32_16x16x32_bf16 v[132:135], a[248:251], v[184:187], v[132:135]
v_exp_f32 v84, v84
v_mfma_f32_16x16x32_bf16 v[136:139], a[248:251], v[208:211], v[56:59]
ds_read_b128 a[228:231], v4 offset:30720
v_mfma_f32_16x16x32_bf16 v[136:139], a[252:255], v[212:215], v[136:139]
v_mfma_f32_16x16x32_bf16 v[136:139], a[192:195], v[216:219], v[136:139]
v_exp_f32 v85, v85
v_mfma_f32_16x16x32_bf16 v[136:139], a[196:199], v[220:223], v[136:139]
buffer_load_dwordx4 v19, s[12:15], s35 offen offset:256 nt lds
v_mfma_f32_16x16x32_bf16 v[136:139], a[200:203], v[224:227], v[136:139]
v_exp_f32 v86, v86
v_mfma_f32_16x16x32_bf16 v[136:139], a[204:207], v[228:231], v[136:139]
v_cvt_pk_bf16_f32 v84, v84, v85
v_mfma_f32_16x16x32_bf16 v[140:143], a[204:207], v[252:255], v[60:63]
v_exp_f32 v87, v87
v_mfma_f32_16x16x32_bf16 v[140:143], a[200:203], v[248:251], v[140:143]
v_mfma_f32_16x16x32_bf16 v[140:143], a[196:199], v[244:247], v[140:143]
ds_read_b128 a[232:235], v3 offset:34816
v_cvt_pk_bf16_f32 v85, v86, v87
v_mfma_f32_16x16x32_bf16 v[140:143], a[192:195], v[240:243], v[140:143]
v_exp_f32 v152, v152
v_mfma_f32_16x16x32_bf16 v[140:143], a[252:255], v[236:239], v[140:143]
s_waitcnt lgkmcnt(1)
v_mfma_f32_16x16x32_bf16 v[140:143], a[248:251], v[232:235], v[140:143]
v_exp_f32 v153, v153
v_mfma_f32_16x16x32_bf16 v[100:103], a[208:211], v[160:163], v[48:51]
v_mfma_f32_16x16x32_bf16 v[100:103], a[212:215], v[164:167], v[100:103]
v_exp_f32 v154, v154
v_mfma_f32_16x16x32_bf16 v[100:103], a[216:219], v[168:171], v[100:103]
ds_read_b128 a[236:239], v4 offset:34816
v_cvt_pk_bf16_f32 v86, v152, v153
v_mfma_f32_16x16x32_bf16 v[100:103], a[220:223], v[172:175], v[100:103]
buffer_load_dwordx4 v19, s[12:15], s35 offen offset:3328 nt lds
v_mfma_f32_16x16x32_bf16 v[100:103], a[224:227], v[176:179], v[100:103]
v_exp_f32 v155, v155
v_mfma_f32_16x16x32_bf16 v[100:103], a[228:231], v[180:183], v[100:103]
ds_read_b128 a[240:243], v3 offset:35840
v_cvt_pk_bf16_f32 v87, v154, v155
v_mfma_f32_16x16x32_bf16 v[108:111], a[228:231], v[204:207], v[52:55]
v_exp_f32 v92, v92
v_mfma_f32_16x16x32_bf16 v[108:111], a[224:227], v[200:203], v[108:111]
ds_read_b128 a[244:247], v4 offset:35840
v_mfma_f32_16x16x32_bf16 v[108:111], a[220:223], v[196:199], v[108:111]
v_exp_f32 v93, v93
v_mfma_f32_16x16x32_bf16 v[108:111], a[216:219], v[192:195], v[108:111]
ds_read_b128 a[248:251], v3 offset:36864
v_cvt_pk_bf16_f32 v92, v92, v93
v_mfma_f32_16x16x32_bf16 v[108:111], a[212:215], v[188:191], v[108:111]
v_mfma_f32_16x16x32_bf16 v[108:111], a[208:211], v[184:187], v[108:111]
v_exp_f32 v94, v94
v_mfma_f32_16x16x32_bf16 v[116:119], a[208:211], v[208:211], v[56:59]
ds_read_b128 a[252:255], v4 offset:36864
s_add_u32 s35, s35, 24576
v_mfma_f32_16x16x32_bf16 v[116:119], a[212:215], v[212:215], v[116:119]
v_exp_f32 v95, v95
v_mfma_f32_16x16x32_bf16 v[116:119], a[216:219], v[216:219], v[116:119]
v_mfma_f32_16x16x32_bf16 v[116:119], a[220:223], v[220:223], v[116:119]
v_exp_f32 v156, v156
v_mfma_f32_16x16x32_bf16 v[116:119], a[224:227], v[224:227], v[116:119]
v_cvt_pk_bf16_f32 v93, v94, v95
v_mfma_f32_16x16x32_bf16 v[116:119], a[228:231], v[228:231], v[116:119]
v_mfma_f32_16x16x32_bf16 v[124:127], a[228:231], v[252:255], v[60:63]
v_exp_f32 v157, v157
v_mfma_f32_16x16x32_bf16 v[124:127], a[224:227], v[248:251], v[124:127]
v_mfma_f32_16x16x32_bf16 v[124:127], a[220:223], v[244:247], v[124:127]
v_exp_f32 v158, v158
v_mfma_f32_16x16x32_bf16 v[124:127], a[216:219], v[240:243], v[124:127]
v_cvt_pk_bf16_f32 v94, v156, v157
s_waitcnt lgkmcnt(0)
v_mfma_f32_16x16x32_bf16 v[124:127], a[212:215], v[236:239], v[124:127]
v_exp_f32 v159, v159
v_mfma_f32_16x16x32_bf16 v[124:127], a[208:211], v[232:235], v[124:127]
v_mfma_f32_16x16x32_bf16 v[144:147], a[232:235], v[160:163], v[48:51]
s_add_u32 m0, s40, 81920
v_cvt_pk_bf16_f32 v95, v158, v159
v_mfma_f32_16x16x32_bf16 v[144:147], a[236:239], v[164:167], v[144:147]
v_mfma_f32_16x16x32_bf16 v[144:147], a[240:243], v[168:171], v[144:147]
v_mfma_f32_16x16x32_bf16 v[144:147], a[244:247], v[172:175], v[144:147]
v_mfma_f32_16x16x32_bf16 v[144:147], a[248:251], v[176:179], v[144:147]
s_waitcnt vmcnt(12) lgkmcnt(0)
s_barrier
v_mfma_f32_16x16x32_bf16 v[144:147], a[252:255], v[180:183], v[144:147]
ds_read_b64_tr_b16 a[192:193], v9 offset:8192
v_mfma_f32_16x16x32_bf16 v[148:151], a[252:255], v[204:207], v[52:55]
buffer_load_dwordx4 v19, s[8:11], s34 offen offset:0 nt lds
v_mfma_f32_16x16x32_bf16 v[148:151], a[248:251], v[200:203], v[148:151]
ds_read_b64_tr_b16 a[194:195], v9 offset:14336
v_mfma_f32_16x16x32_bf16 v[148:151], a[244:247], v[196:199], v[148:151]
ds_read_b64_tr_b16 a[196:197], v9 offset:20480
v_mfma_f32_16x16x32_bf16 v[148:151], a[240:243], v[192:195], v[148:151]
ds_read_b64_tr_b16 a[198:199], v9 offset:26624
v_mfma_f32_16x16x32_bf16 v[148:151], a[236:239], v[188:191], v[148:151]
v_mfma_f32_16x16x32_bf16 v[148:151], a[232:235], v[184:187], v[148:151]
ds_read_b64_tr_b16 a[200:201], v10 offset:8192
v_mfma_f32_16x16x32_bf16 v[152:155], a[232:235], v[208:211], v[56:59]
ds_read_b64_tr_b16 a[202:203], v10 offset:14336
v_mfma_f32_16x16x32_bf16 v[152:155], a[236:239], v[212:215], v[152:155]
buffer_load_dwordx4 v19, s[8:11], s34 offen offset:3072 nt lds
v_mfma_f32_16x16x32_bf16 v[152:155], a[240:243], v[216:219], v[152:155]
ds_read_b64_tr_b16 a[204:205], v10 offset:20480
v_mfma_f32_16x16x32_bf16 v[152:155], a[244:247], v[220:223], v[152:155]
v_mfma_f32_16x16x32_bf16 v[152:155], a[248:251], v[224:227], v[152:155]
ds_read_b64_tr_b16 a[206:207], v10 offset:26624
v_mfma_f32_16x16x32_bf16 v[152:155], a[252:255], v[228:231], v[152:155]
v_mfma_f32_16x16x32_bf16 v[156:159], a[252:255], v[252:255], v[60:63]
ds_read_b64_tr_b16 a[208:209], v11 offset:8192
v_mfma_f32_16x16x32_bf16 v[156:159], a[248:251], v[248:251], v[156:159]
v_mfma_f32_16x16x32_bf16 v[156:159], a[244:247], v[244:247], v[156:159]
ds_read_b64_tr_b16 a[210:211], v11 offset:14336
v_mfma_f32_16x16x32_bf16 v[156:159], a[240:243], v[240:243], v[156:159]
v_mfma_f32_16x16x32_bf16 v[156:159], a[236:239], v[236:239], v[156:159]
s_waitcnt lgkmcnt(6)
v_mfma_f32_16x16x32_bf16 v[156:159], a[232:235], v[232:235], v[156:159]
v_mfma_f32_16x16x32_bf16 a[0:3], a[192:195], v[64:67], a[0:3]
ds_read_b64_tr_b16 a[212:213], v11 offset:20480
v_mfma_f32_16x16x32_bf16 a[0:3], a[196:199], v[68:71], a[0:3]
v_exp_f32 v96, v96
v_mfma_f32_16x16x32_bf16 a[4:7], a[192:195], v[72:75], a[4:7]
ds_read_b64_tr_b16 a[214:215], v11 offset:26624
s_add_u32 m0, s40, 82816
v_mfma_f32_16x16x32_bf16 a[4:7], a[196:199], v[76:79], a[4:7]
v_exp_f32 v97, v97
v_mfma_f32_16x16x32_bf16 a[8:11], a[192:195], v[80:83], a[8:11]
ds_read_b64_tr_b16 a[216:217], v12 offset:8192
v_cvt_pk_bf16_f32 v96, v96, v97
v_mfma_f32_16x16x32_bf16 a[8:11], a[196:199], v[84:87], a[8:11]
v_exp_f32 v98, v98
v_mfma_f32_16x16x32_bf16 a[12:15], a[192:195], v[88:91], a[12:15]
ds_read_b64_tr_b16 a[218:219], v12 offset:14336
s_waitcnt lgkmcnt(6)
v_mfma_f32_16x16x32_bf16 a[12:15], a[196:199], v[92:95], a[12:15]
ds_read_b64_tr_b16 a[220:221], v12 offset:20480
v_mfma_f32_16x16x32_bf16 a[16:19], a[200:203], v[64:67], a[16:19]
buffer_load_dwordx4 v19, s[8:11], s34 offen offset:128 nt lds
v_mfma_f32_16x16x32_bf16 a[16:19], a[204:207], v[68:71], a[16:19]
v_exp_f32 v99, v99
v_mfma_f32_16x16x32_bf16 a[20:23], a[200:203], v[72:75], a[20:23]
ds_read_b64_tr_b16 a[222:223], v12 offset:26624
v_cvt_pk_bf16_f32 v97, v98, v99
v_mfma_f32_16x16x32_bf16 a[20:23], a[204:207], v[76:79], a[20:23]
v_exp_f32 v128, v128
v_mfma_f32_16x16x32_bf16 a[24:27], a[200:203], v[80:83], a[24:27]
ds_read_b64_tr_b16 a[224:225], v9 offset:9216
v_mfma_f32_16x16x32_bf16 a[24:27], a[204:207], v[84:87], a[24:27]
ds_read_b64_tr_b16 a[226:227], v9 offset:15360
s_waitcnt lgkmcnt(6)
v_mfma_f32_16x16x32_bf16 a[28:31], a[200:203], v[88:91], a[28:31]
v_exp_f32 v129, v129
v_mfma_f32_16x16x32_bf16 a[28:31], a[204:207], v[92:95], a[28:31]
ds_read_b64_tr_b16 a[228:229], v9 offset:21504
v_cvt_pk_bf16_f32 v98, v128, v129
v_mfma_f32_16x16x32_bf16 a[32:35], a[208:211], v[64:67], a[32:35]
v_exp_f32 v130, v130
v_mfma_f32_16x16x32_bf16 a[32:35], a[212:215], v[68:71], a[32:35]
ds_read_b64_tr_b16 a[230:231], v9 offset:27648
v_mfma_f32_16x16x32_bf16 a[36:39], a[208:211], v[72:75], a[36:39]
ds_read_b64_tr_b16 a[232:233], v10 offset:9216
v_mfma_f32_16x16x32_bf16 a[36:39], a[212:215], v[76:79], a[36:39]
v_exp_f32 v131, v131
v_mfma_f32_16x16x32_bf16 a[40:43], a[208:211], v[80:83], a[40:43]
ds_read_b64_tr_b16 a[234:235], v10 offset:15360
v_cvt_pk_bf16_f32 v99, v130, v131
v_mfma_f32_16x16x32_bf16 a[40:43], a[212:215], v[84:87], a[40:43]
buffer_load_dwordx4 v19, s[8:11], s34 offen offset:3200 nt lds
v_mfma_f32_16x16x32_bf16 a[44:47], a[208:211], v[88:91], a[44:47]
v_exp_f32 v104, v104
v_mfma_f32_16x16x32_bf16 a[44:47], a[212:215], v[92:95], a[44:47]
s_waitcnt lgkmcnt(6)
ds_read_b64_tr_b16 a[236:237], v10 offset:21504
v_mfma_f32_16x16x32_bf16 a[48:51], a[216:219], v[64:67], a[48:51]
ds_read_b64_tr_b16 a[238:239], v10 offset:27648
v_mfma_f32_16x16x32_bf16 a[48:51], a[220:223], v[68:71], a[48:51]
v_exp_f32 v105, v105
v_mfma_f32_16x16x32_bf16 a[52:55], a[216:219], v[72:75], a[52:55]
ds_read_b64_tr_b16 a[240:241], v11 offset:9216
v_cvt_pk_bf16_f32 v104, v104, v105
v_mfma_f32_16x16x32_bf16 a[52:55], a[220:223], v[76:79], a[52:55]
v_exp_f32 v106, v106
v_mfma_f32_16x16x32_bf16 a[56:59], a[216:219], v[80:83], a[56:59]
ds_read_b64_tr_b16 a[242:243], v11 offset:15360
s_add_u32 m0, s40, 83712
v_mfma_f32_16x16x32_bf16 a[56:59], a[220:223], v[84:87], a[56:59]
ds_read_b64_tr_b16 a[244:245], v11 offset:21504
s_waitcnt lgkmcnt(7)
v_mfma_f32_16x16x32_bf16 a[60:63], a[216:219], v[88:91], a[60:63]
v_exp_f32 v107, v107
v_mfma_f32_16x16x32_bf16 a[60:63], a[220:223], v[92:95], a[60:63]
ds_read_b64_tr_b16 a[246:247], v11 offset:27648
v_cvt_pk_bf16_f32 v105, v106, v107
v_mfma_f32_16x16x32_bf16 a[64:67], a[224:227], v[64:67], a[64:67]
v_exp_f32 v132, v132
v_mfma_f32_16x16x32_bf16 a[64:67], a[228:231], v[68:71], a[64:67]
ds_read_b64_tr_b16 a[248:249], v12 offset:9216
v_mfma_f32_16x16x32_bf16 a[68:71], a[224:227], v[72:75], a[68:71]
ds_read_b64_tr_b16 a[250:251], v12 offset:15360
v_mfma_f32_16x16x32_bf16 a[68:71], a[228:231], v[76:79], a[68:71]
v_exp_f32 v133, v133
v_mfma_f32_16x16x32_bf16 a[72:75], a[224:227], v[80:83], a[72:75]
ds_read_b64_tr_b16 a[252:253], v12 offset:21504
v_cvt_pk_bf16_f32 v106, v132, v133
v_mfma_f32_16x16x32_bf16 a[72:75], a[228:231], v[84:87], a[72:75]
v_exp_f32 v134, v134
v_mfma_f32_16x16x32_bf16 a[76:79], a[224:227], v[88:91], a[76:79]
ds_read_b64_tr_b16 a[254:255], v12 offset:27648
s_waitcnt lgkmcnt(8)
v_mfma_f32_16x16x32_bf16 a[76:79], a[228:231], v[92:95], a[76:79]
buffer_load_dwordx4 v19, s[8:11], s34 offen offset:256 nt lds
v_mfma_f32_16x16x32_bf16 a[80:83], a[232:235], v[64:67], a[80:83]
ds_read_b64_tr_b16 a[192:193], v9 offset:10240
v_mfma_f32_16x16x32_bf16 a[80:83], a[236:239], v[68:71], a[80:83]
v_exp_f32 v135, v135
v_mfma_f32_16x16x32_bf16 a[84:87], a[232:235], v[72:75], a[84:87]
ds_read_b64_tr_b16 a[194:195], v9 offset:16384
v_cvt_pk_bf16_f32 v107, v134, v135
v_mfma_f32_16x16x32_bf16 a[84:87], a[236:239], v[76:79], a[84:87]
v_exp_f32 v112, v112
v_mfma_f32_16x16x32_bf16 a[88:91], a[232:235], v[80:83], a[88:91]
ds_read_b64_tr_b16 a[196:197], v9 offset:22528
v_mfma_f32_16x16x32_bf16 a[88:91], a[236:239], v[84:87], a[88:91]
ds_read_b64_tr_b16 a[198:199], v9 offset:28672
s_waitcnt lgkmcnt(8)
v_mfma_f32_16x16x32_bf16 a[92:95], a[232:235], v[88:91], a[92:95]
v_exp_f32 v113, v113
v_mfma_f32_16x16x32_bf16 a[92:95], a[236:239], v[92:95], a[92:95]
ds_read_b64_tr_b16 a[200:201], v10 offset:10240
v_cvt_pk_bf16_f32 v112, v112, v113
v_mfma_f32_16x16x32_bf16 a[96:99], a[240:243], v[64:67], a[96:99]
v_exp_f32 v114, v114
v_mfma_f32_16x16x32_bf16 a[96:99], a[244:247], v[68:71], a[96:99]
ds_read_b64_tr_b16 a[202:203], v10 offset:16384
v_mfma_f32_16x16x32_bf16 a[100:103], a[240:243], v[72:75], a[100:103]
ds_read_b64_tr_b16 a[204:205], v10 offset:22528
v_mfma_f32_16x16x32_bf16 a[100:103], a[244:247], v[76:79], a[100:103]
v_exp_f32 v115, v115
v_mfma_f32_16x16x32_bf16 a[104:107], a[240:243], v[80:83], a[104:107]
buffer_load_dwordx4 v19, s[8:11], s34 offen offset:3328 nt lds
v_mfma_f32_16x16x32_bf16 a[104:107], a[244:247], v[84:87], a[104:107]
ds_read_b64_tr_b16 a[206:207], v10 offset:28672
v_cvt_pk_bf16_f32 v113, v114, v115
v_mfma_f32_16x16x32_bf16 a[108:111], a[240:243], v[88:91], a[108:111]
v_exp_f32 v136, v136
v_mfma_f32_16x16x32_bf16 a[108:111], a[244:247], v[92:95], a[108:111]
s_waitcnt lgkmcnt(8)
ds_read_b64_tr_b16 a[208:209], v11 offset:10240
v_mfma_f32_16x16x32_bf16 a[112:115], a[248:251], v[64:67], a[112:115]
ds_read_b64_tr_b16 a[210:211], v11 offset:16384
v_mfma_f32_16x16x32_bf16 a[112:115], a[252:255], v[68:71], a[112:115]
v_exp_f32 v137, v137
v_mfma_f32_16x16x32_bf16 a[116:119], a[248:251], v[72:75], a[116:119]
ds_read_b64_tr_b16 a[212:213], v11 offset:22528
v_cvt_pk_bf16_f32 v114, v136, v137
v_mfma_f32_16x16x32_bf16 a[116:119], a[252:255], v[76:79], a[116:119]
v_exp_f32 v138, v138
v_mfma_f32_16x16x32_bf16 a[120:123], a[248:251], v[80:83], a[120:123]
ds_read_b64_tr_b16 a[214:215], v11 offset:28672
s_add_u32 s34, s34, 24576
v_mfma_f32_16x16x32_bf16 a[120:123], a[252:255], v[84:87], a[120:123]
ds_read_b64_tr_b16 a[216:217], v12 offset:10240
s_waitcnt lgkmcnt(9)
v_mfma_f32_16x16x32_bf16 a[124:127], a[248:251], v[88:91], a[124:127]
v_exp_f32 v139, v139
v_mfma_f32_16x16x32_bf16 a[124:127], a[252:255], v[92:95], a[124:127]
ds_read_b64_tr_b16 a[218:219], v12 offset:16384
v_cvt_pk_bf16_f32 v115, v138, v139
v_mfma_f32_16x16x32_bf16 a[128:131], a[192:195], v[64:67], a[128:131]
v_exp_f32 v120, v120
v_mfma_f32_16x16x32_bf16 a[128:131], a[196:199], v[68:71], a[128:131]
ds_read_b64_tr_b16 a[220:221], v12 offset:22528
v_mfma_f32_16x16x32_bf16 a[132:135], a[192:195], v[72:75], a[132:135]
v_mfma_f32_16x16x32_bf16 a[132:135], a[196:199], v[76:79], a[132:135]
ds_read_b64_tr_b16 a[222:223], v12 offset:28672
v_mfma_f32_16x16x32_bf16 a[136:139], a[192:195], v[80:83], a[136:139]
v_exp_f32 v121, v121
v_mfma_f32_16x16x32_bf16 a[136:139], a[196:199], v[84:87], a[136:139]
v_cvt_pk_bf16_f32 v120, v120, v121
s_waitcnt lgkmcnt(8)
v_mfma_f32_16x16x32_bf16 a[140:143], a[192:195], v[88:91], a[140:143]
v_exp_f32 v122, v122
v_mfma_f32_16x16x32_bf16 a[140:143], a[196:199], v[92:95], a[140:143]
v_mfma_f32_16x16x32_bf16 a[144:147], a[200:203], v[64:67], a[144:147]
v_mfma_f32_16x16x32_bf16 a[144:147], a[204:207], v[68:71], a[144:147]
v_exp_f32 v123, v123
v_mfma_f32_16x16x32_bf16 a[148:151], a[200:203], v[72:75], a[148:151]
v_mfma_f32_16x16x32_bf16 a[148:151], a[204:207], v[76:79], a[148:151]
s_add_u32 m0, s40, 106496
v_cvt_pk_bf16_f32 v121, v122, v123
v_mfma_f32_16x16x32_bf16 a[152:155], a[200:203], v[80:83], a[152:155]
s_waitcnt vmcnt(12) lgkmcnt(0)
s_barrier
v_mfma_f32_16x16x32_bf16 a[152:155], a[204:207], v[84:87], a[152:155]
ds_read_b128 a[224:227], v1 offset:32768
v_mfma_f32_16x16x32_bf16 a[156:159], a[200:203], v[88:91], a[156:159]
buffer_load_dwordx4 v19, s[12:15], s35 offen offset:0 nt lds
v_mfma_f32_16x16x32_bf16 a[156:159], a[204:207], v[92:95], a[156:159]
ds_read_b128 a[228:231], v2 offset:32768
v_mfma_f32_16x16x32_bf16 a[160:163], a[208:211], v[64:67], a[160:163]
ds_read_b128 a[232:235], v1 offset:33792
v_mfma_f32_16x16x32_bf16 a[160:163], a[212:215], v[68:71], a[160:163]
ds_read_b128 a[236:239], v2 offset:33792
v_mfma_f32_16x16x32_bf16 a[164:167], a[208:211], v[72:75], a[164:167]
ds_read_b128 a[240:243], v1 offset:34816
v_mfma_f32_16x16x32_bf16 a[164:167], a[212:215], v[76:79], a[164:167]
ds_read_b128 a[244:247], v2 offset:34816
v_mfma_f32_16x16x32_bf16 a[168:171], a[208:211], v[80:83], a[168:171]
v_mfma_f32_16x16x32_bf16 a[168:171], a[212:215], v[84:87], a[168:171]
v_exp_f32 v140, v140
v_mfma_f32_16x16x32_bf16 a[172:175], a[208:211], v[88:91], a[172:175]
v_mfma_f32_16x16x32_bf16 a[172:175], a[212:215], v[92:95], a[172:175]
buffer_load_dwordx4 v19, s[12:15], s35 offen offset:3072 nt lds
v_mfma_f32_16x16x32_bf16 a[176:179], a[216:219], v[64:67], a[176:179]
v_exp_f32 v141, v141
v_mfma_f32_16x16x32_bf16 a[176:179], a[220:223], v[68:71], a[176:179]
s_add_u32 s39, s39, 1
v_cvt_pk_bf16_f32 v122, v140, v141
v_mfma_f32_16x16x32_bf16 a[180:183], a[216:219], v[72:75], a[180:183]
v_exp_f32 v142, v142
v_mfma_f32_16x16x32_bf16 a[180:183], a[220:223], v[76:79], a[180:183]
v_mfma_f32_16x16x32_bf16 a[184:187], a[216:219], v[80:83], a[184:187]
v_mfma_f32_16x16x32_bf16 a[184:187], a[220:223], v[84:87], a[184:187]
v_exp_f32 v143, v143
v_mfma_f32_16x16x32_bf16 a[188:191], a[216:219], v[88:91], a[188:191]
s_or_b32 s80, s1, 0x40
s_bitcmp0_b32 s80, s39
v_mfma_f32_16x16x32_bf16 a[188:191], a[220:223], v[92:95], a[188:191]
v_cvt_pk_bf16_f32 v123, v142, v143
v_smfmac_f32_16x16x64_bf16 v[24:27], v[32:35], v[64:71], v17
v_smfmac_f32_16x16x64_bf16 v[24:27], v[36:39], v[72:79], v17
v_smfmac_f32_16x16x64_bf16 v[24:27], v[40:43], v[80:87], v17
s_waitcnt lgkmcnt(0)
v_smfmac_f32_16x16x64_bf16 v[24:27], v[44:47], v[88:95], v17
s_cbranch_scc1 K1_L
s_cmp_lg_u32 s39, 6
s_cbranch_scc1 K1_LA
s_cmp_eq_u32 s47, 0
s_cbranch_scc1 K1_LASTA
K1_LASTB:
s_cmp_eq_u32 s70, 0
s_cbranch_scc1 K1_REDO
v_mfma_f32_16x16x32_bf16 v[64:67], a[224:227], v[160:163], v[48:51]
v_exp_f32 v100, v100
v_mfma_f32_16x16x32_bf16 v[64:67], a[228:231], v[164:167], v[64:67]
ds_read_b128 a[248:251], v1 offset:38912
s_cmp_le_u32 s52, 0
v_mfma_f32_16x16x32_bf16 v[64:67], a[232:235], v[168:171], v[64:67]
v_exp_f32 v101, v101
v_mfma_f32_16x16x32_bf16 v[64:67], a[236:239], v[172:175], v[64:67]
ds_read_b128 a[252:255], v2 offset:38912
s_cselect_b32 s86, s76, 0x1000
v_mfma_f32_16x16x32_bf16 v[64:67], a[240:243], v[176:179], v[64:67]
v_exp_f32 v102, v102
v_mfma_f32_16x16x32_bf16 v[64:67], a[244:247], v[180:183], v[64:67]
ds_read_b128 a[192:195], v1 offset:39936
v_cvt_pk_bf16_f32 v100, v100, v101
v_mfma_f32_16x16x32_bf16 v[72:75], a[244:247], v[204:207], v[52:55]
v_exp_f32 v103, v103
v_mfma_f32_16x16x32_bf16 v[72:75], a[240:243], v[200:203], v[72:75]
ds_read_b128 a[196:199], v2 offset:39936
s_cselect_b32 s87, 32, 0
v_mfma_f32_16x16x32_bf16 v[72:75], a[236:239], v[196:199], v[72:75]
buffer_load_dwordx2 v[14:15], off, s[72:75], s86 sc1
v_mfma_f32_16x16x32_bf16 v[72:75], a[232:235], v[192:195], v[72:75]
v_exp_f32 v144, v144
v_mfma_f32_16x16x32_bf16 v[72:75], a[228:231], v[188:191], v[72:75]
ds_read_b128 a[200:203], v1 offset:40960
v_cvt_pk_bf16_f32 v101, v102, v103
v_mfma_f32_16x16x32_bf16 v[72:75], a[224:227], v[184:187], v[72:75]
global_load_dword v30, v[28:29], off
v_mfma_f32_16x16x32_bf16 v[80:83], a[224:227], v[208:211], v[56:59]
v_exp_f32 v145, v145
v_mfma_f32_16x16x32_bf16 v[80:83], a[228:231], v[212:215], v[80:83]
v_exp_f32 v146, v146
v_mfma_f32_16x16x32_bf16 v[80:83], a[232:235], v[216:219], v[80:83]
ds_read_b128 a[204:207], v2 offset:40960
v_cvt_pk_bf16_f32 v102, v144, v145
v_mfma_f32_16x16x32_bf16 v[80:83], a[236:239], v[220:223], v[80:83]
s_mov_b64 s[60:61], s[98:99]
s_mov_b32 s62, 30720
v_mfma_f32_16x16x32_bf16 v[80:83], a[240:243], v[224:227], v[80:83]
v_exp_f32 v147, v147
v_mfma_f32_16x16x32_bf16 v[80:83], a[244:247], v[228:231], v[80:83]
s_mov_b32 s55, 16384
v_cvt_pk_bf16_f32 v103, v146, v147
v_mfma_f32_16x16x32_bf16 v[88:91], a[244:247], v[252:255], v[60:63]
v_exp_f32 v108, v108
v_mfma_f32_16x16x32_bf16 v[88:91], a[240:243], v[248:251], v[88:91]
s_mov_b64 s[4:5], s[64:65]
s_mov_b32 s6, s79
v_mfma_f32_16x16x32_bf16 v[88:91], a[236:239], v[244:247], v[88:91]
v_exp_f32 v109, v109
v_mfma_f32_16x16x32_bf16 v[88:91], a[232:235], v[240:243], v[88:91]
v_exp_f32 v110, v110
v_mfma_f32_16x16x32_bf16 v[88:91], a[228:231], v[236:239], v[88:91]
ds_read_b128 a[208:211], v1 offset:45056
s_waitcnt lgkmcnt(1)
v_mfma_f32_16x16x32_bf16 v[88:91], a[224:227], v[232:235], v[88:91]
ds_read_b128 a[212:215], v2 offset:45056
s_movk_i32 s80, 0x70
v_mfma_f32_16x16x32_bf16 v[128:131], a[248:251], v[160:163], v[48:51]
v_cvt_pk_bf16_f32 v108, v108, v109
v_lshrrev_b32 v21, 3, v0
v_mfma_f32_16x16x32_bf16 v[128:131], a[252:255], v[164:167], v[128:131]
ds_read_b128 a[216:219], v1 offset:46080
v_mul_u32_u24 v21, 1280, v21
v_mfma_f32_16x16x32_bf16 v[128:131], a[192:195], v[168:171], v[128:131]
v_and_or_b32 v21, v20, s80, v21
s_add_u32 m0, s40, 107392
v_mfma_f32_16x16x32_bf16 v[128:131], a[196:199], v[172:175], v[128:131]
v_exp_f32 v111, v111
v_mfma_f32_16x16x32_bf16 v[128:131], a[200:203], v[176:179], v[128:131]
ds_read_b128 a[220:223], v2 offset:46080
v_cvt_pk_bf16_f32 v109, v110, v111
v_mfma_f32_16x16x32_bf16 v[128:131], a[204:207], v[180:183], v[128:131]
v_exp_f32 v148, v148
v_mfma_f32_16x16x32_bf16 v[132:135], a[204:207], v[204:207], v[52:55]
buffer_load_dwordx4 v19, s[12:15], s35 offen offset:128 nt lds
v_mfma_f32_16x16x32_bf16 v[132:135], a[200:203], v[200:203], v[132:135]
v_exp_f32 v149, v149
v_mfma_f32_16x16x32_bf16 v[132:135], a[196:199], v[196:199], v[132:135]
ds_read_b128 a[224:227], v1 offset:47104
v_cvt_pk_bf16_f32 v110, v148, v149
v_mfma_f32_16x16x32_bf16 v[132:135], a[192:195], v[192:195], v[132:135]
v_exp_f32 v150, v150
v_mfma_f32_16x16x32_bf16 v[132:135], a[252:255], v[188:191], v[132:135]
buffer_load_dwordx4 v19, s[12:15], s35 offen offset:3200 nt lds
v_mfma_f32_16x16x32_bf16 v[132:135], a[248:251], v[184:187], v[132:135]
ds_read_b128 a[228:231], v2 offset:47104
s_add_u32 m0, s40, 108288
v_mfma_f32_16x16x32_bf16 v[136:139], a[248:251], v[208:211], v[56:59]
v_exp_f32 v151, v151
v_mfma_f32_16x16x32_bf16 v[136:139], a[252:255], v[212:215], v[136:139]
v_cvt_pk_bf16_f32 v111, v150, v151
v_mfma_f32_16x16x32_bf16 v[136:139], a[192:195], v[216:219], v[136:139]
v_exp_f32 v116, v116
v_mfma_f32_16x16x32_bf16 v[136:139], a[196:199], v[220:223], v[136:139]
buffer_load_dwordx4 v19, s[12:15], s35 offen offset:256 nt lds
v_mfma_f32_16x16x32_bf16 v[136:139], a[200:203], v[224:227], v[136:139]
v_exp_f32 v117, v117
v_mfma_f32_16x16x32_bf16 v[136:139], a[204:207], v[228:231], v[136:139]
v_cvt_pk_bf16_f32 v116, v116, v117
v_mfma_f32_16x16x32_bf16 v[140:143], a[204:207], v[252:255], v[60:63]
buffer_load_dwordx4 v19, s[12:15], s35 offen offset:3328 nt lds
v_mfma_f32_16x16x32_bf16 v[140:143], a[200:203], v[248:251], v[140:143]
s_mov_b32 s54, 368640
s_add_u32 m0, s40, 131072
v_mfma_f32_16x16x32_bf16 v[140:143], a[196:199], v[244:247], v[140:143]
v_exp_f32 v118, v118
v_mfma_f32_16x16x32_bf16 v[140:143], a[192:195], v[240:243], v[140:143]
v_exp_f32 v119, v119
v_mfma_f32_16x16x32_bf16 v[140:143], a[252:255], v[236:239], v[140:143]
ds_read_b128 a[232:235], v1 offset:51200
s_waitcnt lgkmcnt(1)
v_mfma_f32_16x16x32_bf16 v[140:143], a[248:251], v[232:235], v[140:143]
ds_read_b128 a[236:239], v2 offset:51200
v_cvt_pk_bf16_f32 v117, v118, v119
v_mfma_f32_16x16x32_bf16 v[68:71], a[208:211], v[160:163], v[48:51]
v_exp_f32 v152, v152
v_mfma_f32_16x16x32_bf16 v[68:71], a[212:215], v[164:167], v[68:71]
buffer_load_dwordx4 v19, s[12:15], s54 offen offset:0 nt lds
v_mfma_f32_16x16x32_bf16 v[68:71], a[216:219], v[168:171], v[68:71]
v_exp_f32 v153, v153
v_mfma_f32_16x16x32_bf16 v[68:71], a[220:223], v[172:175], v[68:71]
ds_read_b128 a[240:243], v1 offset:52224
v_cvt_pk_bf16_f32 v118, v152, v153
v_mfma_f32_16x16x32_bf16 v[68:71], a[224:227], v[176:179], v[68:71]
v_exp_f32 v154, v154
v_mfma_f32_16x16x32_bf16 v[68:71], a[228:231], v[180:183], v[68:71]
buffer_load_dwordx4 v19, s[12:15], s54 offen offset:3072 nt lds
v_mfma_f32_16x16x32_bf16 v[76:79], a[228:231], v[204:207], v[52:55]
ds_read_b128 a[244:247], v2 offset:52224
s_mov_b64 s[8:9], s[100:101]
v_mfma_f32_16x16x32_bf16 v[76:79], a[224:227], v[200:203], v[76:79]
ds_read_b128 a[248:251], v1 offset:53248
s_cmp_lt_u32 s53, 240
v_mfma_f32_16x16x32_bf16 v[76:79], a[220:223], v[196:199], v[76:79]
s_cselect_b32 s10, 17576960, 0
s_and_b32 s51, s53, 7
v_mfma_f32_16x16x32_bf16 v[76:79], a[216:219], v[192:195], v[76:79]
v_exp_f32 v155, v155
v_mfma_f32_16x16x32_bf16 v[76:79], a[212:215], v[188:191], v[76:79]
ds_read_b128 a[252:255], v2 offset:53248
v_cvt_pk_bf16_f32 v119, v154, v155
v_mfma_f32_16x16x32_bf16 v[76:79], a[208:211], v[184:187], v[76:79]
s_lshl_b32 s51, s51, 7
s_add_u32 s51, s51, 64
v_mfma_f32_16x16x32_bf16 v[84:87], a[208:211], v[208:211], v[56:59]
v_exp_f32 v124, v124
v_mfma_f32_16x16x32_bf16 v[84:87], a[212:215], v[212:215], v[84:87]
s_cmp_eq_u32 s52, 0
s_cselect_b32 s50, s51, 0x10000
v_mfma_f32_16x16x32_bf16 v[84:87], a[216:219], v[216:219], v[84:87]
v_exp_f32 v125, v125
v_mfma_f32_16x16x32_bf16 v[84:87], a[220:223], v[220:223], v[84:87]
s_add_u32 s28, s68, 48234496
v_cvt_pk_bf16_f32 v124, v124, v125
v_mfma_f32_16x16x32_bf16 v[84:87], a[224:227], v[224:227], v[84:87]
v_exp_f32 v126, v126
v_mfma_f32_16x16x32_bf16 v[84:87], a[228:231], v[228:231], v[84:87]
s_addc_u32 s29, s69, 0
s_mov_b32 s30, 32768
v_mfma_f32_16x16x32_bf16 v[92:95], a[228:231], v[252:255], v[60:63]
v_exp_f32 v127, v127
v_mfma_f32_16x16x32_bf16 v[92:95], a[224:227], v[248:251], v[92:95]
s_mov_b32 s31, 0x20000
v_cvt_pk_bf16_f32 v125, v126, v127
v_mfma_f32_16x16x32_bf16 v[92:95], a[220:223], v[244:247], v[92:95]
v_exp_f32 v156, v156
v_mfma_f32_16x16x32_bf16 v[92:95], a[216:219], v[240:243], v[92:95]
v_exp_f32 v157, v157
v_mfma_f32_16x16x32_bf16 v[92:95], a[212:215], v[236:239], v[92:95]
v_cvt_pk_bf16_f32 v126, v156, v157
s_waitcnt lgkmcnt(0)
v_mfma_f32_16x16x32_bf16 v[92:95], a[208:211], v[232:235], v[92:95]
s_andn2_b32 s89, 8, s53
s_lshl_b32 s89, s89, 3
s_add_u32 s89, s89, 65536
v_mfma_f32_16x16x32_bf16 v[144:147], a[232:235], v[160:163], v[48:51]
v_exp_f32 v158, v158
v_mfma_f32_16x16x32_bf16 v[144:147], a[236:239], v[164:167], v[144:147]
v_exp_f32 v159, v159
v_mfma_f32_16x16x32_bf16 v[144:147], a[240:243], v[168:171], v[144:147]
s_add_u32 m0, s40, 131968
v_cvt_pk_bf16_f32 v127, v158, v159
v_mfma_f32_16x16x32_bf16 v[144:147], a[244:247], v[172:175], v[144:147]
v_exp_f32 v64, v64
v_mfma_f32_16x16x32_bf16 v[144:147], a[248:251], v[176:179], v[144:147]
s_waitcnt vmcnt(16) lgkmcnt(0)
s_barrier
v_mfma_f32_16x16x32_bf16 v[144:147], a[252:255], v[180:183], v[144:147]
ds_read_b64_tr_b16 a[192:193], v5 offset:24576
v_mfma_f32_16x16x32_bf16 v[148:151], a[252:255], v[204:207], v[52:55]
buffer_load_dwordx4 v19, s[12:15], s54 offen offset:128 nt lds
v_mfma_f32_16x16x32_bf16 v[148:151], a[248:251], v[200:203], v[148:151]
ds_read_b64_tr_b16 a[194:195], v5 offset:30720
v_mfma_f32_16x16x32_bf16 v[148:151], a[244:247], v[196:199], v[148:151]
ds_read_b64_tr_b16 a[196:197], v5 offset:36864
v_mfma_f32_16x16x32_bf16 v[148:151], a[240:243], v[192:195], v[148:151]
ds_read_b64_tr_b16 a[198:199], v5 offset:43008
v_mfma_f32_16x16x32_bf16 v[148:151], a[236:239], v[188:191], v[148:151]
ds_read_b64_tr_b16 a[200:201], v6 offset:24576
v_mfma_f32_16x16x32_bf16 v[148:151], a[232:235], v[184:187], v[148:151]
ds_read_b64_tr_b16 a[202:203], v6 offset:30720
v_mfma_f32_16x16x32_bf16 v[152:155], a[232:235], v[208:211], v[56:59]
buffer_load_dwordx4 v19, s[12:15], s54 offen offset:3200 nt lds
v_mfma_f32_16x16x32_bf16 v[152:155], a[236:239], v[212:215], v[152:155]
v_exp_f32 v65, v65
v_mfma_f32_16x16x32_bf16 v[152:155], a[240:243], v[216:219], v[152:155]
ds_read_b64_tr_b16 a[204:205], v6 offset:36864
v_cvt_pk_bf16_f32 v64, v64, v65
v_mfma_f32_16x16x32_bf16 v[152:155], a[244:247], v[220:223], v[152:155]
v_exp_f32 v66, v66
v_mfma_f32_16x16x32_bf16 v[152:155], a[248:251], v[224:227], v[152:155]
v_exp_f32 v67, v67
v_mfma_f32_16x16x32_bf16 v[152:155], a[252:255], v[228:231], v[152:155]
ds_read_b64_tr_b16 a[206:207], v6 offset:43008
v_cvt_pk_bf16_f32 v65, v66, v67
v_mfma_f32_16x16x32_bf16 v[156:159], a[252:255], v[252:255], v[60:63]
v_exp_f32 v128, v128
v_mfma_f32_16x16x32_bf16 v[156:159], a[248:251], v[248:251], v[156:159]
v_exp_f32 v129, v129
v_mfma_f32_16x16x32_bf16 v[156:159], a[244:247], v[244:247], v[156:159]
ds_read_b64_tr_b16 a[208:209], v7 offset:24576
v_cvt_pk_bf16_f32 v66, v128, v129
v_mfma_f32_16x16x32_bf16 v[156:159], a[240:243], v[240:243], v[156:159]
v_exp_f32 v130, v130
v_mfma_f32_16x16x32_bf16 v[156:159], a[236:239], v[236:239], v[156:159]
v_exp_f32 v131, v131
v_mfma_f32_16x16x32_bf16 v[156:159], a[232:235], v[232:235], v[156:159]
ds_read_b64_tr_b16 a[210:211], v7 offset:30720
v_cvt_pk_bf16_f32 v67, v130, v131
s_waitcnt lgkmcnt(6)
v_mfma_f32_16x16x32_bf16 a[0:3], a[192:195], v[96:99], a[0:3]
ds_read_b64_tr_b16 a[212:213], v7 offset:36864
v_mfma_f32_16x16x32_bf16 a[0:3], a[196:199], v[100:103], a[0:3]
v_exp_f32 v72, v72
v_mfma_f32_16x16x32_bf16 a[4:7], a[192:195], v[104:107], a[4:7]
ds_read_b64_tr_b16 a[214:215], v7 offset:43008
s_waitcnt vmcnt(9)
v_mfma_f32_16x16x32_bf16 a[4:7], a[196:199], v[108:111], a[4:7]
v_exp_f32 v73, v73
v_mfma_f32_16x16x32_bf16 a[8:11], a[192:195], v[112:115], a[8:11]
ds_read_b64_tr_b16 a[216:217], v8 offset:24576
v_cvt_pk_bf16_f32 v72, v72, v73
v_mfma_f32_16x16x32_bf16 a[8:11], a[196:199], v[116:119], a[8:11]
v_exp_f32 v74, v74
v_mfma_f32_16x16x32_bf16 a[12:15], a[192:195], v[120:123], a[12:15]
ds_read_b64_tr_b16 a[218:219], v8 offset:30720
s_waitcnt lgkmcnt(6)
v_mfma_f32_16x16x32_bf16 a[12:15], a[196:199], v[124:127], a[12:15]
v_exp_f32 v75, v75
v_mfma_f32_16x16x32_bf16 a[16:19], a[200:203], v[96:99], a[16:19]
ds_read_b64_tr_b16 a[220:221], v8 offset:36864
v_min_u32 v14, v14, v15
v_mfma_f32_16x16x32_bf16 a[16:19], a[204:207], v[100:103], a[16:19]
v_exp_f32 v132, v132
v_mfma_f32_16x16x32_bf16 a[20:23], a[200:203], v[104:107], a[20:23]
ds_read_b64_tr_b16 a[222:223], v8 offset:43008
v_readfirstlane_b32 s88, v14
v_mfma_f32_16x16x32_bf16 a[20:23], a[204:207], v[108:111], a[20:23]
ds_read_b64_tr_b16 a[224:225], v5 offset:25600
v_cvt_pk_bf16_f32 v73, v74, v75
v_mfma_f32_16x16x32_bf16 a[24:27], a[200:203], v[112:115], a[24:27]
v_exp_f32 v133, v133
v_mfma_f32_16x16x32_bf16 a[24:27], a[204:207], v[116:119], a[24:27]
s_cmp_lt_u32 s88, s87
s_cbranch_scc1 K2_SPIN0
K2_RET0:
v_mfma_f32_16x16x32_bf16 a[28:31], a[200:203], v[120:123], a[28:31]
ds_read_b64_tr_b16 a[226:227], v5 offset:31744
s_waitcnt lgkmcnt(6)
v_mfma_f32_16x16x32_bf16 a[28:31], a[204:207], v[124:127], a[28:31]
v_exp_f32 v134, v134
v_mfma_f32_16x16x32_bf16 a[32:35], a[208:211], v[96:99], a[32:35]
ds_read_b64_tr_b16 a[228:229], v5 offset:37888
v_cvt_pk_bf16_f32 v74, v132, v133
v_mfma_f32_16x16x32_bf16 a[32:35], a[212:215], v[100:103], a[32:35]
v_exp_f32 v135, v135
v_mfma_f32_16x16x32_bf16 a[36:39], a[208:211], v[104:107], a[36:39]
ds_read_b64_tr_b16 a[230:231], v5 offset:44032
v_lshrrev_b32 v14, 5, v0
v_mfma_f32_16x16x32_bf16 a[36:39], a[212:215], v[108:111], a[36:39]
v_exp_f32 v80, v80
v_mfma_f32_16x16x32_bf16 a[40:43], a[208:211], v[112:115], a[40:43]
ds_read_b64_tr_b16 a[232:233], v6 offset:25600
v_cvt_pk_bf16_f32 v75, v134, v135
v_mfma_f32_16x16x32_bf16 a[40:43], a[212:215], v[116:119], a[40:43]
ds_read_b64_tr_b16 a[234:235], v6 offset:31744
s_add_u32 m0, s40, 132864
v_mfma_f32_16x16x32_bf16 a[44:47], a[208:211], v[120:123], a[44:47]
ds_read_b64_tr_b16 a[236:237], v6 offset:37888
s_waitcnt lgkmcnt(7)
v_mfma_f32_16x16x32_bf16 a[44:47], a[212:215], v[124:127], a[44:47]
ds_read_b64_tr_b16 a[238:239], v6 offset:44032
v_lshlrev_b32 v13, 10, v14
v_mfma_f32_16x16x32_bf16 a[48:51], a[216:219], v[96:99], a[48:51]
v_exp_f32 v81, v81
v_mfma_f32_16x16x32_bf16 a[48:51], a[220:223], v[100:103], a[48:51]
ds_read_b64_tr_b16 a[240:241], v7 offset:25600
v_cvt_pk_bf16_f32 v80, v80, v81
v_mfma_f32_16x16x32_bf16 a[52:55], a[216:219], v[104:107], a[52:55]
buffer_load_dwordx4 v19, s[12:15], s54 offen offset:256 nt lds
v_mfma_f32_16x16x32_bf16 a[52:55], a[220:223], v[108:111], a[52:55]
ds_read_b64_tr_b16 a[242:243], v7 offset:31744
v_bfe_u32 v14, v0, 2, 3
v_mfma_f32_16x16x32_bf16 a[56:59], a[216:219], v[112:115], a[56:59]
v_exp_f32 v82, v82
v_mfma_f32_16x16x32_bf16 a[56:59], a[220:223], v[116:119], a[56:59]
v_exp_f32 v83, v83
v_mfma_f32_16x16x32_bf16 a[60:63], a[216:219], v[120:123], a[60:63]
ds_read_b64_tr_b16 a[244:245], v7 offset:37888
s_waitcnt lgkmcnt(7)
v_mfma_f32_16x16x32_bf16 a[60:63], a[220:223], v[124:127], a[60:63]
ds_read_b64_tr_b16 a[246:247], v7 offset:44032
v_cvt_pk_bf16_f32 v81, v82, v83
v_mfma_f32_16x16x32_bf16 a[64:67], a[224:227], v[96:99], a[64:67]
ds_read_b64_tr_b16 a[248:249], v8 offset:25600
v_lshl_add_u32 v13, v14, 7, v13
v_mfma_f32_16x16x32_bf16 a[64:67], a[228:231], v[100:103], a[64:67]
v_exp_f32 v136, v136
v_mfma_f32_16x16x32_bf16 a[68:71], a[224:227], v[104:107], a[68:71]
buffer_load_dwordx4 v19, s[12:15], s54 offen offset:3328 nt lds
v_mfma_f32_16x16x32_bf16 a[68:71], a[228:231], v[108:111], a[68:71]
v_exp_f32 v137, v137
v_mfma_f32_16x16x32_bf16 a[72:75], a[224:227], v[112:115], a[72:75]
ds_read_b64_tr_b16 a[250:251], v8 offset:31744
v_cvt_pk_bf16_f32 v82, v136, v137
v_mfma_f32_16x16x32_bf16 a[72:75], a[228:231], v[116:119], a[72:75]
ds_read_b64_tr_b16 a[252:253], v8 offset:37888
v_and_b32 v14, 6, v14
v_mfma_f32_16x16x32_bf16 a[76:79], a[224:227], v[120:123], a[76:79]
v_exp_f32 v138, v138
v_mfma_f32_16x16x32_bf16 a[76:79], a[228:231], v[124:127], a[76:79]
s_waitcnt lgkmcnt(7)
v_bfe_u32 v15, v0, 1, 1
v_mfma_f32_16x16x32_bf16 a[80:83], a[232:235], v[96:99], a[80:83]
v_exp_f32 v139, v139
v_mfma_f32_16x16x32_bf16 a[80:83], a[236:239], v[100:103], a[80:83]
ds_read_b64_tr_b16 a[254:255], v8 offset:44032
v_cvt_pk_bf16_f32 v83, v138, v139
v_mfma_f32_16x16x32_bf16 a[84:87], a[232:235], v[104:107], a[84:87]
buffer_load_dword v30, v22, s[60:63], 0 offen offset:0
v_mfma_f32_16x16x32_bf16 a[84:87], a[236:239], v[108:111], a[84:87]
v_exp_f32 v88, v88
v_mfma_f32_16x16x32_bf16 a[88:91], a[232:235], v[112:115], a[88:91]
v_exp_f32 v89, v89
v_mfma_f32_16x16x32_bf16 a[88:91], a[236:239], v[116:119], a[88:91]
ds_read_b64_tr_b16 a[192:193], v5 offset:26624
v_cvt_pk_bf16_f32 v88, v88, v89
v_mfma_f32_16x16x32_bf16 a[92:95], a[232:235], v[120:123], a[92:95]
ds_read_b64_tr_b16 a[194:195], v5 offset:32768
s_waitcnt lgkmcnt(6)
v_mfma_f32_16x16x32_bf16 a[92:95], a[236:239], v[124:127], a[92:95]
ds_read_b64_tr_b16 a[196:197], v5 offset:38912
v_xor_b32 v14, v14, v15
v_mfma_f32_16x16x32_bf16 a[96:99], a[240:243], v[96:99], a[96:99]
v_exp_f32 v90, v90
v_mfma_f32_16x16x32_bf16 a[96:99], a[244:247], v[100:103], a[96:99]
ds_read_b64_tr_b16 a[198:199], v5 offset:45056
v_lshl_add_u32 v13, v14, 4, v13
v_mfma_f32_16x16x32_bf16 a[100:103], a[240:243], v[104:107], a[100:103]
buffer_load_dword v30, v22, s[60:63], 0 offen offset:1024
v_mfma_f32_16x16x32_bf16 a[100:103], a[244:247], v[108:111], a[100:103]
v_exp_f32 v91, v91
v_mfma_f32_16x16x32_bf16 a[104:107], a[240:243], v[112:115], a[104:107]
ds_read_b64_tr_b16 a[200:201], v6 offset:26624
v_cvt_pk_bf16_f32 v89, v90, v91
v_mfma_f32_16x16x32_bf16 a[104:107], a[244:247], v[116:119], a[104:107]
v_exp_f32 v140, v140
v_mfma_f32_16x16x32_bf16 a[108:111], a[240:243], v[120:123], a[108:111]
ds_read_b64_tr_b16 a[202:203], v6 offset:32768
s_waitcnt lgkmcnt(6)
v_mfma_f32_16x16x32_bf16 a[108:111], a[244:247], v[124:127], a[108:111]
ds_read_b64_tr_b16 a[204:205], v6 offset:38912
v_and_b32 v14, 1, v0
v_mfma_f32_16x16x32_bf16 a[112:115], a[248:251], v[96:99], a[112:115]
buffer_load_dword v30, v22, s[60:63], 0 offen offset:2048
v_mfma_f32_16x16x32_bf16 a[112:115], a[252:255], v[100:103], a[112:115]
v_exp_f32 v141, v141
v_mfma_f32_16x16x32_bf16 a[116:119], a[248:251], v[104:107], a[116:119]
ds_read_b64_tr_b16 a[206:207], v6 offset:45056
v_cvt_pk_bf16_f32 v90, v140, v141
v_mfma_f32_16x16x32_bf16 a[116:119], a[252:255], v[108:111], a[116:119]
ds_read_b64_tr_b16 a[208:209], v7 offset:26624
v_lshl_add_u32 v13, v14, 3, v13
v_mfma_f32_16x16x32_bf16 a[120:123], a[248:251], v[112:115], a[120:123]
v_exp_f32 v142, v142
v_mfma_f32_16x16x32_bf16 a[120:123], a[252:255], v[116:119], a[120:123]
v_exp_f32 v143, v143
v_mfma_f32_16x16x32_bf16 a[124:127], a[248:251], v[120:123], a[124:127]
ds_read_b64_tr_b16 a[210:211], v7 offset:32768
s_waitcnt lgkmcnt(6)
v_mfma_f32_16x16x32_bf16 a[124:127], a[252:255], v[124:127], a[124:127]
ds_read_b64_tr_b16 a[212:213], v7 offset:38912
v_cvt_pk_bf16_f32 v91, v142, v143
v_mfma_f32_16x16x32_bf16 a[128:131], a[192:195], v[96:99], a[128:131]
ds_read_b64_tr_b16 a[214:215], v7 offset:45056
v_xor_b32 v13, s89, v13
v_mfma_f32_16x16x32_bf16 a[128:131], a[196:199], v[100:103], a[128:131]
buffer_load_dword v30, v22, s[60:63], 0 offen offset:3072
v_mfma_f32_16x16x32_bf16 a[132:135], a[192:195], v[104:107], a[132:135]
v_exp_f32 v68, v68
v_mfma_f32_16x16x32_bf16 a[132:135], a[196:199], v[108:111], a[132:135]
ds_read_b64_tr_b16 a[216:217], v8 offset:26624
v_xor_b32 v14, 32, v13
v_mfma_f32_16x16x32_bf16 a[136:139], a[192:195], v[112:115], a[136:139]
v_exp_f32 v69, v69
v_mfma_f32_16x16x32_bf16 a[136:139], a[196:199], v[116:119], a[136:139]
ds_read_b64_tr_b16 a[218:219], v8 offset:32768
v_cvt_pk_bf16_f32 v68, v68, v69
v_mfma_f32_16x16x32_bf16 a[140:143], a[192:195], v[120:123], a[140:143]
ds_read_b64_tr_b16 a[220:221], v8 offset:38912
s_waitcnt lgkmcnt(7)
v_mfma_f32_16x16x32_bf16 a[140:143], a[196:199], v[124:127], a[140:143]
buffer_load_dword v30, v22, s[60:63], s55 offen offset:0
buffer_load_dword v30, v22, s[60:63], s55 offen offset:1024
ds_read_b64_tr_b16 a[222:223], v8 offset:45056
v_mfma_f32_16x16x32_bf16 a[144:147], a[200:203], v[96:99], a[144:147]
v_xor_b32 v15, 64, v13
v_xor_b32 v16, 96, v13
v_mfma_f32_16x16x32_bf16 a[144:147], a[204:207], v[100:103], a[144:147]
v_exp_f32 v70, v70
v_mfma_f32_16x16x32_bf16 a[148:151], a[200:203], v[104:107], a[148:151]
v_exp_f32 v71, v71
v_mfma_f32_16x16x32_bf16 a[148:151], a[204:207], v[108:111], a[148:151]
v_cvt_pk_bf16_f32 v69, v70, v71
v_mfma_f32_16x16x32_bf16 a[152:155], a[200:203], v[112:115], a[152:155]
s_waitcnt vmcnt(20) lgkmcnt(0)
s_barrier
v_mfma_f32_16x16x32_bf16 a[152:155], a[204:207], v[116:119], a[152:155]
ds_read_b128 a[224:227], v3 offset:16384
v_mfma_f32_16x16x32_bf16 a[156:159], a[200:203], v[120:123], a[156:159]
buffer_load_dword v30, v22, s[60:63], s55 offen offset:2048
v_mfma_f32_16x16x32_bf16 a[156:159], a[204:207], v[124:127], a[156:159]
ds_read_b128 a[228:231], v4 offset:16384
v_mfma_f32_16x16x32_bf16 a[160:163], a[208:211], v[96:99], a[160:163]
ds_read_b128 a[232:235], v3 offset:17408
v_mfma_f32_16x16x32_bf16 a[160:163], a[212:215], v[100:103], a[160:163]
ds_read_b128 a[236:239], v4 offset:17408
v_mfma_f32_16x16x32_bf16 a[164:167], a[208:211], v[104:107], a[164:167]
v_mfma_f32_16x16x32_bf16 a[164:167], a[212:215], v[108:111], a[164:167]
ds_read_b128 a[240:243], v3 offset:18432
v_mfma_f32_16x16x32_bf16 a[168:171], a[208:211], v[112:115], a[168:171]
ds_read_b128 a[244:247], v4 offset:18432
v_mfma_f32_16x16x32_bf16 a[168:171], a[212:215], v[116:119], a[168:171]
v_exp_f32 v144, v144
v_exp_f32 v145, v145
v_mfma_f32_16x16x32_bf16 a[172:175], a[208:211], v[120:123], a[172:175]
v_cvt_pk_bf16_f32 v70, v144, v145
v_lshlrev_b32 v18, 4, v0
v_mfma_f32_16x16x32_bf16 a[172:175], a[212:215], v[124:127], a[172:175]
v_exp_f32 v146, v146
v_mfma_f32_16x16x32_bf16 a[176:179], a[216:219], v[96:99], a[176:179]
v_exp_f32 v147, v147
v_mfma_f32_16x16x32_bf16 a[176:179], a[220:223], v[100:103], a[176:179]
v_cvt_pk_bf16_f32 v71, v146, v147
v_mov_b32 v20, 1
v_mfma_f32_16x16x32_bf16 a[180:183], a[216:219], v[104:107], a[180:183]
v_exp_f32 v76, v76
v_mfma_f32_16x16x32_bf16 a[180:183], a[220:223], v[108:111], a[180:183]
v_exp_f32 v77, v77
v_mfma_f32_16x16x32_bf16 a[184:187], a[216:219], v[112:115], a[184:187]
v_cvt_pk_bf16_f32 v76, v76, v77
v_mfma_f32_16x16x32_bf16 a[184:187], a[220:223], v[116:119], a[184:187]
v_exp_f32 v78, v78
v_mfma_f32_16x16x32_bf16 a[188:191], a[216:219], v[120:123], a[188:191]
v_exp_f32 v79, v79
v_mfma_f32_16x16x32_bf16 a[188:191], a[220:223], v[124:127], a[188:191]
v_cvt_pk_bf16_f32 v77, v78, v79
v_smfmac_f32_16x16x64_bf16 v[24:27], v[32:35], v[96:103], v17
v_exp_f32 v148, v148
v_smfmac_f32_16x16x64_bf16 v[24:27], v[36:39], v[104:111], v17
v_exp_f32 v149, v149
v_smfmac_f32_16x16x64_bf16 v[24:27], v[40:43], v[112:119], v17
v_exp_f32 v150, v150
v_exp_f32 v151, v151
v_smfmac_f32_16x16x64_bf16 v[24:27], v[44:47], v[120:127], v17
buffer_load_dword v30, v22, s[60:63], s55 offen offset:3072
v_cvt_pk_bf16_f32 v78, v148, v149
v_cvt_pk_bf16_f32 v79, v150, v151
s_waitcnt lgkmcnt(0)
v_mfma_f32_16x16x32_bf16 v[96:99], a[224:227], v[160:163], v[48:51]
v_exp_f32 v84, v84
v_mfma_f32_16x16x32_bf16 v[96:99], a[228:231], v[164:167], v[96:99]
ds_read_b128 a[248:251], v3 offset:22528
s_bfe_u32 s80, s53, 0x10001
v_mfma_f32_16x16x32_bf16 v[96:99], a[232:235], v[168:171], v[96:99]
v_exp_f32 v85, v85
v_mfma_f32_16x16x32_bf16 v[96:99], a[236:239], v[172:175], v[96:99]
ds_read_b128 a[252:255], v4 offset:22528
s_lshr_b32 s81, s53, 3
v_mfma_f32_16x16x32_bf16 v[96:99], a[240:243], v[176:179], v[96:99]
v_exp_f32 v86, v86
v_mfma_f32_16x16x32_bf16 v[96:99], a[244:247], v[180:183], v[96:99]
ds_read_b128 a[192:195], v3 offset:23552
v_cvt_pk_bf16_f32 v84, v84, v85
v_mfma_f32_16x16x32_bf16 v[104:107], a[244:247], v[204:207], v[52:55]
v_exp_f32 v87, v87
v_mfma_f32_16x16x32_bf16 v[104:107], a[240:243], v[200:203], v[104:107]
v_exp_f32 v152, v152
v_mfma_f32_16x16x32_bf16 v[104:107], a[236:239], v[196:199], v[104:107]
ds_read_b128 a[196:199], v4 offset:23552
s_lshl1_add_u32 s80, s81, s80
v_mfma_f32_16x16x32_bf16 v[104:107], a[232:235], v[192:195], v[104:107]
v_exp_f32 v153, v153
v_mfma_f32_16x16x32_bf16 v[104:107], a[228:231], v[188:191], v[104:107]
ds_read_b128 a[200:203], v3 offset:24576
s_and_b32 s57, s80, 3
v_mfma_f32_16x16x32_bf16 v[104:107], a[224:227], v[184:187], v[104:107]
v_exp_f32 v154, v154
v_mfma_f32_16x16x32_bf16 v[112:115], a[224:227], v[208:211], v[56:59]
ds_read_b128 a[204:207], v4 offset:24576
s_lshl_b32 s57, s57, 14
v_mfma_f32_16x16x32_bf16 v[112:115], a[228:231], v[212:215], v[112:115]
v_exp_f32 v155, v155
v_mfma_f32_16x16x32_bf16 v[112:115], a[232:235], v[216:219], v[112:115]
s_mul_i32 s81, s80, 30720
v_cvt_pk_bf16_f32 v85, v86, v87
v_mfma_f32_16x16x32_bf16 v[112:115], a[236:239], v[220:223], v[112:115]
v_exp_f32 v92, v92
v_mfma_f32_16x16x32_bf16 v[112:115], a[240:243], v[224:227], v[112:115]
s_sub_u32 s81, 3932160, s81
v_cvt_pk_bf16_f32 v86, v152, v153
v_mfma_f32_16x16x32_bf16 v[112:115], a[244:247], v[228:231], v[112:115]
v_exp_f32 v93, v93
v_mfma_f32_16x16x32_bf16 v[120:123], a[244:247], v[252:255], v[60:63]
s_add_u32 s24, s98, s81
s_addc_u32 s25, s99, 0
v_mfma_f32_16x16x32_bf16 v[120:123], a[240:243], v[248:251], v[120:123]
v_exp_f32 v94, v94
v_mfma_f32_16x16x32_bf16 v[120:123], a[236:239], v[244:247], v[120:123]
s_mov_b32 s26, 1966080
v_cvt_pk_bf16_f32 v87, v154, v155
v_mfma_f32_16x16x32_bf16 v[120:123], a[232:235], v[240:243], v[120:123]
s_mov_b32 s27, 0x20000
s_add_u32 m0, s41, 0
v_mfma_f32_16x16x32_bf16 v[120:123], a[228:231], v[236:239], v[120:123]
v_exp_f32 v95, v95
v_mfma_f32_16x16x32_bf16 v[120:123], a[224:227], v[232:235], v[120:123]
s_waitcnt lgkmcnt(0)
s_mov_b32 s46, 0
v_mfma_f32_16x16x32_bf16 v[128:131], a[248:251], v[160:163], v[48:51]
buffer_load_dwordx4 v21, s[4:7], s46 offen offset:0 lds
v_mfma_f32_16x16x32_bf16 v[128:131], a[252:255], v[164:167], v[128:131]
ds_read_b128 a[208:211], v3 offset:28672
v_cvt_pk_bf16_f32 v92, v92, v93
v_mfma_f32_16x16x32_bf16 v[128:131], a[192:195], v[168:171], v[128:131]
v_exp_f32 v156, v156
v_mfma_f32_16x16x32_bf16 v[128:131], a[196:199], v[172:175], v[128:131]
v_exp_f32 v157, v157
v_mfma_f32_16x16x32_bf16 v[128:131], a[200:203], v[176:179], v[128:131]
ds_read_b128 a[212:215], v4 offset:28672
s_mov_b32 s46, 9216
v_mfma_f32_16x16x32_bf16 v[128:131], a[204:207], v[180:183], v[128:131]
buffer_load_dwordx4 v21, s[4:7], s46 offen offset:1024 lds
v_mfma_f32_16x16x32_bf16 v[132:135], a[204:207], v[204:207], v[52:55]
v_exp_f32 v158, v158
v_mfma_f32_16x16x32_bf16 v[132:135], a[200:203], v[200:203], v[132:135]
ds_read_b128 a[216:219], v3 offset:29696
v_cvt_pk_bf16_f32 v93, v94, v95
v_mfma_f32_16x16x32_bf16 v[132:135], a[196:199], v[196:199], v[132:135]
v_exp_f32 v159, v159
v_mfma_f32_16x16x32_bf16 v[132:135], a[192:195], v[192:195], v[132:135]
ds_read_b128 a[220:223], v4 offset:29696
s_mov_b32 s46, 18432
v_mfma_f32_16x16x32_bf16 v[132:135], a[252:255], v[188:191], v[132:135]
buffer_load_dwordx4 v21, s[4:7], s46 offen offset:2048 lds
v_mfma_f32_16x16x32_bf16 v[132:135], a[248:251], v[184:187], v[132:135]
ds_read_b128 a[224:227], v3 offset:30720
v_cvt_pk_bf16_f32 v94, v156, v157
v_mfma_f32_16x16x32_bf16 v[136:139], a[248:251], v[208:211], v[56:59]
v_exp_f32 v96, v96
v_mfma_f32_16x16x32_bf16 v[136:139], a[252:255], v[212:215], v[136:139]
v_exp_f32 v97, v97
v_mfma_f32_16x16x32_bf16 v[136:139], a[192:195], v[216:219], v[136:139]
ds_read_b128 a[228:231], v4 offset:30720
v_cvt_pk_bf16_f32 v95, v158, v159
v_mfma_f32_16x16x32_bf16 v[136:139], a[196:199], v[220:223], v[136:139]
s_mov_b32 s46, 27648
v_cvt_pk_bf16_f32 v96, v96, v97
v_mfma_f32_16x16x32_bf16 v[136:139], a[200:203], v[224:227], v[136:139]
buffer_load_dwordx4 v21, s[4:7], s46 offen offset:3072 lds
v_mfma_f32_16x16x32_bf16 v[136:139], a[204:207], v[228:231], v[136:139]
v_exp_f32 v98, v98
v_mfma_f32_16x16x32_bf16 v[140:143], a[204:207], v[252:255], v[60:63]
v_exp_f32 v99, v99
v_mfma_f32_16x16x32_bf16 v[140:143], a[200:203], v[248:251], v[140:143]
v_exp_f32 v128, v128
v_mfma_f32_16x16x32_bf16 v[140:143], a[196:199], v[244:247], v[140:143]
s_add_u32 m0, s41, 4096
s_mov_b32 s46, 40960
v_mfma_f32_16x16x32_bf16 v[140:143], a[192:195], v[240:243], v[140:143]
buffer_load_dwordx4 v21, s[4:7], s46 offen offset:0 lds
v_mfma_f32_16x16x32_bf16 v[140:143], a[252:255], v[236:239], v[140:143]
v_exp_f32 v129, v129
v_mfma_f32_16x16x32_bf16 v[140:143], a[248:251], v[232:235], v[140:143]
s_waitcnt lgkmcnt(0)
v_cvt_pk_bf16_f32 v97, v98, v99
v_mfma_f32_16x16x32_bf16 v[100:103], a[208:211], v[160:163], v[48:51]
v_exp_f32 v130, v130
v_mfma_f32_16x16x32_bf16 v[100:103], a[212:215], v[164:167], v[100:103]
v_exp_f32 v131, v131
v_mfma_f32_16x16x32_bf16 v[100:103], a[216:219], v[168:171], v[100:103]
ds_read_b128 a[232:235], v3 offset:34816
s_mov_b32 s46, 50176
v_mfma_f32_16x16x32_bf16 v[100:103], a[220:223], v[172:175], v[100:103]
buffer_load_dwordx4 v21, s[4:7], s46 offen offset:1024 lds
v_mfma_f32_16x16x32_bf16 v[100:103], a[224:227], v[176:179], v[100:103]
ds_read_b128 a[236:239], v4 offset:34816
v_cvt_pk_bf16_f32 v98, v128, v129
v_mfma_f32_16x16x32_bf16 v[100:103], a[228:231], v[180:183], v[100:103]
v_exp_f32 v104, v104
v_mfma_f32_16x16x32_bf16 v[108:111], a[228:231], v[204:207], v[52:55]
ds_read_b128 a[240:243], v3 offset:35840
s_mov_b32 s46, 59392
v_mfma_f32_16x16x32_bf16 v[108:111], a[224:227], v[200:203], v[108:111]
buffer_load_dwordx4 v21, s[4:7], s46 offen offset:2048 lds
v_mfma_f32_16x16x32_bf16 v[108:111], a[220:223], v[196:199], v[108:111]
ds_read_b128 a[244:247], v4 offset:35840
v_cvt_pk_bf16_f32 v99, v130, v131
v_mfma_f32_16x16x32_bf16 v[108:111], a[216:219], v[192:195], v[108:111]
v_exp_f32 v105, v105
v_mfma_f32_16x16x32_bf16 v[108:111], a[212:215], v[188:191], v[108:111]
v_exp_f32 v106, v106
v_mfma_f32_16x16x32_bf16 v[108:111], a[208:211], v[184:187], v[108:111]
ds_read_b128 a[248:251], v3 offset:36864
s_mov_b32 s46, 68608
v_mfma_f32_16x16x32_bf16 v[116:119], a[208:211], v[208:211], v[56:59]
ds_read_b128 a[252:255], v4 offset:36864
v_cvt_pk_bf16_f32 v104, v104, v105
v_mfma_f32_16x16x32_bf16 v[116:119], a[212:215], v[212:215], v[116:119]
buffer_load_dwordx4 v21, s[4:7], s46 offen offset:3072 lds
v_mfma_f32_16x16x32_bf16 v[116:119], a[216:219], v[216:219], v[116:119]
v_exp_f32 v107, v107
v_mfma_f32_16x16x32_bf16 v[116:119], a[220:223], v[220:223], v[116:119]
s_add_u32 m0, s41, 32768
v_cvt_pk_bf16_f32 v105, v106, v107
v_mfma_f32_16x16x32_bf16 v[116:119], a[224:227], v[224:227], v[116:119]
v_exp_f32 v132, v132
v_mfma_f32_16x16x32_bf16 v[116:119], a[228:231], v[228:231], v[116:119]
s_mov_b32 s46, 163840
v_mfma_f32_16x16x32_bf16 v[124:127], a[228:231], v[252:255], v[60:63]
buffer_load_dwordx4 v21, s[4:7], s46 offen offset:0 lds
v_mfma_f32_16x16x32_bf16 v[124:127], a[224:227], v[248:251], v[124:127]
v_exp_f32 v133, v133
v_mfma_f32_16x16x32_bf16 v[124:127], a[220:223], v[244:247], v[124:127]
s_mov_b32 s46, 173056
v_cvt_pk_bf16_f32 v106, v132, v133
v_mfma_f32_16x16x32_bf16 v[124:127], a[216:219], v[240:243], v[124:127]
v_exp_f32 v134, v134
v_mfma_f32_16x16x32_bf16 v[124:127], a[212:215], v[236:239], v[124:127]
buffer_load_dwordx4 v21, s[4:7], s46 offen offset:1024 lds
v_mfma_f32_16x16x32_bf16 v[124:127], a[208:211], v[232:235], v[124:127]
s_mov_b32 s46, 182272
buffer_load_dwordx4 v21, s[4:7], s46 offen offset:2048 lds
s_waitcnt lgkmcnt(0)
v_mfma_f32_16x16x32_bf16 v[144:147], a[232:235], v[160:163], v[48:51]
v_exp_f32 v135, v135
v_mfma_f32_16x16x32_bf16 v[144:147], a[236:239], v[164:167], v[144:147]
s_mov_b32 s46, 191488
v_cvt_pk_bf16_f32 v107, v134, v135
v_mfma_f32_16x16x32_bf16 v[144:147], a[240:243], v[168:171], v[144:147]
v_exp_f32 v112, v112
v_mfma_f32_16x16x32_bf16 v[144:147], a[244:247], v[172:175], v[144:147]
v_exp_f32 v113, v113
v_mfma_f32_16x16x32_bf16 v[144:147], a[248:251], v[176:179], v[144:147]
s_waitcnt vmcnt(25) lgkmcnt(0)
s_barrier
v_mfma_f32_16x16x32_bf16 v[144:147], a[252:255], v[180:183], v[144:147]
ds_read_b64_tr_b16 a[192:193], v9 offset:8192
v_mfma_f32_16x16x32_bf16 v[148:151], a[252:255], v[204:207], v[52:55]
buffer_load_dwordx4 v21, s[4:7], s46 offen offset:3072 lds
v_mfma_f32_16x16x32_bf16 v[148:151], a[248:251], v[200:203], v[148:151]
ds_read_b64_tr_b16 a[194:195], v9 offset:14336
s_add_u32 m0, s41, 36864
v_mfma_f32_16x16x32_bf16 v[148:151], a[244:247], v[196:199], v[148:151]
ds_read_b64_tr_b16 a[196:197], v9 offset:20480
s_mov_b32 s46, 204800
v_mfma_f32_16x16x32_bf16 v[148:151], a[240:243], v[192:195], v[148:151]
ds_read_b64_tr_b16 a[198:199], v9 offset:26624
v_mfma_f32_16x16x32_bf16 v[148:151], a[236:239], v[188:191], v[148:151]
buffer_load_dwordx4 v21, s[4:7], s46 offen offset:0 lds
v_mfma_f32_16x16x32_bf16 v[148:151], a[232:235], v[184:187], v[148:151]
ds_read_b64_tr_b16 a[200:201], v10 offset:8192
s_mov_b32 s46, 214016
v_mfma_f32_16x16x32_bf16 v[152:155], a[232:235], v[208:211], v[56:59]
ds_read_b64_tr_b16 a[202:203], v10 offset:14336
v_mfma_f32_16x16x32_bf16 v[152:155], a[236:239], v[212:215], v[152:155]
ds_read_b64_tr_b16 a[204:205], v10 offset:20480
v_cvt_pk_bf16_f32 v112, v112, v113
v_mfma_f32_16x16x32_bf16 v[152:155], a[240:243], v[216:219], v[152:155]
v_exp_f32 v114, v114
v_mfma_f32_16x16x32_bf16 v[152:155], a[244:247], v[220:223], v[152:155]
v_exp_f32 v115, v115
v_mfma_f32_16x16x32_bf16 v[152:155], a[248:251], v[224:227], v[152:155]
ds_read_b64_tr_b16 a[206:207], v10 offset:26624
v_cvt_pk_bf16_f32 v113, v114, v115
v_mfma_f32_16x16x32_bf16 v[152:155], a[252:255], v[228:231], v[152:155]
v_exp_f32 v136, v136
v_mfma_f32_16x16x32_bf16 v[156:159], a[252:255], v[252:255], v[60:63]
v_exp_f32 v137, v137
v_mfma_f32_16x16x32_bf16 v[156:159], a[248:251], v[248:251], v[156:159]
v_exp_f32 v138, v138
v_mfma_f32_16x16x32_bf16 v[156:159], a[244:247], v[244:247], v[156:159]
buffer_load_dwordx4 v21, s[4:7], s46 offen offset:1024 lds
v_mfma_f32_16x16x32_bf16 v[156:159], a[240:243], v[240:243], v[156:159]
v_exp_f32 v139, v139
v_mfma_f32_16x16x32_bf16 v[156:159], a[236:239], v[236:239], v[156:159]
ds_read_b64_tr_b16 a[208:209], v11 offset:8192
s_waitcnt lgkmcnt(5)
v_mfma_f32_16x16x32_bf16 v[156:159], a[232:235], v[232:235], v[156:159]
ds_read_b64_tr_b16 a[210:211], v11 offset:14336
v_cvt_pk_bf16_f32 v114, v136, v137
v_cvt_pk_bf16_f32 v115, v138, v139
v_mfma_f32_16x16x32_bf16 a[0:3], a[192:195], v[64:67], a[0:3]
ds_read_b64_tr_b16 a[212:213], v11 offset:20480
v_mfma_f32_16x16x32_bf16 a[0:3], a[196:199], v[68:71], a[0:3]
v_exp_f32 v120, v120
v_mfma_f32_16x16x32_bf16 a[4:7], a[192:195], v[72:75], a[4:7]
ds_read_b64_tr_b16 a[214:215], v11 offset:26624
s_mov_b32 s46, 223232
v_mfma_f32_16x16x32_bf16 a[4:7], a[196:199], v[76:79], a[4:7]
v_exp_f32 v121, v121
v_mfma_f32_16x16x32_bf16 a[8:11], a[192:195], v[80:83], a[8:11]
buffer_load_dwordx4 v21, s[4:7], s46 offen offset:2048 lds
v_mfma_f32_16x16x32_bf16 a[8:11], a[196:199], v[84:87], a[8:11]
ds_read_b64_tr_b16 a[216:217], v12 offset:8192
v_xor_b32 v1, 0x10000, v13
v_mfma_f32_16x16x32_bf16 a[12:15], a[192:195], v[88:91], a[12:15]
v_exp_f32 v122, v122
v_mfma_f32_16x16x32_bf16 a[12:15], a[196:199], v[92:95], a[12:15]
s_waitcnt lgkmcnt(5)
v_cvt_pk_bf16_f32 v120, v120, v121
v_mfma_f32_16x16x32_bf16 a[16:19], a[200:203], v[64:67], a[16:19]
ds_read_b64_tr_b16 a[218:219], v12 offset:14336
s_mov_b32 s46, 232448
v_mfma_f32_16x16x32_bf16 a[16:19], a[204:207], v[68:71], a[16:19]
v_exp_f32 v123, v123
v_mfma_f32_16x16x32_bf16 a[20:23], a[200:203], v[72:75], a[20:23]
ds_read_b64_tr_b16 a[220:221], v12 offset:20480
v_cvt_pk_bf16_f32 v121, v122, v123
v_mfma_f32_16x16x32_bf16 a[20:23], a[204:207], v[76:79], a[20:23]
buffer_load_dwordx4 v21, s[4:7], s46 offen offset:3072 lds
v_mfma_f32_16x16x32_bf16 a[24:27], a[200:203], v[80:83], a[24:27]
v_exp_f32 v140, v140
v_mfma_f32_16x16x32_bf16 a[24:27], a[204:207], v[84:87], a[24:27]
ds_read_b64_tr_b16 a[222:223], v12 offset:26624
s_add_u32 m0, s41, 65536
v_mfma_f32_16x16x32_bf16 a[28:31], a[200:203], v[88:91], a[28:31]
v_exp_f32 v141, v141
v_mfma_f32_16x16x32_bf16 a[28:31], a[204:207], v[92:95], a[28:31]
s_waitcnt lgkmcnt(4)
v_cvt_pk_bf16_f32 v122, v140, v141
v_mfma_f32_16x16x32_bf16 a[32:35], a[208:211], v[64:67], a[32:35]
ds_read_b64_tr_b16 a[224:225], v9 offset:9216
s_mov_b32 s46, 327680
v_mfma_f32_16x16x32_bf16 a[32:35], a[212:215], v[68:71], a[32:35]
ds_read_b64_tr_b16 a[226:227], v9 offset:15360
v_xor_b32 v2, 0x10000, v14
v_mfma_f32_16x16x32_bf16 a[36:39], a[208:211], v[72:75], a[36:39]
v_exp_f32 v142, v142
v_mfma_f32_16x16x32_bf16 a[36:39], a[212:215], v[76:79], a[36:39]
ds_read_b64_tr_b16 a[228:229], v9 offset:21504
v_mfma_f32_16x16x32_bf16 a[40:43], a[208:211], v[80:83], a[40:43]
v_exp_f32 v143, v143
v_mfma_f32_16x16x32_bf16 a[40:43], a[212:215], v[84:87], a[40:43]
buffer_load_dwordx4 v21, s[4:7], s46 offen offset:0 lds
v_mfma_f32_16x16x32_bf16 a[44:47], a[208:211], v[88:91], a[44:47]
ds_read_b64_tr_b16 a[230:231], v9 offset:27648
s_waitcnt lgkmcnt(4)
v_mfma_f32_16x16x32_bf16 a[44:47], a[212:215], v[92:95], a[44:47]
ds_read_b64_tr_b16 a[232:233], v10 offset:9216
v_cvt_pk_bf16_f32 v123, v142, v143
v_mfma_f32_16x16x32_bf16 a[48:51], a[216:219], v[64:67], a[48:51]
v_exp_f32 v100, v100
v_mfma_f32_16x16x32_bf16 a[48:51], a[220:223], v[68:71], a[48:51]
v_exp_f32 v101, v101
v_mfma_f32_16x16x32_bf16 a[52:55], a[216:219], v[72:75], a[52:55]
ds_read_b64_tr_b16 a[234:235], v10 offset:15360
s_mov_b32 s46, 336896
v_mfma_f32_16x16x32_bf16 a[52:55], a[220:223], v[76:79], a[52:55]
ds_read_b64_tr_b16 a[236:237], v10 offset:21504
v_cvt_pk_bf16_f32 v100, v100, v101
v_mfma_f32_16x16x32_bf16 a[56:59], a[216:219], v[80:83], a[56:59]
v_exp_f32 v102, v102
v_mfma_f32_16x16x32_bf16 a[56:59], a[220:223], v[84:87], a[56:59]
buffer_load_dwordx4 v21, s[4:7], s46 offen offset:1024 lds
v_mfma_f32_16x16x32_bf16 a[60:63], a[216:219], v[88:91], a[60:63]
ds_read_b64_tr_b16 a[238:239], v10 offset:27648
s_waitcnt lgkmcnt(4)
v_mfma_f32_16x16x32_bf16 a[60:63], a[220:223], v[92:95], a[60:63]
v_exp_f32 v103, v103
v_mfma_f32_16x16x32_bf16 a[64:67], a[224:227], v[64:67], a[64:67]
ds_read_b64_tr_b16 a[240:241], v11 offset:9216
v_cvt_pk_bf16_f32 v101, v102, v103
v_mfma_f32_16x16x32_bf16 a[64:67], a[228:231], v[68:71], a[64:67]
ds_read_b64_tr_b16 a[242:243], v11 offset:15360
s_mov_b32 s46, 346112
v_mfma_f32_16x16x32_bf16 a[68:71], a[224:227], v[72:75], a[68:71]
v_exp_f32 v144, v144
v_mfma_f32_16x16x32_bf16 a[68:71], a[228:231], v[76:79], a[68:71]
buffer_load_dwordx4 v21, s[4:7], s46 offen offset:2048 lds
v_mfma_f32_16x16x32_bf16 a[72:75], a[224:227], v[80:83], a[72:75]
v_exp_f32 v145, v145
v_mfma_f32_16x16x32_bf16 a[72:75], a[228:231], v[84:87], a[72:75]
ds_read_b64_tr_b16 a[244:245], v11 offset:21504
v_cvt_pk_bf16_f32 v102, v144, v145
v_mfma_f32_16x16x32_bf16 a[76:79], a[224:227], v[88:91], a[76:79]
ds_read_b64_tr_b16 a[246:247], v11 offset:27648
s_waitcnt lgkmcnt(4)
v_mfma_f32_16x16x32_bf16 a[76:79], a[228:231], v[92:95], a[76:79]
ds_read_b64_tr_b16 a[248:249], v12 offset:9216
v_xor_b32 v3, 0x10000, v15
v_mfma_f32_16x16x32_bf16 a[80:83], a[232:235], v[64:67], a[80:83]
ds_read_b64_tr_b16 a[250:251], v12 offset:15360
s_mov_b32 s46, 355328
v_mfma_f32_16x16x32_bf16 a[80:83], a[236:239], v[68:71], a[80:83]
v_exp_f32 v146, v146
v_mfma_f32_16x16x32_bf16 a[84:87], a[232:235], v[72:75], a[84:87]
v_exp_f32 v147, v147
v_mfma_f32_16x16x32_bf16 a[84:87], a[236:239], v[76:79], a[84:87]
ds_read_b64_tr_b16 a[252:253], v12 offset:21504
v_cvt_pk_bf16_f32 v103, v146, v147
v_mfma_f32_16x16x32_bf16 a[88:91], a[232:235], v[80:83], a[88:91]
buffer_load_dwordx4 v21, s[4:7], s46 offen offset:3072 lds
v_mfma_f32_16x16x32_bf16 a[88:91], a[236:239], v[84:87], a[88:91]
ds_read_b64_tr_b16 a[254:255], v12 offset:27648
s_add_u32 m0, s41, 69632
v_mfma_f32_16x16x32_bf16 a[92:95], a[232:235], v[88:91], a[92:95]
ds_read_b64_tr_b16 a[192:193], v9 offset:10240
s_waitcnt lgkmcnt(5)
v_mfma_f32_16x16x32_bf16 a[92:95], a[236:239], v[92:95], a[92:95]
ds_read_b64_tr_b16 a[194:195], v9 offset:16384
s_mov_b32 s46, 368640
v_mfma_f32_16x16x32_bf16 a[96:99], a[240:243], v[64:67], a[96:99]
v_exp_f32 v108, v108
v_mfma_f32_16x16x32_bf16 a[96:99], a[244:247], v[68:71], a[96:99]
v_exp_f32 v109, v109
v_mfma_f32_16x16x32_bf16 a[100:103], a[240:243], v[72:75], a[100:103]
ds_read_b64_tr_b16 a[196:197], v9 offset:22528
v_cvt_pk_bf16_f32 v108, v108, v109
v_mfma_f32_16x16x32_bf16 a[100:103], a[244:247], v[76:79], a[100:103]
v_exp_f32 v110, v110
v_mfma_f32_16x16x32_bf16 a[104:107], a[240:243], v[80:83], a[104:107]
ds_read_b64_tr_b16 a[198:199], v9 offset:28672
v_xor_b32 v4, 0x10000, v16
v_mfma_f32_16x16x32_bf16 a[104:107], a[244:247], v[84:87], a[104:107]
buffer_load_dwordx4 v21, s[4:7], s46 offen offset:0 lds
v_mfma_f32_16x16x32_bf16 a[108:111], a[240:243], v[88:91], a[108:111]
ds_read_b64_tr_b16 a[200:201], v10 offset:10240
s_waitcnt lgkmcnt(5)
v_mfma_f32_16x16x32_bf16 a[108:111], a[244:247], v[92:95], a[108:111]
ds_read_b64_tr_b16 a[202:203], v10 offset:16384
s_mov_b32 s46, 377856
v_mfma_f32_16x16x32_bf16 a[112:115], a[248:251], v[64:67], a[112:115]
v_exp_f32 v111, v111
v_mfma_f32_16x16x32_bf16 a[112:115], a[252:255], v[68:71], a[112:115]
ds_read_b64_tr_b16 a[204:205], v10 offset:22528
v_cvt_pk_bf16_f32 v109, v110, v111
v_mfma_f32_16x16x32_bf16 a[116:119], a[248:251], v[72:75], a[116:119]
v_exp_f32 v148, v148
v_mfma_f32_16x16x32_bf16 a[116:119], a[252:255], v[76:79], a[116:119]
v_exp_f32 v149, v149
v_mfma_f32_16x16x32_bf16 a[120:123], a[248:251], v[80:83], a[120:123]
ds_read_b64_tr_b16 a[206:207], v10 offset:28672
v_cvt_pk_bf16_f32 v110, v148, v149
v_mfma_f32_16x16x32_bf16 a[120:123], a[252:255], v[84:87], a[120:123]
buffer_load_dwordx4 v21, s[4:7], s46 offen offset:1024 lds
v_mfma_f32_16x16x32_bf16 a[124:127], a[248:251], v[88:91], a[124:127]
ds_read_b64_tr_b16 a[208:209], v11 offset:10240
s_waitcnt lgkmcnt(5)
v_mfma_f32_16x16x32_bf16 a[124:127], a[252:255], v[92:95], a[124:127]
ds_read_b64_tr_b16 a[210:211], v11 offset:16384
s_mov_b32 s46, 387072
v_mfma_f32_16x16x32_bf16 a[128:131], a[192:195], v[64:67], a[128:131]
v_exp_f32 v150, v150
v_mfma_f32_16x16x32_bf16 a[128:131], a[196:199], v[68:71], a[128:131]
v_exp_f32 v151, v151
v_mfma_f32_16x16x32_bf16 a[132:135], a[192:195], v[72:75], a[132:135]
ds_read_b64_tr_b16 a[212:213], v11 offset:22528
v_cvt_pk_bf16_f32 v111, v150, v151
v_mfma_f32_16x16x32_bf16 a[132:135], a[196:199], v[76:79], a[132:135]
v_exp_f32 v116, v116
v_mfma_f32_16x16x32_bf16 a[136:139], a[192:195], v[80:83], a[136:139]
buffer_load_dwordx4 v21, s[4:7], s46 offen offset:2048 lds
v_mfma_f32_16x16x32_bf16 a[136:139], a[196:199], v[84:87], a[136:139]
ds_read_b64_tr_b16 a[214:215], v11 offset:28672
s_mov_b32 s46, 396288
v_mfma_f32_16x16x32_bf16 a[140:143], a[192:195], v[88:91], a[140:143]
ds_read_b64_tr_b16 a[216:217], v12 offset:10240
s_waitcnt lgkmcnt(5)
v_mfma_f32_16x16x32_bf16 a[140:143], a[196:199], v[92:95], a[140:143]
buffer_load_dwordx4 v21, s[4:7], s46 offen offset:3072 lds
ds_read_b64_tr_b16 a[218:219], v12 offset:16384
ds_read_b64_tr_b16 a[220:221], v12 offset:22528
ds_read_b64_tr_b16 a[222:223], v12 offset:28672
s_mov_b32 s46, 0
buffer_load_dwordx4 v[224:227], v18, s[8:11], s46 offen offset:0 sc1
buffer_load_dwordx4 v[228:231], v18, s[8:11], s46 offen offset:1024 sc1
v_mfma_f32_16x16x32_bf16 a[144:147], a[200:203], v[64:67], a[144:147]
v_exp_f32 v117, v117
v_mfma_f32_16x16x32_bf16 a[144:147], a[204:207], v[68:71], a[144:147]
v_cvt_pk_bf16_f32 v116, v116, v117
v_mfma_f32_16x16x32_bf16 a[148:151], a[200:203], v[72:75], a[148:151]
v_exp_f32 v118, v118
v_mfma_f32_16x16x32_bf16 a[148:151], a[204:207], v[76:79], a[148:151]
v_exp_f32 v119, v119
v_mfma_f32_16x16x32_bf16 a[152:155], a[200:203], v[80:83], a[152:155]
s_waitcnt vmcnt(34) lgkmcnt(0)
s_barrier
v_mfma_f32_16x16x32_bf16 a[152:155], a[204:207], v[84:87], a[152:155]
ds_read_b64_tr_b16 a[224:225], v9 offset:32768
v_mfma_f32_16x16x32_bf16 a[156:159], a[200:203], v[88:91], a[156:159]
buffer_load_dwordx4 v[232:235], v18, s[8:11], s46 offen offset:2048 sc1
v_mfma_f32_16x16x32_bf16 a[156:159], a[204:207], v[92:95], a[156:159]
ds_read_b64_tr_b16 a[226:227], v9 offset:38912
v_mfma_f32_16x16x32_bf16 a[160:163], a[208:211], v[64:67], a[160:163]
ds_read_b64_tr_b16 a[228:229], v9 offset:45056
v_mfma_f32_16x16x32_bf16 a[160:163], a[212:215], v[68:71], a[160:163]
ds_read_b64_tr_b16 a[230:231], v9 offset:51200
v_mfma_f32_16x16x32_bf16 a[164:167], a[208:211], v[72:75], a[164:167]
ds_read_b64_tr_b16 a[232:233], v10 offset:32768
v_mfma_f32_16x16x32_bf16 a[164:167], a[212:215], v[76:79], a[164:167]
buffer_load_dwordx4 v[236:239], v18, s[8:11], s46 offen offset:3072 sc1
v_mfma_f32_16x16x32_bf16 a[168:171], a[208:211], v[80:83], a[168:171]
ds_read_b64_tr_b16 a[234:235], v10 offset:38912
s_mov_b32 s46, 4096
v_mfma_f32_16x16x32_bf16 a[168:171], a[212:215], v[84:87], a[168:171]
ds_read_b64_tr_b16 a[236:237], v10 offset:45056
v_cvt_pk_bf16_f32 v117, v118, v119
v_exp_f32 v152, v152
v_exp_f32 v153, v153
v_mfma_f32_16x16x32_bf16 a[172:175], a[208:211], v[88:91], a[172:175]
ds_read_b64_tr_b16 a[238:239], v10 offset:51200
v_cvt_pk_bf16_f32 v118, v152, v153
v_mfma_f32_16x16x32_bf16 a[172:175], a[212:215], v[92:95], a[172:175]
v_exp_f32 v154, v154
v_mfma_f32_16x16x32_bf16 a[176:179], a[216:219], v[64:67], a[176:179]
v_exp_f32 v155, v155
v_mfma_f32_16x16x32_bf16 a[176:179], a[220:223], v[68:71], a[176:179]
ds_read_b64_tr_b16 a[240:241], v11 offset:32768
v_cvt_pk_bf16_f32 v119, v154, v155
v_mfma_f32_16x16x32_bf16 a[180:183], a[216:219], v[72:75], a[180:183]
v_exp_f32 v124, v124
v_mfma_f32_16x16x32_bf16 a[180:183], a[220:223], v[76:79], a[180:183]
v_exp_f32 v125, v125
v_mfma_f32_16x16x32_bf16 a[184:187], a[216:219], v[80:83], a[184:187]
ds_read_b64_tr_b16 a[242:243], v11 offset:38912
v_cvt_pk_bf16_f32 v124, v124, v125
v_mfma_f32_16x16x32_bf16 a[184:187], a[220:223], v[84:87], a[184:187]
v_exp_f32 v126, v126
v_mfma_f32_16x16x32_bf16 a[188:191], a[216:219], v[88:91], a[188:191]
v_exp_f32 v127, v127
v_mfma_f32_16x16x32_bf16 a[188:191], a[220:223], v[92:95], a[188:191]
v_cvt_pk_bf16_f32 v125, v126, v127
v_smfmac_f32_16x16x64_bf16 v[24:27], v[32:35], v[64:71], v17
v_exp_f32 v156, v156
v_smfmac_f32_16x16x64_bf16 v[24:27], v[36:39], v[72:79], v17
v_exp_f32 v157, v157
v_smfmac_f32_16x16x64_bf16 v[24:27], v[40:43], v[80:87], v17
v_exp_f32 v158, v158
v_smfmac_f32_16x16x64_bf16 v[24:27], v[44:47], v[88:95], v17
v_exp_f32 v159, v159
v_smfmac_f32_16x16x64_bf16 v[24:27], v[32:35], v[96:103], v17
v_cvt_pk_bf16_f32 v126, v156, v157
v_cvt_pk_bf16_f32 v127, v158, v159
v_smfmac_f32_16x16x64_bf16 v[24:27], v[36:39], v[104:111], v17
buffer_load_dwordx4 v[240:243], v18, s[8:11], s46 offen offset:0 sc1
v_smfmac_f32_16x16x64_bf16 v[24:27], v[40:43], v[112:119], v17
s_mov_b32 s46, 122880
s_waitcnt lgkmcnt(6)
v_smfmac_f32_16x16x64_bf16 v[24:27], v[44:47], v[120:127], v17
buffer_load_dwordx4 v[244:247], v18, s[8:11], s46 offen offset:0 sc1
v_mfma_f32_16x16x32_bf16 a[0:3], a[224:227], v[96:99], a[0:3]
ds_read_b64_tr_b16 a[244:245], v11 offset:45056
v_mfma_f32_16x16x32_bf16 a[0:3], a[228:231], v[100:103], a[0:3]
ds_read_b64_tr_b16 a[246:247], v11 offset:51200
v_mfma_f32_16x16x32_bf16 a[4:7], a[224:227], v[104:107], a[4:7]
buffer_load_dwordx4 v[248:251], v18, s[8:11], s46 offen offset:1024 sc1
v_mfma_f32_16x16x32_bf16 a[4:7], a[228:231], v[108:111], a[4:7]
ds_read_b64_tr_b16 a[248:249], v12 offset:32768
v_mfma_f32_16x16x32_bf16 a[8:11], a[224:227], v[112:115], a[8:11]
ds_read_b64_tr_b16 a[250:251], v12 offset:38912
v_mfma_f32_16x16x32_bf16 a[8:11], a[228:231], v[116:119], a[8:11]
ds_read_b64_tr_b16 a[252:253], v12 offset:45056
s_waitcnt lgkmcnt(7)
v_mfma_f32_16x16x32_bf16 a[12:15], a[224:227], v[120:123], a[12:15]
ds_read_b64_tr_b16 a[254:255], v12 offset:51200
v_mfma_f32_16x16x32_bf16 a[12:15], a[228:231], v[124:127], a[12:15]
ds_read_b64_tr_b16 a[192:193], v9 offset:33792
v_mfma_f32_16x16x32_bf16 a[16:19], a[232:235], v[96:99], a[16:19]
buffer_load_dwordx4 v[252:255], v18, s[8:11], s46 offen offset:2048 sc1
v_mfma_f32_16x16x32_bf16 a[16:19], a[236:239], v[100:103], a[16:19]
ds_read_b64_tr_b16 a[194:195], v9 offset:39936
v_mov_b32 v168, v24
v_mfma_f32_16x16x32_bf16 a[20:23], a[232:235], v[104:107], a[20:23]
ds_read_b64_tr_b16 a[196:197], v9 offset:46080
v_mov_b32 v169, v25
v_mfma_f32_16x16x32_bf16 a[20:23], a[236:239], v[108:111], a[20:23]
ds_read_b64_tr_b16 a[198:199], v9 offset:52224
v_mov_b32 v170, v26
v_mfma_f32_16x16x32_bf16 a[24:27], a[232:235], v[112:115], a[24:27]
ds_read_b64_tr_b16 a[200:201], v10 offset:33792
v_mov_b32 v171, v27
v_mfma_f32_16x16x32_bf16 a[24:27], a[236:239], v[116:119], a[24:27]
ds_read_b64_tr_b16 a[202:203], v10 offset:39936
v_permlane16_swap_b32 v24, v168
v_mfma_f32_16x16x32_bf16 a[28:31], a[232:235], v[120:123], a[28:31]
v_permlane16_swap_b32 v25, v169
s_waitcnt lgkmcnt(10)
v_mfma_f32_16x16x32_bf16 a[28:31], a[236:239], v[124:127], a[28:31]
ds_read_b64_tr_b16 a[204:205], v10 offset:46080
v_permlane16_swap_b32 v26, v170
v_mfma_f32_16x16x32_bf16 a[32:35], a[240:243], v[96:99], a[32:35]
ds_read_b64_tr_b16 a[206:207], v10 offset:52224
v_permlane16_swap_b32 v27, v171
v_mfma_f32_16x16x32_bf16 a[32:35], a[244:247], v[100:103], a[32:35]
ds_read_b64_tr_b16 a[208:209], v11 offset:33792
v_add_f32 v24, v24, v168
v_mfma_f32_16x16x32_bf16 a[36:39], a[240:243], v[104:107], a[36:39]
ds_read_b64_tr_b16 a[210:211], v11 offset:39936
v_add_f32 v25, v25, v169
v_mfma_f32_16x16x32_bf16 a[36:39], a[244:247], v[108:111], a[36:39]
ds_read_b64_tr_b16 a[212:213], v11 offset:46080
v_add_f32 v26, v26, v170
v_add_f32 v27, v27, v171
v_mfma_f32_16x16x32_bf16 a[40:43], a[240:243], v[112:115], a[40:43]
v_rcp_f32 v48, v24
v_mfma_f32_16x16x32_bf16 a[40:43], a[244:247], v[116:119], a[40:43]
v_rcp_f32 v50, v25
v_mfma_f32_16x16x32_bf16 a[44:47], a[240:243], v[120:123], a[44:47]
v_rcp_f32 v52, v26
v_mfma_f32_16x16x32_bf16 a[44:47], a[244:247], v[124:127], a[44:47]
s_waitcnt lgkmcnt(11)
ds_read_b64_tr_b16 a[214:215], v11 offset:52224
v_mfma_f32_16x16x32_bf16 a[48:51], a[248:251], v[96:99], a[48:51]
v_rcp_f32 v54, v27
v_mfma_f32_16x16x32_bf16 a[48:51], a[252:255], v[100:103], a[48:51]
ds_read_b64_tr_b16 a[216:217], v12 offset:33792
v_cmp_ngt_f32 s[80:81], s56, v24
v_mfma_f32_16x16x32_bf16 a[52:55], a[248:251], v[104:107], a[52:55]
ds_read_b64_tr_b16 a[218:219], v12 offset:39936
v_cmp_ngt_f32 s[82:83], s56, v25
v_mfma_f32_16x16x32_bf16 a[52:55], a[252:255], v[108:111], a[52:55]
ds_read_b64_tr_b16 a[220:221], v12 offset:46080
v_cmp_ngt_f32 s[84:85], s56, v26
v_mfma_f32_16x16x32_bf16 a[56:59], a[248:251], v[112:115], a[56:59]
ds_read_b64_tr_b16 a[222:223], v12 offset:52224
v_cmp_ngt_f32 s[86:87], s56, v27
v_accvgpr_read_b32 v32, a0
v_accvgpr_read_b32 v33, a1
v_accvgpr_read_b32 v34, a2
v_accvgpr_read_b32 v35, a3
v_mul_f32 v32, v32, v48
v_mul_f32 v33, v33, v48
v_mul_f32 v34, v34, v48
v_mul_f32 v35, v35, v48
v_cvt_pk_bf16_f32 v32, v32, v33
v_cvt_pk_bf16_f32 v33, v34, v35
v_accvgpr_read_b32 v36, a16
v_mfma_f32_16x16x32_bf16 a[56:59], a[252:255], v[116:119], a[56:59]
ds_read_b64_tr_b16 a[224:225], v9 offset:34816
v_accvgpr_read_b32 v37, a17
v_accvgpr_read_b32 v38, a18
v_accvgpr_read_b32 v39, a19
v_mul_f32 v36, v36, v48
v_mul_f32 v37, v37, v48
v_mfma_f32_16x16x32_bf16 a[60:63], a[248:251], v[120:123], a[60:63]
ds_read_b64_tr_b16 a[226:227], v9 offset:40960
s_waitcnt lgkmcnt(14)
v_mul_f32 v38, v38, v48
v_mul_f32 v39, v39, v48
v_cvt_pk_bf16_f32 v34, v36, v37
v_cvt_pk_bf16_f32 v35, v38, v39
v_mfma_f32_16x16x32_bf16 a[60:63], a[252:255], v[124:127], a[60:63]
ds_read_b64_tr_b16 a[228:229], v9 offset:47104
s_or_b64 s[80:81], s[80:81], s[82:83]
v_mfma_f32_16x16x32_bf16 a[64:67], a[192:195], v[96:99], a[64:67]
ds_read_b64_tr_b16 a[230:231], v9 offset:53248
s_or_b64 s[84:85], s[84:85], s[86:87]
v_mfma_f32_16x16x32_bf16 a[64:67], a[196:199], v[100:103], a[64:67]
ds_read_b64_tr_b16 a[232:233], v10 offset:34816
s_or_b64 s[80:81], s[80:81], s[84:85]
v_mfma_f32_16x16x32_bf16 a[68:71], a[192:195], v[104:107], a[68:71]
ds_read_b64_tr_b16 a[234:235], v10 offset:40960
s_or_b32 s80, s80, s81
v_mfma_f32_16x16x32_bf16 a[68:71], a[196:199], v[108:111], a[68:71]
ds_read_b64_tr_b16 a[236:237], v10 offset:47104
s_or_b32 s49, s49, s80
v_mfma_f32_16x16x32_bf16 a[72:75], a[192:195], v[112:115], a[72:75]
s_lshl_b32 s80, s52, 2
s_add_u32 s80, s80, 106496
v_mov_b32 v160, s80
v_mfma_f32_16x16x32_bf16 a[72:75], a[196:199], v[116:119], a[72:75]
buffer_load_dwordx4 a[0:3], v18, s[8:11], s46 offen offset:3072 sc1
v_mfma_f32_16x16x32_bf16 a[76:79], a[192:195], v[120:123], a[76:79]
ds_read_b64_tr_b16 a[238:239], v10 offset:53248
s_waitcnt lgkmcnt(15)
v_mfma_f32_16x16x32_bf16 a[76:79], a[196:199], v[124:127], a[76:79]
ds_read_b64_tr_b16 a[240:241], v11 offset:34816
s_mov_b32 s46, 126976
v_mfma_f32_16x16x32_bf16 a[80:83], a[200:203], v[96:99], a[80:83]
buffer_store_dwordx4 v[32:35], v22, s[16:19], s42 offen offset:0 sc1
v_accvgpr_read_b32 v40, a4
v_accvgpr_read_b32 v41, a5
v_accvgpr_read_b32 v42, a6
v_accvgpr_read_b32 v43, a7
v_mul_f32 v40, v40, v50
v_mul_f32 v41, v41, v50
v_mul_f32 v42, v42, v50
v_mul_f32 v43, v43, v50
v_cvt_pk_bf16_f32 v40, v40, v41
v_cvt_pk_bf16_f32 v41, v42, v43
v_accvgpr_read_b32 v44, a20
v_accvgpr_read_b32 v45, a21
v_accvgpr_read_b32 v46, a22
v_accvgpr_read_b32 v47, a23
v_mul_f32 v44, v44, v50
v_mul_f32 v45, v45, v50
v_mul_f32 v46, v46, v50
v_mul_f32 v47, v47, v50
v_cvt_pk_bf16_f32 v42, v44, v45
v_cvt_pk_bf16_f32 v43, v46, v47
v_mfma_f32_16x16x32_bf16 a[80:83], a[204:207], v[100:103], a[80:83]
ds_read_b64_tr_b16 a[242:243], v11 offset:40960
v_mov_b32 v161, s49
v_mfma_f32_16x16x32_bf16 a[84:87], a[200:203], v[104:107], a[84:87]
buffer_load_dwordx4 a[16:19], v18, s[8:11], s46 offen offset:0 sc1
v_mfma_f32_16x16x32_bf16 a[84:87], a[204:207], v[108:111], a[84:87]
ds_read_b64_tr_b16 a[244:245], v11 offset:47104
s_mov_b32 s46, 245760
v_mfma_f32_16x16x32_bf16 a[88:91], a[200:203], v[112:115], a[88:91]
buffer_store_dwordx4 v[40:43], v22, s[16:19], s42 offen offset:1024 sc1
v_accvgpr_read_b32 v56, a8
v_accvgpr_read_b32 v57, a9
v_accvgpr_read_b32 v58, a10
v_accvgpr_read_b32 v59, a11
v_mul_f32 v56, v56, v52
v_mul_f32 v57, v57, v52
v_mul_f32 v58, v58, v52
v_mul_f32 v59, v59, v52
v_cvt_pk_bf16_f32 v56, v56, v57
v_cvt_pk_bf16_f32 v57, v58, v59
v_accvgpr_read_b32 v60, a24
v_accvgpr_read_b32 v61, a25
v_accvgpr_read_b32 v62, a26
v_accvgpr_read_b32 v63, a27
v_mul_f32 v60, v60, v52
v_mul_f32 v61, v61, v52
v_mul_f32 v62, v62, v52
v_mul_f32 v63, v63, v52
v_cvt_pk_bf16_f32 v58, v60, v61
v_cvt_pk_bf16_f32 v59, v62, v63
v_mfma_f32_16x16x32_bf16 a[88:91], a[204:207], v[116:119], a[88:91]
ds_read_b64_tr_b16 a[246:247], v11 offset:53248
v_mov_b32 v162, 106496
v_mfma_f32_16x16x32_bf16 a[92:95], a[200:203], v[120:123], a[92:95]
buffer_store_dwordx4 v[56:59], v22, s[16:19], s42 offen offset:2048 sc1
v_accvgpr_read_b32 v32, a12
v_accvgpr_read_b32 v33, a13
v_accvgpr_read_b32 v34, a14
v_accvgpr_read_b32 v35, a15
v_mul_f32 v32, v32, v54
v_mul_f32 v33, v33, v54
v_mul_f32 v34, v34, v54
v_mul_f32 v35, v35, v54
v_cvt_pk_bf16_f32 v32, v32, v33
v_cvt_pk_bf16_f32 v33, v34, v35
v_accvgpr_read_b32 v36, a28
v_accvgpr_read_b32 v37, a29
v_accvgpr_read_b32 v38, a30
v_accvgpr_read_b32 v39, a31
v_mul_f32 v36, v36, v54
v_mul_f32 v37, v37, v54
v_mul_f32 v38, v38, v54
v_mul_f32 v39, v39, v54
v_cvt_pk_bf16_f32 v34, v36, v37
v_cvt_pk_bf16_f32 v35, v38, v39
v_mfma_f32_16x16x32_bf16 a[92:95], a[204:207], v[124:127], a[92:95]
s_waitcnt lgkmcnt(15)
ds_read_b64_tr_b16 a[248:249], v12 offset:34816
v_mfma_f32_16x16x32_bf16 a[96:99], a[208:211], v[96:99], a[96:99]
buffer_store_dwordx4 v[32:35], v23, s[16:19], s42 offen offset:3072 sc1
v_accvgpr_read_b32 v40, a32
v_accvgpr_read_b32 v41, a33
v_accvgpr_read_b32 v42, a34
v_accvgpr_read_b32 v43, a35
v_mul_f32 v40, v40, v48
v_mul_f32 v41, v41, v48
v_mul_f32 v42, v42, v48
v_mul_f32 v43, v43, v48
v_cvt_pk_bf16_f32 v40, v40, v41
v_cvt_pk_bf16_f32 v41, v42, v43
v_accvgpr_read_b32 v44, a48
v_accvgpr_read_b32 v45, a49
v_accvgpr_read_b32 v46, a50
v_accvgpr_read_b32 v47, a51
v_mul_f32 v44, v44, v48
v_mul_f32 v45, v45, v48
v_mul_f32 v46, v46, v48
v_mul_f32 v47, v47, v48
v_cvt_pk_bf16_f32 v42, v44, v45
v_cvt_pk_bf16_f32 v43, v46, v47
v_mfma_f32_16x16x32_bf16 a[96:99], a[212:215], v[100:103], a[96:99]
buffer_load_dwordx4 a[4:7], v18, s[8:11], s46 offen offset:0 sc1
v_mfma_f32_16x16x32_bf16 a[100:103], a[208:211], v[104:107], a[100:103]
buffer_store_dwordx4 v[40:43], v22, s[16:19], s43 offen offset:0 sc1
v_accvgpr_read_b32 v56, a36
v_accvgpr_read_b32 v57, a37
v_accvgpr_read_b32 v58, a38
v_accvgpr_read_b32 v59, a39
v_mul_f32 v56, v56, v50
v_mul_f32 v57, v57, v50
v_mul_f32 v58, v58, v50
v_mul_f32 v59, v59, v50
v_cvt_pk_bf16_f32 v56, v56, v57
v_cvt_pk_bf16_f32 v57, v58, v59
v_accvgpr_read_b32 v60, a52
v_accvgpr_read_b32 v61, a53
v_accvgpr_read_b32 v62, a54
v_accvgpr_read_b32 v63, a55
v_mfma_f32_16x16x32_bf16 a[100:103], a[212:215], v[108:111], a[100:103]
ds_read_b64_tr_b16 a[250:251], v12 offset:40960
v_mul_f32 v60, v60, v50
v_mul_f32 v61, v61, v50
v_mul_f32 v62, v62, v50
v_mul_f32 v63, v63, v50
v_cvt_pk_bf16_f32 v58, v60, v61
v_mfma_f32_16x16x32_bf16 a[104:107], a[208:211], v[112:115], a[104:107]
ds_write_b32 v160, v161
v_cvt_pk_bf16_f32 v59, v62, v63
v_mfma_f32_16x16x32_bf16 a[104:107], a[212:215], v[116:119], a[104:107]
buffer_load_dwordx4 a[20:23], v18, s[8:11], s46 offen offset:1024 sc1
v_mfma_f32_16x16x32_bf16 a[108:111], a[208:211], v[120:123], a[108:111]
ds_read_b64_tr_b16 a[252:253], v12 offset:47104
s_waitcnt lgkmcnt(15)
v_mfma_f32_16x16x32_bf16 a[108:111], a[212:215], v[124:127], a[108:111]
ds_read_b64_tr_b16 a[254:255], v12 offset:53248
v_mfma_f32_16x16x32_bf16 a[112:115], a[216:219], v[96:99], a[112:115]
buffer_store_dwordx4 v[56:59], v22, s[16:19], s43 offen offset:1024 sc1
v_accvgpr_read_b32 v32, a40
v_accvgpr_read_b32 v33, a41
v_accvgpr_read_b32 v34, a42
v_accvgpr_read_b32 v35, a43
v_mul_f32 v32, v32, v52
v_mul_f32 v33, v33, v52
v_mul_f32 v34, v34, v52
v_mul_f32 v35, v35, v52
v_cvt_pk_bf16_f32 v32, v32, v33
v_cvt_pk_bf16_f32 v33, v34, v35
v_accvgpr_read_b32 v36, a56
v_accvgpr_read_b32 v37, a57
v_accvgpr_read_b32 v38, a58
v_accvgpr_read_b32 v39, a59
v_mul_f32 v36, v36, v52
v_mul_f32 v37, v37, v52
v_mul_f32 v38, v38, v52
v_mul_f32 v39, v39, v52
v_cvt_pk_bf16_f32 v34, v36, v37
v_cvt_pk_bf16_f32 v35, v38, v39
v_mfma_f32_16x16x32_bf16 a[112:115], a[220:223], v[100:103], a[112:115]
buffer_store_dwordx4 v[32:35], v22, s[16:19], s43 offen offset:2048 sc1
v_accvgpr_read_b32 v40, a44
v_accvgpr_read_b32 v41, a45
v_accvgpr_read_b32 v42, a46
v_accvgpr_read_b32 v43, a47
v_mul_f32 v40, v40, v54
v_mul_f32 v41, v41, v54
v_mfma_f32_16x16x32_bf16 a[116:119], a[216:219], v[104:107], a[116:119]
v_mul_f32 v42, v42, v54
v_mul_f32 v43, v43, v54
v_cvt_pk_bf16_f32 v40, v40, v41
v_cvt_pk_bf16_f32 v41, v42, v43
v_accvgpr_read_b32 v44, a60
v_mfma_f32_16x16x32_bf16 a[116:119], a[220:223], v[108:111], a[116:119]
v_accvgpr_read_b32 v45, a61
v_accvgpr_read_b32 v46, a62
v_accvgpr_read_b32 v47, a63
v_mul_f32 v44, v44, v54
v_mul_f32 v45, v45, v54
v_mfma_f32_16x16x32_bf16 a[120:123], a[216:219], v[112:115], a[120:123]
s_waitcnt vmcnt(35) lgkmcnt(0)
s_barrier
v_mfma_f32_16x16x32_bf16 a[120:123], a[220:223], v[116:119], a[120:123]
buffer_load_dwordx4 a[8:11], v18, s[8:11], s46 offen offset:2048 sc1
v_mfma_f32_16x16x32_bf16 a[124:127], a[216:219], v[120:123], a[124:127]
ds_read_b64_tr_b16 a[192:193], v1 offset:0
v_mfma_f32_16x16x32_bf16 a[124:127], a[220:223], v[124:127], a[124:127]
buffer_load_dwordx4 a[24:27], v18, s[8:11], s46 offen offset:3072 sc1
v_mfma_f32_16x16x32_bf16 a[128:131], a[224:227], v[96:99], a[128:131]
ds_read_b64_tr_b16 a[194:195], v1 offset:2048
s_mov_b32 s46, 249856
v_mfma_f32_16x16x32_bf16 a[128:131], a[228:231], v[100:103], a[128:131]
ds_read_b128 v[164:167], v162
v_mfma_f32_16x16x32_bf16 a[132:135], a[224:227], v[104:107], a[132:135]
ds_read_b64_tr_b16 a[196:197], v1 offset:4096
v_mfma_f32_16x16x32_bf16 a[132:135], a[228:231], v[108:111], a[132:135]
ds_read_b64_tr_b16 a[198:199], v1 offset:6144
v_mfma_f32_16x16x32_bf16 a[136:139], a[224:227], v[112:115], a[136:139]
ds_read_b64_tr_b16 a[200:201], v2 offset:0
v_mfma_f32_16x16x32_bf16 a[136:139], a[228:231], v[116:119], a[136:139]
ds_read_b64_tr_b16 a[202:203], v2 offset:2048
v_mul_f32 v46, v46, v54
v_mul_f32 v47, v47, v54
v_cvt_pk_bf16_f32 v42, v44, v45
v_cvt_pk_bf16_f32 v43, v46, v47
v_mfma_f32_16x16x32_bf16 a[140:143], a[224:227], v[120:123], a[140:143]
buffer_store_dwordx4 v[40:43], v23, s[16:19], s43 offen offset:3072 sc1
v_accvgpr_read_b32 v56, a64
v_accvgpr_read_b32 v57, a65
v_accvgpr_read_b32 v58, a66
v_accvgpr_read_b32 v59, a67
v_mul_f32 v56, v56, v48
v_mul_f32 v57, v57, v48
v_mul_f32 v58, v58, v48
v_mul_f32 v59, v59, v48
v_cvt_pk_bf16_f32 v56, v56, v57
v_cvt_pk_bf16_f32 v57, v58, v59
v_accvgpr_read_b32 v60, a80
v_accvgpr_read_b32 v61, a81
v_accvgpr_read_b32 v62, a82
v_accvgpr_read_b32 v63, a83
v_mul_f32 v60, v60, v48
v_mul_f32 v61, v61, v48
v_mul_f32 v62, v62, v48
v_mul_f32 v63, v63, v48
v_cvt_pk_bf16_f32 v58, v60, v61
v_cvt_pk_bf16_f32 v59, v62, v63
v_mfma_f32_16x16x32_bf16 a[140:143], a[228:231], v[124:127], a[140:143]
buffer_store_dwordx4 v[56:59], v22, s[16:19], s44 offen offset:0 sc1
v_mfma_f32_16x16x32_bf16 a[144:147], a[232:235], v[96:99], a[144:147]
ds_read_b64_tr_b16 a[204:205], v2 offset:4096
v_accvgpr_read_b32 v32, a68
v_mfma_f32_16x16x32_bf16 a[144:147], a[236:239], v[100:103], a[144:147]
buffer_load_dwordx4 a[12:15], v18, s[8:11], s46 offen offset:0 sc1
v_mfma_f32_16x16x32_bf16 a[148:151], a[232:235], v[104:107], a[148:151]
ds_read_b64_tr_b16 a[206:207], v2 offset:6144
v_accvgpr_read_b32 v33, a69
v_accvgpr_read_b32 v34, a70
v_mfma_f32_16x16x32_bf16 a[148:151], a[236:239], v[108:111], a[148:151]
v_accvgpr_read_b32 v35, a71
v_mul_f32 v32, v32, v50
v_mul_f32 v33, v33, v50
v_mul_f32 v34, v34, v50
v_mul_f32 v35, v35, v50
v_mfma_f32_16x16x32_bf16 a[152:155], a[232:235], v[112:115], a[152:155]
v_cvt_pk_bf16_f32 v32, v32, v33
v_cvt_pk_bf16_f32 v33, v34, v35
v_accvgpr_read_b32 v36, a84
v_accvgpr_read_b32 v37, a85
v_accvgpr_read_b32 v38, a86
v_mfma_f32_16x16x32_bf16 a[152:155], a[236:239], v[116:119], a[152:155]
v_accvgpr_read_b32 v39, a87
v_mul_f32 v36, v36, v50
v_mul_f32 v37, v37, v50
v_mul_f32 v38, v38, v50
v_mul_f32 v39, v39, v50
v_mfma_f32_16x16x32_bf16 a[156:159], a[232:235], v[120:123], a[156:159]
v_cvt_pk_bf16_f32 v34, v36, v37
v_cvt_pk_bf16_f32 v35, v38, v39
v_mfma_f32_16x16x32_bf16 a[156:159], a[236:239], v[124:127], a[156:159]
buffer_store_dwordx4 v[32:35], v22, s[16:19], s44 offen offset:1024 sc1
v_accvgpr_read_b32 v40, a72
v_accvgpr_read_b32 v41, a73
v_accvgpr_read_b32 v42, a74
v_accvgpr_read_b32 v43, a75
v_mul_f32 v40, v40, v52
v_mul_f32 v41, v41, v52
v_mul_f32 v42, v42, v52
v_mfma_f32_16x16x32_bf16 a[160:163], a[240:243], v[96:99], a[160:163]
v_mul_f32 v43, v43, v52
v_cvt_pk_bf16_f32 v40, v40, v41
v_cvt_pk_bf16_f32 v41, v42, v43
v_accvgpr_read_b32 v44, a88
v_accvgpr_read_b32 v45, a89
v_mfma_f32_16x16x32_bf16 a[160:163], a[244:247], v[100:103], a[160:163]
v_accvgpr_read_b32 v46, a90
v_accvgpr_read_b32 v47, a91
v_mul_f32 v44, v44, v52
v_mul_f32 v45, v45, v52
v_mul_f32 v46, v46, v52
v_mfma_f32_16x16x32_bf16 a[164:167], a[240:243], v[104:107], a[164:167]
v_mul_f32 v47, v47, v52
v_cvt_pk_bf16_f32 v42, v44, v45
v_cvt_pk_bf16_f32 v43, v46, v47
v_mfma_f32_16x16x32_bf16 a[164:167], a[244:247], v[108:111], a[164:167]
buffer_store_dwordx4 v[40:43], v22, s[16:19], s44 offen offset:2048 sc1
v_accvgpr_read_b32 v56, a76
v_accvgpr_read_b32 v57, a77
v_accvgpr_read_b32 v58, a78
v_accvgpr_read_b32 v59, a79
v_mul_f32 v56, v56, v54
v_mfma_f32_16x16x32_bf16 a[168:171], a[240:243], v[112:115], a[168:171]
v_mul_f32 v57, v57, v54
v_mul_f32 v58, v58, v54
v_mul_f32 v59, v59, v54
v_cvt_pk_bf16_f32 v56, v56, v57
v_cvt_pk_bf16_f32 v57, v58, v59
v_mfma_f32_16x16x32_bf16 a[168:171], a[244:247], v[116:119], a[168:171]
v_accvgpr_read_b32 v60, a92
s_waitcnt lgkmcnt(6)
v_accvgpr_read_b32 v61, a93
v_accvgpr_read_b32 v62, a94
v_accvgpr_read_b32 v63, a95
v_mul_f32 v60, v60, v54
v_mul_f32 v61, v61, v54
v_mfma_f32_16x16x32_bf16 a[172:175], a[240:243], v[120:123], a[172:175]
v_or_b32 v164, v164, v165
v_or3_b32 v164, v164, v166, v167
v_mul_f32 v62, v62, v54
v_mul_f32 v63, v63, v54
v_cvt_pk_bf16_f32 v58, v60, v61
v_cvt_pk_bf16_f32 v59, v62, v63
v_mfma_f32_16x16x32_bf16 a[172:175], a[244:247], v[124:127], a[172:175]
v_readfirstlane_b32 s36, v164
v_mfma_f32_16x16x32_bf16 a[176:179], a[248:251], v[96:99], a[176:179]
buffer_store_dwordx4 v[56:59], v23, s[16:19], s44 offen offset:3072 sc1
v_accvgpr_read_b32 v32, a96
v_accvgpr_read_b32 v33, a97
v_accvgpr_read_b32 v34, a98
v_accvgpr_read_b32 v35, a99
v_mul_f32 v32, v32, v48
v_mul_f32 v33, v33, v48
v_mul_f32 v34, v34, v48
v_mul_f32 v35, v35, v48
v_cvt_pk_bf16_f32 v32, v32, v33
v_mfma_f32_16x16x32_bf16 a[176:179], a[252:255], v[100:103], a[176:179]
v_cvt_pk_bf16_f32 v33, v34, v35
v_accvgpr_read_b32 v36, a112
v_accvgpr_read_b32 v37, a113
v_accvgpr_read_b32 v38, a114
v_accvgpr_read_b32 v39, a115
v_mfma_f32_16x16x32_bf16 a[180:183], a[248:251], v[104:107], a[180:183]
v_mul_f32 v36, v36, v48
v_mul_f32 v37, v37, v48
v_mul_f32 v38, v38, v48
v_mul_f32 v39, v39, v48
v_cvt_pk_bf16_f32 v34, v36, v37
v_mfma_f32_16x16x32_bf16 a[180:183], a[252:255], v[108:111], a[180:183]
v_cvt_pk_bf16_f32 v35, v38, v39
v_accvgpr_read_b32 v40, a100
v_accvgpr_read_b32 v41, a101
v_accvgpr_read_b32 v42, a102
v_accvgpr_read_b32 v43, a103
v_mfma_f32_16x16x32_bf16 a[184:187], a[248:251], v[112:115], a[184:187]
v_mul_f32 v40, v40, v50
v_mul_f32 v41, v41, v50
v_mul_f32 v42, v42, v50
v_mul_f32 v43, v43, v50
v_cvt_pk_bf16_f32 v40, v40, v41
v_cvt_pk_bf16_f32 v41, v42, v43
v_mfma_f32_16x16x32_bf16 a[184:187], a[252:255], v[116:119], a[184:187]
v_accvgpr_read_b32 v44, a116
v_accvgpr_read_b32 v45, a117
v_accvgpr_read_b32 v46, a118
v_accvgpr_read_b32 v47, a119
v_mul_f32 v44, v44, v50
v_mul_f32 v45, v45, v50
v_mul_f32 v46, v46, v50
v_mul_f32 v47, v47, v50
v_cvt_pk_bf16_f32 v42, v44, v45
v_cvt_pk_bf16_f32 v43, v46, v47
v_accvgpr_read_b32 v56, a104
v_accvgpr_read_b32 v57, a105
v_accvgpr_read_b32 v58, a106
v_accvgpr_read_b32 v59, a107
v_mul_f32 v56, v56, v52
v_mul_f32 v57, v57, v52
v_mul_f32 v58, v58, v52
v_mul_f32 v59, v59, v52
v_cvt_pk_bf16_f32 v56, v56, v57
v_cvt_pk_bf16_f32 v57, v58, v59
v_accvgpr_read_b32 v60, a120
v_accvgpr_read_b32 v61, a121
v_accvgpr_read_b32 v62, a122
v_accvgpr_read_b32 v63, a123
v_mul_f32 v60, v60, v52
v_mul_f32 v61, v61, v52
v_mul_f32 v62, v62, v52
v_mul_f32 v63, v63, v52
v_cvt_pk_bf16_f32 v58, v60, v61
v_cvt_pk_bf16_f32 v59, v62, v63
v_mfma_f32_16x16x32_bf16 a[188:191], a[248:251], v[120:123], a[188:191]
s_waitcnt vmcnt(16) lgkmcnt(4)
v_mfma_f32_16x16x32_bf16 a[188:191], a[252:255], v[124:127], a[188:191]
s_cmp_lg_u32 s48, 0
s_cselect_b32 s36, 0, s36
s_cmp_lg_u32 s36, 0
s_cbranch_scc1 K1_REDO
s_cmp_ge_u32 s53, 240
s_cbranch_scc1 K2_IDLE
v_mfma_f32_16x16x32_bf16 v[64:67], a[192:195], v[224:227], 0
ds_read_b64_tr_b16 a[208:209], v3 offset:0
s_mov_b32 s46, 368640
v_mfma_f32_16x16x32_bf16 v[64:67], a[196:199], v[244:247], v[64:67]
ds_read_b64_tr_b16 a[210:211], v3 offset:2048
v_mfma_f32_16x16x32_bf16 v[68:71], a[192:195], v[228:231], 0
v_mfma_f32_16x16x32_bf16 v[68:71], a[196:199], v[248:251], v[68:71]
buffer_load_dwordx4 a[28:31], v18, s[8:11], s46 offen offset:0 sc1
v_mfma_f32_16x16x32_bf16 v[72:75], a[192:195], v[232:235], 0
ds_read_b64_tr_b16 a[212:213], v3 offset:4096
v_mfma_f32_16x16x32_bf16 v[72:75], a[196:199], v[252:255], v[72:75]
ds_read_b64_tr_b16 a[214:215], v3 offset:6144
v_mfma_f32_16x16x32_bf16 v[76:79], a[192:195], v[236:239], 0
v_mfma_f32_16x16x32_bf16 v[76:79], a[196:199], a[0:3], v[76:79]
ds_read_b64_tr_b16 a[216:217], v4 offset:0
s_waitcnt lgkmcnt(5)
v_mfma_f32_16x16x32_bf16 v[80:83], a[192:195], v[240:243], 0
v_mfma_f32_16x16x32_bf16 v[80:83], a[196:199], a[16:19], v[80:83]
buffer_load_dwordx4 a[32:35], v18, s[8:11], s46 offen offset:1024 sc1
v_mfma_f32_16x16x32_bf16 v[84:87], a[200:203], v[224:227], 0
ds_read_b64_tr_b16 a[218:219], v4 offset:2048
v_mfma_f32_16x16x32_bf16 v[84:87], a[204:207], v[244:247], v[84:87]
v_mfma_f32_16x16x32_bf16 v[88:91], a[200:203], v[228:231], 0
ds_read_b64_tr_b16 a[220:221], v4 offset:4096
v_mfma_f32_16x16x32_bf16 v[88:91], a[204:207], v[248:251], v[88:91]
v_mfma_f32_16x16x32_bf16 v[92:95], a[200:203], v[232:235], 0
ds_read_b64_tr_b16 a[222:223], v4 offset:6144
v_mfma_f32_16x16x32_bf16 v[92:95], a[204:207], v[252:255], v[92:95]
buffer_load_dwordx4 a[48:51], v18, s[8:11], s46 offen offset:2048 sc1
v_mfma_f32_16x16x32_bf16 v[96:99], a[200:203], v[236:239], 0
ds_read_b64_tr_b16 a[224:225], v1 offset:8192
v_mfma_f32_16x16x32_bf16 v[96:99], a[204:207], a[0:3], v[96:99]
s_waitcnt lgkmcnt(5)
ds_read_b64_tr_b16 a[226:227], v1 offset:10240
v_mfma_f32_16x16x32_bf16 v[100:103], a[200:203], v[240:243], 0
v_mfma_f32_16x16x32_bf16 v[100:103], a[204:207], a[16:19], v[100:103]
v_mfma_f32_16x16x32_bf16 v[104:107], a[208:211], v[224:227], 0
v_mfma_f32_16x16x32_bf16 v[104:107], a[212:215], v[244:247], v[104:107]
buffer_load_dwordx4 a[36:39], v18, s[8:11], s46 offen offset:3072 sc1
v_mfma_f32_16x16x32_bf16 v[108:111], a[208:211], v[228:231], 0
ds_read_b64_tr_b16 a[228:229], v1 offset:12288
s_mov_b32 s46, 372736
v_mfma_f32_16x16x32_bf16 v[108:111], a[212:215], v[248:251], v[108:111]
ds_read_b64_tr_b16 a[230:231], v1 offset:14336
v_mfma_f32_16x16x32_bf16 v[112:115], a[208:211], v[232:235], 0
v_mfma_f32_16x16x32_bf16 v[112:115], a[212:215], v[252:255], v[112:115]
ds_read_b64_tr_b16 a[232:233], v2 offset:8192
v_mfma_f32_16x16x32_bf16 v[116:119], a[208:211], v[236:239], 0
v_mfma_f32_16x16x32_bf16 v[116:119], a[212:215], a[0:3], v[116:119]
buffer_load_dwordx4 a[52:55], v18, s[8:11], s46 offen offset:0 sc1
v_mfma_f32_16x16x32_bf16 v[120:123], a[208:211], v[240:243], 0
ds_read_b64_tr_b16 a[234:235], v2 offset:10240
s_waitcnt lgkmcnt(6)
v_mfma_f32_16x16x32_bf16 v[120:123], a[212:215], a[16:19], v[120:123]
v_mfma_f32_16x16x32_bf16 v[124:127], a[216:219], v[224:227], 0
ds_read_b64_tr_b16 a[236:237], v2 offset:12288
v_mfma_f32_16x16x32_bf16 v[124:127], a[220:223], v[244:247], v[124:127]
v_mfma_f32_16x16x32_bf16 v[128:131], a[216:219], v[228:231], 0
ds_read_b64_tr_b16 a[238:239], v2 offset:14336
v_mfma_f32_16x16x32_bf16 v[128:131], a[220:223], v[248:251], v[128:131]
buffer_store_dwordx4 v[32:35], v22, s[16:19], s45 offen offset:0 sc1
v_mfma_f32_16x16x32_bf16 v[132:135], a[216:219], v[232:235], 0
ds_read_b64_tr_b16 a[240:241], v3 offset:8192
v_mfma_f32_16x16x32_bf16 v[132:135], a[220:223], v[252:255], v[132:135]
v_accvgpr_read_b32 v32, a108
v_accvgpr_read_b32 v33, a109
v_mfma_f32_16x16x32_bf16 v[136:139], a[216:219], v[236:239], 0
ds_read_b64_tr_b16 a[242:243], v3 offset:10240
v_accvgpr_read_b32 v34, a110
v_mfma_f32_16x16x32_bf16 v[136:139], a[220:223], a[0:3], v[136:139]
v_accvgpr_read_b32 v35, a111
v_mul_f32 v32, v32, v54
v_mfma_f32_16x16x32_bf16 v[140:143], a[216:219], v[240:243], 0
s_waitcnt lgkmcnt(6)
v_mul_f32 v33, v33, v54
v_mfma_f32_16x16x32_bf16 v[140:143], a[220:223], a[16:19], v[140:143]
ds_read_b64_tr_b16 a[244:245], v3 offset:12288
v_mul_f32 v34, v34, v54
v_mfma_f32_16x16x32_bf16 v[144:147], a[224:227], v[224:227], 0
buffer_store_dwordx4 v[40:43], v22, s[16:19], s45 offen offset:1024 sc1
v_mfma_f32_16x16x32_bf16 v[144:147], a[228:231], v[244:247], v[144:147]
ds_read_b64_tr_b16 a[246:247], v3 offset:14336
v_mul_f32 v35, v35, v54
v_mfma_f32_16x16x32_bf16 v[148:151], a[224:227], v[228:231], 0
ds_read_b64_tr_b16 a[248:249], v4 offset:8192
v_cvt_pk_bf16_f32 v32, v32, v33
v_mfma_f32_16x16x32_bf16 v[148:151], a[228:231], v[248:251], v[148:151]
v_cvt_pk_bf16_f32 v33, v34, v35
v_accvgpr_read_b32 v36, a124
v_mfma_f32_16x16x32_bf16 v[152:155], a[224:227], v[232:235], 0
v_accvgpr_read_b32 v37, a125
v_accvgpr_read_b32 v38, a126
v_mfma_f32_16x16x32_bf16 v[152:155], a[228:231], v[252:255], v[152:155]
v_accvgpr_read_b32 v39, a127
v_mul_f32 v36, v36, v54
v_mfma_f32_16x16x32_bf16 v[156:159], a[224:227], v[236:239], 0
buffer_store_dwordx4 v[56:59], v22, s[16:19], s45 offen offset:2048 sc1
v_mfma_f32_16x16x32_bf16 v[156:159], a[228:231], a[0:3], v[156:159]
ds_read_b64_tr_b16 a[250:251], v4 offset:10240
v_mul_f32 v37, v37, v54
v_mfma_f32_16x16x32_bf16 v[160:163], a[224:227], v[240:243], 0
ds_read_b64_tr_b16 a[252:253], v4 offset:12288
s_waitcnt lgkmcnt(7)
v_mfma_f32_16x16x32_bf16 v[160:163], a[228:231], a[16:19], v[160:163]
ds_read_b64_tr_b16 a[254:255], v4 offset:14336
v_mul_f32 v38, v38, v54
v_mfma_f32_16x16x32_bf16 v[164:167], a[232:235], v[224:227], 0
s_mov_b32 s46, 491520
v_mul_f32 v39, v39, v54
v_mfma_f32_16x16x32_bf16 v[164:167], a[236:239], v[244:247], v[164:167]
v_cvt_pk_bf16_f32 v34, v36, v37
v_cvt_pk_bf16_f32 v35, v38, v39
v_mfma_f32_16x16x32_bf16 v[168:171], a[232:235], v[228:231], 0
buffer_load_dwordx4 a[40:43], v18, s[8:11], s46 offen offset:0 sc1
v_mfma_f32_16x16x32_bf16 v[168:171], a[236:239], v[248:251], v[168:171]
v_accvgpr_read_b32 v40, a128
v_accvgpr_read_b32 v41, a129
v_mfma_f32_16x16x32_bf16 v[172:175], a[232:235], v[232:235], 0
v_accvgpr_read_b32 v42, a130
v_accvgpr_read_b32 v43, a131
v_mfma_f32_16x16x32_bf16 v[172:175], a[236:239], v[252:255], v[172:175]
v_mul_f32 v40, v40, v48
v_mul_f32 v41, v41, v48
v_mfma_f32_16x16x32_bf16 v[176:179], a[232:235], v[236:239], 0
v_mul_f32 v42, v42, v48
v_mul_f32 v43, v43, v48
v_mfma_f32_16x16x32_bf16 v[176:179], a[236:239], a[0:3], v[176:179]
v_cvt_pk_bf16_f32 v40, v40, v41
v_cvt_pk_bf16_f32 v41, v42, v43
v_mfma_f32_16x16x32_bf16 v[180:183], a[232:235], v[240:243], 0
buffer_load_dwordx4 a[56:59], v18, s[8:11], s46 offen offset:1024 sc1
v_mfma_f32_16x16x32_bf16 v[180:183], a[236:239], a[16:19], v[180:183]
s_waitcnt lgkmcnt(4)
v_accvgpr_read_b32 v44, a144
v_mfma_f32_16x16x32_bf16 v[184:187], a[240:243], v[224:227], 0
v_accvgpr_read_b32 v45, a145
v_accvgpr_read_b32 v46, a146
v_mfma_f32_16x16x32_bf16 v[184:187], a[244:247], v[244:247], v[184:187]
ds_read_b64_tr_b16 a[192:193], v1 offset:16384
v_accvgpr_read_b32 v47, a147
v_mfma_f32_16x16x32_bf16 v[188:191], a[240:243], v[228:231], 0
ds_read_b64_tr_b16 a[194:195], v1 offset:18432
v_mul_f32 v44, v44, v48
v_mfma_f32_16x16x32_bf16 v[188:191], a[244:247], v[248:251], v[188:191]
ds_read_b64_tr_b16 a[196:197], v1 offset:20480
v_mul_f32 v45, v45, v48
v_mfma_f32_16x16x32_bf16 v[192:195], a[240:243], v[232:235], 0
buffer_load_dwordx4 a[44:47], v18, s[8:11], s46 offen offset:2048 sc1
v_mfma_f32_16x16x32_bf16 v[192:195], a[244:247], v[252:255], v[192:195]
ds_read_b64_tr_b16 a[198:199], v1 offset:22528
v_mul_f32 v46, v46, v48
v_mfma_f32_16x16x32_bf16 v[196:199], a[240:243], v[236:239], 0
ds_read_b64_tr_b16 a[200:201], v2 offset:16384
v_mul_f32 v47, v47, v48
v_mfma_f32_16x16x32_bf16 v[196:199], a[244:247], a[0:3], v[196:199]
ds_read_b64_tr_b16 a[202:203], v2 offset:18432
v_cvt_pk_bf16_f32 v42, v44, v45
v_mfma_f32_16x16x32_bf16 v[200:203], a[240:243], v[240:243], 0
v_cvt_pk_bf16_f32 v43, v46, v47
s_waitcnt lgkmcnt(6)
v_mfma_f32_16x16x32_bf16 v[200:203], a[244:247], a[16:19], v[200:203]
ds_read_b64_tr_b16 a[204:205], v2 offset:20480
v_accvgpr_read_b32 v56, a132
v_mfma_f32_16x16x32_bf16 v[204:207], a[248:251], v[224:227], 0
buffer_load_dwordx4 a[60:63], v18, s[8:11], s46 offen offset:3072 sc1
v_accvgpr_read_b32 v57, a133
v_accvgpr_read_b32 v58, a134
v_mfma_f32_16x16x32_bf16 v[204:207], a[252:255], v[244:247], v[204:207]
ds_read_b64_tr_b16 a[206:207], v2 offset:22528
v_accvgpr_read_b32 v59, a135
v_mfma_f32_16x16x32_bf16 v[208:211], a[248:251], v[228:231], 0
v_mul_f32 v56, v56, v50
v_mul_f32 v57, v57, v50
v_mfma_f32_16x16x32_bf16 v[208:211], a[252:255], v[248:251], v[208:211]
v_mul_f32 v58, v58, v50
v_mul_f32 v59, v59, v50
v_mfma_f32_16x16x32_bf16 v[212:215], a[248:251], v[232:235], 0
s_mov_b32 s46, 495616
v_cvt_pk_bf16_f32 v56, v56, v57
v_mfma_f32_16x16x32_bf16 v[212:215], a[252:255], v[252:255], v[212:215]
v_cvt_pk_bf16_f32 v57, v58, v59
v_accvgpr_read_b32 v60, a148
v_mfma_f32_16x16x32_bf16 v[216:219], a[248:251], v[236:239], 0
buffer_load_dwordx4 a[64:67], v18, s[8:11], s46 offen offset:0 sc1
v_mfma_f32_16x16x32_bf16 v[216:219], a[252:255], a[0:3], v[216:219]
v_accvgpr_read_b32 v61, a149
v_accvgpr_read_b32 v62, a150
v_mfma_f32_16x16x32_bf16 v[220:223], a[248:251], v[240:243], 0
v_accvgpr_read_b32 v63, a151
v_mul_f32 v60, v60, v50
v_mul_f32 v61, v61, v50
v_mul_f32 v62, v62, v50
v_mul_f32 v63, v63, v50
v_cvt_pk_bf16_f32 v58, v60, v61
v_cvt_pk_bf16_f32 v59, v62, v63
v_mfma_f32_16x16x32_bf16 v[220:223], a[252:255], a[16:19], v[220:223]
s_waitcnt vmcnt(8) lgkmcnt(4)
v_mfma_f32_16x16x32_bf16 v[64:67], a[192:195], a[4:7], v[64:67]
ds_read_b64_tr_b16 a[208:209], v3 offset:16384
s_mov_b32 s46, 614400
v_mfma_f32_16x16x32_bf16 v[64:67], a[196:199], a[28:31], v[64:67]
ds_read_b64_tr_b16 a[210:211], v3 offset:18432
v_mfma_f32_16x16x32_bf16 v[68:71], a[192:195], a[20:23], v[68:71]
ds_read_b64_tr_b16 a[212:213], v3 offset:20480
v_mfma_f32_16x16x32_bf16 v[68:71], a[196:199], a[32:35], v[68:71]
buffer_load_dwordx4 a[80:83], v18, s[8:11], s46 offen offset:0 sc1
v_mfma_f32_16x16x32_bf16 v[72:75], a[192:195], a[8:11], v[72:75]
ds_read_b64_tr_b16 a[214:215], v3 offset:22528
v_mfma_f32_16x16x32_bf16 v[72:75], a[196:199], a[48:51], v[72:75]
v_mfma_f32_16x16x32_bf16 v[76:79], a[192:195], a[24:27], v[76:79]
ds_read_b64_tr_b16 a[216:217], v4 offset:16384
v_mfma_f32_16x16x32_bf16 v[76:79], a[196:199], a[36:39], v[76:79]
s_waitcnt lgkmcnt(5)
ds_read_b64_tr_b16 a[218:219], v4 offset:18432
v_mfma_f32_16x16x32_bf16 v[80:83], a[192:195], a[12:15], v[80:83]
v_mfma_f32_16x16x32_bf16 v[80:83], a[196:199], a[52:55], v[80:83]
buffer_load_dwordx4 a[68:71], v18, s[8:11], s46 offen offset:1024 sc1
v_mfma_f32_16x16x32_bf16 v[84:87], a[200:203], a[4:7], v[84:87]
v_mfma_f32_16x16x32_bf16 v[84:87], a[204:207], a[28:31], v[84:87]
ds_read_b64_tr_b16 a[220:221], v4 offset:20480
v_mfma_f32_16x16x32_bf16 v[88:91], a[200:203], a[20:23], v[88:91]
v_mfma_f32_16x16x32_bf16 v[88:91], a[204:207], a[32:35], v[88:91]
ds_read_b64_tr_b16 a[222:223], v4 offset:22528
v_mfma_f32_16x16x32_bf16 v[92:95], a[200:203], a[8:11], v[92:95]
v_mfma_f32_16x16x32_bf16 v[92:95], a[204:207], a[48:51], v[92:95]
buffer_load_dwordx4 a[84:87], v18, s[8:11], s46 offen offset:2048 sc1
v_mfma_f32_16x16x32_bf16 v[96:99], a[200:203], a[24:27], v[96:99]
ds_read_b64_tr_b16 a[224:225], v1 offset:24576
v_mfma_f32_16x16x32_bf16 v[96:99], a[204:207], a[36:39], v[96:99]
s_waitcnt lgkmcnt(5)
ds_read_b64_tr_b16 a[226:227], v1 offset:26624
v_mfma_f32_16x16x32_bf16 v[100:103], a[200:203], a[12:15], v[100:103]
v_mfma_f32_16x16x32_bf16 v[100:103], a[204:207], a[52:55], v[100:103]
v_mfma_f32_16x16x32_bf16 v[104:107], a[208:211], a[4:7], v[104:107]
ds_read_b64_tr_b16 a[228:229], v1 offset:28672
v_mfma_f32_16x16x32_bf16 v[104:107], a[212:215], a[28:31], v[104:107]
buffer_load_dwordx4 a[72:75], v18, s[8:11], s46 offen offset:3072 sc1
v_mfma_f32_16x16x32_bf16 v[108:111], a[208:211], a[20:23], v[108:111]
ds_read_b64_tr_b16 a[230:231], v1 offset:30720
s_mov_b32 s46, 618496
v_mfma_f32_16x16x32_bf16 v[108:111], a[212:215], a[32:35], v[108:111]
v_mfma_f32_16x16x32_bf16 v[112:115], a[208:211], a[8:11], v[112:115]
ds_read_b64_tr_b16 a[232:233], v2 offset:24576
v_mfma_f32_16x16x32_bf16 v[112:115], a[212:215], a[48:51], v[112:115]
v_mfma_f32_16x16x32_bf16 v[116:119], a[208:211], a[24:27], v[116:119]
v_mfma_f32_16x16x32_bf16 v[116:119], a[212:215], a[36:39], v[116:119]
buffer_load_dwordx4 a[88:91], v18, s[8:11], s46 offen offset:0 sc1
v_mfma_f32_16x16x32_bf16 v[120:123], a[208:211], a[12:15], v[120:123]
ds_read_b64_tr_b16 a[234:235], v2 offset:26624
s_waitcnt lgkmcnt(6)
v_mfma_f32_16x16x32_bf16 v[120:123], a[212:215], a[52:55], v[120:123]
ds_read_b64_tr_b16 a[236:237], v2 offset:28672
v_mfma_f32_16x16x32_bf16 v[124:127], a[216:219], a[4:7], v[124:127]
v_mfma_f32_16x16x32_bf16 v[124:127], a[220:223], a[28:31], v[124:127]
ds_read_b64_tr_b16 a[238:239], v2 offset:30720
v_mfma_f32_16x16x32_bf16 v[128:131], a[216:219], a[20:23], v[128:131]
v_mfma_f32_16x16x32_bf16 v[128:131], a[220:223], a[32:35], v[128:131]
buffer_store_dwordx4 v[32:35], v23, s[16:19], s45 offen offset:3072 sc1
v_mfma_f32_16x16x32_bf16 v[132:135], a[216:219], a[8:11], v[132:135]
ds_read_b64_tr_b16 a[240:241], v3 offset:24576
v_mfma_f32_16x16x32_bf16 v[132:135], a[220:223], a[48:51], v[132:135]
v_accvgpr_read_b32 v32, a136
v_accvgpr_read_b32 v33, a137
v_mfma_f32_16x16x32_bf16 v[136:139], a[216:219], a[24:27], v[136:139]
ds_read_b64_tr_b16 a[242:243], v3 offset:26624
v_accvgpr_read_b32 v34, a138
v_mfma_f32_16x16x32_bf16 v[136:139], a[220:223], a[36:39], v[136:139]
v_accvgpr_read_b32 v35, a139
v_mul_f32 v32, v32, v52
v_mfma_f32_16x16x32_bf16 v[140:143], a[216:219], a[12:15], v[140:143]
ds_read_b64_tr_b16 a[244:245], v3 offset:28672
s_waitcnt lgkmcnt(7)
v_mfma_f32_16x16x32_bf16 v[140:143], a[220:223], a[52:55], v[140:143]
ds_read_b64_tr_b16 a[246:247], v3 offset:30720
v_mul_f32 v33, v33, v52
v_mfma_f32_16x16x32_bf16 v[144:147], a[224:227], a[4:7], v[144:147]
buffer_store_dwordx4 v[40:43], v22, s[16:19], s37 offen offset:0 sc1
v_mfma_f32_16x16x32_bf16 v[144:147], a[228:231], a[28:31], v[144:147]
ds_read_b64_tr_b16 a[248:249], v4 offset:24576
v_mul_f32 v34, v34, v52
v_mfma_f32_16x16x32_bf16 v[148:151], a[224:227], a[20:23], v[148:151]
v_mul_f32 v35, v35, v52
v_cvt_pk_bf16_f32 v32, v32, v33
v_mfma_f32_16x16x32_bf16 v[148:151], a[228:231], a[32:35], v[148:151]
ds_read_b64_tr_b16 a[250:251], v4 offset:26624
v_cvt_pk_bf16_f32 v33, v34, v35
v_mfma_f32_16x16x32_bf16 v[152:155], a[224:227], a[8:11], v[152:155]
v_accvgpr_read_b32 v36, a152
v_accvgpr_read_b32 v37, a153
v_mfma_f32_16x16x32_bf16 v[152:155], a[228:231], a[48:51], v[152:155]
ds_read_b64_tr_b16 a[252:253], v4 offset:28672
v_accvgpr_read_b32 v38, a154
v_mfma_f32_16x16x32_bf16 v[156:159], a[224:227], a[24:27], v[156:159]
buffer_store_dwordx4 v[56:59], v22, s[16:19], s37 offen offset:1024 sc1
v_mfma_f32_16x16x32_bf16 v[156:159], a[228:231], a[36:39], v[156:159]
ds_read_b64_tr_b16 a[254:255], v4 offset:30720
v_accvgpr_read_b32 v39, a155
v_mfma_f32_16x16x32_bf16 v[160:163], a[224:227], a[12:15], v[160:163]
v_mul_f32 v36, v36, v52
s_waitcnt lgkmcnt(8)
v_mul_f32 v37, v37, v52
v_mfma_f32_16x16x32_bf16 v[160:163], a[228:231], a[52:55], v[160:163]
v_mul_f32 v38, v38, v52
v_mul_f32 v39, v39, v52
v_mfma_f32_16x16x32_bf16 v[164:167], a[232:235], a[4:7], v[164:167]
s_mov_b32 s46, 737280
v_cvt_pk_bf16_f32 v34, v36, v37
v_mfma_f32_16x16x32_bf16 v[164:167], a[236:239], a[28:31], v[164:167]
v_cvt_pk_bf16_f32 v35, v38, v39
v_accvgpr_read_b32 v40, a140
v_mfma_f32_16x16x32_bf16 v[168:171], a[232:235], a[20:23], v[168:171]
buffer_load_dwordx4 a[76:79], v18, s[8:11], s46 offen offset:0 sc1
v_accvgpr_read_b32 v41, a141
v_accvgpr_read_b32 v42, a142
v_mfma_f32_16x16x32_bf16 v[168:171], a[236:239], a[32:35], v[168:171]
v_accvgpr_read_b32 v43, a143
v_mul_f32 v40, v40, v54
v_mfma_f32_16x16x32_bf16 v[172:175], a[232:235], a[8:11], v[172:175]
v_mul_f32 v41, v41, v54
v_mul_f32 v42, v42, v54
v_mfma_f32_16x16x32_bf16 v[172:175], a[236:239], a[48:51], v[172:175]
v_mul_f32 v43, v43, v54
v_cvt_pk_bf16_f32 v40, v40, v41
v_mfma_f32_16x16x32_bf16 v[176:179], a[232:235], a[24:27], v[176:179]
v_cvt_pk_bf16_f32 v41, v42, v43
v_accvgpr_read_b32 v44, a156
v_mfma_f32_16x16x32_bf16 v[176:179], a[236:239], a[36:39], v[176:179]
v_accvgpr_read_b32 v45, a157
v_accvgpr_read_b32 v46, a158
v_mfma_f32_16x16x32_bf16 v[180:183], a[232:235], a[12:15], v[180:183]
buffer_load_dwordx4 a[92:95], v18, s[8:11], s46 offen offset:1024 sc1
v_mfma_f32_16x16x32_bf16 v[180:183], a[236:239], a[52:55], v[180:183]
s_waitcnt lgkmcnt(4)
v_accvgpr_read_b32 v47, a159
v_mul_f32 v44, v44, v54
v_mfma_f32_16x16x32_bf16 v[184:187], a[240:243], a[4:7], v[184:187]
s_waitcnt vmcnt(58) lgkmcnt(0)
s_barrier
v_mfma_f32_16x16x32_bf16 v[184:187], a[244:247], a[28:31], v[184:187]
ds_read_b64_tr_b16 a[192:193], v1 offset:32768
v_mfma_f32_16x16x32_bf16 v[188:191], a[240:243], a[20:23], v[188:191]
ds_read_b64_tr_b16 a[194:195], v1 offset:34816
v_mfma_f32_16x16x32_bf16 v[188:191], a[244:247], a[32:35], v[188:191]
ds_read_b64_tr_b16 a[196:197], v1 offset:36864
v_mfma_f32_16x16x32_bf16 v[192:195], a[240:243], a[8:11], v[192:195]
buffer_load_dwordx4 a[96:99], v18, s[8:11], s46 offen offset:2048 sc1
v_mfma_f32_16x16x32_bf16 v[192:195], a[244:247], a[48:51], v[192:195]
ds_read_b64_tr_b16 a[198:199], v1 offset:38912
v_mfma_f32_16x16x32_bf16 v[196:199], a[240:243], a[24:27], v[196:199]
ds_read_b64_tr_b16 a[200:201], v2 offset:32768
v_mfma_f32_16x16x32_bf16 v[196:199], a[244:247], a[36:39], v[196:199]
v_mfma_f32_16x16x32_bf16 v[200:203], a[240:243], a[12:15], v[200:203]
ds_read_b64_tr_b16 a[202:203], v2 offset:34816
v_mfma_f32_16x16x32_bf16 v[200:203], a[244:247], a[52:55], v[200:203]
ds_read_b64_tr_b16 a[204:205], v2 offset:36864
v_mul_f32 v45, v45, v54
v_mul_f32 v46, v46, v54
v_mul_f32 v47, v47, v54
v_cvt_pk_bf16_f32 v42, v44, v45
v_cvt_pk_bf16_f32 v43, v46, v47
v_accvgpr_read_b32 v56, a160
v_accvgpr_read_b32 v57, a161
v_accvgpr_read_b32 v58, a162
v_mfma_f32_16x16x32_bf16 v[204:207], a[248:251], a[4:7], v[204:207]
buffer_load_dwordx4 a[112:115], v18, s[8:11], s46 offen offset:3072 sc1
v_mfma_f32_16x16x32_bf16 v[204:207], a[252:255], a[28:31], v[204:207]
ds_read_b64_tr_b16 a[206:207], v2 offset:38912
v_accvgpr_read_b32 v59, a163
v_mfma_f32_16x16x32_bf16 v[208:211], a[248:251], a[20:23], v[208:211]
v_mul_f32 v56, v56, v48
v_mul_f32 v57, v57, v48
v_mfma_f32_16x16x32_bf16 v[208:211], a[252:255], a[32:35], v[208:211]
v_mul_f32 v58, v58, v48
v_mul_f32 v59, v59, v48
v_mfma_f32_16x16x32_bf16 v[212:215], a[248:251], a[8:11], v[212:215]
s_mov_b32 s46, 741376
v_cvt_pk_bf16_f32 v56, v56, v57
v_mfma_f32_16x16x32_bf16 v[212:215], a[252:255], a[48:51], v[212:215]
v_cvt_pk_bf16_f32 v57, v58, v59
v_accvgpr_read_b32 v60, a176
v_mfma_f32_16x16x32_bf16 v[216:219], a[248:251], a[24:27], v[216:219]
buffer_load_dwordx4 a[100:103], v18, s[8:11], s46 offen offset:0 sc1
v_mfma_f32_16x16x32_bf16 v[216:219], a[252:255], a[36:39], v[216:219]
v_accvgpr_read_b32 v61, a177
v_accvgpr_read_b32 v62, a178
v_mfma_f32_16x16x32_bf16 v[220:223], a[248:251], a[12:15], v[220:223]
v_accvgpr_read_b32 v63, a179
v_mul_f32 v60, v60, v48
v_mul_f32 v61, v61, v48
v_mul_f32 v62, v62, v48
v_mul_f32 v63, v63, v48
v_cvt_pk_bf16_f32 v58, v60, v61
v_cvt_pk_bf16_f32 v59, v62, v63
v_mfma_f32_16x16x32_bf16 v[220:223], a[252:255], a[52:55], v[220:223]
s_waitcnt vmcnt(8) lgkmcnt(4)
v_mfma_f32_16x16x32_bf16 v[64:67], a[192:195], a[40:43], v[64:67]
ds_read_b64_tr_b16 a[208:209], v3 offset:32768
s_mov_b32 s46, 860160
v_mfma_f32_16x16x32_bf16 v[64:67], a[196:199], a[80:83], v[64:67]
ds_read_b64_tr_b16 a[210:211], v3 offset:34816
v_mfma_f32_16x16x32_bf16 v[68:71], a[192:195], a[56:59], v[68:71]
buffer_load_dwordx4 a[116:119], v18, s[8:11], s46 offen offset:0 sc1
v_mfma_f32_16x16x32_bf16 v[68:71], a[196:199], a[68:71], v[68:71]
ds_read_b64_tr_b16 a[212:213], v3 offset:36864
v_mfma_f32_16x16x32_bf16 v[72:75], a[192:195], a[44:47], v[72:75]
v_mfma_f32_16x16x32_bf16 v[72:75], a[196:199], a[84:87], v[72:75]
ds_read_b64_tr_b16 a[214:215], v3 offset:38912
v_mfma_f32_16x16x32_bf16 v[76:79], a[192:195], a[60:63], v[76:79]
v_mfma_f32_16x16x32_bf16 v[76:79], a[196:199], a[72:75], v[76:79]
buffer_load_dwordx4 a[104:107], v18, s[8:11], s46 offen offset:1024 sc1
v_mfma_f32_16x16x32_bf16 v[80:83], a[192:195], a[64:67], v[80:83]
ds_read_b64_tr_b16 a[216:217], v4 offset:32768
s_waitcnt lgkmcnt(5)
v_mfma_f32_16x16x32_bf16 v[80:83], a[196:199], a[88:91], v[80:83]
v_mfma_f32_16x16x32_bf16 v[84:87], a[200:203], a[40:43], v[84:87]
ds_read_b64_tr_b16 a[218:219], v4 offset:34816
v_mfma_f32_16x16x32_bf16 v[84:87], a[204:207], a[80:83], v[84:87]
buffer_load_dwordx4 a[120:123], v18, s[8:11], s46 offen offset:2048 sc1
v_mfma_f32_16x16x32_bf16 v[88:91], a[200:203], a[56:59], v[88:91]
ds_read_b64_tr_b16 a[220:221], v4 offset:36864
v_mfma_f32_16x16x32_bf16 v[88:91], a[204:207], a[68:71], v[88:91]
v_mfma_f32_16x16x32_bf16 v[92:95], a[200:203], a[44:47], v[92:95]
ds_read_b64_tr_b16 a[222:223], v4 offset:38912
v_mfma_f32_16x16x32_bf16 v[92:95], a[204:207], a[84:87], v[92:95]
v_mfma_f32_16x16x32_bf16 v[96:99], a[200:203], a[60:63], v[96:99]
buffer_load_dwordx4 v[224:227], v18, s[8:11], s46 offen offset:3072 sc1
v_mfma_f32_16x16x32_bf16 v[96:99], a[204:207], a[72:75], v[96:99]
ds_read_b64_tr_b16 a[224:225], v1 offset:40960
s_waitcnt lgkmcnt(5)
v_mfma_f32_16x16x32_bf16 v[100:103], a[200:203], a[64:67], v[100:103]
s_mov_b32 s46, 864256
ds_read_b64_tr_b16 a[226:227], v1 offset:43008
v_mfma_f32_16x16x32_bf16 v[100:103], a[204:207], a[88:91], v[100:103]
v_mfma_f32_16x16x32_bf16 v[104:107], a[208:211], a[40:43], v[104:107]
v_mfma_f32_16x16x32_bf16 v[104:107], a[212:215], a[80:83], v[104:107]
buffer_load_dwordx4 v[228:231], v18, s[8:11], s46 offen offset:0 sc1
v_mfma_f32_16x16x32_bf16 v[108:111], a[208:211], a[56:59], v[108:111]
ds_read_b64_tr_b16 a[228:229], v1 offset:45056
v_mfma_f32_16x16x32_bf16 v[108:111], a[212:215], a[68:71], v[108:111]
ds_read_b64_tr_b16 a[230:231], v1 offset:47104
v_mfma_f32_16x16x32_bf16 v[112:115], a[208:211], a[44:47], v[112:115]
v_mfma_f32_16x16x32_bf16 v[112:115], a[212:215], a[84:87], v[112:115]
buffer_store_dwordx4 v[32:35], v22, s[16:19], s37 offen offset:2048 sc1
v_mfma_f32_16x16x32_bf16 v[116:119], a[208:211], a[60:63], v[116:119]
ds_read_b64_tr_b16 a[232:233], v2 offset:40960
v_mfma_f32_16x16x32_bf16 v[116:119], a[212:215], a[72:75], v[116:119]
v_accvgpr_read_b32 v32, a164
v_accvgpr_read_b32 v33, a165
v_mfma_f32_16x16x32_bf16 v[120:123], a[208:211], a[64:67], v[120:123]
ds_read_b64_tr_b16 a[234:235], v2 offset:43008
s_waitcnt lgkmcnt(6)
v_mfma_f32_16x16x32_bf16 v[120:123], a[212:215], a[88:91], v[120:123]
v_accvgpr_read_b32 v34, a166
v_accvgpr_read_b32 v35, a167
v_mfma_f32_16x16x32_bf16 v[124:127], a[216:219], a[40:43], v[124:127]
buffer_store_dwordx4 v[40:43], v23, s[16:19], s37 offen offset:3072 sc1
v_mfma_f32_16x16x32_bf16 v[124:127], a[220:223], a[80:83], v[124:127]
ds_read_b64_tr_b16 a[236:237], v2 offset:45056
v_mul_f32 v32, v32, v50
v_mfma_f32_16x16x32_bf16 v[128:131], a[216:219], a[56:59], v[128:131]
ds_read_b64_tr_b16 a[238:239], v2 offset:47104
v_mul_f32 v33, v33, v50
v_mfma_f32_16x16x32_bf16 v[128:131], a[220:223], a[68:71], v[128:131]
v_mul_f32 v34, v34, v50
v_mul_f32 v35, v35, v50
v_mfma_f32_16x16x32_bf16 v[132:135], a[216:219], a[44:47], v[132:135]
ds_read_b64_tr_b16 a[240:241], v3 offset:40960
v_cvt_pk_bf16_f32 v32, v32, v33
v_mfma_f32_16x16x32_bf16 v[132:135], a[220:223], a[84:87], v[132:135]
buffer_store_dwordx4 v[56:59], v22, s[16:19], s38 offen offset:0 sc1
v_mfma_f32_16x16x32_bf16 v[136:139], a[216:219], a[60:63], v[136:139]
ds_read_b64_tr_b16 a[242:243], v3 offset:43008
v_cvt_pk_bf16_f32 v33, v34, v35
v_mfma_f32_16x16x32_bf16 v[136:139], a[220:223], a[72:75], v[136:139]
ds_read_b64_tr_b16 a[244:245], v3 offset:45056
v_accvgpr_read_b32 v36, a180
v_mfma_f32_16x16x32_bf16 v[140:143], a[216:219], a[64:67], v[140:143]
v_accvgpr_read_b32 v37, a181
s_waitcnt lgkmcnt(7)
v_mfma_f32_16x16x32_bf16 v[140:143], a[220:223], a[88:91], v[140:143]
s_add_u32 m0, s41, 0
s_mov_b32 s46, 491520
v_mfma_f32_16x16x32_bf16 v[144:147], a[224:227], a[40:43], v[144:147]
buffer_load_dwordx4 v21, s[4:7], s46 offen offset:0 lds
v_mfma_f32_16x16x32_bf16 v[144:147], a[228:231], a[80:83], v[144:147]
ds_read_b64_tr_b16 a[246:247], v3 offset:47104
v_accvgpr_read_b32 v38, a182
v_mfma_f32_16x16x32_bf16 v[148:151], a[224:227], a[56:59], v[148:151]
ds_read_b64_tr_b16 a[248:249], v4 offset:40960
s_mov_b32 s46, 500736
v_mfma_f32_16x16x32_bf16 v[148:151], a[228:231], a[68:71], v[148:151]
v_accvgpr_read_b32 v39, a183
v_mul_f32 v36, v36, v50
v_mfma_f32_16x16x32_bf16 v[152:155], a[224:227], a[44:47], v[152:155]
buffer_load_dwordx4 v21, s[4:7], s46 offen offset:1024 lds
v_mfma_f32_16x16x32_bf16 v[152:155], a[228:231], a[84:87], v[152:155]
ds_read_b64_tr_b16 a[250:251], v4 offset:43008
v_mul_f32 v37, v37, v50
v_mul_f32 v38, v38, v50
v_mfma_f32_16x16x32_bf16 v[156:159], a[224:227], a[60:63], v[156:159]
ds_read_b64_tr_b16 a[252:253], v4 offset:45056
v_mul_f32 v39, v39, v50
v_mfma_f32_16x16x32_bf16 v[156:159], a[228:231], a[72:75], v[156:159]
s_mov_b32 s46, 509952
v_cvt_pk_bf16_f32 v34, v36, v37
v_mfma_f32_16x16x32_bf16 v[160:163], a[224:227], a[64:67], v[160:163]
ds_read_b64_tr_b16 a[254:255], v4 offset:47104
s_waitcnt lgkmcnt(8)
v_cvt_pk_bf16_f32 v35, v38, v39
v_mfma_f32_16x16x32_bf16 v[160:163], a[228:231], a[88:91], v[160:163]
buffer_load_dwordx4 v21, s[4:7], s46 offen offset:2048 lds
v_accvgpr_read_b32 v40, a168
v_mfma_f32_16x16x32_bf16 v[164:167], a[232:235], a[40:43], v[164:167]
v_accvgpr_read_b32 v41, a169
v_accvgpr_read_b32 v42, a170
v_mfma_f32_16x16x32_bf16 v[164:167], a[236:239], a[80:83], v[164:167]
v_accvgpr_read_b32 v43, a171
v_mul_f32 v40, v40, v52
v_mfma_f32_16x16x32_bf16 v[168:171], a[232:235], a[56:59], v[168:171]
s_mov_b32 s46, 519168
v_mul_f32 v41, v41, v52
v_mfma_f32_16x16x32_bf16 v[168:171], a[236:239], a[68:71], v[168:171]
v_mul_f32 v42, v42, v52
v_mul_f32 v43, v43, v52
v_mfma_f32_16x16x32_bf16 v[172:175], a[232:235], a[44:47], v[172:175]
buffer_load_dwordx4 v21, s[4:7], s46 offen offset:3072 lds
v_mfma_f32_16x16x32_bf16 v[172:175], a[236:239], a[84:87], v[172:175]
v_cvt_pk_bf16_f32 v40, v40, v41
v_cvt_pk_bf16_f32 v41, v42, v43
v_mfma_f32_16x16x32_bf16 v[176:179], a[232:235], a[60:63], v[176:179]
s_mov_b32 s46, 983040
v_accvgpr_read_b32 v44, a184
v_mfma_f32_16x16x32_bf16 v[176:179], a[236:239], a[72:75], v[176:179]
v_accvgpr_read_b32 v45, a185
v_accvgpr_read_b32 v46, a186
v_mfma_f32_16x16x32_bf16 v[180:183], a[232:235], a[64:67], v[180:183]
buffer_load_dwordx4 v[232:235], v18, s[8:11], s46 offen offset:0 sc1
v_mfma_f32_16x16x32_bf16 v[180:183], a[236:239], a[88:91], v[180:183]
s_waitcnt lgkmcnt(4)
v_accvgpr_read_b32 v47, a187
v_mfma_f32_16x16x32_bf16 v[184:187], a[240:243], a[40:43], v[184:187]
v_mul_f32 v44, v44, v52
v_mul_f32 v45, v45, v52
v_mfma_f32_16x16x32_bf16 v[184:187], a[244:247], a[80:83], v[184:187]
ds_read_b64_tr_b16 a[192:193], v1 offset:49152
v_mul_f32 v46, v46, v52
v_mfma_f32_16x16x32_bf16 v[188:191], a[240:243], a[56:59], v[188:191]
ds_read_b64_tr_b16 a[194:195], v1 offset:51200
v_mul_f32 v47, v47, v52
v_mfma_f32_16x16x32_bf16 v[188:191], a[244:247], a[68:71], v[188:191]
buffer_load_dwordx4 v[236:239], v18, s[8:11], s46 offen offset:1024 sc1
v_mfma_f32_16x16x32_bf16 v[192:195], a[240:243], a[44:47], v[192:195]
ds_read_b64_tr_b16 a[196:197], v1 offset:53248
v_cvt_pk_bf16_f32 v42, v44, v45
v_mfma_f32_16x16x32_bf16 v[192:195], a[244:247], a[84:87], v[192:195]
ds_read_b64_tr_b16 a[198:199], v1 offset:55296
v_cvt_pk_bf16_f32 v43, v46, v47
v_mfma_f32_16x16x32_bf16 v[196:199], a[240:243], a[60:63], v[196:199]
ds_read_b64_tr_b16 a[200:201], v2 offset:49152
v_accvgpr_read_b32 v56, a172
v_mfma_f32_16x16x32_bf16 v[196:199], a[244:247], a[72:75], v[196:199]
ds_read_b64_tr_b16 a[202:203], v2 offset:51200
v_accvgpr_read_b32 v57, a173
v_mfma_f32_16x16x32_bf16 v[200:203], a[240:243], a[64:67], v[200:203]
buffer_load_dwordx4 v[240:243], v18, s[8:11], s46 offen offset:2048 sc1
v_accvgpr_read_b32 v58, a174
v_mfma_f32_16x16x32_bf16 v[200:203], a[244:247], a[88:91], v[200:203]
s_waitcnt lgkmcnt(6)
v_accvgpr_read_b32 v59, a175
v_mfma_f32_16x16x32_bf16 v[204:207], a[248:251], a[40:43], v[204:207]
ds_read_b64_tr_b16 a[204:205], v2 offset:53248
v_mul_f32 v56, v56, v54
v_mfma_f32_16x16x32_bf16 v[204:207], a[252:255], a[80:83], v[204:207]
ds_read_b64_tr_b16 a[206:207], v2 offset:55296
v_mul_f32 v57, v57, v54
v_mul_f32 v58, v58, v54
v_mfma_f32_16x16x32_bf16 v[208:211], a[248:251], a[56:59], v[208:211]
buffer_load_dwordx4 v[244:247], v18, s[8:11], s46 offen offset:3072 sc1
v_mul_f32 v59, v59, v54
v_mfma_f32_16x16x32_bf16 v[208:211], a[252:255], a[68:71], v[208:211]
v_cvt_pk_bf16_f32 v56, v56, v57
v_cvt_pk_bf16_f32 v57, v58, v59
v_mfma_f32_16x16x32_bf16 v[212:215], a[248:251], a[44:47], v[212:215]
v_accvgpr_read_b32 v60, a188
v_accvgpr_read_b32 v61, a189
v_mfma_f32_16x16x32_bf16 v[212:215], a[252:255], a[84:87], v[212:215]
s_mov_b32 s46, 987136
v_accvgpr_read_b32 v62, a190
v_mfma_f32_16x16x32_bf16 v[216:219], a[248:251], a[60:63], v[216:219]
v_accvgpr_read_b32 v63, a191
v_mul_f32 v60, v60, v54
v_mfma_f32_16x16x32_bf16 v[216:219], a[252:255], a[72:75], v[216:219]
buffer_load_dwordx4 v[248:251], v18, s[8:11], s46 offen offset:0 sc1
v_mfma_f32_16x16x32_bf16 v[220:223], a[248:251], a[64:67], v[220:223]
v_mul_f32 v61, v61, v54
v_mul_f32 v62, v62, v54
v_mul_f32 v63, v63, v54
v_cvt_pk_bf16_f32 v58, v60, v61
v_cvt_pk_bf16_f32 v59, v62, v63
v_mfma_f32_16x16x32_bf16 v[220:223], a[252:255], a[88:91], v[220:223]
s_waitcnt vmcnt(12) lgkmcnt(4)
v_mfma_f32_16x16x32_bf16 v[64:67], a[192:195], a[76:79], v[64:67]
ds_read_b64_tr_b16 a[208:209], v3 offset:49152
v_mfma_f32_16x16x32_bf16 v[64:67], a[196:199], a[116:119], v[64:67]
ds_read_b64_tr_b16 a[210:211], v3 offset:51200
v_mfma_f32_16x16x32_bf16 v[68:71], a[192:195], a[92:95], v[68:71]
global_load_dword v30, v[28:29], off
v_mfma_f32_16x16x32_bf16 v[68:71], a[196:199], a[104:107], v[68:71]
ds_read_b64_tr_b16 a[212:213], v3 offset:53248
s_mov_b32 s46, 1105920
v_mfma_f32_16x16x32_bf16 v[72:75], a[192:195], a[96:99], v[72:75]
v_mfma_f32_16x16x32_bf16 v[72:75], a[196:199], a[120:123], v[72:75]
ds_read_b64_tr_b16 a[214:215], v3 offset:55296
v_mfma_f32_16x16x32_bf16 v[76:79], a[192:195], a[112:115], v[76:79]
buffer_load_dwordx4 v[252:255], v18, s[8:11], s46 offen offset:0 sc1
v_mfma_f32_16x16x32_bf16 v[76:79], a[196:199], v[224:227], v[76:79]
ds_read_b64_tr_b16 a[216:217], v4 offset:49152
s_waitcnt lgkmcnt(5)
v_mfma_f32_16x16x32_bf16 v[80:83], a[192:195], a[100:103], v[80:83]
v_mfma_f32_16x16x32_bf16 v[80:83], a[196:199], v[228:231], v[80:83]
v_mfma_f32_16x16x32_bf16 v[84:87], a[200:203], a[76:79], v[84:87]
ds_read_b64_tr_b16 a[218:219], v4 offset:51200
v_mfma_f32_16x16x32_bf16 v[84:87], a[204:207], a[116:119], v[84:87]
buffer_load_dwordx4 a[0:3], v18, s[8:11], s46 offen offset:1024 sc1
v_mfma_f32_16x16x32_bf16 v[88:91], a[200:203], a[92:95], v[88:91]
ds_read_b64_tr_b16 a[220:221], v4 offset:53248
v_mfma_f32_16x16x32_bf16 v[88:91], a[204:207], a[104:107], v[88:91]
v_mfma_f32_16x16x32_bf16 v[92:95], a[200:203], a[96:99], v[92:95]
ds_read_b64_tr_b16 a[222:223], v4 offset:55296
v_mfma_f32_16x16x32_bf16 v[92:95], a[204:207], a[120:123], v[92:95]
buffer_load_dwordx4 a[16:19], v18, s[8:11], s46 offen offset:2048 sc1
v_mfma_f32_16x16x32_bf16 v[96:99], a[200:203], a[112:115], v[96:99]
ds_read_b64_tr_b16 a[224:225], v1 offset:57344
v_mfma_f32_16x16x32_bf16 v[96:99], a[204:207], v[224:227], v[96:99]
s_waitcnt lgkmcnt(5)
ds_read_b64_tr_b16 a[226:227], v1 offset:59392
v_mfma_f32_16x16x32_bf16 v[100:103], a[200:203], a[100:103], v[100:103]
v_mfma_f32_16x16x32_bf16 v[100:103], a[204:207], v[228:231], v[100:103]
v_mfma_f32_16x16x32_bf16 v[104:107], a[208:211], a[76:79], v[104:107]
buffer_load_dwordx4 a[108:111], v18, s[8:11], s46 offen offset:3072 sc1
v_mfma_f32_16x16x32_bf16 v[104:107], a[212:215], a[116:119], v[104:107]
ds_read_b64_tr_b16 a[228:229], v1 offset:61440
s_mov_b32 s46, 1110016
v_mfma_f32_16x16x32_bf16 v[108:111], a[208:211], a[92:95], v[108:111]
v_mfma_f32_16x16x32_bf16 v[108:111], a[212:215], a[104:107], v[108:111]
ds_read_b64_tr_b16 a[230:231], v1 offset:63488
v_mfma_f32_16x16x32_bf16 v[112:115], a[208:211], a[96:99], v[112:115]
buffer_load_dwordx4 a[124:127], v18, s[8:11], s46 offen offset:0 sc1
v_mfma_f32_16x16x32_bf16 v[112:115], a[212:215], a[120:123], v[112:115]
ds_read_b64_tr_b16 a[232:233], v2 offset:57344
v_mfma_f32_16x16x32_bf16 v[116:119], a[208:211], a[112:115], v[116:119]
v_mfma_f32_16x16x32_bf16 v[116:119], a[212:215], v[224:227], v[116:119]
s_waitcnt lgkmcnt(5)
ds_read_b64_tr_b16 a[234:235], v2 offset:59392
v_mfma_f32_16x16x32_bf16 v[120:123], a[208:211], a[100:103], v[120:123]
buffer_store_dwordx4 v[32:35], v22, s[16:19], s38 offen offset:1024 sc1
v_mfma_f32_16x16x32_bf16 v[120:123], a[212:215], v[228:231], v[120:123]
v_mfma_f32_16x16x32_bf16 v[124:127], a[216:219], a[76:79], v[124:127]
ds_read_b64_tr_b16 a[236:237], v2 offset:61440
v_mfma_f32_16x16x32_bf16 v[124:127], a[220:223], a[116:119], v[124:127]
v_mfma_f32_16x16x32_bf16 v[128:131], a[216:219], a[92:95], v[128:131]
ds_read_b64_tr_b16 a[238:239], v2 offset:63488
v_mfma_f32_16x16x32_bf16 v[128:131], a[220:223], a[104:107], v[128:131]
buffer_store_dwordx4 v[40:43], v22, s[16:19], s38 offen offset:2048 sc1
v_mfma_f32_16x16x32_bf16 v[132:135], a[216:219], a[96:99], v[132:135]
ds_read_b64_tr_b16 a[240:241], v3 offset:57344
v_mfma_f32_16x16x32_bf16 v[132:135], a[220:223], a[120:123], v[132:135]
v_mfma_f32_16x16x32_bf16 v[136:139], a[216:219], a[112:115], v[136:139]
v_mfma_f32_16x16x32_bf16 v[136:139], a[220:223], v[224:227], v[136:139]
buffer_store_dwordx4 v[56:59], v23, s[16:19], s38 offen offset:3072 sc1
v_mfma_f32_16x16x32_bf16 v[140:143], a[216:219], a[100:103], v[140:143]
ds_read_b64_tr_b16 a[242:243], v3 offset:59392
s_waitcnt lgkmcnt(6)
v_mfma_f32_16x16x32_bf16 v[140:143], a[220:223], v[228:231], v[140:143]
ds_read_b64_tr_b16 a[244:245], v3 offset:61440
s_add_u32 m0, s41, 4096
v_mfma_f32_16x16x32_bf16 v[144:147], a[224:227], a[76:79], v[144:147]
s_mov_b32 s46, 532480
ds_read_b64_tr_b16 a[246:247], v3 offset:63488
v_mfma_f32_16x16x32_bf16 v[144:147], a[228:231], a[116:119], v[144:147]
v_mfma_f32_16x16x32_bf16 v[148:151], a[224:227], a[92:95], v[148:151]
buffer_load_dwordx4 v21, s[4:7], s46 offen offset:0 lds
v_mfma_f32_16x16x32_bf16 v[148:151], a[228:231], a[104:107], v[148:151]
ds_read_b64_tr_b16 a[248:249], v4 offset:57344
s_mov_b32 s46, 541696
v_mfma_f32_16x16x32_bf16 v[152:155], a[224:227], a[96:99], v[152:155]
v_mfma_f32_16x16x32_bf16 v[152:155], a[228:231], a[120:123], v[152:155]
v_mfma_f32_16x16x32_bf16 v[156:159], a[224:227], a[112:115], v[156:159]
buffer_load_dwordx4 v21, s[4:7], s46 offen offset:1024 lds
v_mfma_f32_16x16x32_bf16 v[156:159], a[228:231], v[224:227], v[156:159]
ds_read_b64_tr_b16 a[250:251], v4 offset:59392
s_waitcnt lgkmcnt(6)
v_mfma_f32_16x16x32_bf16 v[160:163], a[224:227], a[100:103], v[160:163]
ds_read_b64_tr_b16 a[252:253], v4 offset:61440
s_mov_b32 s46, 550912
v_mfma_f32_16x16x32_bf16 v[160:163], a[228:231], v[228:231], v[160:163]
v_mfma_f32_16x16x32_bf16 v[164:167], a[232:235], a[76:79], v[164:167]
ds_read_b64_tr_b16 a[254:255], v4 offset:63488
v_mfma_f32_16x16x32_bf16 v[164:167], a[236:239], a[116:119], v[164:167]
buffer_load_dwordx4 v21, s[4:7], s46 offen offset:2048 lds
v_mfma_f32_16x16x32_bf16 v[168:171], a[232:235], a[92:95], v[168:171]
s_mov_b32 s46, 560128
v_mfma_f32_16x16x32_bf16 v[168:171], a[236:239], a[104:107], v[168:171]
v_mfma_f32_16x16x32_bf16 v[172:175], a[232:235], a[96:99], v[172:175]
v_mfma_f32_16x16x32_bf16 v[172:175], a[236:239], a[120:123], v[172:175]
buffer_load_dwordx4 v21, s[4:7], s46 offen offset:3072 lds
v_mfma_f32_16x16x32_bf16 v[176:179], a[232:235], a[112:115], v[176:179]
v_mfma_f32_16x16x32_bf16 v[176:179], a[236:239], v[224:227], v[176:179]
s_waitcnt lgkmcnt(4)
s_mov_b32 s46, 1228800
v_mfma_f32_16x16x32_bf16 v[180:183], a[232:235], a[100:103], v[180:183]
v_mfma_f32_16x16x32_bf16 v[180:183], a[236:239], v[228:231], v[180:183]
v_mfma_f32_16x16x32_bf16 v[184:187], a[240:243], a[76:79], v[184:187]
s_waitcnt vmcnt(63) lgkmcnt(0)
s_barrier
v_mfma_f32_16x16x32_bf16 v[184:187], a[244:247], a[116:119], v[184:187]
buffer_load_dwordx4 a[128:131], v18, s[8:11], s46 offen offset:0 sc1
v_mfma_f32_16x16x32_bf16 v[188:191], a[240:243], a[92:95], v[188:191]
ds_read_b64_tr_b16 a[192:193], v13 offset:0
v_mfma_f32_16x16x32_bf16 v[188:191], a[244:247], a[104:107], v[188:191]
ds_read_b64_tr_b16 a[194:195], v13 offset:2048
v_mfma_f32_16x16x32_bf16 v[192:195], a[240:243], a[96:99], v[192:195]
buffer_load_dwordx4 a[144:147], v18, s[8:11], s46 offen offset:1024 sc1
v_mfma_f32_16x16x32_bf16 v[192:195], a[244:247], a[120:123], v[192:195]
ds_read_b64_tr_b16 a[196:197], v13 offset:4096
v_mfma_f32_16x16x32_bf16 v[196:199], a[240:243], a[112:115], v[196:199]
ds_read_b64_tr_b16 a[198:199], v13 offset:6144
v_mfma_f32_16x16x32_bf16 v[196:199], a[244:247], v[224:227], v[196:199]
ds_read_b64_tr_b16 a[200:201], v14 offset:0
v_mfma_f32_16x16x32_bf16 v[200:203], a[240:243], a[100:103], v[200:203]
buffer_load_dwordx4 a[132:135], v18, s[8:11], s46 offen offset:2048 sc1
v_mfma_f32_16x16x32_bf16 v[200:203], a[244:247], v[228:231], v[200:203]
ds_read_b64_tr_b16 a[202:203], v14 offset:2048
v_mfma_f32_16x16x32_bf16 v[204:207], a[248:251], a[76:79], v[204:207]
v_mfma_f32_16x16x32_bf16 v[204:207], a[252:255], a[116:119], v[204:207]
ds_read_b64_tr_b16 a[204:205], v14 offset:4096
v_mfma_f32_16x16x32_bf16 v[208:211], a[248:251], a[92:95], v[208:211]
v_mfma_f32_16x16x32_bf16 v[208:211], a[252:255], a[104:107], v[208:211]
buffer_load_dwordx4 a[148:151], v18, s[8:11], s46 offen offset:3072 sc1
v_mfma_f32_16x16x32_bf16 v[212:215], a[248:251], a[96:99], v[212:215]
ds_read_b64_tr_b16 a[206:207], v14 offset:6144
s_mov_b32 s46, 1232896
v_mfma_f32_16x16x32_bf16 v[212:215], a[252:255], a[120:123], v[212:215]
v_mfma_f32_16x16x32_bf16 v[216:219], a[248:251], a[112:115], v[216:219]
v_mfma_f32_16x16x32_bf16 v[216:219], a[252:255], v[224:227], v[216:219]
buffer_load_dwordx4 a[4:7], v18, s[8:11], s46 offen offset:0 sc1
v_mfma_f32_16x16x32_bf16 v[220:223], a[248:251], a[100:103], v[220:223]
s_waitcnt vmcnt(12) lgkmcnt(4)
v_mfma_f32_16x16x32_bf16 v[220:223], a[252:255], v[228:231], v[220:223]
v_mfma_f32_16x16x32_bf16 v[64:67], a[192:195], v[232:235], v[64:67]
ds_read_b64_tr_b16 a[208:209], v15 offset:0
s_mov_b32 s46, 1351680
v_mfma_f32_16x16x32_bf16 v[64:67], a[196:199], v[252:255], v[64:67]
ds_read_b64_tr_b16 a[210:211], v15 offset:2048
v_mfma_f32_16x16x32_bf16 v[68:71], a[192:195], v[236:239], v[68:71]
buffer_load_dwordx4 a[20:23], v18, s[8:11], s46 offen offset:0 sc1
v_mfma_f32_16x16x32_bf16 v[68:71], a[196:199], a[0:3], v[68:71]
ds_read_b64_tr_b16 a[212:213], v15 offset:4096
v_mfma_f32_16x16x32_bf16 v[72:75], a[192:195], v[240:243], v[72:75]
v_mfma_f32_16x16x32_bf16 v[72:75], a[196:199], a[16:19], v[72:75]
ds_read_b64_tr_b16 a[214:215], v15 offset:6144
v_mfma_f32_16x16x32_bf16 v[76:79], a[192:195], v[244:247], v[76:79]
v_mfma_f32_16x16x32_bf16 v[76:79], a[196:199], a[108:111], v[76:79]
ds_read_b64_tr_b16 a[216:217], v16 offset:0
s_waitcnt lgkmcnt(5)
v_mfma_f32_16x16x32_bf16 v[80:83], a[192:195], v[248:251], v[80:83]
buffer_load_dwordx4 a[8:11], v18, s[8:11], s46 offen offset:1024 sc1
v_mfma_f32_16x16x32_bf16 v[80:83], a[196:199], a[124:127], v[80:83]
v_mfma_f32_16x16x32_bf16 v[84:87], a[200:203], v[232:235], v[84:87]
ds_read_b64_tr_b16 a[218:219], v16 offset:2048
v_mfma_f32_16x16x32_bf16 v[84:87], a[204:207], v[252:255], v[84:87]
v_mfma_f32_16x16x32_bf16 v[88:91], a[200:203], v[236:239], v[88:91]
ds_read_b64_tr_b16 a[220:221], v16 offset:4096
v_mfma_f32_16x16x32_bf16 v[88:91], a[204:207], a[0:3], v[88:91]
buffer_load_dwordx4 a[24:27], v18, s[8:11], s46 offen offset:2048 sc1
v_mfma_f32_16x16x32_bf16 v[92:95], a[200:203], v[240:243], v[92:95]
ds_read_b64_tr_b16 a[222:223], v16 offset:6144
v_mfma_f32_16x16x32_bf16 v[92:95], a[204:207], a[16:19], v[92:95]
v_mfma_f32_16x16x32_bf16 v[96:99], a[200:203], v[244:247], v[96:99]
ds_read_b64_tr_b16 a[224:225], v13 offset:8192
v_mfma_f32_16x16x32_bf16 v[96:99], a[204:207], a[108:111], v[96:99]
s_waitcnt lgkmcnt(5)
ds_read_b64_tr_b16 a[226:227], v13 offset:10240
v_mfma_f32_16x16x32_bf16 v[100:103], a[200:203], v[248:251], v[100:103]
buffer_load_dwordx4 a[12:15], v18, s[8:11], s46 offen offset:3072 sc1
v_mfma_f32_16x16x32_bf16 v[100:103], a[204:207], a[124:127], v[100:103]
v_mfma_f32_16x16x32_bf16 v[104:107], a[208:211], v[232:235], v[104:107]
v_mfma_f32_16x16x32_bf16 v[104:107], a[212:215], v[252:255], v[104:107]
ds_read_b64_tr_b16 a[228:229], v13 offset:12288
s_mov_b32 s46, 1355776
v_mfma_f32_16x16x32_bf16 v[108:111], a[208:211], v[236:239], v[108:111]
v_mfma_f32_16x16x32_bf16 v[108:111], a[212:215], a[0:3], v[108:111]
ds_read_b64_tr_b16 a[230:231], v13 offset:14336
v_mfma_f32_16x16x32_bf16 v[112:115], a[208:211], v[240:243], v[112:115]
buffer_load_dwordx4 a[28:31], v18, s[8:11], s46 offen offset:0 sc1
v_mfma_f32_16x16x32_bf16 v[112:115], a[212:215], a[16:19], v[112:115]
ds_read_b64_tr_b16 a[232:233], v14 offset:8192
s_add_u32 m0, s41, 32768
v_mfma_f32_16x16x32_bf16 v[116:119], a[208:211], v[244:247], v[116:119]
s_mov_b32 s46, 655360
ds_read_b64_tr_b16 a[234:235], v14 offset:10240
v_mfma_f32_16x16x32_bf16 v[116:119], a[212:215], a[108:111], v[116:119]
s_waitcnt lgkmcnt(6)
ds_read_b64_tr_b16 a[236:237], v14 offset:12288
v_mfma_f32_16x16x32_bf16 v[120:123], a[208:211], v[248:251], v[120:123]
v_mfma_f32_16x16x32_bf16 v[120:123], a[212:215], a[124:127], v[120:123]
buffer_load_dwordx4 v21, s[4:7], s46 offen offset:0 lds
v_mfma_f32_16x16x32_bf16 v[124:127], a[216:219], v[232:235], v[124:127]
v_mfma_f32_16x16x32_bf16 v[124:127], a[220:223], v[252:255], v[124:127]
s_mov_b32 s46, 664576
ds_read_b64_tr_b16 a[238:239], v14 offset:14336
v_mfma_f32_16x16x32_bf16 v[128:131], a[216:219], v[236:239], v[128:131]
v_mfma_f32_16x16x32_bf16 v[128:131], a[220:223], a[0:3], v[128:131]
v_mfma_f32_16x16x32_bf16 v[132:135], a[216:219], v[240:243], v[132:135]
buffer_load_dwordx4 v21, s[4:7], s46 offen offset:1024 lds
v_mfma_f32_16x16x32_bf16 v[132:135], a[220:223], a[16:19], v[132:135]
ds_read_b64_tr_b16 a[240:241], v15 offset:8192
s_mov_b32 s46, 673792
v_mfma_f32_16x16x32_bf16 v[136:139], a[216:219], v[244:247], v[136:139]
v_mfma_f32_16x16x32_bf16 v[136:139], a[220:223], a[108:111], v[136:139]
ds_read_b64_tr_b16 a[242:243], v15 offset:10240
s_waitcnt lgkmcnt(6)
v_mfma_f32_16x16x32_bf16 v[140:143], a[216:219], v[248:251], v[140:143]
v_mfma_f32_16x16x32_bf16 v[140:143], a[220:223], a[124:127], v[140:143]
ds_read_b64_tr_b16 a[244:245], v15 offset:12288
v_mfma_f32_16x16x32_bf16 v[144:147], a[224:227], v[232:235], v[144:147]
buffer_load_dwordx4 v21, s[4:7], s46 offen offset:2048 lds
v_mfma_f32_16x16x32_bf16 v[144:147], a[228:231], v[252:255], v[144:147]
ds_read_b64_tr_b16 a[246:247], v15 offset:14336
s_mov_b32 s46, 683008
v_mfma_f32_16x16x32_bf16 v[148:151], a[224:227], v[236:239], v[148:151]
v_mfma_f32_16x16x32_bf16 v[148:151], a[228:231], a[0:3], v[148:151]
ds_read_b64_tr_b16 a[248:249], v16 offset:8192
v_mfma_f32_16x16x32_bf16 v[152:155], a[224:227], v[240:243], v[152:155]
v_mfma_f32_16x16x32_bf16 v[152:155], a[228:231], a[16:19], v[152:155]
buffer_load_dwordx4 v21, s[4:7], s46 offen offset:3072 lds
v_mfma_f32_16x16x32_bf16 v[156:159], a[224:227], v[244:247], v[156:159]
ds_read_b64_tr_b16 a[250:251], v16 offset:10240
s_mov_b32 s46, 1474560
v_mfma_f32_16x16x32_bf16 v[156:159], a[228:231], a[108:111], v[156:159]
s_waitcnt lgkmcnt(6)
ds_read_b64_tr_b16 a[252:253], v16 offset:12288
v_mfma_f32_16x16x32_bf16 v[160:163], a[224:227], v[248:251], v[160:163]
v_mfma_f32_16x16x32_bf16 v[160:163], a[228:231], a[124:127], v[160:163]
v_mfma_f32_16x16x32_bf16 v[164:167], a[232:235], v[232:235], v[164:167]
buffer_load_dwordx4 a[32:35], v18, s[8:11], s46 offen offset:0 sc1
v_mfma_f32_16x16x32_bf16 v[164:167], a[236:239], v[252:255], v[164:167]
ds_read_b64_tr_b16 a[254:255], v16 offset:14336
v_mfma_f32_16x16x32_bf16 v[168:171], a[232:235], v[236:239], v[168:171]
v_mfma_f32_16x16x32_bf16 v[168:171], a[236:239], a[0:3], v[168:171]
v_mfma_f32_16x16x32_bf16 v[172:175], a[232:235], v[240:243], v[172:175]
v_mfma_f32_16x16x32_bf16 v[172:175], a[236:239], a[16:19], v[172:175]
v_mfma_f32_16x16x32_bf16 v[176:179], a[232:235], v[244:247], v[176:179]
buffer_load_dwordx4 a[48:51], v18, s[8:11], s46 offen offset:1024 sc1
v_mfma_f32_16x16x32_bf16 v[176:179], a[236:239], a[108:111], v[176:179]
s_waitcnt lgkmcnt(4)
v_mfma_f32_16x16x32_bf16 v[180:183], a[232:235], v[248:251], v[180:183]
v_mfma_f32_16x16x32_bf16 v[180:183], a[236:239], a[124:127], v[180:183]
v_mfma_f32_16x16x32_bf16 v[184:187], a[240:243], v[232:235], v[184:187]
s_waitcnt vmcnt(20) lgkmcnt(0)
s_barrier
v_mfma_f32_16x16x32_bf16 v[184:187], a[244:247], v[252:255], v[184:187]
buffer_load_dwordx4 a[36:39], v18, s[8:11], s46 offen offset:2048 sc1
v_mfma_f32_16x16x32_bf16 v[188:191], a[240:243], v[236:239], v[188:191]
ds_read_b64_tr_b16 a[192:193], v13 offset:16384
v_mfma_f32_16x16x32_bf16 v[188:191], a[244:247], a[0:3], v[188:191]
ds_read_b64_tr_b16 a[194:195], v13 offset:18432
v_mfma_f32_16x16x32_bf16 v[192:195], a[240:243], v[240:243], v[192:195]
ds_read_b64_tr_b16 a[196:197], v13 offset:20480
v_mfma_f32_16x16x32_bf16 v[192:195], a[244:247], a[16:19], v[192:195]
ds_read_b64_tr_b16 a[198:199], v13 offset:22528
v_mfma_f32_16x16x32_bf16 v[196:199], a[240:243], v[244:247], v[196:199]
buffer_load_dwordx4 a[52:55], v18, s[8:11], s46 offen offset:3072 sc1
v_mfma_f32_16x16x32_bf16 v[196:199], a[244:247], a[108:111], v[196:199]
ds_read_b64_tr_b16 a[200:201], v14 offset:16384
s_mov_b32 s46, 1478656
v_mfma_f32_16x16x32_bf16 v[200:203], a[240:243], v[248:251], v[200:203]
v_mfma_f32_16x16x32_bf16 v[200:203], a[244:247], a[124:127], v[200:203]
ds_read_b64_tr_b16 a[202:203], v14 offset:18432
v_mfma_f32_16x16x32_bf16 v[204:207], a[248:251], v[232:235], v[204:207]
v_mfma_f32_16x16x32_bf16 v[204:207], a[252:255], v[252:255], v[204:207]
ds_read_b64_tr_b16 a[204:205], v14 offset:20480
v_mfma_f32_16x16x32_bf16 v[208:211], a[248:251], v[236:239], v[208:211]
buffer_load_dwordx4 a[136:139], v18, s[8:11], s46 offen offset:0 sc1
v_mfma_f32_16x16x32_bf16 v[208:211], a[252:255], a[0:3], v[208:211]
ds_read_b64_tr_b16 a[206:207], v14 offset:22528
v_mfma_f32_16x16x32_bf16 v[212:215], a[248:251], v[240:243], v[212:215]
v_mfma_f32_16x16x32_bf16 v[212:215], a[252:255], a[16:19], v[212:215]
v_mfma_f32_16x16x32_bf16 v[216:219], a[248:251], v[244:247], v[216:219]
v_mfma_f32_16x16x32_bf16 v[216:219], a[252:255], a[108:111], v[216:219]
s_mov_b64 exec, 1
buffer_atomic_add v20, off, s[28:31], s50
s_mov_b64 exec, -1
v_mfma_f32_16x16x32_bf16 v[220:223], a[248:251], v[248:251], v[220:223]
s_waitcnt vmcnt(10) lgkmcnt(4)
v_mfma_f32_16x16x32_bf16 v[220:223], a[252:255], a[124:127], v[220:223]
v_mfma_f32_16x16x32_bf16 v[64:67], a[192:195], a[128:131], v[64:67]
ds_read_b64_tr_b16 a[208:209], v15 offset:16384
s_mov_b32 s46, 1597440
v_mfma_f32_16x16x32_bf16 v[64:67], a[196:199], a[20:23], v[64:67]
ds_read_b64_tr_b16 a[210:211], v15 offset:18432
v_mfma_f32_16x16x32_bf16 v[68:71], a[192:195], a[144:147], v[68:71]
buffer_load_dwordx4 a[152:155], v18, s[8:11], s46 offen offset:0 sc1
v_mfma_f32_16x16x32_bf16 v[68:71], a[196:199], a[8:11], v[68:71]
ds_read_b64_tr_b16 a[212:213], v15 offset:20480
v_mfma_f32_16x16x32_bf16 v[72:75], a[192:195], a[132:135], v[72:75]
v_mfma_f32_16x16x32_bf16 v[72:75], a[196:199], a[24:27], v[72:75]
ds_read_b64_tr_b16 a[214:215], v15 offset:22528
v_mfma_f32_16x16x32_bf16 v[76:79], a[192:195], a[148:151], v[76:79]
v_mfma_f32_16x16x32_bf16 v[76:79], a[196:199], a[12:15], v[76:79]
ds_read_b64_tr_b16 a[216:217], v16 offset:16384
s_waitcnt lgkmcnt(5)
v_mfma_f32_16x16x32_bf16 v[80:83], a[192:195], a[4:7], v[80:83]
buffer_load_dwordx4 a[140:143], v18, s[8:11], s46 offen offset:1024 sc1
v_mfma_f32_16x16x32_bf16 v[80:83], a[196:199], a[28:31], v[80:83]
v_mfma_f32_16x16x32_bf16 v[84:87], a[200:203], a[128:131], v[84:87]
ds_read_b64_tr_b16 a[218:219], v16 offset:18432
v_mfma_f32_16x16x32_bf16 v[84:87], a[204:207], a[20:23], v[84:87]
v_mfma_f32_16x16x32_bf16 v[88:91], a[200:203], a[144:147], v[88:91]
ds_read_b64_tr_b16 a[220:221], v16 offset:20480
v_mfma_f32_16x16x32_bf16 v[88:91], a[204:207], a[8:11], v[88:91]
v_mfma_f32_16x16x32_bf16 v[92:95], a[200:203], a[132:135], v[92:95]
buffer_load_dwordx4 a[156:159], v18, s[8:11], s46 offen offset:2048 sc1
v_mfma_f32_16x16x32_bf16 v[92:95], a[204:207], a[24:27], v[92:95]
ds_read_b64_tr_b16 a[222:223], v16 offset:22528
v_mfma_f32_16x16x32_bf16 v[96:99], a[200:203], a[148:151], v[96:99]
ds_read_b64_tr_b16 a[224:225], v13 offset:24576
v_mfma_f32_16x16x32_bf16 v[96:99], a[204:207], a[12:15], v[96:99]
s_waitcnt lgkmcnt(5)
ds_read_b64_tr_b16 a[226:227], v13 offset:26624
v_mfma_f32_16x16x32_bf16 v[100:103], a[200:203], a[4:7], v[100:103]
v_mfma_f32_16x16x32_bf16 v[100:103], a[204:207], a[28:31], v[100:103]
v_mfma_f32_16x16x32_bf16 v[104:107], a[208:211], a[128:131], v[104:107]
buffer_load_dwordx4 a[160:163], v18, s[8:11], s46 offen offset:3072 sc1
v_mfma_f32_16x16x32_bf16 v[104:107], a[212:215], a[20:23], v[104:107]
ds_read_b64_tr_b16 a[228:229], v13 offset:28672
s_mov_b32 s46, 1601536
v_mfma_f32_16x16x32_bf16 v[108:111], a[208:211], a[144:147], v[108:111]
v_mfma_f32_16x16x32_bf16 v[108:111], a[212:215], a[8:11], v[108:111]
ds_read_b64_tr_b16 a[230:231], v13 offset:30720
v_mfma_f32_16x16x32_bf16 v[112:115], a[208:211], a[132:135], v[112:115]
v_mfma_f32_16x16x32_bf16 v[112:115], a[212:215], a[24:27], v[112:115]
buffer_load_dwordx4 a[176:179], v18, s[8:11], s46 offen offset:0 sc1
v_mfma_f32_16x16x32_bf16 v[116:119], a[208:211], a[148:151], v[116:119]
ds_read_b64_tr_b16 a[232:233], v14 offset:24576
s_add_u32 m0, s41, 36864
v_mfma_f32_16x16x32_bf16 v[116:119], a[212:215], a[12:15], v[116:119]
s_waitcnt lgkmcnt(5)
ds_read_b64_tr_b16 a[234:235], v14 offset:26624
v_mfma_f32_16x16x32_bf16 v[120:123], a[208:211], a[4:7], v[120:123]
s_mov_b32 s46, 696320
ds_read_b64_tr_b16 a[236:237], v14 offset:28672
v_mfma_f32_16x16x32_bf16 v[120:123], a[212:215], a[28:31], v[120:123]
v_mfma_f32_16x16x32_bf16 v[124:127], a[216:219], a[128:131], v[124:127]
v_mfma_f32_16x16x32_bf16 v[124:127], a[220:223], a[20:23], v[124:127]
buffer_load_dwordx4 v21, s[4:7], s46 offen offset:0 lds
v_mfma_f32_16x16x32_bf16 v[128:131], a[216:219], a[144:147], v[128:131]
ds_read_b64_tr_b16 a[238:239], v14 offset:30720
s_mov_b32 s46, 705536
v_mfma_f32_16x16x32_bf16 v[128:131], a[220:223], a[8:11], v[128:131]
v_mfma_f32_16x16x32_bf16 v[132:135], a[216:219], a[132:135], v[132:135]
ds_read_b64_tr_b16 a[240:241], v15 offset:24576
v_mfma_f32_16x16x32_bf16 v[132:135], a[220:223], a[24:27], v[132:135]
v_mfma_f32_16x16x32_bf16 v[136:139], a[216:219], a[148:151], v[136:139]
v_mfma_f32_16x16x32_bf16 v[136:139], a[220:223], a[12:15], v[136:139]
buffer_load_dwordx4 v21, s[4:7], s46 offen offset:1024 lds
v_mfma_f32_16x16x32_bf16 v[140:143], a[216:219], a[4:7], v[140:143]
ds_read_b64_tr_b16 a[242:243], v15 offset:26624
s_waitcnt lgkmcnt(6)
v_mfma_f32_16x16x32_bf16 v[140:143], a[220:223], a[28:31], v[140:143]
ds_read_b64_tr_b16 a[244:245], v15 offset:28672
s_mov_b32 s46, 714752
v_mfma_f32_16x16x32_bf16 v[144:147], a[224:227], a[128:131], v[144:147]
v_mfma_f32_16x16x32_bf16 v[144:147], a[228:231], a[20:23], v[144:147]
ds_read_b64_tr_b16 a[246:247], v15 offset:30720
v_mfma_f32_16x16x32_bf16 v[148:151], a[224:227], a[144:147], v[148:151]
buffer_load_dwordx4 v21, s[4:7], s46 offen offset:2048 lds
v_mfma_f32_16x16x32_bf16 v[148:151], a[228:231], a[8:11], v[148:151]
ds_read_b64_tr_b16 a[248:249], v16 offset:24576
s_mov_b32 s46, 723968
v_mfma_f32_16x16x32_bf16 v[152:155], a[224:227], a[132:135], v[152:155]
v_mfma_f32_16x16x32_bf16 v[152:155], a[228:231], a[24:27], v[152:155]
v_mfma_f32_16x16x32_bf16 v[156:159], a[224:227], a[148:151], v[156:159]
ds_read_b64_tr_b16 a[250:251], v16 offset:26624
v_mfma_f32_16x16x32_bf16 v[156:159], a[228:231], a[12:15], v[156:159]
s_waitcnt lgkmcnt(6)
ds_read_b64_tr_b16 a[252:253], v16 offset:28672
v_mfma_f32_16x16x32_bf16 v[160:163], a[224:227], a[4:7], v[160:163]
buffer_load_dwordx4 v21, s[4:7], s46 offen offset:3072 lds
v_mfma_f32_16x16x32_bf16 v[160:163], a[228:231], a[28:31], v[160:163]
v_mfma_f32_16x16x32_bf16 v[164:167], a[232:235], a[128:131], v[164:167]
ds_read_b64_tr_b16 a[254:255], v16 offset:30720
s_mov_b32 s46, 1720320
v_mfma_f32_16x16x32_bf16 v[164:167], a[236:239], a[20:23], v[164:167]
v_mfma_f32_16x16x32_bf16 v[168:171], a[232:235], a[144:147], v[168:171]
v_mfma_f32_16x16x32_bf16 v[168:171], a[236:239], a[8:11], v[168:171]
v_mfma_f32_16x16x32_bf16 v[172:175], a[232:235], a[132:135], v[172:175]
buffer_load_dwordx4 a[40:43], v18, s[8:11], s46 offen offset:0 sc1
v_mfma_f32_16x16x32_bf16 v[172:175], a[236:239], a[24:27], v[172:175]
v_mfma_f32_16x16x32_bf16 v[176:179], a[232:235], a[148:151], v[176:179]
v_mfma_f32_16x16x32_bf16 v[176:179], a[236:239], a[12:15], v[176:179]
s_waitcnt lgkmcnt(4)
v_mfma_f32_16x16x32_bf16 v[180:183], a[232:235], a[4:7], v[180:183]
v_mfma_f32_16x16x32_bf16 v[180:183], a[236:239], a[28:31], v[180:183]
v_mfma_f32_16x16x32_bf16 v[184:187], a[240:243], a[128:131], v[184:187]
s_waitcnt vmcnt(30) lgkmcnt(0)
s_barrier
v_mfma_f32_16x16x32_bf16 v[184:187], a[244:247], a[20:23], v[184:187]
buffer_load_dwordx4 a[56:59], v18, s[8:11], s46 offen offset:1024 sc1
v_mfma_f32_16x16x32_bf16 v[188:191], a[240:243], a[144:147], v[188:191]
ds_read_b64_tr_b16 a[192:193], v1 offset:0
v_mfma_f32_16x16x32_bf16 v[188:191], a[244:247], a[8:11], v[188:191]
ds_read_b64_tr_b16 a[194:195], v1 offset:2048
v_mfma_f32_16x16x32_bf16 v[192:195], a[240:243], a[132:135], v[192:195]
ds_read_b64_tr_b16 a[196:197], v1 offset:4096
v_mfma_f32_16x16x32_bf16 v[192:195], a[244:247], a[24:27], v[192:195]
buffer_load_dwordx4 a[44:47], v18, s[8:11], s46 offen offset:2048 sc1
v_mfma_f32_16x16x32_bf16 v[196:199], a[240:243], a[148:151], v[196:199]
ds_read_b64_tr_b16 a[198:199], v1 offset:6144
v_mfma_f32_16x16x32_bf16 v[196:199], a[244:247], a[12:15], v[196:199]
ds_read_b64_tr_b16 a[200:201], v2 offset:0
v_mfma_f32_16x16x32_bf16 v[200:203], a[240:243], a[4:7], v[200:203]
v_mfma_f32_16x16x32_bf16 v[200:203], a[244:247], a[28:31], v[200:203]
ds_read_b64_tr_b16 a[202:203], v2 offset:2048
v_mfma_f32_16x16x32_bf16 v[204:207], a[248:251], a[128:131], v[204:207]
v_mfma_f32_16x16x32_bf16 v[204:207], a[252:255], a[20:23], v[204:207]
buffer_load_dwordx4 a[60:63], v18, s[8:11], s46 offen offset:3072 sc1
v_mfma_f32_16x16x32_bf16 v[208:211], a[248:251], a[144:147], v[208:211]
ds_read_b64_tr_b16 a[204:205], v2 offset:4096
s_mov_b32 s46, 1724416
v_mfma_f32_16x16x32_bf16 v[208:211], a[252:255], a[8:11], v[208:211]
ds_read_b64_tr_b16 a[206:207], v2 offset:6144
v_mfma_f32_16x16x32_bf16 v[212:215], a[248:251], a[132:135], v[212:215]
v_mfma_f32_16x16x32_bf16 v[212:215], a[252:255], a[24:27], v[212:215]
v_mfma_f32_16x16x32_bf16 v[216:219], a[248:251], a[148:151], v[216:219]
v_mfma_f32_16x16x32_bf16 v[216:219], a[252:255], a[12:15], v[216:219]
buffer_load_dwordx4 a[64:67], v18, s[8:11], s46 offen offset:0 sc1
v_mfma_f32_16x16x32_bf16 v[220:223], a[248:251], a[4:7], v[220:223]
s_waitcnt vmcnt(9) lgkmcnt(4)
v_mfma_f32_16x16x32_bf16 v[220:223], a[252:255], a[28:31], v[220:223]
v_mfma_f32_16x16x32_bf16 v[64:67], a[192:195], a[32:35], v[64:67]
ds_read_b64_tr_b16 a[208:209], v3 offset:0
s_mov_b32 s46, 1843200
v_mfma_f32_16x16x32_bf16 v[64:67], a[196:199], a[152:155], v[64:67]
ds_read_b64_tr_b16 a[210:211], v3 offset:2048
v_mfma_f32_16x16x32_bf16 v[68:71], a[192:195], a[48:51], v[68:71]
buffer_load_dwordx4 a[80:83], v18, s[8:11], s46 offen offset:0 sc1
v_mfma_f32_16x16x32_bf16 v[68:71], a[196:199], a[140:143], v[68:71]
ds_read_b64_tr_b16 a[212:213], v3 offset:4096
v_mfma_f32_16x16x32_bf16 v[72:75], a[192:195], a[36:39], v[72:75]
v_mfma_f32_16x16x32_bf16 v[72:75], a[196:199], a[156:159], v[72:75]
ds_read_b64_tr_b16 a[214:215], v3 offset:6144
v_mfma_f32_16x16x32_bf16 v[76:79], a[192:195], a[52:55], v[76:79]
v_mfma_f32_16x16x32_bf16 v[76:79], a[196:199], a[160:163], v[76:79]
ds_read_b64_tr_b16 a[216:217], v4 offset:0
s_waitcnt lgkmcnt(5)
v_mfma_f32_16x16x32_bf16 v[80:83], a[192:195], a[136:139], v[80:83]
buffer_load_dwordx4 a[68:71], v18, s[8:11], s46 offen offset:1024 sc1
v_mfma_f32_16x16x32_bf16 v[80:83], a[196:199], a[176:179], v[80:83]
v_mfma_f32_16x16x32_bf16 v[84:87], a[200:203], a[32:35], v[84:87]
ds_read_b64_tr_b16 a[218:219], v4 offset:2048
v_mfma_f32_16x16x32_bf16 v[84:87], a[204:207], a[152:155], v[84:87]
v_mfma_f32_16x16x32_bf16 v[88:91], a[200:203], a[48:51], v[88:91]
ds_read_b64_tr_b16 a[220:221], v4 offset:4096
v_mfma_f32_16x16x32_bf16 v[88:91], a[204:207], a[140:143], v[88:91]
v_mfma_f32_16x16x32_bf16 v[92:95], a[200:203], a[36:39], v[92:95]
buffer_load_dwordx4 a[84:87], v18, s[8:11], s46 offen offset:2048 sc1
v_mfma_f32_16x16x32_bf16 v[92:95], a[204:207], a[156:159], v[92:95]
ds_read_b64_tr_b16 a[222:223], v4 offset:6144
v_mfma_f32_16x16x32_bf16 v[96:99], a[200:203], a[52:55], v[96:99]
ds_read_b64_tr_b16 a[224:225], v1 offset:8192
v_mfma_f32_16x16x32_bf16 v[96:99], a[204:207], a[160:163], v[96:99]
s_waitcnt lgkmcnt(5)
ds_read_b64_tr_b16 a[226:227], v1 offset:10240
v_mfma_f32_16x16x32_bf16 v[100:103], a[200:203], a[136:139], v[100:103]
v_mfma_f32_16x16x32_bf16 v[100:103], a[204:207], a[176:179], v[100:103]
v_mfma_f32_16x16x32_bf16 v[104:107], a[208:211], a[32:35], v[104:107]
buffer_load_dwordx4 a[72:75], v18, s[8:11], s46 offen offset:3072 sc1
v_mfma_f32_16x16x32_bf16 v[104:107], a[212:215], a[152:155], v[104:107]
ds_read_b64_tr_b16 a[228:229], v1 offset:12288
s_mov_b32 s46, 1847296
v_mfma_f32_16x16x32_bf16 v[108:111], a[208:211], a[48:51], v[108:111]
v_mfma_f32_16x16x32_bf16 v[108:111], a[212:215], a[140:143], v[108:111]
ds_read_b64_tr_b16 a[230:231], v1 offset:14336
v_mfma_f32_16x16x32_bf16 v[112:115], a[208:211], a[36:39], v[112:115]
v_mfma_f32_16x16x32_bf16 v[112:115], a[212:215], a[156:159], v[112:115]
buffer_load_dwordx4 a[88:91], v18, s[8:11], s46 offen offset:0 sc1
v_mfma_f32_16x16x32_bf16 v[116:119], a[208:211], a[52:55], v[116:119]
ds_read_b64_tr_b16 a[232:233], v2 offset:8192
s_add_u32 m0, s41, 65536
v_mfma_f32_16x16x32_bf16 v[116:119], a[212:215], a[160:163], v[116:119]
s_waitcnt lgkmcnt(5)
ds_read_b64_tr_b16 a[234:235], v2 offset:10240
v_mfma_f32_16x16x32_bf16 v[120:123], a[208:211], a[136:139], v[120:123]
s_mov_b32 s46, 819200
ds_read_b64_tr_b16 a[236:237], v2 offset:12288
v_mfma_f32_16x16x32_bf16 v[120:123], a[212:215], a[176:179], v[120:123]
v_mfma_f32_16x16x32_bf16 v[124:127], a[216:219], a[32:35], v[124:127]
v_mfma_f32_16x16x32_bf16 v[124:127], a[220:223], a[152:155], v[124:127]
buffer_load_dwordx4 v21, s[4:7], s46 offen offset:0 lds
v_mfma_f32_16x16x32_bf16 v[128:131], a[216:219], a[48:51], v[128:131]
ds_read_b64_tr_b16 a[238:239], v2 offset:14336
s_mov_b32 s46, 828416
v_mfma_f32_16x16x32_bf16 v[128:131], a[220:223], a[140:143], v[128:131]
v_mfma_f32_16x16x32_bf16 v[132:135], a[216:219], a[36:39], v[132:135]
ds_read_b64_tr_b16 a[240:241], v3 offset:8192
v_mfma_f32_16x16x32_bf16 v[132:135], a[220:223], a[156:159], v[132:135]
v_mfma_f32_16x16x32_bf16 v[136:139], a[216:219], a[52:55], v[136:139]
v_mfma_f32_16x16x32_bf16 v[136:139], a[220:223], a[160:163], v[136:139]
buffer_load_dwordx4 v21, s[4:7], s46 offen offset:1024 lds
v_mfma_f32_16x16x32_bf16 v[140:143], a[216:219], a[136:139], v[140:143]
ds_read_b64_tr_b16 a[242:243], v3 offset:10240
s_waitcnt lgkmcnt(6)
v_mfma_f32_16x16x32_bf16 v[140:143], a[220:223], a[176:179], v[140:143]
ds_read_b64_tr_b16 a[244:245], v3 offset:12288
s_mov_b32 s46, 837632
v_mfma_f32_16x16x32_bf16 v[144:147], a[224:227], a[32:35], v[144:147]
v_mfma_f32_16x16x32_bf16 v[144:147], a[228:231], a[152:155], v[144:147]
ds_read_b64_tr_b16 a[246:247], v3 offset:14336
v_mfma_f32_16x16x32_bf16 v[148:151], a[224:227], a[48:51], v[148:151]
buffer_load_dwordx4 v21, s[4:7], s46 offen offset:2048 lds
v_mfma_f32_16x16x32_bf16 v[148:151], a[228:231], a[140:143], v[148:151]
ds_read_b64_tr_b16 a[248:249], v4 offset:8192
s_mov_b32 s46, 846848
v_mfma_f32_16x16x32_bf16 v[152:155], a[224:227], a[36:39], v[152:155]
v_mfma_f32_16x16x32_bf16 v[152:155], a[228:231], a[156:159], v[152:155]
v_mfma_f32_16x16x32_bf16 v[156:159], a[224:227], a[52:55], v[156:159]
ds_read_b64_tr_b16 a[250:251], v4 offset:10240
v_mfma_f32_16x16x32_bf16 v[156:159], a[228:231], a[160:163], v[156:159]
s_waitcnt lgkmcnt(6)
ds_read_b64_tr_b16 a[252:253], v4 offset:12288
v_mfma_f32_16x16x32_bf16 v[160:163], a[224:227], a[136:139], v[160:163]
buffer_load_dwordx4 v21, s[4:7], s46 offen offset:3072 lds
v_mfma_f32_16x16x32_bf16 v[160:163], a[228:231], a[176:179], v[160:163]
v_mfma_f32_16x16x32_bf16 v[164:167], a[232:235], a[32:35], v[164:167]
ds_read_b64_tr_b16 a[254:255], v4 offset:14336
s_mov_b32 s46, 1966080
v_mfma_f32_16x16x32_bf16 v[164:167], a[236:239], a[152:155], v[164:167]
v_mfma_f32_16x16x32_bf16 v[168:171], a[232:235], a[48:51], v[168:171]
v_mfma_f32_16x16x32_bf16 v[168:171], a[236:239], a[140:143], v[168:171]
v_mfma_f32_16x16x32_bf16 v[172:175], a[232:235], a[36:39], v[172:175]
buffer_load_dwordx4 a[164:167], v18, s[8:11], s46 offen offset:0 sc1
v_mfma_f32_16x16x32_bf16 v[172:175], a[236:239], a[156:159], v[172:175]
v_mfma_f32_16x16x32_bf16 v[176:179], a[232:235], a[52:55], v[176:179]
v_mfma_f32_16x16x32_bf16 v[176:179], a[236:239], a[160:163], v[176:179]
s_waitcnt lgkmcnt(4)
v_mfma_f32_16x16x32_bf16 v[180:183], a[232:235], a[136:139], v[180:183]
v_mfma_f32_16x16x32_bf16 v[180:183], a[236:239], a[176:179], v[180:183]
v_mfma_f32_16x16x32_bf16 v[184:187], a[240:243], a[32:35], v[184:187]
v_mfma_f32_16x16x32_bf16 v[184:187], a[244:247], a[152:155], v[184:187]
buffer_load_dwordx4 a[180:183], v18, s[8:11], s46 offen offset:1024 sc1
v_mfma_f32_16x16x32_bf16 v[188:191], a[240:243], a[48:51], v[188:191]
ds_read_b64_tr_b16 a[192:193], v1 offset:16384
v_mfma_f32_16x16x32_bf16 v[188:191], a[244:247], a[140:143], v[188:191]
ds_read_b64_tr_b16 a[194:195], v1 offset:18432
v_mfma_f32_16x16x32_bf16 v[192:195], a[240:243], a[36:39], v[192:195]
ds_read_b64_tr_b16 a[196:197], v1 offset:20480
v_mfma_f32_16x16x32_bf16 v[192:195], a[244:247], a[156:159], v[192:195]
buffer_load_dwordx4 a[168:171], v18, s[8:11], s46 offen offset:2048 sc1
v_mfma_f32_16x16x32_bf16 v[196:199], a[240:243], a[52:55], v[196:199]
ds_read_b64_tr_b16 a[198:199], v1 offset:22528
v_mfma_f32_16x16x32_bf16 v[196:199], a[244:247], a[160:163], v[196:199]
ds_read_b64_tr_b16 a[200:201], v2 offset:16384
s_waitcnt lgkmcnt(5)
v_mfma_f32_16x16x32_bf16 v[200:203], a[240:243], a[136:139], v[200:203]
v_mfma_f32_16x16x32_bf16 v[200:203], a[244:247], a[176:179], v[200:203]
ds_read_b64_tr_b16 a[202:203], v2 offset:18432
v_mfma_f32_16x16x32_bf16 v[204:207], a[248:251], a[32:35], v[204:207]
v_mfma_f32_16x16x32_bf16 v[204:207], a[252:255], a[152:155], v[204:207]
buffer_load_dwordx4 a[184:187], v18, s[8:11], s46 offen offset:3072 sc1
v_mfma_f32_16x16x32_bf16 v[208:211], a[248:251], a[48:51], v[208:211]
ds_read_b64_tr_b16 a[204:205], v2 offset:20480
s_mov_b32 s46, 1970176
v_mfma_f32_16x16x32_bf16 v[208:211], a[252:255], a[140:143], v[208:211]
ds_read_b64_tr_b16 a[206:207], v2 offset:22528
v_mfma_f32_16x16x32_bf16 v[212:215], a[248:251], a[36:39], v[212:215]
v_mfma_f32_16x16x32_bf16 v[212:215], a[252:255], a[156:159], v[212:215]
v_mfma_f32_16x16x32_bf16 v[216:219], a[248:251], a[52:55], v[216:219]
v_mfma_f32_16x16x32_bf16 v[216:219], a[252:255], a[160:163], v[216:219]
buffer_load_dwordx4 a[172:175], v18, s[8:11], s46 offen offset:0 sc1
v_mfma_f32_16x16x32_bf16 v[220:223], a[248:251], a[136:139], v[220:223]
s_waitcnt vmcnt(9) lgkmcnt(4)
v_mfma_f32_16x16x32_bf16 v[220:223], a[252:255], a[176:179], v[220:223]
v_mfma_f32_16x16x32_bf16 v[64:67], a[192:195], a[40:43], v[64:67]
ds_read_b64_tr_b16 a[208:209], v3 offset:16384
v_mfma_f32_16x16x32_bf16 v[64:67], a[196:199], a[80:83], v[64:67]
ds_read_b64_tr_b16 a[210:211], v3 offset:18432
v_mfma_f32_16x16x32_bf16 v[68:71], a[192:195], a[56:59], v[68:71]
global_load_dword v30, v[28:29], off
v_mfma_f32_16x16x32_bf16 v[68:71], a[196:199], a[68:71], v[68:71]
ds_read_b64_tr_b16 a[212:213], v3 offset:20480
s_mov_b32 s46, 2088960
v_mfma_f32_16x16x32_bf16 v[72:75], a[192:195], a[44:47], v[72:75]
v_mfma_f32_16x16x32_bf16 v[72:75], a[196:199], a[84:87], v[72:75]
ds_read_b64_tr_b16 a[214:215], v3 offset:22528
v_mfma_f32_16x16x32_bf16 v[76:79], a[192:195], a[60:63], v[76:79]
v_mfma_f32_16x16x32_bf16 v[76:79], a[196:199], a[72:75], v[76:79]
ds_read_b64_tr_b16 a[216:217], v4 offset:16384
s_waitcnt lgkmcnt(5)
v_mfma_f32_16x16x32_bf16 v[80:83], a[192:195], a[64:67], v[80:83]
buffer_load_dwordx4 a[188:191], v18, s[8:11], s46 offen offset:0 sc1
v_mfma_f32_16x16x32_bf16 v[80:83], a[196:199], a[88:91], v[80:83]
v_mfma_f32_16x16x32_bf16 v[84:87], a[200:203], a[40:43], v[84:87]
ds_read_b64_tr_b16 a[218:219], v4 offset:18432
v_mfma_f32_16x16x32_bf16 v[84:87], a[204:207], a[80:83], v[84:87]
v_mfma_f32_16x16x32_bf16 v[88:91], a[200:203], a[56:59], v[88:91]
ds_read_b64_tr_b16 a[220:221], v4 offset:20480
v_mfma_f32_16x16x32_bf16 v[88:91], a[204:207], a[68:71], v[88:91]
buffer_load_dwordx4 a[76:79], v18, s[8:11], s46 offen offset:1024 sc1
v_mfma_f32_16x16x32_bf16 v[92:95], a[200:203], a[44:47], v[92:95]
ds_read_b64_tr_b16 a[222:223], v4 offset:22528
v_mfma_f32_16x16x32_bf16 v[92:95], a[204:207], a[84:87], v[92:95]
v_mfma_f32_16x16x32_bf16 v[96:99], a[200:203], a[60:63], v[96:99]
ds_read_b64_tr_b16 a[224:225], v1 offset:24576
v_mfma_f32_16x16x32_bf16 v[96:99], a[204:207], a[72:75], v[96:99]
s_waitcnt lgkmcnt(5)
ds_read_b64_tr_b16 a[226:227], v1 offset:26624
v_mfma_f32_16x16x32_bf16 v[100:103], a[200:203], a[64:67], v[100:103]
buffer_load_dwordx4 a[92:95], v18, s[8:11], s46 offen offset:2048 sc1
v_mfma_f32_16x16x32_bf16 v[100:103], a[204:207], a[88:91], v[100:103]
v_mfma_f32_16x16x32_bf16 v[104:107], a[208:211], a[40:43], v[104:107]
v_mfma_f32_16x16x32_bf16 v[104:107], a[212:215], a[80:83], v[104:107]
ds_read_b64_tr_b16 a[228:229], v1 offset:28672
v_mfma_f32_16x16x32_bf16 v[108:111], a[208:211], a[56:59], v[108:111]
v_mfma_f32_16x16x32_bf16 v[108:111], a[212:215], a[68:71], v[108:111]
ds_read_b64_tr_b16 a[230:231], v1 offset:30720
v_mfma_f32_16x16x32_bf16 v[112:115], a[208:211], a[44:47], v[112:115]
buffer_load_dwordx4 a[96:99], v18, s[8:11], s46 offen offset:3072 sc1
v_mfma_f32_16x16x32_bf16 v[112:115], a[212:215], a[84:87], v[112:115]
ds_read_b64_tr_b16 a[232:233], v2 offset:24576
s_mov_b32 s46, 2093056
v_mfma_f32_16x16x32_bf16 v[116:119], a[208:211], a[60:63], v[116:119]
v_mfma_f32_16x16x32_bf16 v[116:119], a[212:215], a[72:75], v[116:119]
s_waitcnt lgkmcnt(5)
ds_read_b64_tr_b16 a[234:235], v2 offset:26624
v_mfma_f32_16x16x32_bf16 v[120:123], a[208:211], a[64:67], v[120:123]
v_mfma_f32_16x16x32_bf16 v[120:123], a[212:215], a[88:91], v[120:123]
buffer_load_dwordx4 a[112:115], v18, s[8:11], s46 offen offset:0 sc1
v_mfma_f32_16x16x32_bf16 v[124:127], a[216:219], a[40:43], v[124:127]
ds_read_b64_tr_b16 a[236:237], v2 offset:28672
s_add_u32 m0, s41, 69632
v_mfma_f32_16x16x32_bf16 v[124:127], a[220:223], a[80:83], v[124:127]
s_mov_b32 s46, 860160
ds_read_b64_tr_b16 a[238:239], v2 offset:30720
v_mfma_f32_16x16x32_bf16 v[128:131], a[216:219], a[56:59], v[128:131]
v_mfma_f32_16x16x32_bf16 v[128:131], a[220:223], a[68:71], v[128:131]
v_mfma_f32_16x16x32_bf16 v[132:135], a[216:219], a[44:47], v[132:135]
buffer_load_dwordx4 v21, s[4:7], s46 offen offset:0 lds
v_mfma_f32_16x16x32_bf16 v[132:135], a[220:223], a[84:87], v[132:135]
ds_read_b64_tr_b16 a[240:241], v3 offset:24576
s_mov_b32 s46, 869376
v_mfma_f32_16x16x32_bf16 v[136:139], a[216:219], a[60:63], v[136:139]
v_mfma_f32_16x16x32_bf16 v[136:139], a[220:223], a[72:75], v[136:139]
ds_read_b64_tr_b16 a[242:243], v3 offset:26624
s_waitcnt lgkmcnt(6)
v_mfma_f32_16x16x32_bf16 v[140:143], a[216:219], a[64:67], v[140:143]
v_mfma_f32_16x16x32_bf16 v[140:143], a[220:223], a[88:91], v[140:143]
ds_read_b64_tr_b16 a[244:245], v3 offset:28672
v_mfma_f32_16x16x32_bf16 v[144:147], a[224:227], a[40:43], v[144:147]
buffer_load_dwordx4 v21, s[4:7], s46 offen offset:1024 lds
v_mfma_f32_16x16x32_bf16 v[144:147], a[228:231], a[80:83], v[144:147]
ds_read_b64_tr_b16 a[246:247], v3 offset:30720
s_mov_b32 s46, 878592
v_mfma_f32_16x16x32_bf16 v[148:151], a[224:227], a[56:59], v[148:151]
v_mfma_f32_16x16x32_bf16 v[148:151], a[228:231], a[68:71], v[148:151]
ds_read_b64_tr_b16 a[248:249], v4 offset:24576
v_mfma_f32_16x16x32_bf16 v[152:155], a[224:227], a[44:47], v[152:155]
v_mfma_f32_16x16x32_bf16 v[152:155], a[228:231], a[84:87], v[152:155]
buffer_load_dwordx4 v21, s[4:7], s46 offen offset:2048 lds
v_mfma_f32_16x16x32_bf16 v[156:159], a[224:227], a[60:63], v[156:159]
ds_read_b64_tr_b16 a[250:251], v4 offset:26624
s_mov_b32 s46, 887808
v_mfma_f32_16x16x32_bf16 v[156:159], a[228:231], a[72:75], v[156:159]
s_waitcnt lgkmcnt(6)
ds_read_b64_tr_b16 a[252:253], v4 offset:28672
v_mfma_f32_16x16x32_bf16 v[160:163], a[224:227], a[64:67], v[160:163]
v_mfma_f32_16x16x32_bf16 v[160:163], a[228:231], a[88:91], v[160:163]
v_mfma_f32_16x16x32_bf16 v[164:167], a[232:235], a[40:43], v[164:167]
buffer_load_dwordx4 v21, s[4:7], s46 offen offset:3072 lds
v_mfma_f32_16x16x32_bf16 v[164:167], a[236:239], a[80:83], v[164:167]
ds_read_b64_tr_b16 a[254:255], v4 offset:30720
s_mov_b32 s46, 2211840
v_mfma_f32_16x16x32_bf16 v[168:171], a[232:235], a[56:59], v[168:171]
v_mfma_f32_16x16x32_bf16 v[168:171], a[236:239], a[68:71], v[168:171]
v_mfma_f32_16x16x32_bf16 v[172:175], a[232:235], a[44:47], v[172:175]
v_mfma_f32_16x16x32_bf16 v[172:175], a[236:239], a[84:87], v[172:175]
v_mfma_f32_16x16x32_bf16 v[176:179], a[232:235], a[60:63], v[176:179]
buffer_load_dwordx4 a[100:103], v18, s[8:11], s46 offen offset:0 sc1
v_mfma_f32_16x16x32_bf16 v[176:179], a[236:239], a[72:75], v[176:179]
s_waitcnt lgkmcnt(4)
v_mfma_f32_16x16x32_bf16 v[180:183], a[232:235], a[64:67], v[180:183]
v_mfma_f32_16x16x32_bf16 v[180:183], a[236:239], a[88:91], v[180:183]
v_mfma_f32_16x16x32_bf16 v[184:187], a[240:243], a[40:43], v[184:187]
s_waitcnt vmcnt(30) lgkmcnt(0)
s_barrier
v_mfma_f32_16x16x32_bf16 v[184:187], a[244:247], a[80:83], v[184:187]
buffer_load_dwordx4 a[116:119], v18, s[8:11], s46 offen offset:1024 sc1
v_mfma_f32_16x16x32_bf16 v[188:191], a[240:243], a[56:59], v[188:191]
ds_read_b64_tr_b16 a[192:193], v1 offset:32768
v_mfma_f32_16x16x32_bf16 v[188:191], a[244:247], a[68:71], v[188:191]
ds_read_b64_tr_b16 a[194:195], v1 offset:34816
v_mfma_f32_16x16x32_bf16 v[192:195], a[240:243], a[44:47], v[192:195]
ds_read_b64_tr_b16 a[196:197], v1 offset:36864
v_mfma_f32_16x16x32_bf16 v[192:195], a[244:247], a[84:87], v[192:195]
ds_read_b64_tr_b16 a[198:199], v1 offset:38912
v_mfma_f32_16x16x32_bf16 v[196:199], a[240:243], a[60:63], v[196:199]
buffer_load_dwordx4 a[104:107], v18, s[8:11], s46 offen offset:2048 sc1
v_mfma_f32_16x16x32_bf16 v[196:199], a[244:247], a[72:75], v[196:199]
ds_read_b64_tr_b16 a[200:201], v2 offset:32768
v_mfma_f32_16x16x32_bf16 v[200:203], a[240:243], a[64:67], v[200:203]
v_mfma_f32_16x16x32_bf16 v[200:203], a[244:247], a[88:91], v[200:203]
ds_read_b64_tr_b16 a[202:203], v2 offset:34816
v_mfma_f32_16x16x32_bf16 v[204:207], a[248:251], a[40:43], v[204:207]
v_mfma_f32_16x16x32_bf16 v[204:207], a[252:255], a[80:83], v[204:207]
ds_read_b64_tr_b16 a[204:205], v2 offset:36864
v_mfma_f32_16x16x32_bf16 v[208:211], a[248:251], a[56:59], v[208:211]
buffer_load_dwordx4 a[120:123], v18, s[8:11], s46 offen offset:3072 sc1
v_mfma_f32_16x16x32_bf16 v[208:211], a[252:255], a[68:71], v[208:211]
ds_read_b64_tr_b16 a[206:207], v2 offset:38912
s_mov_b32 s46, 2215936
v_mfma_f32_16x16x32_bf16 v[212:215], a[248:251], a[44:47], v[212:215]
v_mfma_f32_16x16x32_bf16 v[212:215], a[252:255], a[84:87], v[212:215]
v_mfma_f32_16x16x32_bf16 v[216:219], a[248:251], a[60:63], v[216:219]
v_mfma_f32_16x16x32_bf16 v[216:219], a[252:255], a[72:75], v[216:219]
buffer_load_dwordx4 v[224:227], v18, s[8:11], s46 offen offset:0 sc1
v_mfma_f32_16x16x32_bf16 v[220:223], a[248:251], a[64:67], v[220:223]
s_waitcnt vmcnt(9) lgkmcnt(4)
v_mfma_f32_16x16x32_bf16 v[220:223], a[252:255], a[88:91], v[220:223]
s_bitcmp0_b32 s53, 0
s_cbranch_scc1 K2_BODYe
K2_BODYo:
v_mfma_f32_16x16x32_bf16 v[64:67], a[192:195], a[164:167], v[64:67]
ds_read_b64_tr_b16 a[208:209], v3 offset:32768
s_mov_b32 s46, 2334720
v_mfma_f32_16x16x32_bf16 v[64:67], a[196:199], a[188:191], v[64:67]
ds_read_b64_tr_b16 a[210:211], v3 offset:34816
v_mfma_f32_16x16x32_bf16 v[68:71], a[192:195], a[180:183], v[68:71]
buffer_load_dwordx4 v[228:231], v18, s[8:11], s46 offen offset:0 sc1
v_mfma_f32_16x16x32_bf16 v[68:71], a[196:199], a[76:79], v[68:71]
ds_read_b64_tr_b16 a[212:213], v3 offset:36864
v_mfma_f32_16x16x32_bf16 v[72:75], a[192:195], a[168:171], v[72:75]
v_mfma_f32_16x16x32_bf16 v[72:75], a[196:199], a[92:95], v[72:75]
ds_read_b64_tr_b16 a[214:215], v3 offset:38912
v_mfma_f32_16x16x32_bf16 v[76:79], a[192:195], a[184:187], v[76:79]
v_mfma_f32_16x16x32_bf16 v[76:79], a[196:199], a[96:99], v[76:79]
buffer_load_dwordx4 v[232:235], v18, s[8:11], s46 offen offset:1024 sc1
v_mfma_f32_16x16x32_bf16 v[80:83], a[192:195], a[172:175], v[80:83]
ds_read_b64_tr_b16 a[216:217], v4 offset:32768
s_waitcnt lgkmcnt(5)
v_mfma_f32_16x16x32_bf16 v[80:83], a[196:199], a[112:115], v[80:83]
v_mfma_f32_16x16x32_bf16 v[84:87], a[200:203], a[164:167], v[84:87]
ds_read_b64_tr_b16 a[218:219], v4 offset:34816
v_mfma_f32_16x16x32_bf16 v[84:87], a[204:207], a[188:191], v[84:87]
buffer_load_dwordx4 v[236:239], v18, s[8:11], s46 offen offset:2048 sc1
v_mfma_f32_16x16x32_bf16 v[88:91], a[200:203], a[180:183], v[88:91]
ds_read_b64_tr_b16 a[220:221], v4 offset:36864
v_mfma_f32_16x16x32_bf16 v[88:91], a[204:207], a[76:79], v[88:91]
v_mfma_f32_16x16x32_bf16 v[92:95], a[200:203], a[168:171], v[92:95]
ds_read_b64_tr_b16 a[222:223], v4 offset:38912
v_mfma_f32_16x16x32_bf16 v[92:95], a[204:207], a[92:95], v[92:95]
v_mfma_f32_16x16x32_bf16 v[96:99], a[200:203], a[184:187], v[96:99]
buffer_load_dwordx4 v[240:243], v18, s[8:11], s46 offen offset:3072 sc1
v_mfma_f32_16x16x32_bf16 v[96:99], a[204:207], a[96:99], v[96:99]
ds_read_b64_tr_b16 a[224:225], v1 offset:40960
s_waitcnt lgkmcnt(5)
v_mfma_f32_16x16x32_bf16 v[100:103], a[200:203], a[172:175], v[100:103]
s_mov_b32 s46, 2338816
ds_read_b64_tr_b16 a[226:227], v1 offset:43008
v_mfma_f32_16x16x32_bf16 v[100:103], a[204:207], a[112:115], v[100:103]
v_mfma_f32_16x16x32_bf16 v[104:107], a[208:211], a[164:167], v[104:107]
v_mfma_f32_16x16x32_bf16 v[104:107], a[212:215], a[188:191], v[104:107]
buffer_load_dwordx4 v[244:247], v18, s[8:11], s46 offen offset:0 sc1
v_mfma_f32_16x16x32_bf16 v[108:111], a[208:211], a[180:183], v[108:111]
ds_read_b64_tr_b16 a[228:229], v1 offset:45056
s_add_u32 m0, s41, 0
v_mfma_f32_16x16x32_bf16 v[108:111], a[212:215], a[76:79], v[108:111]
ds_read_b64_tr_b16 a[230:231], v1 offset:47104
s_mov_b32 s46, 3932160
v_mfma_f32_16x16x32_bf16 v[112:115], a[208:211], a[168:171], v[112:115]
v_mfma_f32_16x16x32_bf16 v[112:115], a[212:215], a[92:95], v[112:115]
buffer_load_dwordx4 v21, s[4:7], s46 offen offset:0 lds
v_mfma_f32_16x16x32_bf16 v[116:119], a[208:211], a[184:187], v[116:119]
ds_read_b64_tr_b16 a[232:233], v2 offset:40960
s_mov_b32 s46, 3941376
v_mfma_f32_16x16x32_bf16 v[116:119], a[212:215], a[96:99], v[116:119]
s_waitcnt lgkmcnt(5)
ds_read_b64_tr_b16 a[234:235], v2 offset:43008
v_mfma_f32_16x16x32_bf16 v[120:123], a[208:211], a[172:175], v[120:123]
v_mfma_f32_16x16x32_bf16 v[120:123], a[212:215], a[112:115], v[120:123]
v_mfma_f32_16x16x32_bf16 v[124:127], a[216:219], a[164:167], v[124:127]
buffer_load_dwordx4 v21, s[4:7], s46 offen offset:1024 lds
v_mfma_f32_16x16x32_bf16 v[124:127], a[220:223], a[188:191], v[124:127]
ds_read_b64_tr_b16 a[236:237], v2 offset:45056
s_mov_b32 s46, 3950592
v_mfma_f32_16x16x32_bf16 v[128:131], a[216:219], a[180:183], v[128:131]
ds_read_b64_tr_b16 a[238:239], v2 offset:47104
v_mfma_f32_16x16x32_bf16 v[128:131], a[220:223], a[76:79], v[128:131]
v_mfma_f32_16x16x32_bf16 v[132:135], a[216:219], a[168:171], v[132:135]
ds_read_b64_tr_b16 a[240:241], v3 offset:40960
v_mfma_f32_16x16x32_bf16 v[132:135], a[220:223], a[92:95], v[132:135]
buffer_load_dwordx4 v21, s[4:7], s46 offen offset:2048 lds
v_mfma_f32_16x16x32_bf16 v[136:139], a[216:219], a[184:187], v[136:139]
v_mfma_f32_16x16x32_bf16 v[136:139], a[220:223], a[96:99], v[136:139]
ds_read_b64_tr_b16 a[242:243], v3 offset:43008
s_mov_b32 s46, 3959808
v_mfma_f32_16x16x32_bf16 v[140:143], a[216:219], a[172:175], v[140:143]
s_waitcnt lgkmcnt(6)
ds_read_b64_tr_b16 a[244:245], v3 offset:45056
v_mfma_f32_16x16x32_bf16 v[140:143], a[220:223], a[112:115], v[140:143]
v_mfma_f32_16x16x32_bf16 v[144:147], a[224:227], a[164:167], v[144:147]
buffer_load_dwordx4 v21, s[4:7], s46 offen offset:3072 lds
v_mfma_f32_16x16x32_bf16 v[144:147], a[228:231], a[188:191], v[144:147]
ds_read_b64_tr_b16 a[246:247], v3 offset:47104
s_mov_b32 s46, 2457600
v_mfma_f32_16x16x32_bf16 v[148:151], a[224:227], a[180:183], v[148:151]
v_mfma_f32_16x16x32_bf16 v[148:151], a[228:231], a[76:79], v[148:151]
ds_read_b64_tr_b16 a[248:249], v4 offset:40960
v_mfma_f32_16x16x32_bf16 v[152:155], a[224:227], a[168:171], v[152:155]
buffer_load_dwordx4 v[248:251], v18, s[8:11], s46 offen offset:0 sc1
v_mfma_f32_16x16x32_bf16 v[152:155], a[228:231], a[92:95], v[152:155]
v_mfma_f32_16x16x32_bf16 v[156:159], a[224:227], a[184:187], v[156:159]
ds_read_b64_tr_b16 a[250:251], v4 offset:43008
v_mfma_f32_16x16x32_bf16 v[156:159], a[228:231], a[96:99], v[156:159]
s_waitcnt lgkmcnt(6)
ds_read_b64_tr_b16 a[252:253], v4 offset:45056
v_mfma_f32_16x16x32_bf16 v[160:163], a[224:227], a[172:175], v[160:163]
v_mfma_f32_16x16x32_bf16 v[160:163], a[228:231], a[112:115], v[160:163]
buffer_load_dwordx4 v[252:255], v18, s[8:11], s46 offen offset:1024 sc1
v_mfma_f32_16x16x32_bf16 v[164:167], a[232:235], a[164:167], v[164:167]
ds_read_b64_tr_b16 a[254:255], v4 offset:47104
v_mfma_f32_16x16x32_bf16 v[164:167], a[236:239], a[188:191], v[164:167]
v_mfma_f32_16x16x32_bf16 v[168:171], a[232:235], a[180:183], v[168:171]
v_mfma_f32_16x16x32_bf16 v[168:171], a[236:239], a[76:79], v[168:171]
v_mfma_f32_16x16x32_bf16 v[172:175], a[232:235], a[168:171], v[172:175]
buffer_load_dwordx4 a[0:3], v18, s[8:11], s46 offen offset:2048 sc1
v_mfma_f32_16x16x32_bf16 v[172:175], a[236:239], a[92:95], v[172:175]
v_mfma_f32_16x16x32_bf16 v[176:179], a[232:235], a[184:187], v[176:179]
v_mfma_f32_16x16x32_bf16 v[176:179], a[236:239], a[96:99], v[176:179]
s_waitcnt lgkmcnt(4)
v_mfma_f32_16x16x32_bf16 v[180:183], a[232:235], a[172:175], v[180:183]
buffer_load_dwordx4 a[16:19], v18, s[8:11], s46 offen offset:3072 sc1
v_mfma_f32_16x16x32_bf16 v[180:183], a[236:239], a[112:115], v[180:183]
v_mfma_f32_16x16x32_bf16 v[184:187], a[240:243], a[164:167], v[184:187]
s_mov_b32 s46, 2461696
v_mfma_f32_16x16x32_bf16 v[184:187], a[244:247], a[188:191], v[184:187]
ds_read_b64_tr_b16 a[192:193], v1 offset:49152
v_mfma_f32_16x16x32_bf16 v[188:191], a[240:243], a[180:183], v[188:191]
ds_read_b64_tr_b16 a[194:195], v1 offset:51200
v_mfma_f32_16x16x32_bf16 v[188:191], a[244:247], a[76:79], v[188:191]
buffer_load_dwordx4 a[108:111], v18, s[8:11], s46 offen offset:0 sc1
v_mfma_f32_16x16x32_bf16 v[192:195], a[240:243], a[168:171], v[192:195]
ds_read_b64_tr_b16 a[196:197], v1 offset:53248
s_mov_b32 s46, 2580480
v_mfma_f32_16x16x32_bf16 v[192:195], a[244:247], a[92:95], v[192:195]
ds_read_b64_tr_b16 a[198:199], v1 offset:55296
v_mfma_f32_16x16x32_bf16 v[196:199], a[240:243], a[184:187], v[196:199]
v_mfma_f32_16x16x32_bf16 v[196:199], a[244:247], a[96:99], v[196:199]
ds_read_b64_tr_b16 a[200:201], v2 offset:49152
s_waitcnt lgkmcnt(5)
v_mfma_f32_16x16x32_bf16 v[200:203], a[240:243], a[172:175], v[200:203]
buffer_load_dwordx4 a[124:127], v18, s[8:11], s46 offen offset:0 sc1
v_mfma_f32_16x16x32_bf16 v[200:203], a[244:247], a[112:115], v[200:203]
ds_read_b64_tr_b16 a[202:203], v2 offset:51200
v_mfma_f32_16x16x32_bf16 v[204:207], a[248:251], a[164:167], v[204:207]
v_mfma_f32_16x16x32_bf16 v[204:207], a[252:255], a[188:191], v[204:207]
ds_read_b64_tr_b16 a[204:205], v2 offset:53248
v_mfma_f32_16x16x32_bf16 v[208:211], a[248:251], a[180:183], v[208:211]
buffer_load_dwordx4 a[128:131], v18, s[8:11], s46 offen offset:1024 sc1
v_mfma_f32_16x16x32_bf16 v[208:211], a[252:255], a[76:79], v[208:211]
ds_read_b64_tr_b16 a[206:207], v2 offset:55296
v_mfma_f32_16x16x32_bf16 v[212:215], a[248:251], a[168:171], v[212:215]
v_mfma_f32_16x16x32_bf16 v[212:215], a[252:255], a[92:95], v[212:215]
v_mfma_f32_16x16x32_bf16 v[216:219], a[248:251], a[184:187], v[216:219]
v_mfma_f32_16x16x32_bf16 v[216:219], a[252:255], a[96:99], v[216:219]
buffer_load_dwordx4 a[144:147], v18, s[8:11], s46 offen offset:2048 sc1
v_mfma_f32_16x16x32_bf16 v[220:223], a[248:251], a[172:175], v[220:223]
s_waitcnt vmcnt(12) lgkmcnt(4)
v_mfma_f32_16x16x32_bf16 v[220:223], a[252:255], a[112:115], v[220:223]
v_mfma_f32_16x16x32_bf16 v[64:67], a[192:195], a[100:103], v[64:67]
ds_read_b64_tr_b16 a[208:209], v3 offset:49152
v_mfma_f32_16x16x32_bf16 v[64:67], a[196:199], v[228:231], v[64:67]
ds_read_b64_tr_b16 a[210:211], v3 offset:51200
v_mfma_f32_16x16x32_bf16 v[68:71], a[192:195], a[116:119], v[68:71]
buffer_load_dword v9, off, s[28:31], s51 sc1
v_mfma_f32_16x16x32_bf16 v[68:71], a[196:199], v[232:235], v[68:71]
ds_read_b64_tr_b16 a[212:213], v3 offset:53248
s_mov_b32 s46, 2580480
v_mfma_f32_16x16x32_bf16 v[72:75], a[192:195], a[104:107], v[72:75]
v_mfma_f32_16x16x32_bf16 v[72:75], a[196:199], v[236:239], v[72:75]
ds_read_b64_tr_b16 a[214:215], v3 offset:55296
v_mfma_f32_16x16x32_bf16 v[76:79], a[192:195], a[120:123], v[76:79]
buffer_load_dwordx4 a[132:135], v18, s[8:11], s46 offen offset:3072 sc1
v_mfma_f32_16x16x32_bf16 v[76:79], a[196:199], v[240:243], v[76:79]
ds_read_b64_tr_b16 a[216:217], v4 offset:49152
s_mov_b32 s46, 2584576
v_mfma_f32_16x16x32_bf16 v[80:83], a[192:195], v[224:227], v[80:83]
s_waitcnt lgkmcnt(5)
ds_read_b64_tr_b16 a[218:219], v4 offset:51200
v_mfma_f32_16x16x32_bf16 v[80:83], a[196:199], v[244:247], v[80:83]
v_mfma_f32_16x16x32_bf16 v[84:87], a[200:203], a[100:103], v[84:87]
buffer_load_dwordx4 a[148:151], v18, s[8:11], s46 offen offset:0 sc1
v_mfma_f32_16x16x32_bf16 v[84:87], a[204:207], v[228:231], v[84:87]
s_mov_b32 s46, 2703360
ds_read_b64_tr_b16 a[220:221], v4 offset:53248
v_mfma_f32_16x16x32_bf16 v[88:91], a[200:203], a[116:119], v[88:91]
v_mfma_f32_16x16x32_bf16 v[88:91], a[204:207], v[232:235], v[88:91]
v_mfma_f32_16x16x32_bf16 v[92:95], a[200:203], a[104:107], v[92:95]
buffer_load_dwordx4 a[4:7], v18, s[8:11], s46 offen offset:0 sc1
v_mfma_f32_16x16x32_bf16 v[92:95], a[204:207], v[236:239], v[92:95]
ds_read_b64_tr_b16 a[222:223], v4 offset:55296
v_mfma_f32_16x16x32_bf16 v[96:99], a[200:203], a[120:123], v[96:99]
ds_read_b64_tr_b16 a[224:225], v1 offset:57344
v_mfma_f32_16x16x32_bf16 v[96:99], a[204:207], v[240:243], v[96:99]
s_waitcnt lgkmcnt(5)
ds_read_b64_tr_b16 a[226:227], v1 offset:59392
v_mfma_f32_16x16x32_bf16 v[100:103], a[200:203], v[224:227], v[100:103]
buffer_load_dwordx4 a[20:23], v18, s[8:11], s46 offen offset:1024 sc1
v_mfma_f32_16x16x32_bf16 v[100:103], a[204:207], v[244:247], v[100:103]
v_mfma_f32_16x16x32_bf16 v[104:107], a[208:211], a[100:103], v[104:107]
v_mfma_f32_16x16x32_bf16 v[104:107], a[212:215], v[228:231], v[104:107]
ds_read_b64_tr_b16 a[228:229], v1 offset:61440
v_mfma_f32_16x16x32_bf16 v[108:111], a[208:211], a[116:119], v[108:111]
buffer_load_dwordx4 a[8:11], v18, s[8:11], s46 offen offset:2048 sc1
v_mfma_f32_16x16x32_bf16 v[108:111], a[212:215], v[232:235], v[108:111]
ds_read_b64_tr_b16 a[230:231], v1 offset:63488
s_add_u32 m0, s41, 4096
v_mfma_f32_16x16x32_bf16 v[112:115], a[208:211], a[104:107], v[112:115]
s_mov_b32 s46, 3973120
ds_read_b64_tr_b16 a[232:233], v2 offset:57344
v_mfma_f32_16x16x32_bf16 v[112:115], a[212:215], v[236:239], v[112:115]
v_mfma_f32_16x16x32_bf16 v[116:119], a[208:211], a[120:123], v[116:119]
buffer_load_dwordx4 v21, s[4:7], s46 offen offset:0 lds
v_mfma_f32_16x16x32_bf16 v[116:119], a[212:215], v[240:243], v[116:119]
s_mov_b32 s46, 3982336
s_waitcnt lgkmcnt(5)
v_mfma_f32_16x16x32_bf16 v[120:123], a[208:211], v[224:227], v[120:123]
ds_read_b64_tr_b16 a[234:235], v2 offset:59392
v_mfma_f32_16x16x32_bf16 v[120:123], a[212:215], v[244:247], v[120:123]
v_mfma_f32_16x16x32_bf16 v[124:127], a[216:219], a[100:103], v[124:127]
buffer_load_dwordx4 v21, s[4:7], s46 offen offset:1024 lds
v_mfma_f32_16x16x32_bf16 v[124:127], a[220:223], v[228:231], v[124:127]
ds_read_b64_tr_b16 a[236:237], v2 offset:61440
s_mov_b32 s46, 3991552
v_mfma_f32_16x16x32_bf16 v[128:131], a[216:219], a[116:119], v[128:131]
ds_read_b64_tr_b16 a[238:239], v2 offset:63488
v_mfma_f32_16x16x32_bf16 v[128:131], a[220:223], v[232:235], v[128:131]
v_mfma_f32_16x16x32_bf16 v[132:135], a[216:219], a[104:107], v[132:135]
buffer_load_dwordx4 v21, s[4:7], s46 offen offset:2048 lds
v_mfma_f32_16x16x32_bf16 v[132:135], a[220:223], v[236:239], v[132:135]
ds_read_b64_tr_b16 a[240:241], v3 offset:57344
s_mov_b32 s46, 4000768
v_mfma_f32_16x16x32_bf16 v[136:139], a[216:219], a[120:123], v[136:139]
v_mfma_f32_16x16x32_bf16 v[136:139], a[220:223], v[240:243], v[136:139]
ds_read_b64_tr_b16 a[242:243], v3 offset:59392
s_waitcnt lgkmcnt(6)
v_mfma_f32_16x16x32_bf16 v[140:143], a[216:219], v[224:227], v[140:143]
buffer_load_dwordx4 v21, s[4:7], s46 offen offset:3072 lds
v_mfma_f32_16x16x32_bf16 v[140:143], a[220:223], v[244:247], v[140:143]
ds_read_b64_tr_b16 a[244:245], v3 offset:61440
s_mov_b32 s46, 2703360
v_mfma_f32_16x16x32_bf16 v[144:147], a[224:227], a[100:103], v[144:147]
v_mfma_f32_16x16x32_bf16 v[144:147], a[228:231], v[228:231], v[144:147]
ds_read_b64_tr_b16 a[246:247], v3 offset:63488
v_mfma_f32_16x16x32_bf16 v[148:151], a[224:227], a[116:119], v[148:151]
buffer_load_dwordx4 a[24:27], v18, s[8:11], s46 offen offset:3072 sc1
v_mfma_f32_16x16x32_bf16 v[148:151], a[228:231], v[232:235], v[148:151]
ds_read_b64_tr_b16 a[248:249], v4 offset:57344
s_mov_b32 s46, 2707456
v_mfma_f32_16x16x32_bf16 v[152:155], a[224:227], a[104:107], v[152:155]
v_mfma_f32_16x16x32_bf16 v[152:155], a[228:231], v[236:239], v[152:155]
v_mfma_f32_16x16x32_bf16 v[156:159], a[224:227], a[120:123], v[156:159]
buffer_load_dwordx4 a[12:15], v18, s[8:11], s46 offen offset:0 sc1
v_mfma_f32_16x16x32_bf16 v[156:159], a[228:231], v[240:243], v[156:159]
ds_read_b64_tr_b16 a[250:251], v4 offset:59392
s_mov_b32 s46, 2826240
v_mfma_f32_16x16x32_bf16 v[160:163], a[224:227], v[224:227], v[160:163]
ds_read_b64_tr_b16 a[252:253], v4 offset:61440
s_waitcnt lgkmcnt(7)
v_mfma_f32_16x16x32_bf16 v[160:163], a[228:231], v[244:247], v[160:163]
v_mfma_f32_16x16x32_bf16 v[164:167], a[232:235], a[100:103], v[164:167]
buffer_load_dwordx4 a[28:31], v18, s[8:11], s46 offen offset:0 sc1
v_mfma_f32_16x16x32_bf16 v[164:167], a[236:239], v[228:231], v[164:167]
ds_read_b64_tr_b16 a[254:255], v4 offset:63488
v_mfma_f32_16x16x32_bf16 v[168:171], a[232:235], a[116:119], v[168:171]
v_mfma_f32_16x16x32_bf16 v[168:171], a[236:239], v[232:235], v[168:171]
v_mfma_f32_16x16x32_bf16 v[172:175], a[232:235], a[104:107], v[172:175]
buffer_load_dwordx4 a[32:35], v18, s[8:11], s46 offen offset:1024 sc1
v_mfma_f32_16x16x32_bf16 v[172:175], a[236:239], v[236:239], v[172:175]
v_mfma_f32_16x16x32_bf16 v[176:179], a[232:235], a[120:123], v[176:179]
v_mfma_f32_16x16x32_bf16 v[176:179], a[236:239], v[240:243], v[176:179]
s_waitcnt lgkmcnt(4)
v_mfma_f32_16x16x32_bf16 v[180:183], a[232:235], v[224:227], v[180:183]
buffer_load_dwordx4 a[48:51], v18, s[8:11], s46 offen offset:2048 sc1
v_mfma_f32_16x16x32_bf16 v[180:183], a[236:239], v[244:247], v[180:183]
v_mfma_f32_16x16x32_bf16 v[184:187], a[240:243], a[100:103], v[184:187]
s_waitcnt vmcnt(37) lgkmcnt(0)
s_barrier
v_mfma_f32_16x16x32_bf16 v[184:187], a[244:247], v[228:231], v[184:187]
ds_read_b64_tr_b16 a[192:193], v13 offset:0
v_mfma_f32_16x16x32_bf16 v[188:191], a[240:243], a[116:119], v[188:191]
buffer_load_dwordx4 a[36:39], v18, s[8:11], s46 offen offset:3072 sc1
v_mfma_f32_16x16x32_bf16 v[188:191], a[244:247], v[232:235], v[188:191]
ds_read_b64_tr_b16 a[194:195], v13 offset:2048
s_mov_b32 s46, 2830336
v_mfma_f32_16x16x32_bf16 v[192:195], a[240:243], a[104:107], v[192:195]
ds_read_b64_tr_b16 a[196:197], v13 offset:4096
v_mfma_f32_16x16x32_bf16 v[192:195], a[244:247], v[236:239], v[192:195]
ds_read_b64_tr_b16 a[198:199], v13 offset:6144
v_mfma_f32_16x16x32_bf16 v[196:199], a[240:243], a[120:123], v[196:199]
buffer_load_dwordx4 a[52:55], v18, s[8:11], s46 offen offset:0 sc1
v_mfma_f32_16x16x32_bf16 v[196:199], a[244:247], v[240:243], v[196:199]
ds_read_b64_tr_b16 a[200:201], v14 offset:0
v_mfma_f32_16x16x32_bf16 v[200:203], a[240:243], v[224:227], v[200:203]
v_mfma_f32_16x16x32_bf16 v[200:203], a[244:247], v[244:247], v[200:203]
ds_read_b64_tr_b16 a[202:203], v14 offset:2048
s_waitcnt vmcnt(16)
v_mfma_f32_16x16x32_bf16 v[204:207], a[248:251], a[100:103], v[204:207]
ds_read_b64_tr_b16 a[204:205], v14 offset:4096
v_readfirstlane_b32 s88, v9
v_mfma_f32_16x16x32_bf16 v[204:207], a[252:255], v[228:231], v[204:207]
v_mfma_f32_16x16x32_bf16 v[208:211], a[248:251], a[116:119], v[208:211]
v_mfma_f32_16x16x32_bf16 v[208:211], a[252:255], v[232:235], v[208:211]
s_cmp_lt_u32 s88, 32
s_cbranch_scc1 K2_SPIN12o
K2_RET12o:
v_mfma_f32_16x16x32_bf16 v[212:215], a[248:251], a[104:107], v[212:215]
ds_read_b64_tr_b16 a[206:207], v14 offset:6144
s_mov_b32 s46, 2949120
v_mfma_f32_16x16x32_bf16 v[212:215], a[252:255], v[236:239], v[212:215]
v_mfma_f32_16x16x32_bf16 v[216:219], a[248:251], a[120:123], v[216:219]
v_mfma_f32_16x16x32_bf16 v[216:219], a[252:255], v[240:243], v[216:219]
buffer_load_dwordx4 a[136:139], v18, s[8:11], s46 offen offset:0 sc1
v_mfma_f32_16x16x32_bf16 v[220:223], a[248:251], v[224:227], v[220:223]
s_waitcnt vmcnt(15) lgkmcnt(4)
v_mfma_f32_16x16x32_bf16 v[220:223], a[252:255], v[244:247], v[220:223]
v_mfma_f32_16x16x32_bf16 v[64:67], a[192:195], v[248:251], v[64:67]
ds_read_b64_tr_b16 a[208:209], v15 offset:0
s_mov_b32 s46, 2949120
v_mfma_f32_16x16x32_bf16 v[64:67], a[196:199], a[124:127], v[64:67]
ds_read_b64_tr_b16 a[210:211], v15 offset:2048
v_mfma_f32_16x16x32_bf16 v[68:71], a[192:195], v[252:255], v[68:71]
buffer_load_dwordx4 a[152:155], v18, s[8:11], s46 offen offset:1024 sc1
v_mfma_f32_16x16x32_bf16 v[68:71], a[196:199], a[128:131], v[68:71]
ds_read_b64_tr_b16 a[212:213], v15 offset:4096
v_mfma_f32_16x16x32_bf16 v[72:75], a[192:195], a[0:3], v[72:75]
v_mfma_f32_16x16x32_bf16 v[72:75], a[196:199], a[144:147], v[72:75]
ds_read_b64_tr_b16 a[214:215], v15 offset:6144
v_mfma_f32_16x16x32_bf16 v[76:79], a[192:195], a[16:19], v[76:79]
v_mfma_f32_16x16x32_bf16 v[76:79], a[196:199], a[132:135], v[76:79]
buffer_load_dwordx4 a[140:143], v18, s[8:11], s46 offen offset:2048 sc1
v_mfma_f32_16x16x32_bf16 v[80:83], a[192:195], a[108:111], v[80:83]
ds_read_b64_tr_b16 a[216:217], v16 offset:0
s_waitcnt lgkmcnt(5)
v_mfma_f32_16x16x32_bf16 v[80:83], a[196:199], a[148:151], v[80:83]
v_mfma_f32_16x16x32_bf16 v[84:87], a[200:203], v[248:251], v[84:87]
ds_read_b64_tr_b16 a[218:219], v16 offset:2048
v_mfma_f32_16x16x32_bf16 v[84:87], a[204:207], a[124:127], v[84:87]
buffer_load_dwordx4 a[156:159], v18, s[8:11], s46 offen offset:3072 sc1
v_mfma_f32_16x16x32_bf16 v[88:91], a[200:203], v[252:255], v[88:91]
ds_read_b64_tr_b16 a[220:221], v16 offset:4096
s_mov_b32 s46, 2953216
v_mfma_f32_16x16x32_bf16 v[88:91], a[204:207], a[128:131], v[88:91]
v_mfma_f32_16x16x32_bf16 v[92:95], a[200:203], a[0:3], v[92:95]
ds_read_b64_tr_b16 a[222:223], v16 offset:6144
v_mfma_f32_16x16x32_bf16 v[92:95], a[204:207], a[144:147], v[92:95]
v_mfma_f32_16x16x32_bf16 v[96:99], a[200:203], a[16:19], v[96:99]
buffer_load_dwordx4 a[160:163], v18, s[8:11], s46 offen offset:0 sc1
v_mfma_f32_16x16x32_bf16 v[96:99], a[204:207], a[132:135], v[96:99]
ds_read_b64_tr_b16 a[224:225], v13 offset:8192
s_waitcnt lgkmcnt(5)
v_mfma_f32_16x16x32_bf16 v[100:103], a[200:203], a[108:111], v[100:103]
s_mov_b32 s46, 3072000
ds_read_b64_tr_b16 a[226:227], v13 offset:10240
v_mfma_f32_16x16x32_bf16 v[100:103], a[204:207], a[148:151], v[100:103]
v_mfma_f32_16x16x32_bf16 v[104:107], a[208:211], v[248:251], v[104:107]
v_mfma_f32_16x16x32_bf16 v[104:107], a[212:215], a[124:127], v[104:107]
buffer_load_dwordx4 a[176:179], v18, s[8:11], s46 offen offset:0 sc1
v_mfma_f32_16x16x32_bf16 v[108:111], a[208:211], v[252:255], v[108:111]
ds_read_b64_tr_b16 a[228:229], v13 offset:12288
s_add_u32 m0, s41, 32768
v_mfma_f32_16x16x32_bf16 v[108:111], a[212:215], a[128:131], v[108:111]
ds_read_b64_tr_b16 a[230:231], v13 offset:14336
s_mov_b32 s46, 4096000
v_mfma_f32_16x16x32_bf16 v[112:115], a[208:211], a[0:3], v[112:115]
v_mfma_f32_16x16x32_bf16 v[112:115], a[212:215], a[144:147], v[112:115]
buffer_load_dwordx4 v21, s[4:7], s46 offen offset:0 lds
v_mfma_f32_16x16x32_bf16 v[116:119], a[208:211], a[16:19], v[116:119]
ds_read_b64_tr_b16 a[232:233], v14 offset:8192
s_mov_b32 s46, 4105216
v_mfma_f32_16x16x32_bf16 v[116:119], a[212:215], a[132:135], v[116:119]
s_waitcnt lgkmcnt(5)
ds_read_b64_tr_b16 a[234:235], v14 offset:10240
v_mfma_f32_16x16x32_bf16 v[120:123], a[208:211], a[108:111], v[120:123]
v_mfma_f32_16x16x32_bf16 v[120:123], a[212:215], a[148:151], v[120:123]
v_mfma_f32_16x16x32_bf16 v[124:127], a[216:219], v[248:251], v[124:127]
buffer_load_dwordx4 v21, s[4:7], s46 offen offset:1024 lds
v_mfma_f32_16x16x32_bf16 v[124:127], a[220:223], a[124:127], v[124:127]
ds_read_b64_tr_b16 a[236:237], v14 offset:12288
s_mov_b32 s46, 4114432
v_mfma_f32_16x16x32_bf16 v[128:131], a[216:219], v[252:255], v[128:131]
ds_read_b64_tr_b16 a[238:239], v14 offset:14336
v_mfma_f32_16x16x32_bf16 v[128:131], a[220:223], a[128:131], v[128:131]
v_mfma_f32_16x16x32_bf16 v[132:135], a[216:219], a[0:3], v[132:135]
ds_read_b64_tr_b16 a[240:241], v15 offset:8192
v_mfma_f32_16x16x32_bf16 v[132:135], a[220:223], a[144:147], v[132:135]
buffer_load_dwordx4 v21, s[4:7], s46 offen offset:2048 lds
v_mfma_f32_16x16x32_bf16 v[136:139], a[216:219], a[16:19], v[136:139]
v_mfma_f32_16x16x32_bf16 v[136:139], a[220:223], a[132:135], v[136:139]
ds_read_b64_tr_b16 a[242:243], v15 offset:10240
s_mov_b32 s46, 4123648
v_mfma_f32_16x16x32_bf16 v[140:143], a[216:219], a[108:111], v[140:143]
s_waitcnt lgkmcnt(6)
ds_read_b64_tr_b16 a[244:245], v15 offset:12288
v_mfma_f32_16x16x32_bf16 v[140:143], a[220:223], a[148:151], v[140:143]
v_mfma_f32_16x16x32_bf16 v[144:147], a[224:227], v[248:251], v[144:147]
buffer_load_dwordx4 v21, s[4:7], s46 offen offset:3072 lds
v_mfma_f32_16x16x32_bf16 v[144:147], a[228:231], a[124:127], v[144:147]
ds_read_b64_tr_b16 a[246:247], v15 offset:14336
s_mov_b32 s46, 3072000
v_mfma_f32_16x16x32_bf16 v[148:151], a[224:227], v[252:255], v[148:151]
v_mfma_f32_16x16x32_bf16 v[148:151], a[228:231], a[128:131], v[148:151]
ds_read_b64_tr_b16 a[248:249], v16 offset:8192
v_mfma_f32_16x16x32_bf16 v[152:155], a[224:227], a[0:3], v[152:155]
buffer_load_dwordx4 a[40:43], v18, s[8:11], s46 offen offset:1024 sc1
v_mfma_f32_16x16x32_bf16 v[152:155], a[228:231], a[144:147], v[152:155]
v_mfma_f32_16x16x32_bf16 v[156:159], a[224:227], a[16:19], v[156:159]
ds_read_b64_tr_b16 a[250:251], v16 offset:10240
v_mfma_f32_16x16x32_bf16 v[156:159], a[228:231], a[132:135], v[156:159]
s_waitcnt lgkmcnt(6)
ds_read_b64_tr_b16 a[252:253], v16 offset:12288
v_mfma_f32_16x16x32_bf16 v[160:163], a[224:227], a[108:111], v[160:163]
v_mfma_f32_16x16x32_bf16 v[160:163], a[228:231], a[148:151], v[160:163]
buffer_load_dwordx4 a[56:59], v18, s[8:11], s46 offen offset:2048 sc1
v_mfma_f32_16x16x32_bf16 v[164:167], a[232:235], v[248:251], v[164:167]
ds_read_b64_tr_b16 a[254:255], v16 offset:14336
v_mfma_f32_16x16x32_bf16 v[164:167], a[236:239], a[124:127], v[164:167]
v_mfma_f32_16x16x32_bf16 v[168:171], a[232:235], v[252:255], v[168:171]
v_mfma_f32_16x16x32_bf16 v[168:171], a[236:239], a[128:131], v[168:171]
v_mfma_f32_16x16x32_bf16 v[172:175], a[232:235], a[0:3], v[172:175]
buffer_load_dwordx4 a[44:47], v18, s[8:11], s46 offen offset:3072 sc1
v_mfma_f32_16x16x32_bf16 v[172:175], a[236:239], a[144:147], v[172:175]
s_mov_b32 s46, 3076096
v_mfma_f32_16x16x32_bf16 v[176:179], a[232:235], a[16:19], v[176:179]
v_mfma_f32_16x16x32_bf16 v[176:179], a[236:239], a[132:135], v[176:179]
s_waitcnt lgkmcnt(4)
v_mfma_f32_16x16x32_bf16 v[180:183], a[232:235], a[108:111], v[180:183]
buffer_load_dwordx4 a[60:63], v18, s[8:11], s46 offen offset:0 sc1
v_mfma_f32_16x16x32_bf16 v[180:183], a[236:239], a[148:151], v[180:183]
v_mfma_f32_16x16x32_bf16 v[184:187], a[240:243], v[248:251], v[184:187]
s_mov_b32 s46, 3194880
v_mfma_f32_16x16x32_bf16 v[184:187], a[244:247], a[124:127], v[184:187]
ds_read_b64_tr_b16 a[192:193], v13 offset:16384
v_mfma_f32_16x16x32_bf16 v[188:191], a[240:243], v[252:255], v[188:191]
ds_read_b64_tr_b16 a[194:195], v13 offset:18432
v_mfma_f32_16x16x32_bf16 v[188:191], a[244:247], a[128:131], v[188:191]
buffer_load_dwordx4 a[64:67], v18, s[8:11], s46 offen offset:0 sc1
v_mfma_f32_16x16x32_bf16 v[192:195], a[240:243], a[0:3], v[192:195]
ds_read_b64_tr_b16 a[196:197], v13 offset:20480
v_mfma_f32_16x16x32_bf16 v[192:195], a[244:247], a[144:147], v[192:195]
ds_read_b64_tr_b16 a[198:199], v13 offset:22528
v_mfma_f32_16x16x32_bf16 v[196:199], a[240:243], a[16:19], v[196:199]
v_mfma_f32_16x16x32_bf16 v[196:199], a[244:247], a[132:135], v[196:199]
ds_read_b64_tr_b16 a[200:201], v14 offset:16384
s_waitcnt lgkmcnt(5)
v_mfma_f32_16x16x32_bf16 v[200:203], a[240:243], a[108:111], v[200:203]
buffer_load_dwordx4 a[80:83], v18, s[8:11], s46 offen offset:1024 sc1
v_mfma_f32_16x16x32_bf16 v[200:203], a[244:247], a[148:151], v[200:203]
ds_read_b64_tr_b16 a[202:203], v14 offset:18432
v_mfma_f32_16x16x32_bf16 v[204:207], a[248:251], v[248:251], v[204:207]
v_mfma_f32_16x16x32_bf16 v[204:207], a[252:255], a[124:127], v[204:207]
ds_read_b64_tr_b16 a[204:205], v14 offset:20480
v_mfma_f32_16x16x32_bf16 v[208:211], a[248:251], v[252:255], v[208:211]
buffer_load_dwordx4 a[68:71], v18, s[8:11], s46 offen offset:2048 sc1
v_mfma_f32_16x16x32_bf16 v[208:211], a[252:255], a[128:131], v[208:211]
ds_read_b64_tr_b16 a[206:207], v14 offset:22528
v_mfma_f32_16x16x32_bf16 v[212:215], a[248:251], a[0:3], v[212:215]
v_mfma_f32_16x16x32_bf16 v[212:215], a[252:255], a[144:147], v[212:215]
v_mfma_f32_16x16x32_bf16 v[216:219], a[248:251], a[16:19], v[216:219]
v_mfma_f32_16x16x32_bf16 v[216:219], a[252:255], a[132:135], v[216:219]
buffer_load_dwordx4 a[84:87], v18, s[8:11], s46 offen offset:3072 sc1
v_mfma_f32_16x16x32_bf16 v[220:223], a[248:251], a[108:111], v[220:223]
s_waitcnt vmcnt(18) lgkmcnt(4)
v_mfma_f32_16x16x32_bf16 v[220:223], a[252:255], a[148:151], v[220:223]
v_mfma_f32_16x16x32_bf16 v[64:67], a[192:195], a[4:7], v[64:67]
ds_read_b64_tr_b16 a[208:209], v15 offset:16384
v_mfma_f32_16x16x32_bf16 v[64:67], a[196:199], a[28:31], v[64:67]
ds_read_b64_tr_b16 a[210:211], v15 offset:18432
v_mfma_f32_16x16x32_bf16 v[68:71], a[192:195], a[20:23], v[68:71]
global_load_dword v30, v[28:29], off
v_mfma_f32_16x16x32_bf16 v[68:71], a[196:199], a[32:35], v[68:71]
ds_read_b64_tr_b16 a[212:213], v15 offset:20480
s_mov_b32 s46, 3198976
v_mfma_f32_16x16x32_bf16 v[72:75], a[192:195], a[8:11], v[72:75]
v_mfma_f32_16x16x32_bf16 v[72:75], a[196:199], a[48:51], v[72:75]
ds_read_b64_tr_b16 a[214:215], v15 offset:22528
v_mfma_f32_16x16x32_bf16 v[76:79], a[192:195], a[24:27], v[76:79]
buffer_load_dwordx4 a[72:75], v18, s[8:11], s46 offen offset:0 sc1
v_mfma_f32_16x16x32_bf16 v[76:79], a[196:199], a[36:39], v[76:79]
ds_read_b64_tr_b16 a[216:217], v16 offset:16384
s_waitcnt lgkmcnt(5)
v_mfma_f32_16x16x32_bf16 v[80:83], a[192:195], a[12:15], v[80:83]
s_mov_b32 s46, 3317760
ds_read_b64_tr_b16 a[218:219], v16 offset:18432
v_mfma_f32_16x16x32_bf16 v[80:83], a[196:199], a[52:55], v[80:83]
v_mfma_f32_16x16x32_bf16 v[84:87], a[200:203], a[4:7], v[84:87]
v_mfma_f32_16x16x32_bf16 v[84:87], a[204:207], a[28:31], v[84:87]
buffer_load_dwordx4 a[88:91], v18, s[8:11], s46 offen offset:0 sc1
v_mfma_f32_16x16x32_bf16 v[88:91], a[200:203], a[20:23], v[88:91]
ds_read_b64_tr_b16 a[220:221], v16 offset:20480
v_mfma_f32_16x16x32_bf16 v[88:91], a[204:207], a[32:35], v[88:91]
v_mfma_f32_16x16x32_bf16 v[92:95], a[200:203], a[8:11], v[92:95]
ds_read_b64_tr_b16 a[222:223], v16 offset:22528
v_mfma_f32_16x16x32_bf16 v[92:95], a[204:207], a[48:51], v[92:95]
buffer_load_dwordx4 a[164:167], v18, s[8:11], s46 offen offset:1024 sc1
v_mfma_f32_16x16x32_bf16 v[96:99], a[200:203], a[24:27], v[96:99]
ds_read_b64_tr_b16 a[224:225], v13 offset:24576
v_mfma_f32_16x16x32_bf16 v[96:99], a[204:207], a[36:39], v[96:99]
s_waitcnt lgkmcnt(5)
ds_read_b64_tr_b16 a[226:227], v13 offset:26624
v_mfma_f32_16x16x32_bf16 v[100:103], a[200:203], a[12:15], v[100:103]
v_mfma_f32_16x16x32_bf16 v[100:103], a[204:207], a[52:55], v[100:103]
v_mfma_f32_16x16x32_bf16 v[104:107], a[208:211], a[4:7], v[104:107]
buffer_load_dwordx4 a[180:183], v18, s[8:11], s46 offen offset:2048 sc1
v_mfma_f32_16x16x32_bf16 v[104:107], a[212:215], a[28:31], v[104:107]
ds_read_b64_tr_b16 a[228:229], v13 offset:28672
v_mfma_f32_16x16x32_bf16 v[108:111], a[208:211], a[20:23], v[108:111]
v_mfma_f32_16x16x32_bf16 v[108:111], a[212:215], a[32:35], v[108:111]
ds_read_b64_tr_b16 a[230:231], v13 offset:30720
v_mfma_f32_16x16x32_bf16 v[112:115], a[208:211], a[8:11], v[112:115]
buffer_load_dwordx4 a[168:171], v18, s[8:11], s46 offen offset:3072 sc1
v_mfma_f32_16x16x32_bf16 v[112:115], a[212:215], a[48:51], v[112:115]
ds_read_b64_tr_b16 a[232:233], v14 offset:24576
s_add_u32 m0, s41, 36864
v_mfma_f32_16x16x32_bf16 v[116:119], a[208:211], a[24:27], v[116:119]
s_mov_b32 s46, 4136960
ds_read_b64_tr_b16 a[234:235], v14 offset:26624
v_mfma_f32_16x16x32_bf16 v[116:119], a[212:215], a[36:39], v[116:119]
s_waitcnt lgkmcnt(6)
ds_read_b64_tr_b16 a[236:237], v14 offset:28672
v_mfma_f32_16x16x32_bf16 v[120:123], a[208:211], a[12:15], v[120:123]
buffer_load_dwordx4 v21, s[4:7], s46 offen offset:0 lds
v_mfma_f32_16x16x32_bf16 v[120:123], a[212:215], a[52:55], v[120:123]
v_mfma_f32_16x16x32_bf16 v[124:127], a[216:219], a[4:7], v[124:127]
s_mov_b32 s46, 4146176
ds_read_b64_tr_b16 a[238:239], v14 offset:30720
v_mfma_f32_16x16x32_bf16 v[124:127], a[220:223], a[28:31], v[124:127]
v_mfma_f32_16x16x32_bf16 v[128:131], a[216:219], a[20:23], v[128:131]
v_mfma_f32_16x16x32_bf16 v[128:131], a[220:223], a[32:35], v[128:131]
buffer_load_dwordx4 v21, s[4:7], s46 offen offset:1024 lds
v_mfma_f32_16x16x32_bf16 v[132:135], a[216:219], a[8:11], v[132:135]
ds_read_b64_tr_b16 a[240:241], v15 offset:24576
s_mov_b32 s46, 4155392
v_mfma_f32_16x16x32_bf16 v[132:135], a[220:223], a[48:51], v[132:135]
v_mfma_f32_16x16x32_bf16 v[136:139], a[216:219], a[24:27], v[136:139]
v_mfma_f32_16x16x32_bf16 v[136:139], a[220:223], a[36:39], v[136:139]
buffer_load_dwordx4 v21, s[4:7], s46 offen offset:2048 lds
v_mfma_f32_16x16x32_bf16 v[140:143], a[216:219], a[12:15], v[140:143]
ds_read_b64_tr_b16 a[242:243], v15 offset:26624
s_waitcnt lgkmcnt(6)
v_mfma_f32_16x16x32_bf16 v[140:143], a[220:223], a[52:55], v[140:143]
ds_read_b64_tr_b16 a[244:245], v15 offset:28672
s_mov_b32 s46, 4164608
v_mfma_f32_16x16x32_bf16 v[144:147], a[224:227], a[4:7], v[144:147]
v_mfma_f32_16x16x32_bf16 v[144:147], a[228:231], a[28:31], v[144:147]
ds_read_b64_tr_b16 a[246:247], v15 offset:30720
v_mfma_f32_16x16x32_bf16 v[148:151], a[224:227], a[20:23], v[148:151]
buffer_load_dwordx4 v21, s[4:7], s46 offen offset:3072 lds
v_mfma_f32_16x16x32_bf16 v[148:151], a[228:231], a[32:35], v[148:151]
ds_read_b64_tr_b16 a[248:249], v16 offset:24576
s_mov_b32 s46, 3321856
v_mfma_f32_16x16x32_bf16 v[152:155], a[224:227], a[8:11], v[152:155]
v_mfma_f32_16x16x32_bf16 v[152:155], a[228:231], a[48:51], v[152:155]
v_mfma_f32_16x16x32_bf16 v[156:159], a[224:227], a[24:27], v[156:159]
buffer_load_dwordx4 a[184:187], v18, s[8:11], s46 offen offset:0 sc1
v_mfma_f32_16x16x32_bf16 v[156:159], a[228:231], a[36:39], v[156:159]
ds_read_b64_tr_b16 a[250:251], v16 offset:26624
s_waitcnt lgkmcnt(6)
v_mfma_f32_16x16x32_bf16 v[160:163], a[224:227], a[12:15], v[160:163]
ds_read_b64_tr_b16 a[252:253], v16 offset:28672
s_mov_b32 s46, 3440640
v_mfma_f32_16x16x32_bf16 v[160:163], a[228:231], a[52:55], v[160:163]
v_mfma_f32_16x16x32_bf16 v[164:167], a[232:235], a[4:7], v[164:167]
ds_read_b64_tr_b16 a[254:255], v16 offset:30720
v_mfma_f32_16x16x32_bf16 v[164:167], a[236:239], a[28:31], v[164:167]
buffer_load_dwordx4 a[172:175], v18, s[8:11], s46 offen offset:0 sc1
v_mfma_f32_16x16x32_bf16 v[168:171], a[232:235], a[20:23], v[168:171]
v_mfma_f32_16x16x32_bf16 v[168:171], a[236:239], a[32:35], v[168:171]
v_mfma_f32_16x16x32_bf16 v[172:175], a[232:235], a[8:11], v[172:175]
v_mfma_f32_16x16x32_bf16 v[172:175], a[236:239], a[48:51], v[172:175]
buffer_load_dwordx4 a[188:191], v18, s[8:11], s46 offen offset:1024 sc1
v_mfma_f32_16x16x32_bf16 v[176:179], a[232:235], a[24:27], v[176:179]
v_mfma_f32_16x16x32_bf16 v[176:179], a[236:239], a[36:39], v[176:179]
s_waitcnt lgkmcnt(4)
v_mfma_f32_16x16x32_bf16 v[180:183], a[232:235], a[12:15], v[180:183]
v_mfma_f32_16x16x32_bf16 v[180:183], a[236:239], a[52:55], v[180:183]
v_mfma_f32_16x16x32_bf16 v[184:187], a[240:243], a[4:7], v[184:187]
s_waitcnt vmcnt(38) lgkmcnt(0)
s_barrier
v_mfma_f32_16x16x32_bf16 v[184:187], a[244:247], a[28:31], v[184:187]
buffer_load_dwordx4 a[76:79], v18, s[8:11], s46 offen offset:2048 sc1
v_mfma_f32_16x16x32_bf16 v[188:191], a[240:243], a[20:23], v[188:191]
ds_read_b64_tr_b16 a[192:193], v1 offset:0
v_mfma_f32_16x16x32_bf16 v[188:191], a[244:247], a[32:35], v[188:191]
ds_read_b64_tr_b16 a[194:195], v1 offset:2048
v_mfma_f32_16x16x32_bf16 v[192:195], a[240:243], a[8:11], v[192:195]
buffer_load_dwordx4 a[92:95], v18, s[8:11], s46 offen offset:3072 sc1
v_mfma_f32_16x16x32_bf16 v[192:195], a[244:247], a[48:51], v[192:195]
ds_read_b64_tr_b16 a[196:197], v1 offset:4096
s_mov_b32 s46, 3444736
v_mfma_f32_16x16x32_bf16 v[196:199], a[240:243], a[24:27], v[196:199]
ds_read_b64_tr_b16 a[198:199], v1 offset:6144
v_mfma_f32_16x16x32_bf16 v[196:199], a[244:247], a[36:39], v[196:199]
ds_read_b64_tr_b16 a[200:201], v2 offset:0
v_mfma_f32_16x16x32_bf16 v[200:203], a[240:243], a[12:15], v[200:203]
buffer_load_dwordx4 a[96:99], v18, s[8:11], s46 offen offset:0 sc1
v_mfma_f32_16x16x32_bf16 v[200:203], a[244:247], a[52:55], v[200:203]
ds_read_b64_tr_b16 a[202:203], v2 offset:2048
s_mov_b32 s46, 3563520
v_mfma_f32_16x16x32_bf16 v[204:207], a[248:251], a[4:7], v[204:207]
v_mfma_f32_16x16x32_bf16 v[204:207], a[252:255], a[28:31], v[204:207]
ds_read_b64_tr_b16 a[204:205], v2 offset:4096
v_mfma_f32_16x16x32_bf16 v[208:211], a[248:251], a[20:23], v[208:211]
v_mfma_f32_16x16x32_bf16 v[208:211], a[252:255], a[32:35], v[208:211]
buffer_load_dwordx4 a[112:115], v18, s[8:11], s46 offen offset:0 sc1
v_mfma_f32_16x16x32_bf16 v[212:215], a[248:251], a[8:11], v[212:215]
ds_read_b64_tr_b16 a[206:207], v2 offset:6144
v_mfma_f32_16x16x32_bf16 v[212:215], a[252:255], a[48:51], v[212:215]
v_mfma_f32_16x16x32_bf16 v[216:219], a[248:251], a[24:27], v[216:219]
v_mfma_f32_16x16x32_bf16 v[216:219], a[252:255], a[36:39], v[216:219]
buffer_load_dwordx4 a[100:103], v18, s[8:11], s46 offen offset:1024 sc1
v_mfma_f32_16x16x32_bf16 v[220:223], a[248:251], a[12:15], v[220:223]
s_waitcnt vmcnt(22) lgkmcnt(4)
v_mfma_f32_16x16x32_bf16 v[220:223], a[252:255], a[52:55], v[220:223]
v_mfma_f32_16x16x32_bf16 v[64:67], a[192:195], a[136:139], v[64:67]
ds_read_b64_tr_b16 a[208:209], v3 offset:0
s_mov_b32 s46, 3563520
v_mfma_f32_16x16x32_bf16 v[64:67], a[196:199], a[176:179], v[64:67]
ds_read_b64_tr_b16 a[210:211], v3 offset:2048
v_mfma_f32_16x16x32_bf16 v[68:71], a[192:195], a[152:155], v[68:71]
buffer_load_dwordx4 a[116:119], v18, s[8:11], s46 offen offset:2048 sc1
v_mfma_f32_16x16x32_bf16 v[68:71], a[196:199], a[40:43], v[68:71]
ds_read_b64_tr_b16 a[212:213], v3 offset:4096
v_mfma_f32_16x16x32_bf16 v[72:75], a[192:195], a[140:143], v[72:75]
v_mfma_f32_16x16x32_bf16 v[72:75], a[196:199], a[56:59], v[72:75]
ds_read_b64_tr_b16 a[214:215], v3 offset:6144
v_mfma_f32_16x16x32_bf16 v[76:79], a[192:195], a[156:159], v[76:79]
v_mfma_f32_16x16x32_bf16 v[76:79], a[196:199], a[44:47], v[76:79]
buffer_load_dwordx4 a[104:107], v18, s[8:11], s46 offen offset:3072 sc1
v_mfma_f32_16x16x32_bf16 v[80:83], a[192:195], a[160:163], v[80:83]
ds_read_b64_tr_b16 a[216:217], v4 offset:0
s_waitcnt lgkmcnt(5)
v_mfma_f32_16x16x32_bf16 v[80:83], a[196:199], a[60:63], v[80:83]
s_mov_b32 s46, 3567616
ds_read_b64_tr_b16 a[218:219], v4 offset:2048
v_mfma_f32_16x16x32_bf16 v[84:87], a[200:203], a[136:139], v[84:87]
v_mfma_f32_16x16x32_bf16 v[84:87], a[204:207], a[176:179], v[84:87]
buffer_load_dwordx4 a[120:123], v18, s[8:11], s46 offen offset:0 sc1
v_mfma_f32_16x16x32_bf16 v[88:91], a[200:203], a[152:155], v[88:91]
ds_read_b64_tr_b16 a[220:221], v4 offset:4096
s_mov_b32 s46, 3686400
v_mfma_f32_16x16x32_bf16 v[88:91], a[204:207], a[40:43], v[88:91]
v_mfma_f32_16x16x32_bf16 v[92:95], a[200:203], a[140:143], v[92:95]
ds_read_b64_tr_b16 a[222:223], v4 offset:6144
v_mfma_f32_16x16x32_bf16 v[92:95], a[204:207], a[56:59], v[92:95]
v_mfma_f32_16x16x32_bf16 v[96:99], a[200:203], a[156:159], v[96:99]
buffer_load_dwordx4 v[224:227], v18, s[8:11], s46 offen offset:0 sc1
v_mfma_f32_16x16x32_bf16 v[96:99], a[204:207], a[44:47], v[96:99]
ds_read_b64_tr_b16 a[224:225], v1 offset:8192
s_waitcnt lgkmcnt(5)
v_mfma_f32_16x16x32_bf16 v[100:103], a[200:203], a[160:163], v[100:103]
v_mfma_f32_16x16x32_bf16 v[100:103], a[204:207], a[60:63], v[100:103]
ds_read_b64_tr_b16 a[226:227], v1 offset:10240
v_mfma_f32_16x16x32_bf16 v[104:107], a[208:211], a[136:139], v[104:107]
v_mfma_f32_16x16x32_bf16 v[104:107], a[212:215], a[176:179], v[104:107]
buffer_load_dwordx4 v[228:231], v18, s[8:11], s46 offen offset:1024 sc1
v_mfma_f32_16x16x32_bf16 v[108:111], a[208:211], a[152:155], v[108:111]
ds_read_b64_tr_b16 a[228:229], v1 offset:12288
s_add_u32 m0, s41, 65536
v_mfma_f32_16x16x32_bf16 v[108:111], a[212:215], a[40:43], v[108:111]
ds_read_b64_tr_b16 a[230:231], v1 offset:14336
s_mov_b32 s46, 4259840
v_mfma_f32_16x16x32_bf16 v[112:115], a[208:211], a[140:143], v[112:115]
v_mfma_f32_16x16x32_bf16 v[112:115], a[212:215], a[56:59], v[112:115]
buffer_load_dwordx4 v21, s[4:7], s46 offen offset:0 lds
v_mfma_f32_16x16x32_bf16 v[116:119], a[208:211], a[156:159], v[116:119]
ds_read_b64_tr_b16 a[232:233], v2 offset:8192
s_mov_b32 s46, 4269056
v_mfma_f32_16x16x32_bf16 v[116:119], a[212:215], a[44:47], v[116:119]
s_waitcnt lgkmcnt(5)
ds_read_b64_tr_b16 a[234:235], v2 offset:10240
v_mfma_f32_16x16x32_bf16 v[120:123], a[208:211], a[160:163], v[120:123]
v_mfma_f32_16x16x32_bf16 v[120:123], a[212:215], a[60:63], v[120:123]
v_mfma_f32_16x16x32_bf16 v[124:127], a[216:219], a[136:139], v[124:127]
buffer_load_dwordx4 v21, s[4:7], s46 offen offset:1024 lds
v_mfma_f32_16x16x32_bf16 v[124:127], a[220:223], a[176:179], v[124:127]
ds_read_b64_tr_b16 a[236:237], v2 offset:12288
s_mov_b32 s46, 4278272
v_mfma_f32_16x16x32_bf16 v[128:131], a[216:219], a[152:155], v[128:131]
ds_read_b64_tr_b16 a[238:239], v2 offset:14336
v_mfma_f32_16x16x32_bf16 v[128:131], a[220:223], a[40:43], v[128:131]
v_mfma_f32_16x16x32_bf16 v[132:135], a[216:219], a[140:143], v[132:135]
ds_read_b64_tr_b16 a[240:241], v3 offset:8192
v_mfma_f32_16x16x32_bf16 v[132:135], a[220:223], a[56:59], v[132:135]
buffer_load_dwordx4 v21, s[4:7], s46 offen offset:2048 lds
v_mfma_f32_16x16x32_bf16 v[136:139], a[216:219], a[156:159], v[136:139]
v_mfma_f32_16x16x32_bf16 v[136:139], a[220:223], a[44:47], v[136:139]
ds_read_b64_tr_b16 a[242:243], v3 offset:10240
s_mov_b32 s46, 4287488
v_mfma_f32_16x16x32_bf16 v[140:143], a[216:219], a[160:163], v[140:143]
s_waitcnt lgkmcnt(6)
ds_read_b64_tr_b16 a[244:245], v3 offset:12288
v_mfma_f32_16x16x32_bf16 v[140:143], a[220:223], a[60:63], v[140:143]
v_mfma_f32_16x16x32_bf16 v[144:147], a[224:227], a[136:139], v[144:147]
buffer_load_dwordx4 v21, s[4:7], s46 offen offset:3072 lds
v_mfma_f32_16x16x32_bf16 v[144:147], a[228:231], a[176:179], v[144:147]
ds_read_b64_tr_b16 a[246:247], v3 offset:14336
s_mov_b32 s46, 3686400
v_mfma_f32_16x16x32_bf16 v[148:151], a[224:227], a[152:155], v[148:151]
v_mfma_f32_16x16x32_bf16 v[148:151], a[228:231], a[40:43], v[148:151]
ds_read_b64_tr_b16 a[248:249], v4 offset:8192
v_mfma_f32_16x16x32_bf16 v[152:155], a[224:227], a[140:143], v[152:155]
buffer_load_dwordx4 v[232:235], v18, s[8:11], s46 offen offset:2048 sc1
v_mfma_f32_16x16x32_bf16 v[152:155], a[228:231], a[56:59], v[152:155]
v_mfma_f32_16x16x32_bf16 v[156:159], a[224:227], a[156:159], v[156:159]
ds_read_b64_tr_b16 a[250:251], v4 offset:10240
v_mfma_f32_16x16x32_bf16 v[156:159], a[228:231], a[44:47], v[156:159]
s_waitcnt lgkmcnt(6)
ds_read_b64_tr_b16 a[252:253], v4 offset:12288
v_mfma_f32_16x16x32_bf16 v[160:163], a[224:227], a[160:163], v[160:163]
v_mfma_f32_16x16x32_bf16 v[160:163], a[228:231], a[60:63], v[160:163]
buffer_load_dwordx4 v[236:239], v18, s[8:11], s46 offen offset:3072 sc1
v_mfma_f32_16x16x32_bf16 v[164:167], a[232:235], a[136:139], v[164:167]
ds_read_b64_tr_b16 a[254:255], v4 offset:14336
s_mov_b32 s46, 3690496
v_mfma_f32_16x16x32_bf16 v[164:167], a[236:239], a[176:179], v[164:167]
v_mfma_f32_16x16x32_bf16 v[168:171], a[232:235], a[152:155], v[168:171]
v_mfma_f32_16x16x32_bf16 v[168:171], a[236:239], a[40:43], v[168:171]
v_mfma_f32_16x16x32_bf16 v[172:175], a[232:235], a[140:143], v[172:175]
buffer_load_dwordx4 v[240:243], v18, s[8:11], s46 offen offset:0 sc1
v_mfma_f32_16x16x32_bf16 v[172:175], a[236:239], a[56:59], v[172:175]
s_mov_b32 s46, 3809280
v_mfma_f32_16x16x32_bf16 v[176:179], a[232:235], a[156:159], v[176:179]
v_mfma_f32_16x16x32_bf16 v[176:179], a[236:239], a[44:47], v[176:179]
s_waitcnt lgkmcnt(4)
v_mfma_f32_16x16x32_bf16 v[180:183], a[232:235], a[160:163], v[180:183]
buffer_load_dwordx4 v[244:247], v18, s[8:11], s46 offen offset:0 sc1
v_mfma_f32_16x16x32_bf16 v[180:183], a[236:239], a[60:63], v[180:183]
v_mfma_f32_16x16x32_bf16 v[184:187], a[240:243], a[136:139], v[184:187]
v_mfma_f32_16x16x32_bf16 v[184:187], a[244:247], a[176:179], v[184:187]
ds_read_b64_tr_b16 a[192:193], v1 offset:16384
v_mfma_f32_16x16x32_bf16 v[188:191], a[240:243], a[152:155], v[188:191]
ds_read_b64_tr_b16 a[194:195], v1 offset:18432
v_mfma_f32_16x16x32_bf16 v[188:191], a[244:247], a[40:43], v[188:191]
buffer_load_dwordx4 v[248:251], v18, s[8:11], s46 offen offset:1024 sc1
v_mfma_f32_16x16x32_bf16 v[192:195], a[240:243], a[140:143], v[192:195]
ds_read_b64_tr_b16 a[196:197], v1 offset:20480
v_mfma_f32_16x16x32_bf16 v[192:195], a[244:247], a[56:59], v[192:195]
ds_read_b64_tr_b16 a[198:199], v1 offset:22528
v_mfma_f32_16x16x32_bf16 v[196:199], a[240:243], a[156:159], v[196:199]
v_mfma_f32_16x16x32_bf16 v[196:199], a[244:247], a[44:47], v[196:199]
ds_read_b64_tr_b16 a[200:201], v2 offset:16384
s_waitcnt lgkmcnt(5)
v_mfma_f32_16x16x32_bf16 v[200:203], a[240:243], a[160:163], v[200:203]
buffer_load_dwordx4 v[252:255], v18, s[8:11], s46 offen offset:2048 sc1
v_mfma_f32_16x16x32_bf16 v[200:203], a[244:247], a[60:63], v[200:203]
ds_read_b64_tr_b16 a[202:203], v2 offset:18432
v_mfma_f32_16x16x32_bf16 v[204:207], a[248:251], a[136:139], v[204:207]
v_mfma_f32_16x16x32_bf16 v[204:207], a[252:255], a[176:179], v[204:207]
ds_read_b64_tr_b16 a[204:205], v2 offset:20480
v_mfma_f32_16x16x32_bf16 v[208:211], a[248:251], a[152:155], v[208:211]
buffer_load_dwordx4 a[0:3], v18, s[8:11], s46 offen offset:3072 sc1
v_mfma_f32_16x16x32_bf16 v[208:211], a[252:255], a[40:43], v[208:211]
ds_read_b64_tr_b16 a[206:207], v2 offset:22528
s_mov_b32 s46, 3813376
v_mfma_f32_16x16x32_bf16 v[212:215], a[248:251], a[140:143], v[212:215]
v_mfma_f32_16x16x32_bf16 v[212:215], a[252:255], a[56:59], v[212:215]
v_mfma_f32_16x16x32_bf16 v[216:219], a[248:251], a[156:159], v[216:219]
v_mfma_f32_16x16x32_bf16 v[216:219], a[252:255], a[44:47], v[216:219]
buffer_load_dwordx4 a[16:19], v18, s[8:11], s46 offen offset:0 sc1
v_mfma_f32_16x16x32_bf16 v[220:223], a[248:251], a[160:163], v[220:223]
s_waitcnt vmcnt(24) lgkmcnt(4)
v_mfma_f32_16x16x32_bf16 v[220:223], a[252:255], a[60:63], v[220:223]
v_mfma_f32_16x16x32_bf16 v[64:67], a[192:195], a[64:67], v[64:67]
ds_read_b64_tr_b16 a[208:209], v3 offset:16384
s_mov_b32 s46, 3932160
v_mfma_f32_16x16x32_bf16 v[64:67], a[196:199], a[88:91], v[64:67]
ds_read_b64_tr_b16 a[210:211], v3 offset:18432
v_mfma_f32_16x16x32_bf16 v[68:71], a[192:195], a[80:83], v[68:71]
buffer_load_dwordx4 a[108:111], v18, s[8:11], s46 offen offset:0 sc1
v_mfma_f32_16x16x32_bf16 v[68:71], a[196:199], a[164:167], v[68:71]
ds_read_b64_tr_b16 a[212:213], v3 offset:20480
v_mfma_f32_16x16x32_bf16 v[72:75], a[192:195], a[68:71], v[72:75]
v_mfma_f32_16x16x32_bf16 v[72:75], a[196:199], a[180:183], v[72:75]
ds_read_b64_tr_b16 a[214:215], v3 offset:22528
v_mfma_f32_16x16x32_bf16 v[76:79], a[192:195], a[84:87], v[76:79]
buffer_load_dwordx4 a[124:127], v18, s[8:11], s46 offen offset:1024 sc1
v_mfma_f32_16x16x32_bf16 v[76:79], a[196:199], a[168:171], v[76:79]
ds_read_b64_tr_b16 a[216:217], v4 offset:16384
s_waitcnt lgkmcnt(5)
v_mfma_f32_16x16x32_bf16 v[80:83], a[192:195], a[72:75], v[80:83]
v_mfma_f32_16x16x32_bf16 v[80:83], a[196:199], a[184:187], v[80:83]
v_mfma_f32_16x16x32_bf16 v[84:87], a[200:203], a[64:67], v[84:87]
ds_read_b64_tr_b16 a[218:219], v4 offset:18432
v_mfma_f32_16x16x32_bf16 v[84:87], a[204:207], a[88:91], v[84:87]
buffer_load_dwordx4 a[128:131], v18, s[8:11], s46 offen offset:2048 sc1
v_mfma_f32_16x16x32_bf16 v[88:91], a[200:203], a[80:83], v[88:91]
ds_read_b64_tr_b16 a[220:221], v4 offset:20480
v_mfma_f32_16x16x32_bf16 v[88:91], a[204:207], a[164:167], v[88:91]
v_mfma_f32_16x16x32_bf16 v[92:95], a[200:203], a[68:71], v[92:95]
ds_read_b64_tr_b16 a[222:223], v4 offset:22528
v_mfma_f32_16x16x32_bf16 v[92:95], a[204:207], a[180:183], v[92:95]
buffer_load_dwordx4 a[144:147], v18, s[8:11], s46 offen offset:3072 sc1
v_mfma_f32_16x16x32_bf16 v[96:99], a[200:203], a[84:87], v[96:99]
ds_read_b64_tr_b16 a[224:225], v1 offset:24576
s_mov_b32 s46, 3936256
v_mfma_f32_16x16x32_bf16 v[96:99], a[204:207], a[168:171], v[96:99]
s_waitcnt lgkmcnt(5)
ds_read_b64_tr_b16 a[226:227], v1 offset:26624
v_mfma_f32_16x16x32_bf16 v[100:103], a[200:203], a[72:75], v[100:103]
v_mfma_f32_16x16x32_bf16 v[100:103], a[204:207], a[184:187], v[100:103]
v_mfma_f32_16x16x32_bf16 v[104:107], a[208:211], a[64:67], v[104:107]
buffer_load_dwordx4 a[132:135], v18, s[8:11], s46 offen offset:0 sc1
v_mfma_f32_16x16x32_bf16 v[104:107], a[212:215], a[88:91], v[104:107]
ds_read_b64_tr_b16 a[228:229], v1 offset:28672
s_add_u32 m0, s41, 69632
v_mfma_f32_16x16x32_bf16 v[108:111], a[208:211], a[80:83], v[108:111]
s_mov_b32 s46, 4300800
ds_read_b64_tr_b16 a[230:231], v1 offset:30720
v_mfma_f32_16x16x32_bf16 v[108:111], a[212:215], a[164:167], v[108:111]
v_mfma_f32_16x16x32_bf16 v[112:115], a[208:211], a[68:71], v[112:115]
buffer_load_dwordx4 v21, s[4:7], s46 offen offset:0 lds
v_mfma_f32_16x16x32_bf16 v[112:115], a[212:215], a[180:183], v[112:115]
ds_read_b64_tr_b16 a[232:233], v2 offset:24576
s_mov_b32 s46, 4310016
v_mfma_f32_16x16x32_bf16 v[116:119], a[208:211], a[84:87], v[116:119]
v_mfma_f32_16x16x32_bf16 v[116:119], a[212:215], a[168:171], v[116:119]
s_waitcnt lgkmcnt(5)
ds_read_b64_tr_b16 a[234:235], v2 offset:26624
v_mfma_f32_16x16x32_bf16 v[120:123], a[208:211], a[72:75], v[120:123]
buffer_load_dwordx4 v21, s[4:7], s46 offen offset:1024 lds
v_mfma_f32_16x16x32_bf16 v[120:123], a[212:215], a[184:187], v[120:123]
v_mfma_f32_16x16x32_bf16 v[124:127], a[216:219], a[64:67], v[124:127]
ds_read_b64_tr_b16 a[236:237], v2 offset:28672
s_mov_b32 s46, 4319232
v_mfma_f32_16x16x32_bf16 v[124:127], a[220:223], a[88:91], v[124:127]
v_mfma_f32_16x16x32_bf16 v[128:131], a[216:219], a[80:83], v[128:131]
ds_read_b64_tr_b16 a[238:239], v2 offset:30720
v_mfma_f32_16x16x32_bf16 v[128:131], a[220:223], a[164:167], v[128:131]
buffer_load_dwordx4 v21, s[4:7], s46 offen offset:2048 lds
v_mfma_f32_16x16x32_bf16 v[132:135], a[216:219], a[68:71], v[132:135]
ds_read_b64_tr_b16 a[240:241], v3 offset:24576
s_mov_b32 s46, 4328448
v_mfma_f32_16x16x32_bf16 v[132:135], a[220:223], a[180:183], v[132:135]
v_mfma_f32_16x16x32_bf16 v[136:139], a[216:219], a[84:87], v[136:139]
v_mfma_f32_16x16x32_bf16 v[136:139], a[220:223], a[168:171], v[136:139]
buffer_load_dwordx4 v21, s[4:7], s46 offen offset:3072 lds
v_mfma_f32_16x16x32_bf16 v[140:143], a[216:219], a[72:75], v[140:143]
ds_read_b64_tr_b16 a[242:243], v3 offset:26624
s_waitcnt lgkmcnt(6)
v_mfma_f32_16x16x32_bf16 v[140:143], a[220:223], a[184:187], v[140:143]
ds_read_b64_tr_b16 a[244:245], v3 offset:28672
s_mov_b32 s46, 4055040
v_mfma_f32_16x16x32_bf16 v[144:147], a[224:227], a[64:67], v[144:147]
v_mfma_f32_16x16x32_bf16 v[144:147], a[228:231], a[88:91], v[144:147]
ds_read_b64_tr_b16 a[246:247], v3 offset:30720
v_mfma_f32_16x16x32_bf16 v[148:151], a[224:227], a[80:83], v[148:151]
buffer_load_dwordx4 a[148:151], v18, s[8:11], s46 offen offset:0 sc1
v_mfma_f32_16x16x32_bf16 v[148:151], a[228:231], a[164:167], v[148:151]
ds_read_b64_tr_b16 a[248:249], v4 offset:24576
v_mfma_f32_16x16x32_bf16 v[152:155], a[224:227], a[68:71], v[152:155]
v_mfma_f32_16x16x32_bf16 v[152:155], a[228:231], a[180:183], v[152:155]
v_mfma_f32_16x16x32_bf16 v[156:159], a[224:227], a[84:87], v[156:159]
buffer_load_dwordx4 a[4:7], v18, s[8:11], s46 offen offset:1024 sc1
v_mfma_f32_16x16x32_bf16 v[156:159], a[228:231], a[168:171], v[156:159]
ds_read_b64_tr_b16 a[250:251], v4 offset:26624
s_waitcnt lgkmcnt(6)
v_mfma_f32_16x16x32_bf16 v[160:163], a[224:227], a[72:75], v[160:163]
ds_read_b64_tr_b16 a[252:253], v4 offset:28672
v_mfma_f32_16x16x32_bf16 v[160:163], a[228:231], a[184:187], v[160:163]
v_mfma_f32_16x16x32_bf16 v[164:167], a[232:235], a[64:67], v[164:167]
ds_read_b64_tr_b16 a[254:255], v4 offset:30720
v_mfma_f32_16x16x32_bf16 v[164:167], a[236:239], a[88:91], v[164:167]
buffer_load_dwordx4 a[20:23], v18, s[8:11], s46 offen offset:2048 sc1
v_mfma_f32_16x16x32_bf16 v[168:171], a[232:235], a[80:83], v[168:171]
v_mfma_f32_16x16x32_bf16 v[168:171], a[236:239], a[164:167], v[168:171]
v_mfma_f32_16x16x32_bf16 v[172:175], a[232:235], a[68:71], v[172:175]
v_mfma_f32_16x16x32_bf16 v[172:175], a[236:239], a[180:183], v[172:175]
buffer_load_dwordx4 a[8:11], v18, s[8:11], s46 offen offset:3072 sc1
v_mfma_f32_16x16x32_bf16 v[176:179], a[232:235], a[84:87], v[176:179]
v_mfma_f32_16x16x32_bf16 v[176:179], a[236:239], a[168:171], v[176:179]
s_waitcnt lgkmcnt(4)
s_mov_b32 s46, 4059136
v_mfma_f32_16x16x32_bf16 v[180:183], a[232:235], a[72:75], v[180:183]
v_mfma_f32_16x16x32_bf16 v[180:183], a[236:239], a[184:187], v[180:183]
v_mfma_f32_16x16x32_bf16 v[184:187], a[240:243], a[64:67], v[184:187]
s_waitcnt vmcnt(38) lgkmcnt(0)
s_barrier
v_mfma_f32_16x16x32_bf16 v[184:187], a[244:247], a[88:91], v[184:187]
buffer_load_dwordx4 a[24:27], v18, s[8:11], s46 offen offset:0 sc1
v_mfma_f32_16x16x32_bf16 v[188:191], a[240:243], a[80:83], v[188:191]
ds_read_b64_tr_b16 a[192:193], v1 offset:32768
s_mov_b32 s46, 4177920
v_mfma_f32_16x16x32_bf16 v[188:191], a[244:247], a[164:167], v[188:191]
ds_read_b64_tr_b16 a[194:195], v1 offset:34816
v_mfma_f32_16x16x32_bf16 v[192:195], a[240:243], a[68:71], v[192:195]
buffer_load_dwordx4 a[12:15], v18, s[8:11], s46 offen offset:0 sc1
v_mfma_f32_16x16x32_bf16 v[192:195], a[244:247], a[180:183], v[192:195]
ds_read_b64_tr_b16 a[196:197], v1 offset:36864
v_mfma_f32_16x16x32_bf16 v[196:199], a[240:243], a[84:87], v[196:199]
ds_read_b64_tr_b16 a[198:199], v1 offset:38912
v_mfma_f32_16x16x32_bf16 v[196:199], a[244:247], a[168:171], v[196:199]
ds_read_b64_tr_b16 a[200:201], v2 offset:32768
v_mfma_f32_16x16x32_bf16 v[200:203], a[240:243], a[72:75], v[200:203]
buffer_load_dwordx4 a[28:31], v18, s[8:11], s46 offen offset:1024 sc1
v_mfma_f32_16x16x32_bf16 v[200:203], a[244:247], a[184:187], v[200:203]
ds_read_b64_tr_b16 a[202:203], v2 offset:34816
v_mfma_f32_16x16x32_bf16 v[204:207], a[248:251], a[64:67], v[204:207]
v_mfma_f32_16x16x32_bf16 v[204:207], a[252:255], a[88:91], v[204:207]
ds_read_b64_tr_b16 a[204:205], v2 offset:36864
v_mfma_f32_16x16x32_bf16 v[208:211], a[248:251], a[80:83], v[208:211]
v_mfma_f32_16x16x32_bf16 v[208:211], a[252:255], a[164:167], v[208:211]
buffer_load_dwordx4 a[32:35], v18, s[8:11], s46 offen offset:2048 sc1
v_mfma_f32_16x16x32_bf16 v[212:215], a[248:251], a[68:71], v[212:215]
ds_read_b64_tr_b16 a[206:207], v2 offset:38912
v_mfma_f32_16x16x32_bf16 v[212:215], a[252:255], a[180:183], v[212:215]
v_mfma_f32_16x16x32_bf16 v[216:219], a[248:251], a[84:87], v[216:219]
v_mfma_f32_16x16x32_bf16 v[216:219], a[252:255], a[168:171], v[216:219]
buffer_load_dwordx4 a[48:51], v18, s[8:11], s46 offen offset:3072 sc1
v_mfma_f32_16x16x32_bf16 v[220:223], a[248:251], a[72:75], v[220:223]
s_waitcnt vmcnt(32) lgkmcnt(4)
v_mfma_f32_16x16x32_bf16 v[220:223], a[252:255], a[184:187], v[220:223]
v_mfma_f32_16x16x32_bf16 v[64:67], a[192:195], a[172:175], v[64:67]
ds_read_b64_tr_b16 a[208:209], v3 offset:32768
s_mov_b32 s46, 4182016
v_mfma_f32_16x16x32_bf16 v[64:67], a[196:199], a[112:115], v[64:67]
ds_read_b64_tr_b16 a[210:211], v3 offset:34816
s_mov_b64 s[12:13], s[66:67]
v_mfma_f32_16x16x32_bf16 v[68:71], a[192:195], a[188:191], v[68:71]
buffer_load_dwordx4 a[36:39], v18, s[8:11], s46 offen offset:0 sc1
v_mfma_f32_16x16x32_bf16 v[68:71], a[196:199], a[100:103], v[68:71]
ds_read_b64_tr_b16 a[212:213], v3 offset:36864
s_mov_b32 s14, 202304
v_mfma_f32_16x16x32_bf16 v[72:75], a[192:195], a[76:79], v[72:75]
ds_read_b64_tr_b16 a[214:215], v3 offset:38912
s_mov_b32 s15, 0x20000
v_mfma_f32_16x16x32_bf16 v[72:75], a[196:199], a[116:119], v[72:75]
s_add_u32 s20, s68, 49283072
s_addc_u32 s21, s69, 0
v_mfma_f32_16x16x32_bf16 v[76:79], a[192:195], a[92:95], v[76:79]
s_mov_b32 s46, 4300800
s_mov_b32 s22, 14745600
v_mfma_f32_16x16x32_bf16 v[76:79], a[196:199], a[104:107], v[76:79]
buffer_load_dwordx4 a[52:55], v18, s[8:11], s46 offen offset:0 sc1
v_mfma_f32_16x16x32_bf16 v[80:83], a[192:195], a[96:99], v[80:83]
ds_read_b64_tr_b16 a[216:217], v4 offset:32768
s_waitcnt lgkmcnt(5)
v_mfma_f32_16x16x32_bf16 v[80:83], a[196:199], a[120:123], v[80:83]
s_mov_b32 s23, 0x20000
s_lshl2_add_u32 s88, s53, s52
v_mfma_f32_16x16x32_bf16 v[84:87], a[200:203], a[172:175], v[84:87]
ds_read_b64_tr_b16 a[218:219], v4 offset:34816
s_mul_i32 s32, s88, 15360
v_mfma_f32_16x16x32_bf16 v[84:87], a[204:207], a[112:115], v[84:87]
buffer_load_dwordx4 a[136:139], v18, s[8:11], s46 offen offset:1024 sc1
v_mfma_f32_16x16x32_bf16 v[88:91], a[200:203], a[188:191], v[88:91]
ds_read_b64_tr_b16 a[220:221], v4 offset:36864
s_xor_b32 s89, s88, 32
v_mfma_f32_16x16x32_bf16 v[88:91], a[204:207], a[100:103], v[88:91]
s_mul_i32 s33, s89, 15360
ds_read_b64_tr_b16 a[222:223], v4 offset:38912
v_mfma_f32_16x16x32_bf16 v[92:95], a[200:203], a[76:79], v[92:95]
s_xor_b32 s89, s88, 4
ds_read_b64_tr_b16 a[224:225], v1 offset:40960
v_mfma_f32_16x16x32_bf16 v[92:95], a[204:207], a[116:119], v[92:95]
v_mfma_f32_16x16x32_bf16 v[96:99], a[200:203], a[92:95], v[96:99]
buffer_load_dwordx4 a[152:155], v18, s[8:11], s46 offen offset:2048 sc1
v_mfma_f32_16x16x32_bf16 v[96:99], a[204:207], a[104:107], v[96:99]
s_mul_i32 s34, s89, 15360
s_xor_b32 s89, s88, 36
v_mfma_f32_16x16x32_bf16 v[100:103], a[200:203], a[96:99], v[100:103]
s_waitcnt lgkmcnt(5)
s_mul_i32 s35, s89, 15360
v_mfma_f32_16x16x32_bf16 v[100:103], a[204:207], a[120:123], v[100:103]
ds_read_b64_tr_b16 a[226:227], v1 offset:43008
s_mul_i32 s88, s52, 5120
v_mfma_f32_16x16x32_bf16 v[104:107], a[208:211], a[172:175], v[104:107]
v_mfma_f32_16x16x32_bf16 v[104:107], a[212:215], a[112:115], v[104:107]
buffer_load_dwordx4 a[140:143], v18, s[8:11], s46 offen offset:3072 sc1
v_mfma_f32_16x16x32_bf16 v[108:111], a[208:211], a[188:191], v[108:111]
ds_read_b64_tr_b16 a[228:229], v1 offset:45056
s_add_u32 s88, s88, 131072
v_mfma_f32_16x16x32_bf16 v[108:111], a[212:215], a[100:103], v[108:111]
ds_read_b64_tr_b16 a[230:231], v1 offset:47104
s_add_u32 m0, s41, 0
v_mfma_f32_16x16x32_bf16 v[112:115], a[208:211], a[76:79], v[112:115]
s_mov_b32 s46, 4423680
v_add_u32 v12, s88, v18
v_mfma_f32_16x16x32_bf16 v[112:115], a[212:215], a[116:119], v[112:115]
buffer_load_dwordx4 v21, s[4:7], s46 offen offset:0 lds
v_mfma_f32_16x16x32_bf16 v[116:119], a[208:211], a[92:95], v[116:119]
ds_read_b64_tr_b16 a[232:233], v2 offset:40960
v_and_b32 v5, 15, v0
v_mfma_f32_16x16x32_bf16 v[116:119], a[212:215], a[104:107], v[116:119]
ds_read_b64_tr_b16 a[234:235], v2 offset:43008
v_lshrrev_b32 v6, 4, v0
v_mfma_f32_16x16x32_bf16 v[120:123], a[208:211], a[96:99], v[120:123]
ds_read_b64_tr_b16 a[236:237], v2 offset:45056
s_waitcnt lgkmcnt(7)
v_mfma_f32_16x16x32_bf16 v[120:123], a[212:215], a[120:123], v[120:123]
s_mov_b32 s46, 4432896
v_lshl_add_u32 v7, v5, 2, v6
v_mfma_f32_16x16x32_bf16 v[124:127], a[216:219], a[172:175], v[124:127]
buffer_load_dwordx4 v21, s[4:7], s46 offen offset:1024 lds
v_mfma_f32_16x16x32_bf16 v[124:127], a[220:223], a[112:115], v[124:127]
ds_read_b64_tr_b16 a[238:239], v2 offset:47104
v_lshlrev_b32 v7, 4, v7
v_mfma_f32_16x16x32_bf16 v[128:131], a[216:219], a[188:191], v[128:131]
ds_read_b64_tr_b16 a[240:241], v3 offset:40960
v_add_u32 v17, s88, v7
v_mfma_f32_16x16x32_bf16 v[128:131], a[220:223], a[100:103], v[128:131]
s_mov_b32 s46, 4442112
v_lshlrev_b32 v6, 2, v6
v_mfma_f32_16x16x32_bf16 v[132:135], a[216:219], a[76:79], v[132:135]
v_sub_u32 v5, v5, v6
v_and_b32 v6, 1, v5
v_mfma_f32_16x16x32_bf16 v[132:135], a[220:223], a[116:119], v[132:135]
buffer_load_dwordx4 v21, s[4:7], s46 offen offset:2048 lds
v_mfma_f32_16x16x32_bf16 v[136:139], a[216:219], a[92:95], v[136:139]
ds_read_b64_tr_b16 a[242:243], v3 offset:43008
v_lshlrev_b32 v6, 4, v6
v_mfma_f32_16x16x32_bf16 v[136:139], a[220:223], a[104:107], v[136:139]
v_mov_b32 v7, 0x3f80
v_lshlrev_b32 v6, v6, v7
v_mfma_f32_16x16x32_bf16 v[140:143], a[216:219], a[96:99], v[140:143]
s_mov_b32 s46, 4451328
s_waitcnt lgkmcnt(6)
v_mfma_f32_16x16x32_bf16 v[140:143], a[220:223], a[120:123], v[140:143]
ds_read_b64_tr_b16 a[244:245], v3 offset:45056
v_lshrrev_b32 v5, 1, v5
v_mfma_f32_16x16x32_bf16 v[144:147], a[224:227], a[172:175], v[144:147]
buffer_load_dwordx4 v21, s[4:7], s46 offen offset:3072 lds
v_mfma_f32_16x16x32_bf16 v[144:147], a[228:231], a[112:115], v[144:147]
ds_read_b64_tr_b16 a[246:247], v3 offset:47104
v_cmp_eq_u32 s[84:85], 0, v5
v_mfma_f32_16x16x32_bf16 v[148:151], a[224:227], a[188:191], v[148:151]
s_mov_b32 s46, 4304896
v_cmp_eq_u32 s[86:87], 1, v5
v_mfma_f32_16x16x32_bf16 v[148:151], a[228:231], a[100:103], v[148:151]
ds_read_b64_tr_b16 a[248:249], v4 offset:40960
v_mov_b32 v34, 0
v_mfma_f32_16x16x32_bf16 v[152:155], a[224:227], a[76:79], v[152:155]
buffer_load_dwordx4 a[156:159], v18, s[8:11], s46 offen offset:0 sc1
v_mfma_f32_16x16x32_bf16 v[152:155], a[228:231], a[116:119], v[152:155]
v_mov_b32 v35, 0
v_cndmask_b32 v32, 0, v6, s[84:85]
v_mfma_f32_16x16x32_bf16 v[156:159], a[224:227], a[92:95], v[156:159]
ds_read_b64_tr_b16 a[250:251], v4 offset:43008
s_mov_b32 s46, 4423680
v_mfma_f32_16x16x32_bf16 v[156:159], a[228:231], a[104:107], v[156:159]
v_cndmask_b32 v33, 0, v6, s[86:87]
s_waitcnt lgkmcnt(6)
v_mfma_f32_16x16x32_bf16 v[160:163], a[224:227], a[96:99], v[160:163]
ds_read_b64_tr_b16 a[252:253], v4 offset:45056
v_mov_b32 v36, 0
v_mfma_f32_16x16x32_bf16 v[160:163], a[228:231], a[120:123], v[160:163]
buffer_load_dwordx4 a[160:163], v18, s[8:11], s46 offen offset:0 sc1
v_mfma_f32_16x16x32_bf16 v[164:167], a[232:235], a[172:175], v[164:167]
ds_read_b64_tr_b16 a[254:255], v4 offset:47104
v_mov_b32 v37, 0
v_mfma_f32_16x16x32_bf16 v[164:167], a[236:239], a[112:115], v[164:167]
v_mov_b32 v38, v32
v_mov_b32 v39, v33
v_mfma_f32_16x16x32_bf16 v[168:171], a[232:235], a[188:191], v[168:171]
v_mfma_f32_16x16x32_bf16 v[168:171], a[236:239], a[100:103], v[168:171]
v_lshrrev_b32 v5, 2, v0
v_and_b32 v6, 3, v0
v_mfma_f32_16x16x32_bf16 v[172:175], a[232:235], a[76:79], v[172:175]
buffer_load_dwordx4 a[176:179], v18, s[8:11], s46 offen offset:1024 sc1
v_mfma_f32_16x16x32_bf16 v[172:175], a[236:239], a[116:119], v[172:175]
v_mfma_f32_16x16x32_bf16 v[176:179], a[232:235], a[92:95], v[176:179]
v_mul_u32_u24 v10, 2560, v5
v_lshl_add_u32 v10, v6, 4, v10
v_mfma_f32_16x16x32_bf16 v[176:179], a[236:239], a[104:107], v[176:179]
s_waitcnt lgkmcnt(4)
v_min_u32 v6, 2, v0
v_mfma_f32_16x16x32_bf16 v[180:183], a[232:235], a[96:99], v[180:183]
buffer_load_dwordx4 a[40:43], v18, s[8:11], s46 offen offset:2048 sc1
v_mfma_f32_16x16x32_bf16 v[180:183], a[236:239], a[120:123], v[180:183]
v_mfma_f32_16x16x32_bf16 v[184:187], a[240:243], a[172:175], v[184:187]
v_add_u32 v6, 1, v6
v_and_b32 v5, 1, v6
v_mfma_f32_16x16x32_bf16 v[184:187], a[244:247], a[112:115], v[184:187]
ds_read_b64_tr_b16 a[192:193], v1 offset:49152
v_lshrrev_b32 v6, 1, v6
v_mfma_f32_16x16x32_bf16 v[188:191], a[240:243], a[188:191], v[188:191]
ds_read_b64_tr_b16 a[194:195], v1 offset:51200
v_lshl_or_b32 v5, v5, 3, v6
v_mfma_f32_16x16x32_bf16 v[188:191], a[244:247], a[100:103], v[188:191]
buffer_load_dwordx4 a[56:59], v18, s[8:11], s46 offen offset:3072 sc1
v_mfma_f32_16x16x32_bf16 v[192:195], a[240:243], a[76:79], v[192:195]
ds_read_b64_tr_b16 a[196:197], v1 offset:53248
s_mov_b32 s46, 4427776
v_mfma_f32_16x16x32_bf16 v[192:195], a[244:247], a[116:119], v[192:195]
ds_read_b64_tr_b16 a[198:199], v1 offset:55296
v_xor_b32 v5, s53, v5
v_mfma_f32_16x16x32_bf16 v[196:199], a[240:243], a[92:95], v[196:199]
ds_read_b64_tr_b16 a[200:201], v2 offset:49152
v_lshlrev_b32 v11, 7, v5
v_mfma_f32_16x16x32_bf16 v[196:199], a[244:247], a[104:107], v[196:199]
s_waitcnt lgkmcnt(5)
ds_read_b64_tr_b16 a[202:203], v2 offset:51200
v_mfma_f32_16x16x32_bf16 v[200:203], a[240:243], a[96:99], v[200:203]
buffer_load_dwordx4 a[44:47], v18, s[8:11], s46 offen offset:0 sc1
v_mfma_f32_16x16x32_bf16 v[200:203], a[244:247], a[120:123], v[200:203]
s_mov_b32 s46, 4546560
v_min_u32 v6, 2, v0
v_mfma_f32_16x16x32_bf16 v[204:207], a[248:251], a[172:175], v[204:207]
v_lshl_add_u32 v11, v6, 2, v11
s_add_u32 s34, s34, 5120
v_mfma_f32_16x16x32_bf16 v[204:207], a[252:255], a[112:115], v[204:207]
ds_read_b64_tr_b16 a[204:205], v2 offset:53248
s_add_u32 s35, s35, 10240
v_mfma_f32_16x16x32_bf16 v[208:211], a[248:251], a[188:191], v[208:211]
buffer_load_dwordx4 a[60:63], v18, s[8:11], s46 offen offset:0 sc1
v_mfma_f32_16x16x32_bf16 v[208:211], a[252:255], a[100:103], v[208:211]
ds_read_b64_tr_b16 a[206:207], v2 offset:55296
s_mov_b32 s40, 0
v_mfma_f32_16x16x32_bf16 v[212:215], a[248:251], a[76:79], v[212:215]
s_lshl_b32 s55, s53, 7
v_mfma_f32_16x16x32_bf16 v[212:215], a[252:255], a[116:119], v[212:215]
s_cmp_eq_u32 s52, 0
s_cselect_b32 s55, s55, 0x10000
v_mfma_f32_16x16x32_bf16 v[216:219], a[248:251], a[92:95], v[216:219]
v_mfma_f32_16x16x32_bf16 v[216:219], a[252:255], a[104:107], v[216:219]
buffer_load_dwordx4 a[64:67], v18, s[8:11], s46 offen offset:1024 sc1
v_mfma_f32_16x16x32_bf16 v[220:223], a[248:251], a[96:99], v[220:223]
s_waitcnt vmcnt(35) lgkmcnt(4)
v_mfma_f32_16x16x32_bf16 v[220:223], a[252:255], a[120:123], v[220:223]
v_mfma_f32_16x16x32_bf16 v[64:67], a[192:195], v[224:227], v[64:67]
ds_read_b64_tr_b16 a[208:209], v3 offset:49152
v_mfma_f32_16x16x32_bf16 v[64:67], a[196:199], v[244:247], v[64:67]
ds_read_b64_tr_b16 a[210:211], v3 offset:51200
v_mfma_f32_16x16x32_bf16 v[68:71], a[192:195], v[228:231], v[68:71]
global_load_dword v30, v[28:29], off
v_mfma_f32_16x16x32_bf16 v[68:71], a[196:199], v[248:251], v[68:71]
ds_read_b64_tr_b16 a[212:213], v3 offset:53248
s_mov_b32 s46, 4546560
v_mfma_f32_16x16x32_bf16 v[72:75], a[192:195], v[232:235], v[72:75]
v_mfma_f32_16x16x32_bf16 v[72:75], a[196:199], v[252:255], v[72:75]
ds_read_b64_tr_b16 a[214:215], v3 offset:55296
v_mfma_f32_16x16x32_bf16 v[76:79], a[192:195], v[236:239], v[76:79]
buffer_load_dwordx4 a[80:83], v18, s[8:11], s46 offen offset:2048 sc1
v_mfma_f32_16x16x32_bf16 v[76:79], a[196:199], a[0:3], v[76:79]
ds_read_b64_tr_b16 a[216:217], v4 offset:49152
s_waitcnt lgkmcnt(5)
v_mfma_f32_16x16x32_bf16 v[80:83], a[192:195], v[240:243], v[80:83]
v_mfma_f32_16x16x32_bf16 v[80:83], a[196:199], a[16:19], v[80:83]
v_mfma_f32_16x16x32_bf16 v[84:87], a[200:203], v[224:227], v[84:87]
ds_read_b64_tr_b16 a[218:219], v4 offset:51200
v_mfma_f32_16x16x32_bf16 v[84:87], a[204:207], v[244:247], v[84:87]
buffer_load_dwordx4 a[68:71], v18, s[8:11], s46 offen offset:3072 sc1
v_mfma_f32_16x16x32_bf16 v[88:91], a[200:203], v[228:231], v[88:91]
ds_read_b64_tr_b16 a[220:221], v4 offset:53248
s_mov_b32 s46, 4550656
v_mfma_f32_16x16x32_bf16 v[88:91], a[204:207], v[248:251], v[88:91]
v_mfma_f32_16x16x32_bf16 v[92:95], a[200:203], v[232:235], v[92:95]
ds_read_b64_tr_b16 a[222:223], v4 offset:55296
v_mfma_f32_16x16x32_bf16 v[92:95], a[204:207], v[252:255], v[92:95]
buffer_load_dwordx4 a[84:87], v18, s[8:11], s46 offen offset:0 sc1
v_mfma_f32_16x16x32_bf16 v[96:99], a[200:203], v[236:239], v[96:99]
ds_read_b64_tr_b16 a[224:225], v1 offset:57344
s_mov_b32 s46, 4669440
v_mfma_f32_16x16x32_bf16 v[96:99], a[204:207], a[0:3], v[96:99]
s_waitcnt lgkmcnt(5)
ds_read_b64_tr_b16 a[226:227], v1 offset:59392
v_mfma_f32_16x16x32_bf16 v[100:103], a[200:203], v[240:243], v[100:103]
v_mfma_f32_16x16x32_bf16 v[100:103], a[204:207], a[16:19], v[100:103]
v_mfma_f32_16x16x32_bf16 v[104:107], a[208:211], v[224:227], v[104:107]
buffer_load_dwordx4 a[72:75], v18, s[8:11], s46 offen offset:0 sc1
v_mfma_f32_16x16x32_bf16 v[104:107], a[212:215], v[244:247], v[104:107]
ds_read_b64_tr_b16 a[228:229], v1 offset:61440
v_mfma_f32_16x16x32_bf16 v[108:111], a[208:211], v[228:231], v[108:111]
v_mfma_f32_16x16x32_bf16 v[108:111], a[212:215], v[248:251], v[108:111]
ds_read_b64_tr_b16 a[230:231], v1 offset:63488
v_mfma_f32_16x16x32_bf16 v[112:115], a[208:211], v[232:235], v[112:115]
buffer_load_dwordx4 a[88:91], v18, s[8:11], s46 offen offset:1024 sc1
v_mfma_f32_16x16x32_bf16 v[112:115], a[212:215], v[252:255], v[112:115]
ds_read_b64_tr_b16 a[232:233], v2 offset:57344
s_add_u32 m0, s41, 4096
v_mfma_f32_16x16x32_bf16 v[116:119], a[208:211], v[236:239], v[116:119]
s_mov_b32 s46, 4464640
ds_read_b64_tr_b16 a[234:235], v2 offset:59392
v_mfma_f32_16x16x32_bf16 v[116:119], a[212:215], a[0:3], v[116:119]
s_waitcnt lgkmcnt(6)
ds_read_b64_tr_b16 a[236:237], v2 offset:61440
v_mfma_f32_16x16x32_bf16 v[120:123], a[208:211], v[240:243], v[120:123]
buffer_load_dwordx4 v21, s[4:7], s46 offen offset:0 lds
v_mfma_f32_16x16x32_bf16 v[120:123], a[212:215], a[16:19], v[120:123]
v_mfma_f32_16x16x32_bf16 v[124:127], a[216:219], v[224:227], v[124:127]
s_mov_b32 s46, 4473856
ds_read_b64_tr_b16 a[238:239], v2 offset:63488
v_mfma_f32_16x16x32_bf16 v[124:127], a[220:223], v[244:247], v[124:127]
v_mfma_f32_16x16x32_bf16 v[128:131], a[216:219], v[228:231], v[128:131]
v_mfma_f32_16x16x32_bf16 v[128:131], a[220:223], v[248:251], v[128:131]
buffer_load_dwordx4 v21, s[4:7], s46 offen offset:1024 lds
v_mfma_f32_16x16x32_bf16 v[132:135], a[216:219], v[232:235], v[132:135]
ds_read_b64_tr_b16 a[240:241], v3 offset:57344
s_mov_b32 s46, 4483072
v_mfma_f32_16x16x32_bf16 v[132:135], a[220:223], v[252:255], v[132:135]
v_mfma_f32_16x16x32_bf16 v[136:139], a[216:219], v[236:239], v[136:139]
v_mfma_f32_16x16x32_bf16 v[136:139], a[220:223], a[0:3], v[136:139]
buffer_load_dwordx4 v21, s[4:7], s46 offen offset:2048 lds
v_mfma_f32_16x16x32_bf16 v[140:143], a[216:219], v[240:243], v[140:143]
ds_read_b64_tr_b16 a[242:243], v3 offset:59392
s_waitcnt lgkmcnt(6)
v_mfma_f32_16x16x32_bf16 v[140:143], a[220:223], a[16:19], v[140:143]
ds_read_b64_tr_b16 a[244:245], v3 offset:61440
s_mov_b32 s46, 4492288
v_mfma_f32_16x16x32_bf16 v[144:147], a[224:227], v[224:227], v[144:147]
v_mfma_f32_16x16x32_bf16 v[144:147], a[228:231], v[244:247], v[144:147]
ds_read_b64_tr_b16 a[246:247], v3 offset:63488
v_mfma_f32_16x16x32_bf16 v[148:151], a[224:227], v[228:231], v[148:151]
buffer_load_dwordx4 v21, s[4:7], s46 offen offset:3072 lds
v_mfma_f32_16x16x32_bf16 v[148:151], a[228:231], v[248:251], v[148:151]
ds_read_b64_tr_b16 a[248:249], v4 offset:57344
s_mov_b32 s46, 4669440
v_mfma_f32_16x16x32_bf16 v[152:155], a[224:227], v[232:235], v[152:155]
v_mfma_f32_16x16x32_bf16 v[152:155], a[228:231], v[252:255], v[152:155]
v_mfma_f32_16x16x32_bf16 v[156:159], a[224:227], v[236:239], v[156:159]
buffer_load_dwordx4 a[164:167], v18, s[8:11], s46 offen offset:2048 sc1
v_mfma_f32_16x16x32_bf16 v[156:159], a[228:231], a[0:3], v[156:159]
ds_read_b64_tr_b16 a[250:251], v4 offset:59392
s_waitcnt lgkmcnt(6)
v_mfma_f32_16x16x32_bf16 v[160:163], a[224:227], v[240:243], v[160:163]
ds_read_b64_tr_b16 a[252:253], v4 offset:61440
v_mfma_f32_16x16x32_bf16 v[160:163], a[228:231], a[16:19], v[160:163]
v_mfma_f32_16x16x32_bf16 v[164:167], a[232:235], v[224:227], v[164:167]
ds_read_b64_tr_b16 a[254:255], v4 offset:63488
v_mfma_f32_16x16x32_bf16 v[164:167], a[236:239], v[244:247], v[164:167]
buffer_load_dwordx4 a[180:183], v18, s[8:11], s46 offen offset:3072 sc1
v_mfma_f32_16x16x32_bf16 v[168:171], a[232:235], v[228:231], v[168:171]
s_mov_b32 s46, 4673536
v_mfma_f32_16x16x32_bf16 v[168:171], a[236:239], v[248:251], v[168:171]
v_mfma_f32_16x16x32_bf16 v[172:175], a[232:235], v[232:235], v[172:175]
v_mfma_f32_16x16x32_bf16 v[172:175], a[236:239], v[252:255], v[172:175]
buffer_load_dwordx4 a[168:171], v18, s[8:11], s46 offen offset:0 sc1
v_mfma_f32_16x16x32_bf16 v[176:179], a[232:235], v[236:239], v[176:179]
v_mfma_f32_16x16x32_bf16 v[176:179], a[236:239], a[0:3], v[176:179]
s_waitcnt lgkmcnt(4)
s_mov_b32 s46, 4792320
v_mfma_f32_16x16x32_bf16 v[180:183], a[232:235], v[240:243], v[180:183]
v_mfma_f32_16x16x32_bf16 v[180:183], a[236:239], a[16:19], v[180:183]
v_mfma_f32_16x16x32_bf16 v[184:187], a[240:243], v[224:227], v[184:187]
s_waitcnt vmcnt(39) lgkmcnt(0)
s_barrier
v_mfma_f32_16x16x32_bf16 v[184:187], a[244:247], v[244:247], v[184:187]
buffer_load_dwordx4 a[184:187], v18, s[8:11], s46 offen offset:0 sc1
v_mfma_f32_16x16x32_bf16 v[188:191], a[240:243], v[228:231], v[188:191]
ds_read_b64_tr_b16 a[192:193], v13 offset:0
v_mfma_f32_16x16x32_bf16 v[188:191], a[244:247], v[248:251], v[188:191]
ds_read_b64_tr_b16 a[194:195], v13 offset:2048
v_mfma_f32_16x16x32_bf16 v[192:195], a[240:243], v[232:235], v[192:195]
buffer_load_dwordx4 a[172:175], v18, s[8:11], s46 offen offset:1024 sc1
v_mfma_f32_16x16x32_bf16 v[192:195], a[244:247], v[252:255], v[192:195]
ds_read_b64_tr_b16 a[196:197], v13 offset:4096
v_mfma_f32_16x16x32_bf16 v[196:199], a[240:243], v[236:239], v[196:199]
ds_read_b64_tr_b16 a[198:199], v13 offset:6144
v_mfma_f32_16x16x32_bf16 v[196:199], a[244:247], a[0:3], v[196:199]
ds_read_b64_tr_b16 a[200:201], v14 offset:0
v_mfma_f32_16x16x32_bf16 v[200:203], a[240:243], v[240:243], v[200:203]
buffer_load_dwordx4 a[188:191], v18, s[8:11], s46 offen offset:2048 sc1
v_mfma_f32_16x16x32_bf16 v[200:203], a[244:247], a[16:19], v[200:203]
ds_read_b64_tr_b16 a[202:203], v14 offset:2048
v_mfma_f32_16x16x32_bf16 v[204:207], a[248:251], v[224:227], v[204:207]
v_mfma_f32_16x16x32_bf16 v[204:207], a[252:255], v[244:247], v[204:207]
ds_read_b64_tr_b16 a[204:205], v14 offset:4096
v_mfma_f32_16x16x32_bf16 v[208:211], a[248:251], v[228:231], v[208:211]
v_mfma_f32_16x16x32_bf16 v[208:211], a[252:255], v[248:251], v[208:211]
buffer_load_dwordx4 a[76:79], v18, s[8:11], s46 offen offset:3072 sc1
v_mfma_f32_16x16x32_bf16 v[212:215], a[248:251], v[232:235], v[212:215]
ds_read_b64_tr_b16 a[206:207], v14 offset:6144
s_mov_b32 s46, 4796416
v_mfma_f32_16x16x32_bf16 v[212:215], a[252:255], v[252:255], v[212:215]
v_mfma_f32_16x16x32_bf16 v[216:219], a[248:251], v[236:239], v[216:219]
v_mfma_f32_16x16x32_bf16 v[216:219], a[252:255], a[0:3], v[216:219]
buffer_load_dwordx4 a[92:95], v18, s[8:11], s46 offen offset:0 sc1
v_mfma_f32_16x16x32_bf16 v[220:223], a[248:251], v[240:243], v[220:223]
s_waitcnt vmcnt(39) lgkmcnt(4)
v_mfma_f32_16x16x32_bf16 v[220:223], a[252:255], a[16:19], v[220:223]
v_mfma_f32_16x16x32_bf16 v[64:67], a[192:195], a[108:111], v[64:67]
s_mov_b32 s46, 4915200
ds_read_b64_tr_b16 a[208:209], v15 offset:0
v_mfma_f32_16x16x32_bf16 v[64:67], a[196:199], a[148:151], v[64:67]
buffer_load_dwordx4 a[96:99], v18, s[8:11], s46 offen offset:0 sc1
v_mfma_f32_16x16x32_bf16 v[68:71], a[192:195], a[124:127], v[68:71]
ds_read_b64_tr_b16 a[210:211], v15 offset:2048
v_mfma_f32_16x16x32_bf16 v[68:71], a[196:199], a[4:7], v[68:71]
ds_read_b64_tr_b16 a[212:213], v15 offset:4096
v_mfma_f32_16x16x32_bf16 v[72:75], a[192:195], a[128:131], v[72:75]
v_mfma_f32_16x16x32_bf16 v[72:75], a[196:199], a[20:23], v[72:75]
buffer_load_dwordx4 a[112:115], v18, s[8:11], s46 offen offset:1024 sc1
v_mfma_f32_16x16x32_bf16 v[76:79], a[192:195], a[144:147], v[76:79]
ds_read_b64_tr_b16 a[214:215], v15 offset:6144
v_mfma_f32_16x16x32_bf16 v[76:79], a[196:199], a[8:11], v[76:79]
ds_read_b64_tr_b16 a[216:217], v16 offset:0
s_waitcnt lgkmcnt(5)
v_mfma_f32_16x16x32_bf16 v[80:83], a[192:195], a[132:135], v[80:83]
v_mfma_f32_16x16x32_bf16 v[80:83], a[196:199], a[24:27], v[80:83]
buffer_load_dwordx4 a[100:103], v18, s[8:11], s46 offen offset:2048 sc1
v_mfma_f32_16x16x32_bf16 v[84:87], a[200:203], a[108:111], v[84:87]
ds_read_b64_tr_b16 a[218:219], v16 offset:2048
v_mfma_f32_16x16x32_bf16 v[84:87], a[204:207], a[148:151], v[84:87]
v_mfma_f32_16x16x32_bf16 v[88:91], a[200:203], a[124:127], v[88:91]
ds_read_b64_tr_b16 a[220:221], v16 offset:4096
v_mfma_f32_16x16x32_bf16 v[88:91], a[204:207], a[4:7], v[88:91]
buffer_load_dwordx4 a[116:119], v18, s[8:11], s46 offen offset:3072 sc1
v_mfma_f32_16x16x32_bf16 v[92:95], a[200:203], a[128:131], v[92:95]
ds_read_b64_tr_b16 a[222:223], v16 offset:6144
s_mov_b32 s46, 4919296
v_mfma_f32_16x16x32_bf16 v[92:95], a[204:207], a[20:23], v[92:95]
v_mfma_f32_16x16x32_bf16 v[96:99], a[200:203], a[144:147], v[96:99]
ds_read_b64_tr_b16 a[224:225], v13 offset:8192
v_mfma_f32_16x16x32_bf16 v[96:99], a[204:207], a[8:11], v[96:99]
buffer_load_dwordx4 a[104:107], v18, s[8:11], s46 offen offset:0 sc1
v_mfma_f32_16x16x32_bf16 v[100:103], a[200:203], a[132:135], v[100:103]
s_add_u32 m0, s41, 32768
s_waitcnt lgkmcnt(5)
v_mfma_f32_16x16x32_bf16 v[100:103], a[204:207], a[24:27], v[100:103]
s_mov_b32 s46, 4587520
ds_read_b64_tr_b16 a[226:227], v13 offset:10240
v_mfma_f32_16x16x32_bf16 v[104:107], a[208:211], a[108:111], v[104:107]
buffer_load_dwordx4 v21, s[4:7], s46 offen offset:0 lds
v_mfma_f32_16x16x32_bf16 v[104:107], a[212:215], a[148:151], v[104:107]
ds_read_b64_tr_b16 a[228:229], v13 offset:12288
s_mov_b32 s46, 4596736
v_mfma_f32_16x16x32_bf16 v[108:111], a[208:211], a[124:127], v[108:111]
v_mfma_f32_16x16x32_bf16 v[108:111], a[212:215], a[4:7], v[108:111]
ds_read_b64_tr_b16 a[230:231], v13 offset:14336
v_mfma_f32_16x16x32_bf16 v[112:115], a[208:211], a[128:131], v[112:115]
buffer_load_dwordx4 v21, s[4:7], s46 offen offset:1024 lds
v_mfma_f32_16x16x32_bf16 v[112:115], a[212:215], a[20:23], v[112:115]
ds_read_b64_tr_b16 a[232:233], v14 offset:8192
s_mov_b32 s46, 4605952
v_mfma_f32_16x16x32_bf16 v[116:119], a[208:211], a[144:147], v[116:119]
v_mfma_f32_16x16x32_bf16 v[116:119], a[212:215], a[8:11], v[116:119]
s_waitcnt lgkmcnt(5)
ds_read_b64_tr_b16 a[234:235], v14 offset:10240
v_mfma_f32_16x16x32_bf16 v[120:123], a[208:211], a[132:135], v[120:123]
buffer_load_dwordx4 v21, s[4:7], s46 offen offset:2048 lds
v_mfma_f32_16x16x32_bf16 v[120:123], a[212:215], a[24:27], v[120:123]
s_mov_b32 s46, 4615168
ds_read_b64_tr_b16 a[236:237], v14 offset:12288
v_mfma_f32_16x16x32_bf16 v[124:127], a[216:219], a[108:111], v[124:127]
v_mfma_f32_16x16x32_bf16 v[124:127], a[220:223], a[148:151], v[124:127]
v_mfma_f32_16x16x32_bf16 v[128:131], a[216:219], a[124:127], v[128:131]
buffer_load_dwordx4 v21, s[4:7], s46 offen offset:3072 lds
v_mfma_f32_16x16x32_bf16 v[128:131], a[220:223], a[4:7], v[128:131]
ds_read_b64_tr_b16 a[238:239], v14 offset:14336
s_add_u32 m0, s41, 36864
v_mfma_f32_16x16x32_bf16 v[132:135], a[216:219], a[128:131], v[132:135]
ds_read_b64_tr_b16 a[240:241], v15 offset:8192
s_mov_b32 s46, 4628480
v_mfma_f32_16x16x32_bf16 v[132:135], a[220:223], a[20:23], v[132:135]
v_mfma_f32_16x16x32_bf16 v[136:139], a[216:219], a[144:147], v[136:139]
buffer_load_dwordx4 v21, s[4:7], s46 offen offset:0 lds
v_mfma_f32_16x16x32_bf16 v[136:139], a[220:223], a[8:11], v[136:139]
ds_read_b64_tr_b16 a[242:243], v15 offset:10240
s_mov_b32 s46, 4637696
v_mfma_f32_16x16x32_bf16 v[140:143], a[216:219], a[132:135], v[140:143]
s_waitcnt lgkmcnt(6)
ds_read_b64_tr_b16 a[244:245], v15 offset:12288
v_mfma_f32_16x16x32_bf16 v[140:143], a[220:223], a[24:27], v[140:143]
v_mfma_f32_16x16x32_bf16 v[144:147], a[224:227], a[108:111], v[144:147]
buffer_load_dwordx4 v21, s[4:7], s46 offen offset:1024 lds
v_mfma_f32_16x16x32_bf16 v[144:147], a[228:231], a[148:151], v[144:147]
ds_read_b64_tr_b16 a[246:247], v15 offset:14336
s_mov_b32 s46, 4646912
v_mfma_f32_16x16x32_bf16 v[148:151], a[224:227], a[124:127], v[148:151]
v_mfma_f32_16x16x32_bf16 v[148:151], a[228:231], a[4:7], v[148:151]
buffer_load_dwordx4 v21, s[4:7], s46 offen offset:2048 lds
v_mfma_f32_16x16x32_bf16 v[152:155], a[224:227], a[128:131], v[152:155]
ds_read_b64_tr_b16 a[248:249], v16 offset:8192
s_mov_b32 s46, 4656128
v_mfma_f32_16x16x32_bf16 v[152:155], a[228:231], a[20:23], v[152:155]
v_mfma_f32_16x16x32_bf16 v[156:159], a[224:227], a[144:147], v[156:159]
ds_read_b64_tr_b16 a[250:251], v16 offset:10240
v_mfma_f32_16x16x32_bf16 v[156:159], a[228:231], a[8:11], v[156:159]
buffer_load_dwordx4 v21, s[4:7], s46 offen offset:3072 lds
v_mfma_f32_16x16x32_bf16 v[160:163], a[224:227], a[132:135], v[160:163]
ds_read_b64_tr_b16 a[252:253], v16 offset:12288
s_waitcnt lgkmcnt(7)
v_mfma_f32_16x16x32_bf16 v[160:163], a[228:231], a[24:27], v[160:163]
s_mov_b32 s46, 5038080
ds_read_b64_tr_b16 a[254:255], v16 offset:14336
v_mfma_f32_16x16x32_bf16 v[164:167], a[232:235], a[108:111], v[164:167]
v_mfma_f32_16x16x32_bf16 v[164:167], a[236:239], a[148:151], v[164:167]
buffer_load_dwordx4 a[120:123], v18, s[8:11], s46 offen offset:0 sc1
v_mfma_f32_16x16x32_bf16 v[168:171], a[232:235], a[124:127], v[168:171]
v_mfma_f32_16x16x32_bf16 v[168:171], a[236:239], a[4:7], v[168:171]
v_mfma_f32_16x16x32_bf16 v[172:175], a[232:235], a[128:131], v[172:175]
v_mfma_f32_16x16x32_bf16 v[172:175], a[236:239], a[20:23], v[172:175]
buffer_load_dwordx4 v[224:227], v18, s[8:11], s46 offen offset:1024 sc1
v_mfma_f32_16x16x32_bf16 v[176:179], a[232:235], a[144:147], v[176:179]
v_mfma_f32_16x16x32_bf16 v[176:179], a[236:239], a[8:11], v[176:179]
s_waitcnt lgkmcnt(4)
v_mfma_f32_16x16x32_bf16 v[180:183], a[232:235], a[132:135], v[180:183]
v_mfma_f32_16x16x32_bf16 v[180:183], a[236:239], a[24:27], v[180:183]
buffer_load_dwordx4 v[228:231], v18, s[8:11], s46 offen offset:2048 sc1
v_mfma_f32_16x16x32_bf16 v[184:187], a[240:243], a[108:111], v[184:187]
v_mfma_f32_16x16x32_bf16 v[184:187], a[244:247], a[148:151], v[184:187]
ds_read_b64_tr_b16 a[192:193], v13 offset:16384
v_mfma_f32_16x16x32_bf16 v[188:191], a[240:243], a[124:127], v[188:191]
buffer_load_dwordx4 v[232:235], v18, s[8:11], s46 offen offset:3072 sc1
v_mfma_f32_16x16x32_bf16 v[188:191], a[244:247], a[4:7], v[188:191]
ds_read_b64_tr_b16 a[194:195], v13 offset:18432
s_mov_b32 s46, 5042176
v_mfma_f32_16x16x32_bf16 v[192:195], a[240:243], a[128:131], v[192:195]
ds_read_b64_tr_b16 a[196:197], v13 offset:20480
v_mfma_f32_16x16x32_bf16 v[192:195], a[244:247], a[20:23], v[192:195]
ds_read_b64_tr_b16 a[198:199], v13 offset:22528
v_mfma_f32_16x16x32_bf16 v[196:199], a[240:243], a[144:147], v[196:199]
buffer_load_dwordx4 v[236:239], v18, s[8:11], s46 offen offset:0 sc1
v_mfma_f32_16x16x32_bf16 v[196:199], a[244:247], a[8:11], v[196:199]
ds_read_b64_tr_b16 a[200:201], v14 offset:16384
s_mov_b32 s46, 5160960
v_mfma_f32_16x16x32_bf16 v[200:203], a[240:243], a[132:135], v[200:203]
s_waitcnt lgkmcnt(5)
ds_read_b64_tr_b16 a[202:203], v14 offset:18432
v_mfma_f32_16x16x32_bf16 v[200:203], a[244:247], a[24:27], v[200:203]
v_mfma_f32_16x16x32_bf16 v[204:207], a[248:251], a[108:111], v[204:207]
buffer_load_dwordx4 v[240:243], v18, s[8:11], s46 offen offset:0 sc1
v_mfma_f32_16x16x32_bf16 v[204:207], a[252:255], a[148:151], v[204:207]
ds_read_b64_tr_b16 a[204:205], v14 offset:20480
v_mfma_f32_16x16x32_bf16 v[208:211], a[248:251], a[124:127], v[208:211]
v_mfma_f32_16x16x32_bf16 v[208:211], a[252:255], a[4:7], v[208:211]
ds_read_b64_tr_b16 a[206:207], v14 offset:22528
v_mfma_f32_16x16x32_bf16 v[212:215], a[248:251], a[128:131], v[212:215]
buffer_load_dwordx4 v[244:247], v18, s[8:11], s46 offen offset:1024 sc1
v_mfma_f32_16x16x32_bf16 v[212:215], a[252:255], a[20:23], v[212:215]
v_mfma_f32_16x16x32_bf16 v[216:219], a[248:251], a[144:147], v[216:219]
v_mfma_f32_16x16x32_bf16 v[216:219], a[252:255], a[8:11], v[216:219]
v_mfma_f32_16x16x32_bf16 v[220:223], a[248:251], a[132:135], v[220:223]
buffer_load_dwordx4 v[248:251], v18, s[8:11], s46 offen offset:2048 sc1
v_mfma_f32_16x16x32_bf16 v[220:223], a[252:255], a[24:27], v[220:223]
s_waitcnt vmcnt(46) lgkmcnt(4)
v_mfma_f32_16x16x32_bf16 v[64:67], a[192:195], a[12:15], v[64:67]
ds_read_b64_tr_b16 a[208:209], v15 offset:16384
v_mfma_f32_16x16x32_bf16 v[64:67], a[196:199], a[52:55], v[64:67]
ds_read_b64_tr_b16 a[210:211], v15 offset:18432
v_mfma_f32_16x16x32_bf16 v[68:71], a[192:195], a[28:31], v[68:71]
global_load_dword v30, v[28:29], off
v_mfma_f32_16x16x32_bf16 v[68:71], a[196:199], a[136:139], v[68:71]
ds_read_b64_tr_b16 a[212:213], v15 offset:20480
s_mov_b32 s46, 5160960
v_mfma_f32_16x16x32_bf16 v[72:75], a[192:195], a[32:35], v[72:75]
v_mfma_f32_16x16x32_bf16 v[72:75], a[196:199], a[152:155], v[72:75]
ds_read_b64_tr_b16 a[214:215], v15 offset:22528
v_mfma_f32_16x16x32_bf16 v[76:79], a[192:195], a[48:51], v[76:79]
v_mfma_f32_16x16x32_bf16 v[76:79], a[196:199], a[140:143], v[76:79]
ds_read_b64_tr_b16 a[216:217], v16 offset:16384
s_waitcnt lgkmcnt(5)
v_mfma_f32_16x16x32_bf16 v[80:83], a[192:195], a[36:39], v[80:83]
buffer_load_dwordx4 v[252:255], v18, s[8:11], s46 offen offset:3072 sc1
v_mfma_f32_16x16x32_bf16 v[80:83], a[196:199], a[156:159], v[80:83]
ds_read_b64_tr_b16 a[218:219], v16 offset:18432
s_mov_b32 s46, 5165056
v_mfma_f32_16x16x32_bf16 v[84:87], a[200:203], a[12:15], v[84:87]
v_mfma_f32_16x16x32_bf16 v[84:87], a[204:207], a[52:55], v[84:87]
ds_read_b64_tr_b16 a[220:221], v16 offset:20480
v_mfma_f32_16x16x32_bf16 v[88:91], a[200:203], a[28:31], v[88:91]
v_mfma_f32_16x16x32_bf16 v[88:91], a[204:207], a[136:139], v[88:91]
buffer_load_dwordx4 a[0:3], v18, s[8:11], s46 offen offset:0 sc1
v_mfma_f32_16x16x32_bf16 v[92:95], a[200:203], a[32:35], v[92:95]
ds_read_b64_tr_b16 a[222:223], v16 offset:22528
s_mov_b32 s46, 5283840
v_mfma_f32_16x16x32_bf16 v[92:95], a[204:207], a[152:155], v[92:95]
ds_read_b64_tr_b16 a[224:225], v13 offset:24576
v_mfma_f32_16x16x32_bf16 v[96:99], a[200:203], a[48:51], v[96:99]
v_mfma_f32_16x16x32_bf16 v[96:99], a[204:207], a[140:143], v[96:99]
ds_read_b64_tr_b16 a[226:227], v13 offset:26624
s_waitcnt lgkmcnt(6)
v_mfma_f32_16x16x32_bf16 v[100:103], a[200:203], a[36:39], v[100:103]
v_mfma_f32_16x16x32_bf16 v[100:103], a[204:207], a[156:159], v[100:103]
buffer_load_dwordx4 a[16:19], v18, s[8:11], s46 offen offset:0 sc1
v_mfma_f32_16x16x32_bf16 v[104:107], a[208:211], a[12:15], v[104:107]
ds_read_b64_tr_b16 a[228:229], v13 offset:28672
v_mfma_f32_16x16x32_bf16 v[104:107], a[212:215], a[52:55], v[104:107]
ds_read_b64_tr_b16 a[230:231], v13 offset:30720
v_mfma_f32_16x16x32_bf16 v[108:111], a[208:211], a[28:31], v[108:111]
v_mfma_f32_16x16x32_bf16 v[108:111], a[212:215], a[136:139], v[108:111]
ds_read_b64_tr_b16 a[232:233], v14 offset:24576
v_mfma_f32_16x16x32_bf16 v[112:115], a[208:211], a[32:35], v[112:115]
buffer_load_dwordx4 a[108:111], v18, s[8:11], s46 offen offset:1024 sc1
v_mfma_f32_16x16x32_bf16 v[112:115], a[212:215], a[152:155], v[112:115]
ds_read_b64_tr_b16 a[234:235], v14 offset:26624
v_mfma_f32_16x16x32_bf16 v[116:119], a[208:211], a[48:51], v[116:119]
v_mfma_f32_16x16x32_bf16 v[116:119], a[212:215], a[140:143], v[116:119]
ds_read_b64_tr_b16 a[236:237], v14 offset:28672
s_waitcnt lgkmcnt(7)
v_mfma_f32_16x16x32_bf16 v[120:123], a[208:211], a[36:39], v[120:123]
v_mfma_f32_16x16x32_bf16 v[120:123], a[212:215], a[156:159], v[120:123]
ds_read_b64_tr_b16 a[238:239], v14 offset:30720
v_mfma_f32_16x16x32_bf16 v[124:127], a[216:219], a[12:15], v[124:127]
buffer_load_dwordx4 a[124:127], v18, s[8:11], s46 offen offset:2048 sc1
v_mfma_f32_16x16x32_bf16 v[124:127], a[220:223], a[52:55], v[124:127]
ds_read_b64_tr_b16 a[240:241], v15 offset:24576
s_mov_b32 s46, 5283840
v_mfma_f32_16x16x32_bf16 v[128:131], a[216:219], a[28:31], v[128:131]
v_mfma_f32_16x16x32_bf16 v[128:131], a[220:223], a[136:139], v[128:131]
ds_read_b64_tr_b16 a[242:243], v15 offset:26624
v_mfma_f32_16x16x32_bf16 v[132:135], a[216:219], a[32:35], v[132:135]
v_mfma_f32_16x16x32_bf16 v[132:135], a[220:223], a[152:155], v[132:135]
buffer_load_dwordx4 a[128:131], v18, s[8:11], s46 offen offset:3072 sc1
v_mfma_f32_16x16x32_bf16 v[136:139], a[216:219], a[48:51], v[136:139]
ds_read_b64_tr_b16 a[244:245], v15 offset:28672
s_mov_b32 s46, 5287936
v_mfma_f32_16x16x32_bf16 v[136:139], a[220:223], a[140:143], v[136:139]
ds_read_b64_tr_b16 a[246:247], v15 offset:30720
s_waitcnt lgkmcnt(8)
v_mfma_f32_16x16x32_bf16 v[140:143], a[216:219], a[36:39], v[140:143]
v_mfma_f32_16x16x32_bf16 v[140:143], a[220:223], a[156:159], v[140:143]
ds_read_b64_tr_b16 a[248:249], v16 offset:24576
v_mfma_f32_16x16x32_bf16 v[144:147], a[224:227], a[12:15], v[144:147]
v_mfma_f32_16x16x32_bf16 v[144:147], a[228:231], a[52:55], v[144:147]
buffer_load_dwordx4 a[144:147], v18, s[8:11], s46 offen offset:0 sc1
v_mfma_f32_16x16x32_bf16 v[148:151], a[224:227], a[28:31], v[148:151]
ds_read_b64_tr_b16 a[250:251], v16 offset:26624
v_mfma_f32_16x16x32_bf16 v[148:151], a[228:231], a[136:139], v[148:151]
ds_read_b64_tr_b16 a[252:253], v16 offset:28672
v_mfma_f32_16x16x32_bf16 v[152:155], a[224:227], a[32:35], v[152:155]
v_mfma_f32_16x16x32_bf16 v[152:155], a[228:231], a[152:155], v[152:155]
ds_read_b64_tr_b16 a[254:255], v16 offset:30720
v_mfma_f32_16x16x32_bf16 v[156:159], a[224:227], a[48:51], v[156:159]
v_mfma_f32_16x16x32_bf16 v[156:159], a[228:231], a[140:143], v[156:159]
s_waitcnt lgkmcnt(8)
v_mfma_f32_16x16x32_bf16 v[160:163], a[224:227], a[36:39], v[160:163]
v_mfma_f32_16x16x32_bf16 v[160:163], a[228:231], a[156:159], v[160:163]
v_mfma_f32_16x16x32_bf16 v[164:167], a[232:235], a[12:15], v[164:167]
v_mfma_f32_16x16x32_bf16 v[164:167], a[236:239], a[52:55], v[164:167]
v_mfma_f32_16x16x32_bf16 v[168:171], a[232:235], a[28:31], v[168:171]
v_mfma_f32_16x16x32_bf16 v[168:171], a[236:239], a[136:139], v[168:171]
v_mfma_f32_16x16x32_bf16 v[172:175], a[232:235], a[32:35], v[172:175]
s_waitcnt vmcnt(16) lgkmcnt(0)
s_barrier
v_mfma_f32_16x16x32_bf16 v[172:175], a[236:239], a[152:155], v[172:175]
ds_read_b64_tr_b16 a[192:193], v1 offset:0
v_mfma_f32_16x16x32_bf16 v[176:179], a[232:235], a[48:51], v[176:179]
ds_read_b64_tr_b16 a[194:195], v1 offset:2048
v_mfma_f32_16x16x32_bf16 v[176:179], a[236:239], a[140:143], v[176:179]
ds_read_b64_tr_b16 a[196:197], v1 offset:4096
s_waitcnt lgkmcnt(7)
v_mfma_f32_16x16x32_bf16 v[180:183], a[232:235], a[36:39], v[180:183]
ds_read_b64_tr_b16 a[198:199], v1 offset:6144
v_mfma_f32_16x16x32_bf16 v[180:183], a[236:239], a[156:159], v[180:183]
ds_read_b64_tr_b16 a[200:201], v1 offset:16384
v_mfma_f32_16x16x32_bf16 v[184:187], a[240:243], a[12:15], v[184:187]
ds_read_b64_tr_b16 a[202:203], v1 offset:18432
v_mfma_f32_16x16x32_bf16 v[184:187], a[244:247], a[52:55], v[184:187]
ds_read_b64_tr_b16 a[204:205], v1 offset:20480
v_mfma_f32_16x16x32_bf16 v[188:191], a[240:243], a[28:31], v[188:191]
ds_read_b64_tr_b16 a[206:207], v1 offset:22528
v_mfma_f32_16x16x32_bf16 v[188:191], a[244:247], a[136:139], v[188:191]
ds_read_b64_tr_b16 a[208:209], v1 offset:32768
v_mfma_f32_16x16x32_bf16 v[192:195], a[240:243], a[32:35], v[192:195]
v_mfma_f32_16x16x32_bf16 v[192:195], a[244:247], a[152:155], v[192:195]
ds_read_b64_tr_b16 a[210:211], v1 offset:34816
v_mfma_f32_16x16x32_bf16 v[196:199], a[240:243], a[48:51], v[196:199]
ds_read_b64_tr_b16 a[212:213], v1 offset:36864
v_mfma_f32_16x16x32_bf16 v[196:199], a[244:247], a[140:143], v[196:199]
ds_read_b64_tr_b16 a[214:215], v1 offset:38912
v_mfma_f32_16x16x32_bf16 v[200:203], a[240:243], a[36:39], v[200:203]
ds_read_b64_tr_b16 a[216:217], v1 offset:49152
v_mfma_f32_16x16x32_bf16 v[200:203], a[244:247], a[156:159], v[200:203]
ds_read_b64_tr_b16 a[218:219], v1 offset:51200
v_mfma_f32_16x16x32_bf16 v[204:207], a[248:251], a[12:15], v[204:207]
ds_read_b64_tr_b16 a[220:221], v1 offset:53248
v_mfma_f32_16x16x32_bf16 v[204:207], a[252:255], a[52:55], v[204:207]
ds_read_b64_tr_b16 a[222:223], v1 offset:55296
v_mfma_f32_16x16x32_bf16 v[208:211], a[248:251], a[28:31], v[208:211]
v_mfma_f32_16x16x32_bf16 v[208:211], a[252:255], a[136:139], v[208:211]
v_mfma_f32_16x16x32_bf16 v[212:215], a[248:251], a[32:35], v[212:215]
v_mfma_f32_16x16x32_bf16 v[212:215], a[252:255], a[152:155], v[212:215]
v_mfma_f32_16x16x32_bf16 v[216:219], a[248:251], a[48:51], v[216:219]
v_mfma_f32_16x16x32_bf16 v[216:219], a[252:255], a[140:143], v[216:219]
v_mfma_f32_16x16x32_bf16 v[220:223], a[248:251], a[36:39], v[220:223]
s_waitcnt vmcnt(0) lgkmcnt(0)
v_mfma_f32_16x16x32_bf16 v[220:223], a[252:255], a[156:159], v[220:223]
v_mfma_f32_16x16x32_bf16 v[64:67], a[192:195], a[160:163], v[64:67]
ds_read_b64_tr_b16 a[224:225], v2 offset:0
v_mfma_f32_16x16x32_bf16 v[64:67], a[196:199], a[60:63], v[64:67]
ds_read_b64_tr_b16 a[226:227], v2 offset:2048
v_mfma_f32_16x16x32_bf16 v[64:67], a[200:203], a[72:75], v[64:67]
ds_read_b64_tr_b16 a[228:229], v2 offset:4096
v_mfma_f32_16x16x32_bf16 v[64:67], a[204:207], a[184:187], v[64:67]
ds_read_b64_tr_b16 a[230:231], v2 offset:6144
v_mfma_f32_16x16x32_bf16 v[64:67], a[208:211], a[96:99], v[64:67]
v_mfma_f32_16x16x32_bf16 v[64:67], a[212:215], a[120:123], v[64:67]
ds_read_b64_tr_b16 a[232:233], v2 offset:16384
v_mfma_f32_16x16x32_bf16 v[64:67], a[216:219], v[240:243], v[64:67]
ds_read_b64_tr_b16 a[234:235], v2 offset:18432
v_mfma_f32_16x16x32_bf16 v[64:67], a[220:223], a[16:19], v[64:67]
v_mfma_f32_16x16x32_bf16 v[68:71], a[220:223], a[108:111], v[68:71]
v_mfma_f32_16x16x32_bf16 v[68:71], a[216:219], v[244:247], v[68:71]
ds_read_b64_tr_b16 a[236:237], v2 offset:20480
v_mfma_f32_16x16x32_bf16 v[68:71], a[212:215], v[224:227], v[68:71]
ds_read_b64_tr_b16 a[238:239], v2 offset:22528
v_mfma_f32_16x16x32_bf16 v[68:71], a[208:211], a[112:115], v[68:71]
v_mfma_f32_16x16x32_bf16 v[68:71], a[204:207], a[172:175], v[68:71]
v_mfma_f32_16x16x32_bf16 v[68:71], a[200:203], a[88:91], v[68:71]
ds_read_b64_tr_b16 a[240:241], v2 offset:32768
v_mfma_f32_16x16x32_bf16 v[68:71], a[196:199], a[64:67], v[68:71]
ds_read_b64_tr_b16 a[242:243], v2 offset:34816
v_mfma_f32_16x16x32_bf16 v[68:71], a[192:195], a[176:179], v[68:71]
v_mfma_f32_16x16x32_bf16 v[72:75], a[192:195], a[40:43], v[72:75]
v_mfma_f32_16x16x32_bf16 v[72:75], a[196:199], a[80:83], v[72:75]
ds_read_b64_tr_b16 a[244:245], v2 offset:36864
v_mfma_f32_16x16x32_bf16 v[72:75], a[200:203], a[164:167], v[72:75]
ds_read_b64_tr_b16 a[246:247], v2 offset:38912
v_mfma_f32_16x16x32_bf16 v[72:75], a[204:207], a[188:191], v[72:75]
v_mfma_f32_16x16x32_bf16 v[72:75], a[208:211], a[100:103], v[72:75]
v_mfma_f32_16x16x32_bf16 v[72:75], a[212:215], v[228:231], v[72:75]
ds_read_b64_tr_b16 a[248:249], v2 offset:49152
v_mfma_f32_16x16x32_bf16 v[72:75], a[216:219], v[248:251], v[72:75]
ds_read_b64_tr_b16 a[250:251], v2 offset:51200
v_mfma_f32_16x16x32_bf16 v[72:75], a[220:223], a[124:127], v[72:75]
v_mfma_f32_16x16x32_bf16 v[76:79], a[220:223], a[128:131], v[76:79]
v_mfma_f32_16x16x32_bf16 v[76:79], a[216:219], v[252:255], v[76:79]
ds_read_b64_tr_b16 a[252:253], v2 offset:53248
v_mfma_f32_16x16x32_bf16 v[76:79], a[212:215], v[232:235], v[76:79]
ds_read_b64_tr_b16 a[254:255], v2 offset:55296
v_mfma_f32_16x16x32_bf16 v[76:79], a[208:211], a[116:119], v[76:79]
v_mfma_f32_16x16x32_bf16 v[76:79], a[204:207], a[76:79], v[76:79]
v_mfma_f32_16x16x32_bf16 v[76:79], a[200:203], a[180:183], v[76:79]
v_mfma_f32_16x16x32_bf16 v[76:79], a[196:199], a[68:71], v[76:79]
v_mfma_f32_16x16x32_bf16 v[76:79], a[192:195], a[56:59], v[76:79]
v_mfma_f32_16x16x32_bf16 v[80:83], a[192:195], a[44:47], v[80:83]
v_mfma_f32_16x16x32_bf16 v[80:83], a[196:199], a[84:87], v[80:83]
v_mfma_f32_16x16x32_bf16 v[80:83], a[200:203], a[168:171], v[80:83]
v_mfma_f32_16x16x32_bf16 v[80:83], a[204:207], a[92:95], v[80:83]
v_mfma_f32_16x16x32_bf16 v[80:83], a[208:211], a[104:107], v[80:83]
v_mfma_f32_16x16x32_bf16 v[80:83], a[212:215], v[236:239], v[80:83]
ds_read_b64_tr_b16 a[192:193], v3 offset:0
s_waitcnt lgkmcnt(1)
v_mfma_f32_16x16x32_bf16 v[80:83], a[216:219], a[0:3], v[80:83]
ds_read_b64_tr_b16 a[194:195], v3 offset:2048
v_mfma_f32_16x16x32_bf16 v[80:83], a[220:223], a[144:147], v[80:83]
v_mfma_f32_16x16x32_bf16 v[84:87], a[224:227], a[160:163], v[84:87]
v_mfma_f32_16x16x32_bf16 v[84:87], a[228:231], a[60:63], v[84:87]
ds_read_b64_tr_b16 a[196:197], v3 offset:4096
v_mfma_f32_16x16x32_bf16 v[84:87], a[232:235], a[72:75], v[84:87]
ds_read_b64_tr_b16 a[198:199], v3 offset:6144
v_mfma_f32_16x16x32_bf16 v[84:87], a[236:239], a[184:187], v[84:87]
v_mfma_f32_16x16x32_bf16 v[84:87], a[240:243], a[96:99], v[84:87]
v_mfma_f32_16x16x32_bf16 v[84:87], a[244:247], a[120:123], v[84:87]
ds_read_b64_tr_b16 a[200:201], v3 offset:16384
v_mfma_f32_16x16x32_bf16 v[84:87], a[248:251], v[240:243], v[84:87]
ds_read_b64_tr_b16 a[202:203], v3 offset:18432
v_mfma_f32_16x16x32_bf16 v[84:87], a[252:255], a[16:19], v[84:87]
v_mfma_f32_16x16x32_bf16 v[88:91], a[252:255], a[108:111], v[88:91]
v_mfma_f32_16x16x32_bf16 v[88:91], a[248:251], v[244:247], v[88:91]
ds_read_b64_tr_b16 a[204:205], v3 offset:20480
v_cvt_pk_bf16_f32 v64, v64, v65
v_mfma_f32_16x16x32_bf16 v[88:91], a[244:247], v[224:227], v[88:91]
ds_read_b64_tr_b16 a[206:207], v3 offset:22528
v_cvt_pk_bf16_f32 v65, v66, v67
v_mfma_f32_16x16x32_bf16 v[88:91], a[240:243], a[112:115], v[88:91]
v_mfma_f32_16x16x32_bf16 v[88:91], a[236:239], a[172:175], v[88:91]
v_mfma_f32_16x16x32_bf16 v[88:91], a[232:235], a[88:91], v[88:91]
ds_read_b64_tr_b16 a[208:209], v3 offset:32768
v_mfma_f32_16x16x32_bf16 v[88:91], a[228:231], a[64:67], v[88:91]
ds_read_b64_tr_b16 a[210:211], v3 offset:34816
v_mfma_f32_16x16x32_bf16 v[88:91], a[224:227], a[176:179], v[88:91]
v_cvt_pk_bf16_f32 v66, v84, v85
v_cvt_pk_bf16_f32 v67, v86, v87
v_mfma_f32_16x16x32_bf16 v[92:95], a[224:227], a[40:43], v[92:95]
s_add_u32 s39, s32, 10240
ds_read_b64_tr_b16 a[212:213], v3 offset:36864
v_mfma_f32_16x16x32_bf16 v[92:95], a[228:231], a[80:83], v[92:95]
buffer_store_dwordx4 v[64:67], v18, s[20:23], s39 offen offset:0 sc1
v_mfma_f32_16x16x32_bf16 v[92:95], a[232:235], a[164:167], v[92:95]
ds_read_b64_tr_b16 a[214:215], v3 offset:38912
v_cvt_pk_bf16_f32 v68, v68, v69
v_mfma_f32_16x16x32_bf16 v[92:95], a[236:239], a[188:191], v[92:95]
v_mfma_f32_16x16x32_bf16 v[92:95], a[240:243], a[100:103], v[92:95]
v_mfma_f32_16x16x32_bf16 v[92:95], a[244:247], v[228:231], v[92:95]
ds_read_b64_tr_b16 a[216:217], v3 offset:49152
v_cvt_pk_bf16_f32 v69, v70, v71
v_mfma_f32_16x16x32_bf16 v[92:95], a[248:251], v[248:251], v[92:95]
ds_read_b64_tr_b16 a[218:219], v3 offset:51200
v_mfma_f32_16x16x32_bf16 v[92:95], a[252:255], a[124:127], v[92:95]
v_cvt_pk_bf16_f32 v70, v88, v89
v_cvt_pk_bf16_f32 v71, v90, v91
v_mfma_f32_16x16x32_bf16 v[96:99], a[252:255], a[128:131], v[96:99]
buffer_store_dwordx4 v[68:71], v18, s[20:23], s39 offen offset:1024 sc1
v_mfma_f32_16x16x32_bf16 v[96:99], a[248:251], v[252:255], v[96:99]
ds_read_b64_tr_b16 a[220:221], v3 offset:53248
v_cvt_pk_bf16_f32 v72, v72, v73
v_mfma_f32_16x16x32_bf16 v[96:99], a[244:247], v[232:235], v[96:99]
ds_read_b64_tr_b16 a[222:223], v3 offset:55296
v_cvt_pk_bf16_f32 v73, v74, v75
v_mfma_f32_16x16x32_bf16 v[96:99], a[240:243], a[116:119], v[96:99]
v_mfma_f32_16x16x32_bf16 v[96:99], a[236:239], a[76:79], v[96:99]
v_mfma_f32_16x16x32_bf16 v[96:99], a[232:235], a[180:183], v[96:99]
v_mfma_f32_16x16x32_bf16 v[96:99], a[228:231], a[68:71], v[96:99]
v_mfma_f32_16x16x32_bf16 v[96:99], a[224:227], a[56:59], v[96:99]
v_cvt_pk_bf16_f32 v74, v92, v93
v_cvt_pk_bf16_f32 v75, v94, v95
v_mfma_f32_16x16x32_bf16 v[100:103], a[224:227], a[44:47], v[100:103]
buffer_store_dwordx4 v[72:75], v18, s[20:23], s39 offen offset:2048 sc1
v_mfma_f32_16x16x32_bf16 v[100:103], a[228:231], a[84:87], v[100:103]
v_mfma_f32_16x16x32_bf16 v[100:103], a[232:235], a[168:171], v[100:103]
v_mfma_f32_16x16x32_bf16 v[100:103], a[236:239], a[92:95], v[100:103]
v_mfma_f32_16x16x32_bf16 v[100:103], a[240:243], a[104:107], v[100:103]
v_mfma_f32_16x16x32_bf16 v[100:103], a[244:247], v[236:239], v[100:103]
ds_read_b64_tr_b16 a[224:225], v4 offset:0
s_waitcnt lgkmcnt(1)
v_mfma_f32_16x16x32_bf16 v[100:103], a[248:251], a[0:3], v[100:103]
ds_read_b64_tr_b16 a[226:227], v4 offset:2048
v_cvt_pk_bf16_f32 v76, v76, v77
v_mfma_f32_16x16x32_bf16 v[100:103], a[252:255], a[144:147], v[100:103]
v_cvt_pk_bf16_f32 v77, v78, v79
v_cvt_pk_bf16_f32 v78, v96, v97
v_mfma_f32_16x16x32_bf16 v[104:107], a[192:195], a[160:163], v[104:107]
ds_read_b64_tr_b16 a[228:229], v4 offset:4096
v_cvt_pk_bf16_f32 v79, v98, v99
v_mfma_f32_16x16x32_bf16 v[104:107], a[196:199], a[60:63], v[104:107]
buffer_store_dwordx4 v[76:79], v18, s[20:23], s39 offen offset:3072 sc1
v_mfma_f32_16x16x32_bf16 v[104:107], a[200:203], a[72:75], v[104:107]
ds_read_b64_tr_b16 a[230:231], v4 offset:6144
v_cvt_pk_bf16_f32 v80, v80, v81
v_mfma_f32_16x16x32_bf16 v[104:107], a[204:207], a[184:187], v[104:107]
v_mfma_f32_16x16x32_bf16 v[104:107], a[208:211], a[96:99], v[104:107]
v_mfma_f32_16x16x32_bf16 v[104:107], a[212:215], a[120:123], v[104:107]
ds_read_b64_tr_b16 a[232:233], v4 offset:16384
v_cvt_pk_bf16_f32 v81, v82, v83
v_mfma_f32_16x16x32_bf16 v[104:107], a[216:219], v[240:243], v[104:107]
ds_read_b64_tr_b16 a[234:235], v4 offset:18432
v_mfma_f32_16x16x32_bf16 v[104:107], a[220:223], a[16:19], v[104:107]
v_cvt_pk_bf16_f32 v82, v100, v101
v_cvt_pk_bf16_f32 v83, v102, v103
v_mfma_f32_16x16x32_bf16 v[108:111], a[220:223], a[108:111], v[108:111]
s_add_u32 s39, s32, 14336
ds_read_b64_tr_b16 a[236:237], v4 offset:20480
v_mfma_f32_16x16x32_bf16 v[108:111], a[216:219], v[244:247], v[108:111]
buffer_store_dwordx4 v[80:83], v18, s[20:23], s39 offen offset:0 sc1
v_mfma_f32_16x16x32_bf16 v[108:111], a[212:215], v[224:227], v[108:111]
ds_read_b64_tr_b16 a[238:239], v4 offset:22528
v_mfma_f32_16x16x32_bf16 v[108:111], a[208:211], a[112:115], v[108:111]
v_mfma_f32_16x16x32_bf16 v[108:111], a[204:207], a[172:175], v[108:111]
v_mfma_f32_16x16x32_bf16 v[108:111], a[200:203], a[88:91], v[108:111]
ds_read_b64_tr_b16 a[240:241], v4 offset:32768
v_mfma_f32_16x16x32_bf16 v[108:111], a[196:199], a[64:67], v[108:111]
ds_read_b64_tr_b16 a[242:243], v4 offset:34816
v_mfma_f32_16x16x32_bf16 v[108:111], a[192:195], a[176:179], v[108:111]
v_mfma_f32_16x16x32_bf16 v[112:115], a[192:195], a[40:43], v[112:115]
v_mfma_f32_16x16x32_bf16 v[112:115], a[196:199], a[80:83], v[112:115]
ds_read_b64_tr_b16 a[244:245], v4 offset:36864
v_mfma_f32_16x16x32_bf16 v[112:115], a[200:203], a[164:167], v[112:115]
ds_read_b64_tr_b16 a[246:247], v4 offset:38912
v_mfma_f32_16x16x32_bf16 v[112:115], a[204:207], a[188:191], v[112:115]
v_mfma_f32_16x16x32_bf16 v[112:115], a[208:211], a[100:103], v[112:115]
v_mfma_f32_16x16x32_bf16 v[112:115], a[212:215], v[228:231], v[112:115]
ds_read_b64_tr_b16 a[248:249], v4 offset:49152
v_mfma_f32_16x16x32_bf16 v[112:115], a[216:219], v[248:251], v[112:115]
ds_read_b64_tr_b16 a[250:251], v4 offset:51200
v_mfma_f32_16x16x32_bf16 v[112:115], a[220:223], a[124:127], v[112:115]
v_mfma_f32_16x16x32_bf16 v[116:119], a[220:223], a[128:131], v[116:119]
v_mfma_f32_16x16x32_bf16 v[116:119], a[216:219], v[252:255], v[116:119]
ds_read_b64_tr_b16 a[252:253], v4 offset:53248
v_mfma_f32_16x16x32_bf16 v[116:119], a[212:215], v[232:235], v[116:119]
ds_read_b64_tr_b16 a[254:255], v4 offset:55296
v_mfma_f32_16x16x32_bf16 v[116:119], a[208:211], a[116:119], v[116:119]
v_mfma_f32_16x16x32_bf16 v[116:119], a[204:207], a[76:79], v[116:119]
v_mfma_f32_16x16x32_bf16 v[116:119], a[200:203], a[180:183], v[116:119]
v_mfma_f32_16x16x32_bf16 v[116:119], a[196:199], a[68:71], v[116:119]
v_mfma_f32_16x16x32_bf16 v[116:119], a[192:195], a[56:59], v[116:119]
v_mfma_f32_16x16x32_bf16 v[120:123], a[192:195], a[44:47], v[120:123]
v_mfma_f32_16x16x32_bf16 v[120:123], a[196:199], a[84:87], v[120:123]
v_mfma_f32_16x16x32_bf16 v[120:123], a[200:203], a[168:171], v[120:123]
v_mfma_f32_16x16x32_bf16 v[120:123], a[204:207], a[92:95], v[120:123]
v_mfma_f32_16x16x32_bf16 v[120:123], a[208:211], a[104:107], v[120:123]
v_mfma_f32_16x16x32_bf16 v[120:123], a[212:215], v[236:239], v[120:123]
ds_read_b64_tr_b16 a[192:193], v1 offset:8192
s_waitcnt lgkmcnt(1)
v_mfma_f32_16x16x32_bf16 v[120:123], a[216:219], a[0:3], v[120:123]
ds_read_b64_tr_b16 a[194:195], v1 offset:10240
v_mfma_f32_16x16x32_bf16 v[120:123], a[220:223], a[144:147], v[120:123]
v_mfma_f32_16x16x32_bf16 v[124:127], a[224:227], a[160:163], v[124:127]
v_mfma_f32_16x16x32_bf16 v[124:127], a[228:231], a[60:63], v[124:127]
ds_read_b64_tr_b16 a[196:197], v1 offset:12288
v_mfma_f32_16x16x32_bf16 v[124:127], a[232:235], a[72:75], v[124:127]
ds_read_b64_tr_b16 a[198:199], v1 offset:14336
v_mfma_f32_16x16x32_bf16 v[124:127], a[236:239], a[184:187], v[124:127]
v_mfma_f32_16x16x32_bf16 v[124:127], a[240:243], a[96:99], v[124:127]
v_mfma_f32_16x16x32_bf16 v[124:127], a[244:247], a[120:123], v[124:127]
ds_read_b64_tr_b16 a[200:201], v1 offset:24576
v_mfma_f32_16x16x32_bf16 v[124:127], a[248:251], v[240:243], v[124:127]
ds_read_b64_tr_b16 a[202:203], v1 offset:26624
v_mfma_f32_16x16x32_bf16 v[124:127], a[252:255], a[16:19], v[124:127]
v_mfma_f32_16x16x32_bf16 v[128:131], a[252:255], a[108:111], v[128:131]
v_mfma_f32_16x16x32_bf16 v[128:131], a[248:251], v[244:247], v[128:131]
ds_read_b64_tr_b16 a[204:205], v1 offset:28672
v_cvt_pk_bf16_f32 v104, v104, v105
v_mfma_f32_16x16x32_bf16 v[128:131], a[244:247], v[224:227], v[128:131]
ds_read_b64_tr_b16 a[206:207], v1 offset:30720
v_cvt_pk_bf16_f32 v105, v106, v107
v_mfma_f32_16x16x32_bf16 v[128:131], a[240:243], a[112:115], v[128:131]
v_mfma_f32_16x16x32_bf16 v[128:131], a[236:239], a[172:175], v[128:131]
v_mfma_f32_16x16x32_bf16 v[128:131], a[232:235], a[88:91], v[128:131]
ds_read_b64_tr_b16 a[208:209], v1 offset:40960
v_mfma_f32_16x16x32_bf16 v[128:131], a[228:231], a[64:67], v[128:131]
ds_read_b64_tr_b16 a[210:211], v1 offset:43008
v_mfma_f32_16x16x32_bf16 v[128:131], a[224:227], a[176:179], v[128:131]
v_cvt_pk_bf16_f32 v106, v124, v125
v_cvt_pk_bf16_f32 v107, v126, v127
v_mfma_f32_16x16x32_bf16 v[132:135], a[224:227], a[40:43], v[132:135]
s_add_u32 s39, s32, 5120
ds_read_b64_tr_b16 a[212:213], v1 offset:45056
v_mfma_f32_16x16x32_bf16 v[132:135], a[228:231], a[80:83], v[132:135]
buffer_store_dwordx4 v[104:107], v18, s[20:23], s39 offen offset:0 sc1
v_mfma_f32_16x16x32_bf16 v[132:135], a[232:235], a[164:167], v[132:135]
ds_read_b64_tr_b16 a[214:215], v1 offset:47104
v_cvt_pk_bf16_f32 v108, v108, v109
v_mfma_f32_16x16x32_bf16 v[132:135], a[236:239], a[188:191], v[132:135]
v_mfma_f32_16x16x32_bf16 v[132:135], a[240:243], a[100:103], v[132:135]
v_mfma_f32_16x16x32_bf16 v[132:135], a[244:247], v[228:231], v[132:135]
ds_read_b64_tr_b16 a[216:217], v1 offset:57344
v_cvt_pk_bf16_f32 v109, v110, v111
v_mfma_f32_16x16x32_bf16 v[132:135], a[248:251], v[248:251], v[132:135]
ds_read_b64_tr_b16 a[218:219], v1 offset:59392
v_mfma_f32_16x16x32_bf16 v[132:135], a[252:255], a[124:127], v[132:135]
v_cvt_pk_bf16_f32 v110, v128, v129
v_cvt_pk_bf16_f32 v111, v130, v131
v_mfma_f32_16x16x32_bf16 v[136:139], a[252:255], a[128:131], v[136:139]
buffer_store_dwordx4 v[108:111], v18, s[20:23], s39 offen offset:1024 sc1
v_mfma_f32_16x16x32_bf16 v[136:139], a[248:251], v[252:255], v[136:139]
ds_read_b64_tr_b16 a[220:221], v1 offset:61440
v_cvt_pk_bf16_f32 v112, v112, v113
v_mfma_f32_16x16x32_bf16 v[136:139], a[244:247], v[232:235], v[136:139]
ds_read_b64_tr_b16 a[222:223], v1 offset:63488
v_cvt_pk_bf16_f32 v113, v114, v115
v_mfma_f32_16x16x32_bf16 v[136:139], a[240:243], a[116:119], v[136:139]
v_mfma_f32_16x16x32_bf16 v[136:139], a[236:239], a[76:79], v[136:139]
v_mfma_f32_16x16x32_bf16 v[136:139], a[232:235], a[180:183], v[136:139]
v_mfma_f32_16x16x32_bf16 v[136:139], a[228:231], a[68:71], v[136:139]
v_mfma_f32_16x16x32_bf16 v[136:139], a[224:227], a[56:59], v[136:139]
v_cvt_pk_bf16_f32 v114, v132, v133
v_cvt_pk_bf16_f32 v115, v134, v135
v_mfma_f32_16x16x32_bf16 v[140:143], a[224:227], a[44:47], v[140:143]
buffer_store_dwordx4 v[112:115], v18, s[20:23], s39 offen offset:2048 sc1
v_mfma_f32_16x16x32_bf16 v[140:143], a[228:231], a[84:87], v[140:143]
v_mfma_f32_16x16x32_bf16 v[140:143], a[232:235], a[168:171], v[140:143]
s_waitcnt vmcnt(3)
s_barrier
v_mfma_f32_16x16x32_bf16 v[140:143], a[236:239], a[92:95], v[140:143]
s_mov_b64 exec, 1
buffer_store_dword v20, off, s[28:31], s55 offset:8 sc1
s_mov_b64 exec, -1
v_mfma_f32_16x16x32_bf16 v[140:143], a[240:243], a[104:107], v[140:143]
v_mfma_f32_16x16x32_bf16 v[140:143], a[244:247], v[236:239], v[140:143]
ds_read_b64_tr_b16 a[224:225], v2 offset:8192
s_waitcnt lgkmcnt(1)
v_mfma_f32_16x16x32_bf16 v[140:143], a[248:251], a[0:3], v[140:143]
ds_read_b64_tr_b16 a[226:227], v2 offset:10240
v_mfma_f32_16x16x32_bf16 v[140:143], a[252:255], a[144:147], v[140:143]
v_mfma_f32_16x16x32_bf16 v[144:147], a[192:195], a[160:163], v[144:147]
v_mfma_f32_16x16x32_bf16 v[144:147], a[196:199], a[60:63], v[144:147]
ds_read_b64_tr_b16 a[228:229], v2 offset:12288
v_mfma_f32_16x16x32_bf16 v[144:147], a[200:203], a[72:75], v[144:147]
ds_read_b64_tr_b16 a[230:231], v2 offset:14336
v_mfma_f32_16x16x32_bf16 v[144:147], a[204:207], a[184:187], v[144:147]
ds_read_b64_tr_b16 a[232:233], v2 offset:24576
v_cvt_pk_bf16_f32 v116, v116, v117
v_mfma_f32_16x16x32_bf16 v[144:147], a[208:211], a[96:99], v[144:147]
ds_read_b64_tr_b16 a[234:235], v2 offset:26624
v_cvt_pk_bf16_f32 v117, v118, v119
v_mfma_f32_16x16x32_bf16 v[144:147], a[212:215], a[120:123], v[144:147]
v_cvt_pk_bf16_f32 v118, v136, v137
v_cvt_pk_bf16_f32 v119, v138, v139
v_mfma_f32_16x16x32_bf16 v[144:147], a[216:219], v[240:243], v[144:147]
buffer_store_dwordx4 v[116:119], v18, s[20:23], s39 offen offset:3072 sc1
v_mfma_f32_16x16x32_bf16 v[144:147], a[220:223], a[16:19], v[144:147]
v_cvt_pk_bf16_f32 v120, v120, v121
v_cvt_pk_bf16_f32 v121, v122, v123
v_mfma_f32_16x16x32_bf16 v[148:151], a[220:223], a[108:111], v[148:151]
v_cvt_pk_bf16_f32 v122, v140, v141
v_cvt_pk_bf16_f32 v123, v142, v143
v_mfma_f32_16x16x32_bf16 v[148:151], a[216:219], v[244:247], v[148:151]
ds_read_b64_tr_b16 a[236:237], v2 offset:28672
s_add_u32 s39, s32, 9216
v_mfma_f32_16x16x32_bf16 v[148:151], a[212:215], v[224:227], v[148:151]
buffer_store_dwordx4 v[120:123], v18, s[20:23], s39 offen offset:0 sc1
v_mfma_f32_16x16x32_bf16 v[148:151], a[208:211], a[112:115], v[148:151]
ds_read_b64_tr_b16 a[238:239], v2 offset:30720
v_mfma_f32_16x16x32_bf16 v[148:151], a[204:207], a[172:175], v[148:151]
v_mfma_f32_16x16x32_bf16 v[148:151], a[200:203], a[88:91], v[148:151]
ds_read_b64_tr_b16 a[240:241], v2 offset:40960
v_mfma_f32_16x16x32_bf16 v[148:151], a[196:199], a[64:67], v[148:151]
ds_read_b64_tr_b16 a[242:243], v2 offset:43008
v_mfma_f32_16x16x32_bf16 v[148:151], a[192:195], a[176:179], v[148:151]
v_mfma_f32_16x16x32_bf16 v[152:155], a[192:195], a[40:43], v[152:155]
v_mfma_f32_16x16x32_bf16 v[152:155], a[196:199], a[80:83], v[152:155]
ds_read_b64_tr_b16 a[244:245], v2 offset:45056
v_mfma_f32_16x16x32_bf16 v[152:155], a[200:203], a[164:167], v[152:155]
ds_read_b64_tr_b16 a[246:247], v2 offset:47104
v_mfma_f32_16x16x32_bf16 v[152:155], a[204:207], a[188:191], v[152:155]
v_mfma_f32_16x16x32_bf16 v[152:155], a[208:211], a[100:103], v[152:155]
v_mfma_f32_16x16x32_bf16 v[152:155], a[212:215], v[228:231], v[152:155]
ds_read_b64_tr_b16 a[248:249], v2 offset:57344
v_mfma_f32_16x16x32_bf16 v[152:155], a[216:219], v[248:251], v[152:155]
ds_read_b64_tr_b16 a[250:251], v2 offset:59392
v_mfma_f32_16x16x32_bf16 v[152:155], a[220:223], a[124:127], v[152:155]
v_mfma_f32_16x16x32_bf16 v[156:159], a[220:223], a[128:131], v[156:159]
v_mfma_f32_16x16x32_bf16 v[156:159], a[216:219], v[252:255], v[156:159]
ds_read_b64_tr_b16 a[252:253], v2 offset:61440
v_mfma_f32_16x16x32_bf16 v[156:159], a[212:215], v[232:235], v[156:159]
ds_read_b64_tr_b16 a[254:255], v2 offset:63488
v_mfma_f32_16x16x32_bf16 v[156:159], a[208:211], a[116:119], v[156:159]
v_mfma_f32_16x16x32_bf16 v[156:159], a[204:207], a[76:79], v[156:159]
v_mfma_f32_16x16x32_bf16 v[156:159], a[200:203], a[180:183], v[156:159]
v_mfma_f32_16x16x32_bf16 v[156:159], a[196:199], a[68:71], v[156:159]
v_mfma_f32_16x16x32_bf16 v[156:159], a[192:195], a[56:59], v[156:159]
v_mfma_f32_16x16x32_bf16 v[160:163], a[192:195], a[44:47], v[160:163]
v_mfma_f32_16x16x32_bf16 v[160:163], a[196:199], a[84:87], v[160:163]
v_mfma_f32_16x16x32_bf16 v[160:163], a[200:203], a[168:171], v[160:163]
v_mfma_f32_16x16x32_bf16 v[160:163], a[204:207], a[92:95], v[160:163]
v_mfma_f32_16x16x32_bf16 v[160:163], a[208:211], a[104:107], v[160:163]
v_mfma_f32_16x16x32_bf16 v[160:163], a[212:215], v[236:239], v[160:163]
ds_read_b64_tr_b16 a[192:193], v3 offset:8192
s_waitcnt lgkmcnt(1)
v_mfma_f32_16x16x32_bf16 v[160:163], a[216:219], a[0:3], v[160:163]
ds_read_b64_tr_b16 a[194:195], v3 offset:10240
v_mfma_f32_16x16x32_bf16 v[160:163], a[220:223], a[144:147], v[160:163]
v_mfma_f32_16x16x32_bf16 v[164:167], a[224:227], a[160:163], v[164:167]
v_mfma_f32_16x16x32_bf16 v[164:167], a[228:231], a[60:63], v[164:167]
ds_read_b64_tr_b16 a[196:197], v3 offset:12288
v_mfma_f32_16x16x32_bf16 v[164:167], a[232:235], a[72:75], v[164:167]
ds_read_b64_tr_b16 a[198:199], v3 offset:14336
v_mfma_f32_16x16x32_bf16 v[164:167], a[236:239], a[184:187], v[164:167]
v_mfma_f32_16x16x32_bf16 v[164:167], a[240:243], a[96:99], v[164:167]
v_mfma_f32_16x16x32_bf16 v[164:167], a[244:247], a[120:123], v[164:167]
ds_read_b64_tr_b16 a[200:201], v3 offset:24576
v_mfma_f32_16x16x32_bf16 v[164:167], a[248:251], v[240:243], v[164:167]
ds_read_b64_tr_b16 a[202:203], v3 offset:26624
v_mfma_f32_16x16x32_bf16 v[164:167], a[252:255], a[16:19], v[164:167]
v_mfma_f32_16x16x32_bf16 v[168:171], a[252:255], a[108:111], v[168:171]
v_mfma_f32_16x16x32_bf16 v[168:171], a[248:251], v[244:247], v[168:171]
ds_read_b64_tr_b16 a[204:205], v3 offset:28672
v_cvt_pk_bf16_f32 v144, v144, v145
v_mfma_f32_16x16x32_bf16 v[168:171], a[244:247], v[224:227], v[168:171]
ds_read_b64_tr_b16 a[206:207], v3 offset:30720
v_cvt_pk_bf16_f32 v145, v146, v147
v_mfma_f32_16x16x32_bf16 v[168:171], a[240:243], a[112:115], v[168:171]
v_mfma_f32_16x16x32_bf16 v[168:171], a[236:239], a[172:175], v[168:171]
v_mfma_f32_16x16x32_bf16 v[168:171], a[232:235], a[88:91], v[168:171]
ds_read_b64_tr_b16 a[208:209], v3 offset:40960
v_mfma_f32_16x16x32_bf16 v[168:171], a[228:231], a[64:67], v[168:171]
ds_read_b64_tr_b16 a[210:211], v3 offset:43008
v_mfma_f32_16x16x32_bf16 v[168:171], a[224:227], a[176:179], v[168:171]
v_cvt_pk_bf16_f32 v146, v164, v165
v_cvt_pk_bf16_f32 v147, v166, v167
v_mfma_f32_16x16x32_bf16 v[172:175], a[224:227], a[40:43], v[172:175]
s_add_u32 s39, s32, 0
ds_read_b64_tr_b16 a[212:213], v3 offset:45056
v_mfma_f32_16x16x32_bf16 v[172:175], a[228:231], a[80:83], v[172:175]
buffer_store_dwordx4 v[144:147], v18, s[20:23], s39 offen offset:0 sc1
v_mfma_f32_16x16x32_bf16 v[172:175], a[232:235], a[164:167], v[172:175]
ds_read_b64_tr_b16 a[214:215], v3 offset:47104
v_cvt_pk_bf16_f32 v148, v148, v149
v_mfma_f32_16x16x32_bf16 v[172:175], a[236:239], a[188:191], v[172:175]
v_mfma_f32_16x16x32_bf16 v[172:175], a[240:243], a[100:103], v[172:175]
v_mfma_f32_16x16x32_bf16 v[172:175], a[244:247], v[228:231], v[172:175]
ds_read_b64_tr_b16 a[216:217], v3 offset:57344
v_cvt_pk_bf16_f32 v149, v150, v151
v_mfma_f32_16x16x32_bf16 v[172:175], a[248:251], v[248:251], v[172:175]
ds_read_b64_tr_b16 a[218:219], v3 offset:59392
v_mfma_f32_16x16x32_bf16 v[172:175], a[252:255], a[124:127], v[172:175]
v_cvt_pk_bf16_f32 v150, v168, v169
v_cvt_pk_bf16_f32 v151, v170, v171
v_mfma_f32_16x16x32_bf16 v[176:179], a[252:255], a[128:131], v[176:179]
buffer_store_dwordx4 v[148:151], v18, s[20:23], s39 offen offset:1024 sc1
v_mfma_f32_16x16x32_bf16 v[176:179], a[248:251], v[252:255], v[176:179]
ds_read_b64_tr_b16 a[220:221], v3 offset:61440
v_cvt_pk_bf16_f32 v152, v152, v153
v_mfma_f32_16x16x32_bf16 v[176:179], a[244:247], v[232:235], v[176:179]
ds_read_b64_tr_b16 a[222:223], v3 offset:63488
v_cvt_pk_bf16_f32 v153, v154, v155
v_mfma_f32_16x16x32_bf16 v[176:179], a[240:243], a[116:119], v[176:179]
v_mfma_f32_16x16x32_bf16 v[176:179], a[236:239], a[76:79], v[176:179]
v_mfma_f32_16x16x32_bf16 v[176:179], a[232:235], a[180:183], v[176:179]
v_mfma_f32_16x16x32_bf16 v[176:179], a[228:231], a[68:71], v[176:179]
v_mfma_f32_16x16x32_bf16 v[176:179], a[224:227], a[56:59], v[176:179]
v_cvt_pk_bf16_f32 v154, v172, v173
v_cvt_pk_bf16_f32 v155, v174, v175
v_mfma_f32_16x16x32_bf16 v[180:183], a[224:227], a[44:47], v[180:183]
buffer_store_dwordx4 v[152:155], v18, s[20:23], s39 offen offset:2048 sc1
v_mfma_f32_16x16x32_bf16 v[180:183], a[228:231], a[84:87], v[180:183]
v_mfma_f32_16x16x32_bf16 v[180:183], a[232:235], a[168:171], v[180:183]
s_waitcnt vmcnt(3)
s_barrier
v_mfma_f32_16x16x32_bf16 v[180:183], a[236:239], a[92:95], v[180:183]
s_mov_b64 exec, 1
buffer_store_dword v20, off, s[28:31], s55 offset:4 sc1
s_mov_b64 exec, -1
v_mfma_f32_16x16x32_bf16 v[180:183], a[240:243], a[104:107], v[180:183]
v_mfma_f32_16x16x32_bf16 v[180:183], a[244:247], v[236:239], v[180:183]
ds_read_b64_tr_b16 a[224:225], v4 offset:8192
s_waitcnt lgkmcnt(1)
v_mfma_f32_16x16x32_bf16 v[180:183], a[248:251], a[0:3], v[180:183]
ds_read_b64_tr_b16 a[226:227], v4 offset:10240
v_mfma_f32_16x16x32_bf16 v[180:183], a[252:255], a[144:147], v[180:183]
v_mfma_f32_16x16x32_bf16 v[184:187], a[192:195], a[160:163], v[184:187]
v_mfma_f32_16x16x32_bf16 v[184:187], a[196:199], a[60:63], v[184:187]
ds_read_b64_tr_b16 a[228:229], v4 offset:12288
v_mfma_f32_16x16x32_bf16 v[184:187], a[200:203], a[72:75], v[184:187]
ds_read_b64_tr_b16 a[230:231], v4 offset:14336
v_mfma_f32_16x16x32_bf16 v[184:187], a[204:207], a[184:187], v[184:187]
ds_read_b64_tr_b16 a[232:233], v4 offset:24576
v_cvt_pk_bf16_f32 v156, v156, v157
v_mfma_f32_16x16x32_bf16 v[184:187], a[208:211], a[96:99], v[184:187]
ds_read_b64_tr_b16 a[234:235], v4 offset:26624
v_cvt_pk_bf16_f32 v157, v158, v159
v_mfma_f32_16x16x32_bf16 v[184:187], a[212:215], a[120:123], v[184:187]
v_cvt_pk_bf16_f32 v158, v176, v177
v_cvt_pk_bf16_f32 v159, v178, v179
v_mfma_f32_16x16x32_bf16 v[184:187], a[216:219], v[240:243], v[184:187]
buffer_store_dwordx4 v[156:159], v18, s[20:23], s39 offen offset:3072 sc1
v_mfma_f32_16x16x32_bf16 v[184:187], a[220:223], a[16:19], v[184:187]
v_cvt_pk_bf16_f32 v160, v160, v161
v_cvt_pk_bf16_f32 v161, v162, v163
v_mfma_f32_16x16x32_bf16 v[188:191], a[220:223], a[108:111], v[188:191]
v_cvt_pk_bf16_f32 v162, v180, v181
v_cvt_pk_bf16_f32 v163, v182, v183
v_mfma_f32_16x16x32_bf16 v[188:191], a[216:219], v[244:247], v[188:191]
ds_read_b64_tr_b16 a[236:237], v4 offset:28672
s_add_u32 s39, s32, 4096
v_mfma_f32_16x16x32_bf16 v[188:191], a[212:215], v[224:227], v[188:191]
buffer_store_dwordx4 v[160:163], v18, s[20:23], s39 offen offset:0 sc1
v_mfma_f32_16x16x32_bf16 v[188:191], a[208:211], a[112:115], v[188:191]
ds_read_b64_tr_b16 a[238:239], v4 offset:30720
v_mfma_f32_16x16x32_bf16 v[188:191], a[204:207], a[172:175], v[188:191]
v_mfma_f32_16x16x32_bf16 v[188:191], a[200:203], a[88:91], v[188:191]
ds_read_b64_tr_b16 a[240:241], v4 offset:40960
v_mfma_f32_16x16x32_bf16 v[188:191], a[196:199], a[64:67], v[188:191]
ds_read_b64_tr_b16 a[242:243], v4 offset:43008
v_mfma_f32_16x16x32_bf16 v[188:191], a[192:195], a[176:179], v[188:191]
v_mfma_f32_16x16x32_bf16 v[192:195], a[192:195], a[40:43], v[192:195]
v_mfma_f32_16x16x32_bf16 v[192:195], a[196:199], a[80:83], v[192:195]
ds_read_b64_tr_b16 a[244:245], v4 offset:45056
v_mfma_f32_16x16x32_bf16 v[192:195], a[200:203], a[164:167], v[192:195]
ds_read_b64_tr_b16 a[246:247], v4 offset:47104
v_mfma_f32_16x16x32_bf16 v[192:195], a[204:207], a[188:191], v[192:195]
v_mfma_f32_16x16x32_bf16 v[192:195], a[208:211], a[100:103], v[192:195]
v_mfma_f32_16x16x32_bf16 v[192:195], a[212:215], v[228:231], v[192:195]
ds_read_b64_tr_b16 a[248:249], v4 offset:57344
v_mfma_f32_16x16x32_bf16 v[192:195], a[216:219], v[248:251], v[192:195]
ds_read_b64_tr_b16 a[250:251], v4 offset:59392
v_mfma_f32_16x16x32_bf16 v[192:195], a[220:223], a[124:127], v[192:195]
v_mfma_f32_16x16x32_bf16 v[196:199], a[220:223], a[128:131], v[196:199]
v_mfma_f32_16x16x32_bf16 v[196:199], a[216:219], v[252:255], v[196:199]
ds_read_b64_tr_b16 a[252:253], v4 offset:61440
v_mfma_f32_16x16x32_bf16 v[196:199], a[212:215], v[232:235], v[196:199]
ds_read_b64_tr_b16 a[254:255], v4 offset:63488
v_mfma_f32_16x16x32_bf16 v[196:199], a[208:211], a[116:119], v[196:199]
v_mfma_f32_16x16x32_bf16 v[196:199], a[204:207], a[76:79], v[196:199]
v_mfma_f32_16x16x32_bf16 v[196:199], a[200:203], a[180:183], v[196:199]
v_mfma_f32_16x16x32_bf16 v[196:199], a[196:199], a[68:71], v[196:199]
v_mfma_f32_16x16x32_bf16 v[196:199], a[192:195], a[56:59], v[196:199]
v_mfma_f32_16x16x32_bf16 v[200:203], a[192:195], a[44:47], v[200:203]
v_mfma_f32_16x16x32_bf16 v[200:203], a[196:199], a[84:87], v[200:203]
v_mfma_f32_16x16x32_bf16 v[200:203], a[200:203], a[168:171], v[200:203]
v_mfma_f32_16x16x32_bf16 v[200:203], a[204:207], a[92:95], v[200:203]
buffer_load_dword v7, v11, s[28:31], 0 offen sc1
v_mfma_f32_16x16x32_bf16 v[200:203], a[208:211], a[104:107], v[200:203]
v_mfma_f32_16x16x32_bf16 v[200:203], a[212:215], v[236:239], v[200:203]
s_waitcnt lgkmcnt(0)
v_mfma_f32_16x16x32_bf16 v[200:203], a[216:219], a[0:3], v[200:203]
v_mfma_f32_16x16x32_bf16 v[200:203], a[220:223], a[144:147], v[200:203]
v_mfma_f32_16x16x32_bf16 v[204:207], a[224:227], a[160:163], v[204:207]
v_mfma_f32_16x16x32_bf16 v[204:207], a[228:231], a[60:63], v[204:207]
v_mfma_f32_16x16x32_bf16 v[204:207], a[232:235], a[72:75], v[204:207]
v_mfma_f32_16x16x32_bf16 v[204:207], a[236:239], a[184:187], v[204:207]
v_mfma_f32_16x16x32_bf16 v[204:207], a[240:243], a[96:99], v[204:207]
v_mfma_f32_16x16x32_bf16 v[204:207], a[244:247], a[120:123], v[204:207]
v_mfma_f32_16x16x32_bf16 v[204:207], a[248:251], v[240:243], v[204:207]
v_mfma_f32_16x16x32_bf16 v[204:207], a[252:255], a[16:19], v[204:207]
v_mfma_f32_16x16x32_bf16 v[208:211], a[252:255], a[108:111], v[208:211]
v_mfma_f32_16x16x32_bf16 v[208:211], a[248:251], v[244:247], v[208:211]
v_mfma_f32_16x16x32_bf16 v[208:211], a[244:247], v[224:227], v[208:211]
v_mfma_f32_16x16x32_bf16 v[208:211], a[240:243], a[112:115], v[208:211]
v_mfma_f32_16x16x32_bf16 v[208:211], a[236:239], a[172:175], v[208:211]
v_mfma_f32_16x16x32_bf16 v[208:211], a[232:235], a[88:91], v[208:211]
v_mfma_f32_16x16x32_bf16 v[208:211], a[228:231], a[64:67], v[208:211]
v_mfma_f32_16x16x32_bf16 v[208:211], a[224:227], a[176:179], v[208:211]
v_mfma_f32_16x16x32_bf16 v[212:215], a[224:227], a[40:43], v[212:215]
v_mfma_f32_16x16x32_bf16 v[212:215], a[228:231], a[80:83], v[212:215]
v_mfma_f32_16x16x32_bf16 v[212:215], a[232:235], a[164:167], v[212:215]
v_mfma_f32_16x16x32_bf16 v[212:215], a[236:239], a[188:191], v[212:215]
v_mfma_f32_16x16x32_bf16 v[212:215], a[240:243], a[100:103], v[212:215]
v_mfma_f32_16x16x32_bf16 v[212:215], a[244:247], v[228:231], v[212:215]
v_mfma_f32_16x16x32_bf16 v[212:215], a[248:251], v[248:251], v[212:215]
v_mfma_f32_16x16x32_bf16 v[212:215], a[252:255], a[124:127], v[212:215]
v_mfma_f32_16x16x32_bf16 v[216:219], a[252:255], a[128:131], v[216:219]
v_mfma_f32_16x16x32_bf16 v[216:219], a[248:251], v[252:255], v[216:219]
v_mfma_f32_16x16x32_bf16 v[216:219], a[244:247], v[232:235], v[216:219]
v_mfma_f32_16x16x32_bf16 v[216:219], a[240:243], a[116:119], v[216:219]
v_mfma_f32_16x16x32_bf16 v[216:219], a[236:239], a[76:79], v[216:219]
s_waitcnt vmcnt(1)
s_barrier
v_mfma_f32_16x16x32_bf16 v[216:219], a[232:235], a[180:183], v[216:219]
s_mov_b64 exec, 1
buffer_store_dword v20, off, s[28:31], s55 offset:0 sc1
s_mov_b64 exec, -1
v_mfma_f32_16x16x32_bf16 v[216:219], a[228:231], a[68:71], v[216:219]
v_mfma_f32_16x16x32_bf16 v[216:219], a[224:227], a[56:59], v[216:219]
v_mfma_f32_16x16x32_bf16 v[220:223], a[224:227], a[44:47], v[220:223]
v_mfma_f32_16x16x32_bf16 v[220:223], a[228:231], a[84:87], v[220:223]
v_mfma_f32_16x16x32_bf16 v[220:223], a[232:235], a[168:171], v[220:223]
v_mfma_f32_16x16x32_bf16 v[220:223], a[236:239], a[92:95], v[220:223]
v_mfma_f32_16x16x32_bf16 v[220:223], a[240:243], a[104:107], v[220:223]
v_mfma_f32_16x16x32_bf16 v[220:223], a[244:247], v[236:239], v[220:223]
v_mfma_f32_16x16x32_bf16 v[220:223], a[248:251], a[0:3], v[220:223]
v_mfma_f32_16x16x32_bf16 v[220:223], a[252:255], a[144:147], v[220:223]
s_waitcnt vmcnt(1)
K2_PSo:
v_cmp_eq_u32 s[84:85], 1, v7
s_add_u32 s78, s78, 1
s_cmp_gt_u32 s78, 0x40000
s_nop 0
s_cselect_b32 s84, 7, s84
s_andn2_b32 s85, s84, s40
s_or_b32 s40, s40, s84
s_and_b32 s40, s40, 7
s_bitcmp0_b32 s85, 2
s_cbranch_scc1 K2_W3o
buffer_load_dwordx4 a[4:7], v18, s[20:23], s35 offen offset:0 sc1
buffer_load_dwordx4 a[24:27], v18, s[20:23], s35 offen offset:1024 sc1
buffer_load_dwordx4 a[32:35], v18, s[20:23], s35 offen offset:2048 sc1
buffer_load_dwordx4 a[52:55], v18, s[20:23], s35 offen offset:3072 sc1
s_add_u32 s46, s35, 4096
buffer_load_dwordx4 a[140:143], v18, s[20:23], s46 offen offset:0 sc1
K2_W3o:
s_bitcmp0_b32 s85, 1
s_cbranch_scc1 K2_W2o
buffer_load_dwordx4 a[148:151], v18, s[20:23], s34 offen offset:0 sc1
buffer_load_dwordx4 a[8:11], v18, s[20:23], s34 offen offset:1024 sc1
buffer_load_dwordx4 a[28:31], v18, s[20:23], s34 offen offset:2048 sc1
buffer_load_dwordx4 a[36:39], v18, s[20:23], s34 offen offset:3072 sc1
s_add_u32 s46, s34, 4096
buffer_load_dwordx4 a[152:155], v18, s[20:23], s46 offen offset:0 sc1
K2_W2o:
s_bitcmp0_b32 s85, 0
s_cbranch_scc1 K2_W1o
buffer_load_dwordx4 a[132:135], v18, s[20:23], s33 offen offset:0 sc1
buffer_load_dwordx4 a[20:23], v18, s[20:23], s33 offen offset:1024 sc1
buffer_load_dwordx4 a[12:15], v18, s[20:23], s33 offen offset:2048 sc1
buffer_load_dwordx4 a[48:51], v18, s[20:23], s33 offen offset:3072 sc1
s_add_u32 s46, s33, 4096
buffer_load_dwordx4 a[136:139], v18, s[20:23], s46 offen offset:0 sc1
K2_W1o:
s_cmp_lg_u32 s40, 7
s_cbranch_scc1 K2_WXo
K2_GOo:
s_waitcnt vmcnt(4)
v_mfma_f32_16x16x32_bf16 v[184:187], v[32:35], a[4:7], v[184:187]
v_mfma_f32_16x16x32_bf16 v[184:187], v[32:35], a[148:151], v[184:187]
v_mfma_f32_16x16x32_bf16 v[184:187], v[32:35], a[132:135], v[184:187]
v_mfma_f32_16x16x32_bf16 v[204:207], v[36:39], a[4:7], v[204:207]
v_mfma_f32_16x16x32_bf16 v[204:207], v[36:39], a[148:151], v[204:207]
v_mfma_f32_16x16x32_bf16 v[204:207], v[36:39], a[132:135], v[204:207]
s_waitcnt vmcnt(3)
v_mfma_f32_16x16x32_bf16 v[188:191], v[32:35], a[24:27], v[188:191]
v_mfma_f32_16x16x32_bf16 v[188:191], v[32:35], a[8:11], v[188:191]
v_mfma_f32_16x16x32_bf16 v[188:191], v[32:35], a[20:23], v[188:191]
v_mfma_f32_16x16x32_bf16 v[208:211], v[36:39], a[24:27], v[208:211]
v_mfma_f32_16x16x32_bf16 v[208:211], v[36:39], a[8:11], v[208:211]
v_mfma_f32_16x16x32_bf16 v[208:211], v[36:39], a[20:23], v[208:211]
v_cvt_pk_bf16_f32 v184, v184, v185
v_cvt_pk_bf16_f32 v185, v186, v187
v_cvt_pk_bf16_f32 v186, v204, v205
v_cvt_pk_bf16_f32 v187, v206, v207
s_nop 1
v_permlane16_swap_b32 v184, v186
v_permlane16_swap_b32 v185, v187
ds_write_b128 v17, v[184:187] offset:0
ds_read_b128 v[144:147], v12 offset:0
s_waitcnt vmcnt(2)
v_mfma_f32_16x16x32_bf16 v[192:195], v[32:35], a[32:35], v[192:195]
v_mfma_f32_16x16x32_bf16 v[192:195], v[32:35], a[28:31], v[192:195]
v_mfma_f32_16x16x32_bf16 v[192:195], v[32:35], a[12:15], v[192:195]
v_mfma_f32_16x16x32_bf16 v[212:215], v[36:39], a[32:35], v[212:215]
v_mfma_f32_16x16x32_bf16 v[212:215], v[36:39], a[28:31], v[212:215]
v_mfma_f32_16x16x32_bf16 v[212:215], v[36:39], a[12:15], v[212:215]
v_cvt_pk_bf16_f32 v188, v188, v189
v_cvt_pk_bf16_f32 v189, v190, v191
v_cvt_pk_bf16_f32 v190, v208, v209
v_cvt_pk_bf16_f32 v191, v210, v211
s_nop 1
v_permlane16_swap_b32 v188, v190
v_permlane16_swap_b32 v189, v191
ds_write_b128 v17, v[188:191] offset:1024
ds_read_b128 v[148:151], v12 offset:1024
s_waitcnt vmcnt(1)
v_mfma_f32_16x16x32_bf16 v[196:199], v[32:35], a[52:55], v[196:199]
v_mfma_f32_16x16x32_bf16 v[196:199], v[32:35], a[36:39], v[196:199]
v_mfma_f32_16x16x32_bf16 v[196:199], v[32:35], a[48:51], v[196:199]
v_mfma_f32_16x16x32_bf16 v[216:219], v[36:39], a[52:55], v[216:219]
v_mfma_f32_16x16x32_bf16 v[216:219], v[36:39], a[36:39], v[216:219]
v_mfma_f32_16x16x32_bf16 v[216:219], v[36:39], a[48:51], v[216:219]
v_cvt_pk_bf16_f32 v192, v192, v193
v_cvt_pk_bf16_f32 v193, v194, v195
v_cvt_pk_bf16_f32 v194, v212, v213
v_cvt_pk_bf16_f32 v195, v214, v215
s_nop 1
v_permlane16_swap_b32 v192, v194
v_permlane16_swap_b32 v193, v195
ds_write_b128 v17, v[192:195] offset:2048
ds_read_b128 v[152:155], v12 offset:2048
s_waitcnt vmcnt(0)
v_mfma_f32_16x16x32_bf16 v[200:203], v[32:35], a[140:143], v[200:203]
v_mfma_f32_16x16x32_bf16 v[200:203], v[32:35], a[152:155], v[200:203]
v_mfma_f32_16x16x32_bf16 v[200:203], v[32:35], a[136:139], v[200:203]
v_mfma_f32_16x16x32_bf16 v[220:223], v[36:39], a[140:143], v[220:223]
v_mfma_f32_16x16x32_bf16 v[220:223], v[36:39], a[152:155], v[220:223]
v_mfma_f32_16x16x32_bf16 v[220:223], v[36:39], a[136:139], v[220:223]
v_cvt_pk_bf16_f32 v196, v196, v197
v_cvt_pk_bf16_f32 v197, v198, v199
v_cvt_pk_bf16_f32 v198, v216, v217
v_cvt_pk_bf16_f32 v199, v218, v219
s_nop 1
v_permlane16_swap_b32 v196, v198
v_permlane16_swap_b32 v197, v199
ds_write_b128 v17, v[196:199] offset:3072
ds_read_b128 v[156:159], v12 offset:3072
s_mov_b32 s87, 0
s_waitcnt lgkmcnt(6)
buffer_store_dwordx4 v[144:147], v10, s[12:15], s87 offen sc1
s_mov_b32 s87, 40960
s_waitcnt lgkmcnt(4)
buffer_store_dwordx4 v[148:151], v10, s[12:15], s87 offen sc1
s_mov_b32 s87, 81920
s_waitcnt lgkmcnt(2)
buffer_store_dwordx4 v[152:155], v10, s[12:15], s87 offen sc1
v_cvt_pk_bf16_f32 v200, v200, v201
v_cvt_pk_bf16_f32 v201, v202, v203
v_cvt_pk_bf16_f32 v202, v220, v221
v_cvt_pk_bf16_f32 v203, v222, v223
s_nop 1
v_permlane16_swap_b32 v200, v202
v_permlane16_swap_b32 v201, v203
ds_write_b128 v17, v[200:203] offset:4096
ds_read_b128 v[160:163], v12 offset:4096
s_mov_b32 s87, 122880
s_waitcnt lgkmcnt(2)
buffer_store_dwordx4 v[156:159], v10, s[12:15], s87 offen sc1
s_mov_b32 s87, 163840
s_waitcnt lgkmcnt(0)
buffer_store_dwordx4 v[160:163], v10, s[12:15], s87 offen sc1
s_endpgm
K2_WXo:
buffer_load_dword v7, v11, s[28:31], 0 offen sc1
s_waitcnt vmcnt(0)
s_branch K2_PSo
K2_SPIN12o:
s_add_u32 s78, s78, 1
s_cmp_gt_u32 s78, 0x40000
s_cbranch_scc1 K2_RET12o
s_sleep 4
buffer_load_dword v9, off, s[28:31], s51 sc1
s_waitcnt vmcnt(0)
v_readfirstlane_b32 s88, v9
s_nop 3
s_cmp_lt_u32 s88, 32
s_cbranch_scc1 K2_SPIN12o
s_branch K2_RET12o
K2_BODYe:
v_mfma_f32_16x16x32_bf16 v[64:67], a[192:195], a[164:167], v[64:67]
ds_read_b64_tr_b16 a[208:209], v3 offset:32768
s_mov_b32 s46, 2334720
v_mfma_f32_16x16x32_bf16 v[64:67], a[196:199], a[188:191], v[64:67]
ds_read_b64_tr_b16 a[210:211], v3 offset:34816
v_mfma_f32_16x16x32_bf16 v[68:71], a[192:195], a[180:183], v[68:71]
buffer_load_dwordx4 v[228:231], v18, s[8:11], s46 offen offset:0 sc1
v_mfma_f32_16x16x32_bf16 v[68:71], a[196:199], a[76:79], v[68:71]
ds_read_b64_tr_b16 a[212:213], v3 offset:36864
v_mfma_f32_16x16x32_bf16 v[72:75], a[192:195], a[168:171], v[72:75]
v_mfma_f32_16x16x32_bf16 v[72:75], a[196:199], a[92:95], v[72:75]
ds_read_b64_tr_b16 a[214:215], v3 offset:38912
v_mfma_f32_16x16x32_bf16 v[76:79], a[192:195], a[184:187], v[76:79]
v_mfma_f32_16x16x32_bf16 v[76:79], a[196:199], a[96:99], v[76:79]
buffer_load_dwordx4 v[232:235], v18, s[8:11], s46 offen offset:1024 sc1
v_mfma_f32_16x16x32_bf16 v[80:83], a[192:195], a[172:175], v[80:83]
ds_read_b64_tr_b16 a[216:217], v4 offset:32768
s_waitcnt lgkmcnt(5)
v_mfma_f32_16x16x32_bf16 v[80:83], a[196:199], a[112:115], v[80:83]
v_mfma_f32_16x16x32_bf16 v[84:87], a[200:203], a[164:167], v[84:87]
ds_read_b64_tr_b16 a[218:219], v4 offset:34816
v_mfma_f32_16x16x32_bf16 v[84:87], a[204:207], a[188:191], v[84:87]
v_mfma_f32_16x16x32_bf16 v[88:91], a[200:203], a[180:183], v[88:91]
buffer_load_dwordx4 v[236:239], v18, s[8:11], s46 offen offset:2048 sc1
v_mfma_f32_16x16x32_bf16 v[88:91], a[204:207], a[76:79], v[88:91]
ds_read_b64_tr_b16 a[220:221], v4 offset:36864
v_mfma_f32_16x16x32_bf16 v[92:95], a[200:203], a[168:171], v[92:95]
ds_read_b64_tr_b16 a[222:223], v4 offset:38912
v_mfma_f32_16x16x32_bf16 v[92:95], a[204:207], a[92:95], v[92:95]
v_mfma_f32_16x16x32_bf16 v[96:99], a[200:203], a[184:187], v[96:99]
ds_read_b64_tr_b16 a[224:225], v1 offset:40960
v_mfma_f32_16x16x32_bf16 v[96:99], a[204:207], a[96:99], v[96:99]
buffer_load_dwordx4 v[240:243], v18, s[8:11], s46 offen offset:3072 sc1
v_mfma_f32_16x16x32_bf16 v[100:103], a[200:203], a[172:175], v[100:103]
s_waitcnt lgkmcnt(5)
ds_read_b64_tr_b16 a[226:227], v1 offset:43008
v_mfma_f32_16x16x32_bf16 v[100:103], a[204:207], a[112:115], v[100:103]
s_mov_b32 s46, 2338816
ds_read_b64_tr_b16 a[228:229], v1 offset:45056
v_mfma_f32_16x16x32_bf16 v[104:107], a[208:211], a[164:167], v[104:107]
v_mfma_f32_16x16x32_bf16 v[104:107], a[212:215], a[188:191], v[104:107]
v_mfma_f32_16x16x32_bf16 v[108:111], a[208:211], a[180:183], v[108:111]
buffer_load_dwordx4 v[244:247], v18, s[8:11], s46 offen offset:0 sc1
v_mfma_f32_16x16x32_bf16 v[108:111], a[212:215], a[76:79], v[108:111]
ds_read_b64_tr_b16 a[230:231], v1 offset:47104
s_add_u32 m0, s41, 0
v_mfma_f32_16x16x32_bf16 v[112:115], a[208:211], a[168:171], v[112:115]
s_mov_b32 s46, 3932160
ds_read_b64_tr_b16 a[232:233], v2 offset:40960
v_mfma_f32_16x16x32_bf16 v[112:115], a[212:215], a[92:95], v[112:115]
v_mfma_f32_16x16x32_bf16 v[116:119], a[208:211], a[184:187], v[116:119]
v_mfma_f32_16x16x32_bf16 v[116:119], a[212:215], a[96:99], v[116:119]
buffer_load_dwordx4 v21, s[4:7], s46 offen offset:0 lds
v_mfma_f32_16x16x32_bf16 v[120:123], a[208:211], a[172:175], v[120:123]
ds_read_b64_tr_b16 a[234:235], v2 offset:43008
s_waitcnt lgkmcnt(6)
v_mfma_f32_16x16x32_bf16 v[120:123], a[212:215], a[112:115], v[120:123]
s_mov_b32 s46, 3941376
ds_read_b64_tr_b16 a[236:237], v2 offset:45056
v_mfma_f32_16x16x32_bf16 v[124:127], a[216:219], a[164:167], v[124:127]
v_mfma_f32_16x16x32_bf16 v[124:127], a[220:223], a[188:191], v[124:127]
v_mfma_f32_16x16x32_bf16 v[128:131], a[216:219], a[180:183], v[128:131]
buffer_load_dwordx4 v21, s[4:7], s46 offen offset:1024 lds
v_mfma_f32_16x16x32_bf16 v[128:131], a[220:223], a[76:79], v[128:131]
ds_read_b64_tr_b16 a[238:239], v2 offset:47104
s_mov_b32 s46, 3950592
v_mfma_f32_16x16x32_bf16 v[132:135], a[216:219], a[168:171], v[132:135]
ds_read_b64_tr_b16 a[240:241], v3 offset:40960
v_mfma_f32_16x16x32_bf16 v[132:135], a[220:223], a[92:95], v[132:135]
v_mfma_f32_16x16x32_bf16 v[136:139], a[216:219], a[184:187], v[136:139]
v_mfma_f32_16x16x32_bf16 v[136:139], a[220:223], a[96:99], v[136:139]
buffer_load_dwordx4 v21, s[4:7], s46 offen offset:2048 lds
v_mfma_f32_16x16x32_bf16 v[140:143], a[216:219], a[172:175], v[140:143]
ds_read_b64_tr_b16 a[242:243], v3 offset:43008
s_waitcnt lgkmcnt(6)
v_mfma_f32_16x16x32_bf16 v[140:143], a[220:223], a[112:115], v[140:143]
ds_read_b64_tr_b16 a[244:245], v3 offset:45056
s_mov_b32 s46, 3959808
v_mfma_f32_16x16x32_bf16 v[144:147], a[224:227], a[164:167], v[144:147]
v_mfma_f32_16x16x32_bf16 v[144:147], a[228:231], a[188:191], v[144:147]
ds_read_b64_tr_b16 a[246:247], v3 offset:47104
v_mfma_f32_16x16x32_bf16 v[148:151], a[224:227], a[180:183], v[148:151]
buffer_load_dwordx4 v21, s[4:7], s46 offen offset:3072 lds
v_mfma_f32_16x16x32_bf16 v[148:151], a[228:231], a[76:79], v[148:151]
ds_read_b64_tr_b16 a[248:249], v4 offset:40960
s_mov_b32 s46, 2457600
v_mfma_f32_16x16x32_bf16 v[152:155], a[224:227], a[168:171], v[152:155]
v_mfma_f32_16x16x32_bf16 v[152:155], a[228:231], a[92:95], v[152:155]
v_mfma_f32_16x16x32_bf16 v[156:159], a[224:227], a[184:187], v[156:159]
ds_read_b64_tr_b16 a[250:251], v4 offset:43008
v_mfma_f32_16x16x32_bf16 v[156:159], a[228:231], a[96:99], v[156:159]
buffer_load_dwordx4 v[248:251], v18, s[8:11], s46 offen offset:0 sc1
v_mfma_f32_16x16x32_bf16 v[160:163], a[224:227], a[172:175], v[160:163]
ds_read_b64_tr_b16 a[252:253], v4 offset:45056
s_waitcnt lgkmcnt(7)
v_mfma_f32_16x16x32_bf16 v[160:163], a[228:231], a[112:115], v[160:163]
v_mfma_f32_16x16x32_bf16 v[164:167], a[232:235], a[164:167], v[164:167]
ds_read_b64_tr_b16 a[254:255], v4 offset:47104
v_mfma_f32_16x16x32_bf16 v[164:167], a[236:239], a[188:191], v[164:167]
v_mfma_f32_16x16x32_bf16 v[168:171], a[232:235], a[180:183], v[168:171]
buffer_load_dwordx4 v[252:255], v18, s[8:11], s46 offen offset:1024 sc1
v_mfma_f32_16x16x32_bf16 v[168:171], a[236:239], a[76:79], v[168:171]
v_mfma_f32_16x16x32_bf16 v[172:175], a[232:235], a[168:171], v[172:175]
v_mfma_f32_16x16x32_bf16 v[172:175], a[236:239], a[92:95], v[172:175]
v_mfma_f32_16x16x32_bf16 v[176:179], a[232:235], a[184:187], v[176:179]
v_mfma_f32_16x16x32_bf16 v[176:179], a[236:239], a[96:99], v[176:179]
buffer_load_dwordx4 a[0:3], v18, s[8:11], s46 offen offset:2048 sc1
v_mfma_f32_16x16x32_bf16 v[180:183], a[232:235], a[172:175], v[180:183]
s_waitcnt lgkmcnt(4)
v_mfma_f32_16x16x32_bf16 v[180:183], a[236:239], a[112:115], v[180:183]
v_mfma_f32_16x16x32_bf16 v[184:187], a[240:243], a[164:167], v[184:187]
v_mfma_f32_16x16x32_bf16 v[184:187], a[244:247], a[188:191], v[184:187]
ds_read_b64_tr_b16 a[192:193], v1 offset:49152
v_mfma_f32_16x16x32_bf16 v[188:191], a[240:243], a[180:183], v[188:191]
buffer_load_dwordx4 a[16:19], v18, s[8:11], s46 offen offset:3072 sc1
v_mfma_f32_16x16x32_bf16 v[188:191], a[244:247], a[76:79], v[188:191]
ds_read_b64_tr_b16 a[194:195], v1 offset:51200
s_mov_b32 s46, 2461696
v_mfma_f32_16x16x32_bf16 v[192:195], a[240:243], a[168:171], v[192:195]
ds_read_b64_tr_b16 a[196:197], v1 offset:53248
v_mfma_f32_16x16x32_bf16 v[192:195], a[244:247], a[92:95], v[192:195]
ds_read_b64_tr_b16 a[198:199], v1 offset:55296
v_mfma_f32_16x16x32_bf16 v[196:199], a[240:243], a[184:187], v[196:199]
v_mfma_f32_16x16x32_bf16 v[196:199], a[244:247], a[96:99], v[196:199]
buffer_load_dwordx4 a[108:111], v18, s[8:11], s46 offen offset:0 sc1
v_mfma_f32_16x16x32_bf16 v[200:203], a[240:243], a[172:175], v[200:203]
ds_read_b64_tr_b16 a[200:201], v2 offset:49152
s_waitcnt lgkmcnt(5)
v_mfma_f32_16x16x32_bf16 v[200:203], a[244:247], a[112:115], v[200:203]
ds_read_b64_tr_b16 a[202:203], v2 offset:51200
s_mov_b32 s46, 2580480
v_mfma_f32_16x16x32_bf16 v[204:207], a[248:251], a[164:167], v[204:207]
v_mfma_f32_16x16x32_bf16 v[204:207], a[252:255], a[188:191], v[204:207]
ds_read_b64_tr_b16 a[204:205], v2 offset:53248
v_mfma_f32_16x16x32_bf16 v[208:211], a[248:251], a[180:183], v[208:211]
buffer_load_dwordx4 a[124:127], v18, s[8:11], s46 offen offset:0 sc1
v_mfma_f32_16x16x32_bf16 v[208:211], a[252:255], a[76:79], v[208:211]
ds_read_b64_tr_b16 a[206:207], v2 offset:55296
v_mfma_f32_16x16x32_bf16 v[212:215], a[248:251], a[168:171], v[212:215]
v_mfma_f32_16x16x32_bf16 v[212:215], a[252:255], a[92:95], v[212:215]
v_mfma_f32_16x16x32_bf16 v[216:219], a[248:251], a[184:187], v[216:219]
v_mfma_f32_16x16x32_bf16 v[216:219], a[252:255], a[96:99], v[216:219]
buffer_load_dwordx4 a[128:131], v18, s[8:11], s46 offen offset:1024 sc1
v_mfma_f32_16x16x32_bf16 v[220:223], a[248:251], a[172:175], v[220:223]
s_waitcnt vmcnt(11) lgkmcnt(4)
v_mfma_f32_16x16x32_bf16 v[220:223], a[252:255], a[112:115], v[220:223]
v_mfma_f32_16x16x32_bf16 v[64:67], a[192:195], a[100:103], v[64:67]
ds_read_b64_tr_b16 a[208:209], v3 offset:49152
s_mov_b32 s46, 2580480
v_mfma_f32_16x16x32_bf16 v[64:67], a[196:199], v[228:231], v[64:67]
ds_read_b64_tr_b16 a[210:211], v3 offset:51200
v_mfma_f32_16x16x32_bf16 v[68:71], a[192:195], a[116:119], v[68:71]
buffer_load_dwordx4 a[144:147], v18, s[8:11], s46 offen offset:2048 sc1
v_mfma_f32_16x16x32_bf16 v[68:71], a[196:199], v[232:235], v[68:71]
ds_read_b64_tr_b16 a[212:213], v3 offset:53248
v_mfma_f32_16x16x32_bf16 v[72:75], a[192:195], a[104:107], v[72:75]
v_mfma_f32_16x16x32_bf16 v[72:75], a[196:199], v[236:239], v[72:75]
ds_read_b64_tr_b16 a[214:215], v3 offset:55296
v_mfma_f32_16x16x32_bf16 v[76:79], a[192:195], a[120:123], v[76:79]
v_mfma_f32_16x16x32_bf16 v[76:79], a[196:199], v[240:243], v[76:79]
buffer_load_dwordx4 a[132:135], v18, s[8:11], s46 offen offset:3072 sc1
v_mfma_f32_16x16x32_bf16 v[80:83], a[192:195], v[224:227], v[80:83]
ds_read_b64_tr_b16 a[216:217], v4 offset:49152
s_waitcnt lgkmcnt(5)
v_mfma_f32_16x16x32_bf16 v[80:83], a[196:199], v[244:247], v[80:83]
s_mov_b32 s46, 2584576
ds_read_b64_tr_b16 a[218:219], v4 offset:51200
v_mfma_f32_16x16x32_bf16 v[84:87], a[200:203], a[100:103], v[84:87]
v_mfma_f32_16x16x32_bf16 v[84:87], a[204:207], v[228:231], v[84:87]
v_mfma_f32_16x16x32_bf16 v[88:91], a[200:203], a[116:119], v[88:91]
buffer_load_dwordx4 a[148:151], v18, s[8:11], s46 offen offset:0 sc1
v_mfma_f32_16x16x32_bf16 v[88:91], a[204:207], v[232:235], v[88:91]
ds_read_b64_tr_b16 a[220:221], v4 offset:53248
s_mov_b32 s46, 2703360
v_mfma_f32_16x16x32_bf16 v[92:95], a[200:203], a[104:107], v[92:95]
ds_read_b64_tr_b16 a[222:223], v4 offset:55296
v_mfma_f32_16x16x32_bf16 v[92:95], a[204:207], v[236:239], v[92:95]
v_mfma_f32_16x16x32_bf16 v[96:99], a[200:203], a[120:123], v[96:99]
ds_read_b64_tr_b16 a[224:225], v1 offset:57344
v_mfma_f32_16x16x32_bf16 v[96:99], a[204:207], v[240:243], v[96:99]
buffer_load_dwordx4 a[4:7], v18, s[8:11], s46 offen offset:0 sc1
v_mfma_f32_16x16x32_bf16 v[100:103], a[200:203], v[224:227], v[100:103]
s_waitcnt lgkmcnt(5)
ds_read_b64_tr_b16 a[226:227], v1 offset:59392
v_mfma_f32_16x16x32_bf16 v[100:103], a[204:207], v[244:247], v[100:103]
v_mfma_f32_16x16x32_bf16 v[104:107], a[208:211], a[100:103], v[104:107]
v_mfma_f32_16x16x32_bf16 v[104:107], a[212:215], v[228:231], v[104:107]
ds_read_b64_tr_b16 a[228:229], v1 offset:61440
v_mfma_f32_16x16x32_bf16 v[108:111], a[208:211], a[116:119], v[108:111]
buffer_load_dwordx4 a[20:23], v18, s[8:11], s46 offen offset:1024 sc1
v_mfma_f32_16x16x32_bf16 v[108:111], a[212:215], v[232:235], v[108:111]
ds_read_b64_tr_b16 a[230:231], v1 offset:63488
s_add_u32 m0, s41, 4096
v_mfma_f32_16x16x32_bf16 v[112:115], a[208:211], a[104:107], v[112:115]
s_mov_b32 s46, 3973120
ds_read_b64_tr_b16 a[232:233], v2 offset:57344
v_mfma_f32_16x16x32_bf16 v[112:115], a[212:215], v[236:239], v[112:115]
v_mfma_f32_16x16x32_bf16 v[116:119], a[208:211], a[120:123], v[116:119]
v_mfma_f32_16x16x32_bf16 v[116:119], a[212:215], v[240:243], v[116:119]
buffer_load_dwordx4 v21, s[4:7], s46 offen offset:0 lds
v_mfma_f32_16x16x32_bf16 v[120:123], a[208:211], v[224:227], v[120:123]
ds_read_b64_tr_b16 a[234:235], v2 offset:59392
s_waitcnt lgkmcnt(6)
v_mfma_f32_16x16x32_bf16 v[120:123], a[212:215], v[244:247], v[120:123]
s_mov_b32 s46, 3982336
ds_read_b64_tr_b16 a[236:237], v2 offset:61440
v_mfma_f32_16x16x32_bf16 v[124:127], a[216:219], a[100:103], v[124:127]
v_mfma_f32_16x16x32_bf16 v[124:127], a[220:223], v[228:231], v[124:127]
v_mfma_f32_16x16x32_bf16 v[128:131], a[216:219], a[116:119], v[128:131]
buffer_load_dwordx4 v21, s[4:7], s46 offen offset:1024 lds
v_mfma_f32_16x16x32_bf16 v[128:131], a[220:223], v[232:235], v[128:131]
ds_read_b64_tr_b16 a[238:239], v2 offset:63488
s_mov_b32 s46, 3991552
v_mfma_f32_16x16x32_bf16 v[132:135], a[216:219], a[104:107], v[132:135]
ds_read_b64_tr_b16 a[240:241], v3 offset:57344
v_mfma_f32_16x16x32_bf16 v[132:135], a[220:223], v[236:239], v[132:135]
v_mfma_f32_16x16x32_bf16 v[136:139], a[216:219], a[120:123], v[136:139]
v_mfma_f32_16x16x32_bf16 v[136:139], a[220:223], v[240:243], v[136:139]
buffer_load_dwordx4 v21, s[4:7], s46 offen offset:2048 lds
v_mfma_f32_16x16x32_bf16 v[140:143], a[216:219], v[224:227], v[140:143]
ds_read_b64_tr_b16 a[242:243], v3 offset:59392
s_waitcnt lgkmcnt(6)
v_mfma_f32_16x16x32_bf16 v[140:143], a[220:223], v[244:247], v[140:143]
ds_read_b64_tr_b16 a[244:245], v3 offset:61440
s_mov_b32 s46, 4000768
v_mfma_f32_16x16x32_bf16 v[144:147], a[224:227], a[100:103], v[144:147]
v_mfma_f32_16x16x32_bf16 v[144:147], a[228:231], v[228:231], v[144:147]
ds_read_b64_tr_b16 a[246:247], v3 offset:63488
v_mfma_f32_16x16x32_bf16 v[148:151], a[224:227], a[116:119], v[148:151]
buffer_load_dwordx4 v21, s[4:7], s46 offen offset:3072 lds
v_mfma_f32_16x16x32_bf16 v[148:151], a[228:231], v[232:235], v[148:151]
ds_read_b64_tr_b16 a[248:249], v4 offset:57344
s_mov_b32 s46, 2703360
v_mfma_f32_16x16x32_bf16 v[152:155], a[224:227], a[104:107], v[152:155]
v_mfma_f32_16x16x32_bf16 v[152:155], a[228:231], v[236:239], v[152:155]
v_mfma_f32_16x16x32_bf16 v[156:159], a[224:227], a[120:123], v[156:159]
ds_read_b64_tr_b16 a[250:251], v4 offset:59392
v_mfma_f32_16x16x32_bf16 v[156:159], a[228:231], v[240:243], v[156:159]
buffer_load_dwordx4 a[8:11], v18, s[8:11], s46 offen offset:2048 sc1
v_mfma_f32_16x16x32_bf16 v[160:163], a[224:227], v[224:227], v[160:163]
ds_read_b64_tr_b16 a[252:253], v4 offset:61440
s_waitcnt lgkmcnt(7)
v_mfma_f32_16x16x32_bf16 v[160:163], a[228:231], v[244:247], v[160:163]
v_mfma_f32_16x16x32_bf16 v[164:167], a[232:235], a[100:103], v[164:167]
ds_read_b64_tr_b16 a[254:255], v4 offset:63488
v_mfma_f32_16x16x32_bf16 v[164:167], a[236:239], v[228:231], v[164:167]
v_mfma_f32_16x16x32_bf16 v[168:171], a[232:235], a[116:119], v[168:171]
buffer_load_dwordx4 a[24:27], v18, s[8:11], s46 offen offset:3072 sc1
v_mfma_f32_16x16x32_bf16 v[168:171], a[236:239], v[232:235], v[168:171]
v_mfma_f32_16x16x32_bf16 v[172:175], a[232:235], a[104:107], v[172:175]
s_mov_b32 s46, 2707456
v_mfma_f32_16x16x32_bf16 v[172:175], a[236:239], v[236:239], v[172:175]
v_mfma_f32_16x16x32_bf16 v[176:179], a[232:235], a[120:123], v[176:179]
v_mfma_f32_16x16x32_bf16 v[176:179], a[236:239], v[240:243], v[176:179]
buffer_load_dwordx4 a[12:15], v18, s[8:11], s46 offen offset:0 sc1
v_mfma_f32_16x16x32_bf16 v[180:183], a[232:235], v[224:227], v[180:183]
s_waitcnt lgkmcnt(4)
s_mov_b32 s46, 2826240
v_mfma_f32_16x16x32_bf16 v[180:183], a[236:239], v[244:247], v[180:183]
v_mfma_f32_16x16x32_bf16 v[184:187], a[240:243], a[100:103], v[184:187]
s_waitcnt vmcnt(33) lgkmcnt(0)
s_barrier
v_mfma_f32_16x16x32_bf16 v[184:187], a[244:247], v[228:231], v[184:187]
ds_read_b64_tr_b16 a[192:193], v13 offset:0
v_mfma_f32_16x16x32_bf16 v[188:191], a[240:243], a[116:119], v[188:191]
buffer_load_dwordx4 a[28:31], v18, s[8:11], s46 offen offset:0 sc1
v_mfma_f32_16x16x32_bf16 v[188:191], a[244:247], v[232:235], v[188:191]
ds_read_b64_tr_b16 a[194:195], v13 offset:2048
v_mfma_f32_16x16x32_bf16 v[192:195], a[240:243], a[104:107], v[192:195]
ds_read_b64_tr_b16 a[196:197], v13 offset:4096
v_mfma_f32_16x16x32_bf16 v[192:195], a[244:247], v[236:239], v[192:195]
ds_read_b64_tr_b16 a[198:199], v13 offset:6144
v_mfma_f32_16x16x32_bf16 v[196:199], a[240:243], a[120:123], v[196:199]
v_mfma_f32_16x16x32_bf16 v[196:199], a[244:247], v[240:243], v[196:199]
buffer_load_dwordx4 a[32:35], v18, s[8:11], s46 offen offset:1024 sc1
v_mfma_f32_16x16x32_bf16 v[200:203], a[240:243], v[224:227], v[200:203]
ds_read_b64_tr_b16 a[200:201], v14 offset:0
v_mfma_f32_16x16x32_bf16 v[200:203], a[244:247], v[244:247], v[200:203]
ds_read_b64_tr_b16 a[202:203], v14 offset:2048
v_mfma_f32_16x16x32_bf16 v[204:207], a[248:251], a[100:103], v[204:207]
v_mfma_f32_16x16x32_bf16 v[204:207], a[252:255], v[228:231], v[204:207]
ds_read_b64_tr_b16 a[204:205], v14 offset:4096
v_mfma_f32_16x16x32_bf16 v[208:211], a[248:251], a[116:119], v[208:211]
buffer_load_dwordx4 a[48:51], v18, s[8:11], s46 offen offset:2048 sc1
v_mfma_f32_16x16x32_bf16 v[208:211], a[252:255], v[232:235], v[208:211]
ds_read_b64_tr_b16 a[206:207], v14 offset:6144
v_mfma_f32_16x16x32_bf16 v[212:215], a[248:251], a[104:107], v[212:215]
v_mfma_f32_16x16x32_bf16 v[212:215], a[252:255], v[236:239], v[212:215]
v_mfma_f32_16x16x32_bf16 v[216:219], a[248:251], a[120:123], v[216:219]
v_mfma_f32_16x16x32_bf16 v[216:219], a[252:255], v[240:243], v[216:219]
buffer_load_dwordx4 a[36:39], v18, s[8:11], s46 offen offset:3072 sc1
v_mfma_f32_16x16x32_bf16 v[220:223], a[248:251], v[224:227], v[220:223]
s_waitcnt vmcnt(13) lgkmcnt(4)
v_mfma_f32_16x16x32_bf16 v[220:223], a[252:255], v[244:247], v[220:223]
v_mfma_f32_16x16x32_bf16 v[64:67], a[192:195], v[248:251], v[64:67]
ds_read_b64_tr_b16 a[208:209], v15 offset:0
v_mfma_f32_16x16x32_bf16 v[64:67], a[196:199], a[124:127], v[64:67]
ds_read_b64_tr_b16 a[210:211], v15 offset:2048
v_mfma_f32_16x16x32_bf16 v[68:71], a[192:195], v[252:255], v[68:71]
v_mfma_f32_16x16x32_bf16 v[68:71], a[196:199], a[128:131], v[68:71]
ds_read_b64_tr_b16 a[212:213], v15 offset:4096
v_mfma_f32_16x16x32_bf16 v[72:75], a[192:195], a[0:3], v[72:75]
buffer_load_dword v9, off, s[28:31], s51 sc1
v_mfma_f32_16x16x32_bf16 v[72:75], a[196:199], a[144:147], v[72:75]
ds_read_b64_tr_b16 a[214:215], v15 offset:6144
s_mov_b32 s46, 2830336
v_mfma_f32_16x16x32_bf16 v[76:79], a[192:195], a[16:19], v[76:79]
v_mfma_f32_16x16x32_bf16 v[76:79], a[196:199], a[132:135], v[76:79]
ds_read_b64_tr_b16 a[216:217], v16 offset:0
s_waitcnt lgkmcnt(5)
v_mfma_f32_16x16x32_bf16 v[80:83], a[192:195], a[108:111], v[80:83]
v_mfma_f32_16x16x32_bf16 v[80:83], a[196:199], a[148:151], v[80:83]
v_mfma_f32_16x16x32_bf16 v[84:87], a[200:203], v[248:251], v[84:87]
ds_read_b64_tr_b16 a[218:219], v16 offset:2048
v_mfma_f32_16x16x32_bf16 v[84:87], a[204:207], a[124:127], v[84:87]
v_mfma_f32_16x16x32_bf16 v[88:91], a[200:203], v[252:255], v[88:91]
ds_read_b64_tr_b16 a[220:221], v16 offset:4096
v_mfma_f32_16x16x32_bf16 v[88:91], a[204:207], a[128:131], v[88:91]
buffer_load_dwordx4 a[52:55], v18, s[8:11], s46 offen offset:0 sc1
v_mfma_f32_16x16x32_bf16 v[92:95], a[200:203], a[0:3], v[92:95]
ds_read_b64_tr_b16 a[222:223], v16 offset:6144
s_add_u32 m0, s41, 32768
v_mfma_f32_16x16x32_bf16 v[92:95], a[204:207], a[144:147], v[92:95]
v_mfma_f32_16x16x32_bf16 v[96:99], a[200:203], a[16:19], v[96:99]
ds_read_b64_tr_b16 a[224:225], v13 offset:8192
s_mov_b32 s46, 4096000
v_mfma_f32_16x16x32_bf16 v[96:99], a[204:207], a[132:135], v[96:99]
s_waitcnt lgkmcnt(5)
ds_read_b64_tr_b16 a[226:227], v13 offset:10240
v_mfma_f32_16x16x32_bf16 v[100:103], a[200:203], a[108:111], v[100:103]
v_mfma_f32_16x16x32_bf16 v[100:103], a[204:207], a[148:151], v[100:103]
v_mfma_f32_16x16x32_bf16 v[104:107], a[208:211], v[248:251], v[104:107]
v_mfma_f32_16x16x32_bf16 v[104:107], a[212:215], a[124:127], v[104:107]
buffer_load_dwordx4 v21, s[4:7], s46 offen offset:0 lds
v_mfma_f32_16x16x32_bf16 v[108:111], a[208:211], v[252:255], v[108:111]
ds_read_b64_tr_b16 a[228:229], v13 offset:12288
s_mov_b32 s46, 4105216
v_mfma_f32_16x16x32_bf16 v[108:111], a[212:215], a[128:131], v[108:111]
ds_read_b64_tr_b16 a[230:231], v13 offset:14336
v_mfma_f32_16x16x32_bf16 v[112:115], a[208:211], a[0:3], v[112:115]
v_mfma_f32_16x16x32_bf16 v[112:115], a[212:215], a[144:147], v[112:115]
ds_read_b64_tr_b16 a[232:233], v14 offset:8192
v_mfma_f32_16x16x32_bf16 v[116:119], a[208:211], a[16:19], v[116:119]
v_mfma_f32_16x16x32_bf16 v[116:119], a[212:215], a[132:135], v[116:119]
s_waitcnt lgkmcnt(5)
ds_read_b64_tr_b16 a[234:235], v14 offset:10240
v_mfma_f32_16x16x32_bf16 v[120:123], a[208:211], a[108:111], v[120:123]
v_mfma_f32_16x16x32_bf16 v[120:123], a[212:215], a[148:151], v[120:123]
v_mfma_f32_16x16x32_bf16 v[124:127], a[216:219], v[248:251], v[124:127]
buffer_load_dwordx4 v21, s[4:7], s46 offen offset:1024 lds
v_mfma_f32_16x16x32_bf16 v[124:127], a[220:223], a[124:127], v[124:127]
ds_read_b64_tr_b16 a[236:237], v14 offset:12288
s_mov_b32 s46, 4114432
v_mfma_f32_16x16x32_bf16 v[128:131], a[216:219], v[252:255], v[128:131]
ds_read_b64_tr_b16 a[238:239], v14 offset:14336
v_mfma_f32_16x16x32_bf16 v[128:131], a[220:223], a[128:131], v[128:131]
v_mfma_f32_16x16x32_bf16 v[132:135], a[216:219], a[0:3], v[132:135]
ds_read_b64_tr_b16 a[240:241], v15 offset:8192
v_mfma_f32_16x16x32_bf16 v[132:135], a[220:223], a[144:147], v[132:135]
v_mfma_f32_16x16x32_bf16 v[136:139], a[216:219], a[16:19], v[136:139]
v_mfma_f32_16x16x32_bf16 v[136:139], a[220:223], a[132:135], v[136:139]
ds_read_b64_tr_b16 a[242:243], v15 offset:10240
s_waitcnt lgkmcnt(6)
v_mfma_f32_16x16x32_bf16 v[140:143], a[216:219], a[108:111], v[140:143]
v_mfma_f32_16x16x32_bf16 v[140:143], a[220:223], a[148:151], v[140:143]
buffer_load_dwordx4 v21, s[4:7], s46 offen offset:2048 lds
v_mfma_f32_16x16x32_bf16 v[144:147], a[224:227], v[248:251], v[144:147]
ds_read_b64_tr_b16 a[244:245], v15 offset:12288
s_mov_b32 s46, 4123648
v_mfma_f32_16x16x32_bf16 v[144:147], a[228:231], a[124:127], v[144:147]
ds_read_b64_tr_b16 a[246:247], v15 offset:14336
v_mfma_f32_16x16x32_bf16 v[148:151], a[224:227], v[252:255], v[148:151]
v_mfma_f32_16x16x32_bf16 v[148:151], a[228:231], a[128:131], v[148:151]
ds_read_b64_tr_b16 a[248:249], v16 offset:8192
v_mfma_f32_16x16x32_bf16 v[152:155], a[224:227], a[0:3], v[152:155]
v_mfma_f32_16x16x32_bf16 v[152:155], a[228:231], a[144:147], v[152:155]
v_mfma_f32_16x16x32_bf16 v[156:159], a[224:227], a[16:19], v[156:159]
ds_read_b64_tr_b16 a[250:251], v16 offset:10240
v_mfma_f32_16x16x32_bf16 v[156:159], a[228:231], a[132:135], v[156:159]
buffer_load_dwordx4 v21, s[4:7], s46 offen offset:3072 lds
v_mfma_f32_16x16x32_bf16 v[160:163], a[224:227], a[108:111], v[160:163]
ds_read_b64_tr_b16 a[252:253], v16 offset:12288
s_waitcnt lgkmcnt(7)
v_mfma_f32_16x16x32_bf16 v[160:163], a[228:231], a[148:151], v[160:163]
v_mfma_f32_16x16x32_bf16 v[164:167], a[232:235], v[248:251], v[164:167]
ds_read_b64_tr_b16 a[254:255], v16 offset:14336
v_mfma_f32_16x16x32_bf16 v[164:167], a[236:239], a[124:127], v[164:167]
v_mfma_f32_16x16x32_bf16 v[168:171], a[232:235], v[252:255], v[168:171]
s_waitcnt vmcnt(5)
v_readfirstlane_b32 s88, v9
v_mfma_f32_16x16x32_bf16 v[168:171], a[236:239], a[128:131], v[168:171]
v_mfma_f32_16x16x32_bf16 v[172:175], a[232:235], a[0:3], v[172:175]
v_mfma_f32_16x16x32_bf16 v[172:175], a[236:239], a[144:147], v[172:175]
s_cmp_lt_u32 s88, 32
s_cbranch_scc1 K2_SPIN12e
K2_RET12e:
v_mfma_f32_16x16x32_bf16 v[176:179], a[232:235], a[16:19], v[176:179]
s_mov_b32 s46, 2949120
v_mfma_f32_16x16x32_bf16 v[176:179], a[236:239], a[132:135], v[176:179]
buffer_load_dwordx4 a[136:139], v18, s[8:11], s46 offen offset:0 sc1
v_mfma_f32_16x16x32_bf16 v[180:183], a[232:235], a[108:111], v[180:183]
s_waitcnt lgkmcnt(4)
v_mfma_f32_16x16x32_bf16 v[180:183], a[236:239], a[148:151], v[180:183]
buffer_load_dwordx4 a[152:155], v18, s[8:11], s46 offen offset:1024 sc1
v_mfma_f32_16x16x32_bf16 v[184:187], a[240:243], v[248:251], v[184:187]
v_mfma_f32_16x16x32_bf16 v[184:187], a[244:247], a[124:127], v[184:187]
buffer_load_dwordx4 a[140:143], v18, s[8:11], s46 offen offset:2048 sc1
v_mfma_f32_16x16x32_bf16 v[188:191], a[240:243], v[252:255], v[188:191]
ds_read_b64_tr_b16 a[192:193], v13 offset:16384
v_mfma_f32_16x16x32_bf16 v[188:191], a[244:247], a[128:131], v[188:191]
buffer_load_dwordx4 a[156:159], v18, s[8:11], s46 offen offset:3072 sc1
v_mfma_f32_16x16x32_bf16 v[192:195], a[240:243], a[0:3], v[192:195]
s_mov_b32 s46, 2953216
ds_read_b64_tr_b16 a[194:195], v13 offset:18432
v_mfma_f32_16x16x32_bf16 v[192:195], a[244:247], a[144:147], v[192:195]
buffer_load_dwordx4 a[160:163], v18, s[8:11], s46 offen offset:0 sc1
v_mfma_f32_16x16x32_bf16 v[196:199], a[240:243], a[16:19], v[196:199]
s_mov_b32 s46, 3072000
ds_read_b64_tr_b16 a[196:197], v13 offset:20480
v_mfma_f32_16x16x32_bf16 v[196:199], a[244:247], a[132:135], v[196:199]
buffer_load_dwordx4 a[176:179], v18, s[8:11], s46 offen offset:0 sc1
v_mfma_f32_16x16x32_bf16 v[200:203], a[240:243], a[108:111], v[200:203]
ds_read_b64_tr_b16 a[198:199], v13 offset:22528
s_waitcnt lgkmcnt(4)
v_mfma_f32_16x16x32_bf16 v[200:203], a[244:247], a[148:151], v[200:203]
buffer_load_dwordx4 a[40:43], v18, s[8:11], s46 offen offset:1024 sc1
v_mfma_f32_16x16x32_bf16 v[204:207], a[248:251], v[248:251], v[204:207]
ds_read_b64_tr_b16 a[200:201], v14 offset:16384
v_mfma_f32_16x16x32_bf16 v[204:207], a[252:255], a[124:127], v[204:207]
buffer_load_dwordx4 a[56:59], v18, s[8:11], s46 offen offset:2048 sc1
v_mfma_f32_16x16x32_bf16 v[208:211], a[248:251], v[252:255], v[208:211]
ds_read_b64_tr_b16 a[202:203], v14 offset:18432
v_mfma_f32_16x16x32_bf16 v[208:211], a[252:255], a[128:131], v[208:211]
buffer_load_dwordx4 a[44:47], v18, s[8:11], s46 offen offset:3072 sc1
v_mfma_f32_16x16x32_bf16 v[212:215], a[248:251], a[0:3], v[212:215]
s_mov_b32 s46, 3076096
ds_read_b64_tr_b16 a[204:205], v14 offset:20480
v_mfma_f32_16x16x32_bf16 v[212:215], a[252:255], a[144:147], v[212:215]
ds_read_b64_tr_b16 a[206:207], v14 offset:22528
v_mfma_f32_16x16x32_bf16 v[216:219], a[248:251], a[16:19], v[216:219]
buffer_load_dwordx4 a[60:63], v18, s[8:11], s46 offen offset:0 sc1
s_mov_b32 s46, 3194880
v_mfma_f32_16x16x32_bf16 v[216:219], a[252:255], a[132:135], v[216:219]
buffer_load_dwordx4 a[64:67], v18, s[8:11], s46 offen offset:0 sc1
v_mfma_f32_16x16x32_bf16 v[220:223], a[248:251], a[108:111], v[220:223]
s_waitcnt vmcnt(15) lgkmcnt(4)
v_mfma_f32_16x16x32_bf16 v[220:223], a[252:255], a[148:151], v[220:223]
buffer_load_dwordx4 a[80:83], v18, s[8:11], s46 offen offset:1024 sc1
v_mfma_f32_16x16x32_bf16 v[64:67], a[192:195], a[4:7], v[64:67]
ds_read_b64_tr_b16 a[208:209], v15 offset:16384
v_mfma_f32_16x16x32_bf16 v[64:67], a[196:199], a[28:31], v[64:67]
ds_read_b64_tr_b16 a[210:211], v15 offset:18432
v_mfma_f32_16x16x32_bf16 v[68:71], a[192:195], a[20:23], v[68:71]
global_load_dword v30, v[28:29], off
v_mfma_f32_16x16x32_bf16 v[68:71], a[196:199], a[32:35], v[68:71]
ds_read_b64_tr_b16 a[212:213], v15 offset:20480
s_mov_b32 s46, 3194880
v_mfma_f32_16x16x32_bf16 v[72:75], a[192:195], a[8:11], v[72:75]
v_mfma_f32_16x16x32_bf16 v[72:75], a[196:199], a[48:51], v[72:75]
ds_read_b64_tr_b16 a[214:215], v15 offset:22528
v_mfma_f32_16x16x32_bf16 v[76:79], a[192:195], a[24:27], v[76:79]
v_mfma_f32_16x16x32_bf16 v[76:79], a[196:199], a[36:39], v[76:79]
buffer_load_dwordx4 a[68:71], v18, s[8:11], s46 offen offset:2048 sc1
v_mfma_f32_16x16x32_bf16 v[80:83], a[192:195], a[12:15], v[80:83]
ds_read_b64_tr_b16 a[216:217], v16 offset:16384
s_waitcnt lgkmcnt(5)
v_mfma_f32_16x16x32_bf16 v[80:83], a[196:199], a[52:55], v[80:83]
v_mfma_f32_16x16x32_bf16 v[84:87], a[200:203], a[4:7], v[84:87]
ds_read_b64_tr_b16 a[218:219], v16 offset:18432
v_mfma_f32_16x16x32_bf16 v[84:87], a[204:207], a[28:31], v[84:87]
buffer_load_dwordx4 a[84:87], v18, s[8:11], s46 offen offset:3072 sc1
v_mfma_f32_16x16x32_bf16 v[88:91], a[200:203], a[20:23], v[88:91]
ds_read_b64_tr_b16 a[220:221], v16 offset:20480
s_mov_b32 s46, 3198976
v_mfma_f32_16x16x32_bf16 v[88:91], a[204:207], a[32:35], v[88:91]
v_mfma_f32_16x16x32_bf16 v[92:95], a[200:203], a[8:11], v[92:95]
ds_read_b64_tr_b16 a[222:223], v16 offset:22528
v_mfma_f32_16x16x32_bf16 v[92:95], a[204:207], a[48:51], v[92:95]
v_mfma_f32_16x16x32_bf16 v[96:99], a[200:203], a[24:27], v[96:99]
buffer_load_dwordx4 a[72:75], v18, s[8:11], s46 offen offset:0 sc1
v_mfma_f32_16x16x32_bf16 v[96:99], a[204:207], a[36:39], v[96:99]
ds_read_b64_tr_b16 a[224:225], v13 offset:24576
s_waitcnt lgkmcnt(5)
v_mfma_f32_16x16x32_bf16 v[100:103], a[200:203], a[12:15], v[100:103]
s_mov_b32 s46, 3317760
ds_read_b64_tr_b16 a[226:227], v13 offset:26624
v_mfma_f32_16x16x32_bf16 v[100:103], a[204:207], a[52:55], v[100:103]
v_mfma_f32_16x16x32_bf16 v[104:107], a[208:211], a[4:7], v[104:107]
v_mfma_f32_16x16x32_bf16 v[104:107], a[212:215], a[28:31], v[104:107]
buffer_load_dwordx4 a[88:91], v18, s[8:11], s46 offen offset:0 sc1
v_mfma_f32_16x16x32_bf16 v[108:111], a[208:211], a[20:23], v[108:111]
ds_read_b64_tr_b16 a[228:229], v13 offset:28672
v_mfma_f32_16x16x32_bf16 v[108:111], a[212:215], a[32:35], v[108:111]
ds_read_b64_tr_b16 a[230:231], v13 offset:30720
v_mfma_f32_16x16x32_bf16 v[112:115], a[208:211], a[8:11], v[112:115]
v_mfma_f32_16x16x32_bf16 v[112:115], a[212:215], a[48:51], v[112:115]
buffer_load_dwordx4 a[164:167], v18, s[8:11], s46 offen offset:1024 sc1
v_mfma_f32_16x16x32_bf16 v[116:119], a[208:211], a[24:27], v[116:119]
ds_read_b64_tr_b16 a[232:233], v14 offset:24576
s_add_u32 m0, s41, 36864
v_mfma_f32_16x16x32_bf16 v[116:119], a[212:215], a[36:39], v[116:119]
s_mov_b32 s46, 4136960
s_waitcnt lgkmcnt(5)
v_mfma_f32_16x16x32_bf16 v[120:123], a[208:211], a[12:15], v[120:123]
ds_read_b64_tr_b16 a[234:235], v14 offset:26624
v_mfma_f32_16x16x32_bf16 v[120:123], a[212:215], a[52:55], v[120:123]
v_mfma_f32_16x16x32_bf16 v[124:127], a[216:219], a[4:7], v[124:127]
buffer_load_dwordx4 v21, s[4:7], s46 offen offset:0 lds
v_mfma_f32_16x16x32_bf16 v[124:127], a[220:223], a[28:31], v[124:127]
ds_read_b64_tr_b16 a[236:237], v14 offset:28672
s_mov_b32 s46, 4146176
v_mfma_f32_16x16x32_bf16 v[128:131], a[216:219], a[20:23], v[128:131]
ds_read_b64_tr_b16 a[238:239], v14 offset:30720
v_mfma_f32_16x16x32_bf16 v[128:131], a[220:223], a[32:35], v[128:131]
v_mfma_f32_16x16x32_bf16 v[132:135], a[216:219], a[8:11], v[132:135]
ds_read_b64_tr_b16 a[240:241], v15 offset:24576
v_mfma_f32_16x16x32_bf16 v[132:135], a[220:223], a[48:51], v[132:135]
buffer_load_dwordx4 v21, s[4:7], s46 offen offset:1024 lds
v_mfma_f32_16x16x32_bf16 v[136:139], a[216:219], a[24:27], v[136:139]
v_mfma_f32_16x16x32_bf16 v[136:139], a[220:223], a[36:39], v[136:139]
ds_read_b64_tr_b16 a[242:243], v15 offset:26624
s_mov_b32 s46, 4155392
v_mfma_f32_16x16x32_bf16 v[140:143], a[216:219], a[12:15], v[140:143]
s_waitcnt lgkmcnt(6)
ds_read_b64_tr_b16 a[244:245], v15 offset:28672
v_mfma_f32_16x16x32_bf16 v[140:143], a[220:223], a[52:55], v[140:143]
v_mfma_f32_16x16x32_bf16 v[144:147], a[224:227], a[4:7], v[144:147]
buffer_load_dwordx4 v21, s[4:7], s46 offen offset:2048 lds
v_mfma_f32_16x16x32_bf16 v[144:147], a[228:231], a[28:31], v[144:147]
ds_read_b64_tr_b16 a[246:247], v15 offset:30720
s_mov_b32 s46, 4164608
v_mfma_f32_16x16x32_bf16 v[148:151], a[224:227], a[20:23], v[148:151]
v_mfma_f32_16x16x32_bf16 v[148:151], a[228:231], a[32:35], v[148:151]
ds_read_b64_tr_b16 a[248:249], v16 offset:24576
v_mfma_f32_16x16x32_bf16 v[152:155], a[224:227], a[8:11], v[152:155]
buffer_load_dwordx4 v21, s[4:7], s46 offen offset:3072 lds
v_mfma_f32_16x16x32_bf16 v[152:155], a[228:231], a[48:51], v[152:155]
v_mfma_f32_16x16x32_bf16 v[156:159], a[224:227], a[24:27], v[156:159]
ds_read_b64_tr_b16 a[250:251], v16 offset:26624
s_mov_b32 s46, 3317760
v_mfma_f32_16x16x32_bf16 v[156:159], a[228:231], a[36:39], v[156:159]
s_waitcnt lgkmcnt(6)
ds_read_b64_tr_b16 a[252:253], v16 offset:28672
v_mfma_f32_16x16x32_bf16 v[160:163], a[224:227], a[12:15], v[160:163]
v_mfma_f32_16x16x32_bf16 v[160:163], a[228:231], a[52:55], v[160:163]
buffer_load_dwordx4 a[180:183], v18, s[8:11], s46 offen offset:2048 sc1
v_mfma_f32_16x16x32_bf16 v[164:167], a[232:235], a[4:7], v[164:167]
ds_read_b64_tr_b16 a[254:255], v16 offset:30720
v_mfma_f32_16x16x32_bf16 v[164:167], a[236:239], a[28:31], v[164:167]
v_mfma_f32_16x16x32_bf16 v[168:171], a[232:235], a[20:23], v[168:171]
v_mfma_f32_16x16x32_bf16 v[168:171], a[236:239], a[32:35], v[168:171]
v_mfma_f32_16x16x32_bf16 v[172:175], a[232:235], a[8:11], v[172:175]
buffer_load_dwordx4 a[168:171], v18, s[8:11], s46 offen offset:3072 sc1
v_mfma_f32_16x16x32_bf16 v[172:175], a[236:239], a[48:51], v[172:175]
s_mov_b32 s46, 3321856
v_mfma_f32_16x16x32_bf16 v[176:179], a[232:235], a[24:27], v[176:179]
v_mfma_f32_16x16x32_bf16 v[176:179], a[236:239], a[36:39], v[176:179]
s_waitcnt lgkmcnt(4)
v_mfma_f32_16x16x32_bf16 v[180:183], a[232:235], a[12:15], v[180:183]
buffer_load_dwordx4 a[184:187], v18, s[8:11], s46 offen offset:0 sc1
v_mfma_f32_16x16x32_bf16 v[180:183], a[236:239], a[52:55], v[180:183]
v_mfma_f32_16x16x32_bf16 v[184:187], a[240:243], a[4:7], v[184:187]
s_waitcnt vmcnt(38) lgkmcnt(0)
s_barrier
v_mfma_f32_16x16x32_bf16 v[184:187], a[244:247], a[28:31], v[184:187]
ds_read_b64_tr_b16 a[192:193], v1 offset:0
s_mov_b32 s46, 3440640
v_mfma_f32_16x16x32_bf16 v[188:191], a[240:243], a[20:23], v[188:191]
ds_read_b64_tr_b16 a[194:195], v1 offset:2048
v_mfma_f32_16x16x32_bf16 v[188:191], a[244:247], a[32:35], v[188:191]
buffer_load_dwordx4 a[172:175], v18, s[8:11], s46 offen offset:0 sc1
v_mfma_f32_16x16x32_bf16 v[192:195], a[240:243], a[8:11], v[192:195]
ds_read_b64_tr_b16 a[196:197], v1 offset:4096
v_mfma_f32_16x16x32_bf16 v[192:195], a[244:247], a[48:51], v[192:195]
ds_read_b64_tr_b16 a[198:199], v1 offset:6144
v_mfma_f32_16x16x32_bf16 v[196:199], a[240:243], a[24:27], v[196:199]
v_mfma_f32_16x16x32_bf16 v[196:199], a[244:247], a[36:39], v[196:199]
ds_read_b64_tr_b16 a[200:201], v2 offset:0
v_mfma_f32_16x16x32_bf16 v[200:203], a[240:243], a[12:15], v[200:203]
buffer_load_dwordx4 a[188:191], v18, s[8:11], s46 offen offset:1024 sc1
v_mfma_f32_16x16x32_bf16 v[200:203], a[244:247], a[52:55], v[200:203]
ds_read_b64_tr_b16 a[202:203], v2 offset:2048
v_mfma_f32_16x16x32_bf16 v[204:207], a[248:251], a[4:7], v[204:207]
v_mfma_f32_16x16x32_bf16 v[204:207], a[252:255], a[28:31], v[204:207]
ds_read_b64_tr_b16 a[204:205], v2 offset:4096
v_mfma_f32_16x16x32_bf16 v[208:211], a[248:251], a[20:23], v[208:211]
buffer_load_dwordx4 a[76:79], v18, s[8:11], s46 offen offset:2048 sc1
v_mfma_f32_16x16x32_bf16 v[208:211], a[252:255], a[32:35], v[208:211]
ds_read_b64_tr_b16 a[206:207], v2 offset:6144
v_mfma_f32_16x16x32_bf16 v[212:215], a[248:251], a[8:11], v[212:215]
v_mfma_f32_16x16x32_bf16 v[212:215], a[252:255], a[48:51], v[212:215]
v_mfma_f32_16x16x32_bf16 v[216:219], a[248:251], a[24:27], v[216:219]
v_mfma_f32_16x16x32_bf16 v[216:219], a[252:255], a[36:39], v[216:219]
buffer_load_dwordx4 a[92:95], v18, s[8:11], s46 offen offset:3072 sc1
v_mfma_f32_16x16x32_bf16 v[220:223], a[248:251], a[12:15], v[220:223]
s_waitcnt vmcnt(19) lgkmcnt(4)
v_mfma_f32_16x16x32_bf16 v[220:223], a[252:255], a[52:55], v[220:223]
v_mfma_f32_16x16x32_bf16 v[64:67], a[192:195], a[136:139], v[64:67]
ds_read_b64_tr_b16 a[208:209], v3 offset:0
s_mov_b32 s46, 3444736
v_mfma_f32_16x16x32_bf16 v[64:67], a[196:199], a[176:179], v[64:67]
ds_read_b64_tr_b16 a[210:211], v3 offset:2048
v_mfma_f32_16x16x32_bf16 v[68:71], a[192:195], a[152:155], v[68:71]
buffer_load_dwordx4 a[96:99], v18, s[8:11], s46 offen offset:0 sc1
v_mfma_f32_16x16x32_bf16 v[68:71], a[196:199], a[40:43], v[68:71]
ds_read_b64_tr_b16 a[212:213], v3 offset:4096
s_mov_b32 s46, 3563520
v_mfma_f32_16x16x32_bf16 v[72:75], a[192:195], a[140:143], v[72:75]
v_mfma_f32_16x16x32_bf16 v[72:75], a[196:199], a[56:59], v[72:75]
ds_read_b64_tr_b16 a[214:215], v3 offset:6144
v_mfma_f32_16x16x32_bf16 v[76:79], a[192:195], a[156:159], v[76:79]
v_mfma_f32_16x16x32_bf16 v[76:79], a[196:199], a[44:47], v[76:79]
buffer_load_dwordx4 a[112:115], v18, s[8:11], s46 offen offset:0 sc1
v_mfma_f32_16x16x32_bf16 v[80:83], a[192:195], a[160:163], v[80:83]
ds_read_b64_tr_b16 a[216:217], v4 offset:0
s_waitcnt lgkmcnt(5)
v_mfma_f32_16x16x32_bf16 v[80:83], a[196:199], a[60:63], v[80:83]
v_mfma_f32_16x16x32_bf16 v[84:87], a[200:203], a[136:139], v[84:87]
ds_read_b64_tr_b16 a[218:219], v4 offset:2048
v_mfma_f32_16x16x32_bf16 v[84:87], a[204:207], a[176:179], v[84:87]
v_mfma_f32_16x16x32_bf16 v[88:91], a[200:203], a[152:155], v[88:91]
buffer_load_dwordx4 a[100:103], v18, s[8:11], s46 offen offset:1024 sc1
v_mfma_f32_16x16x32_bf16 v[88:91], a[204:207], a[40:43], v[88:91]
ds_read_b64_tr_b16 a[220:221], v4 offset:4096
v_mfma_f32_16x16x32_bf16 v[92:95], a[200:203], a[140:143], v[92:95]
ds_read_b64_tr_b16 a[222:223], v4 offset:6144
v_mfma_f32_16x16x32_bf16 v[92:95], a[204:207], a[56:59], v[92:95]
v_mfma_f32_16x16x32_bf16 v[96:99], a[200:203], a[156:159], v[96:99]
ds_read_b64_tr_b16 a[224:225], v1 offset:8192
v_mfma_f32_16x16x32_bf16 v[96:99], a[204:207], a[44:47], v[96:99]
buffer_load_dwordx4 a[116:119], v18, s[8:11], s46 offen offset:2048 sc1
v_mfma_f32_16x16x32_bf16 v[100:103], a[200:203], a[160:163], v[100:103]
s_waitcnt lgkmcnt(5)
ds_read_b64_tr_b16 a[226:227], v1 offset:10240
v_mfma_f32_16x16x32_bf16 v[100:103], a[204:207], a[60:63], v[100:103]
v_mfma_f32_16x16x32_bf16 v[104:107], a[208:211], a[136:139], v[104:107]
v_mfma_f32_16x16x32_bf16 v[104:107], a[212:215], a[176:179], v[104:107]
ds_read_b64_tr_b16 a[228:229], v1 offset:12288
v_mfma_f32_16x16x32_bf16 v[108:111], a[208:211], a[152:155], v[108:111]
buffer_load_dwordx4 a[104:107], v18, s[8:11], s46 offen offset:3072 sc1
v_mfma_f32_16x16x32_bf16 v[108:111], a[212:215], a[40:43], v[108:111]
ds_read_b64_tr_b16 a[230:231], v1 offset:14336
s_add_u32 m0, s41, 65536
v_mfma_f32_16x16x32_bf16 v[112:115], a[208:211], a[140:143], v[112:115]
s_mov_b32 s46, 4259840
ds_read_b64_tr_b16 a[232:233], v2 offset:8192
v_mfma_f32_16x16x32_bf16 v[112:115], a[212:215], a[56:59], v[112:115]
v_mfma_f32_16x16x32_bf16 v[116:119], a[208:211], a[156:159], v[116:119]
v_mfma_f32_16x16x32_bf16 v[116:119], a[212:215], a[44:47], v[116:119]
buffer_load_dwordx4 v21, s[4:7], s46 offen offset:0 lds
v_mfma_f32_16x16x32_bf16 v[120:123], a[208:211], a[160:163], v[120:123]
ds_read_b64_tr_b16 a[234:235], v2 offset:10240
s_waitcnt lgkmcnt(6)
v_mfma_f32_16x16x32_bf16 v[120:123], a[212:215], a[60:63], v[120:123]
s_mov_b32 s46, 4269056
ds_read_b64_tr_b16 a[236:237], v2 offset:12288
v_mfma_f32_16x16x32_bf16 v[124:127], a[216:219], a[136:139], v[124:127]
v_mfma_f32_16x16x32_bf16 v[124:127], a[220:223], a[176:179], v[124:127]
v_mfma_f32_16x16x32_bf16 v[128:131], a[216:219], a[152:155], v[128:131]
buffer_load_dwordx4 v21, s[4:7], s46 offen offset:1024 lds
v_mfma_f32_16x16x32_bf16 v[128:131], a[220:223], a[40:43], v[128:131]
ds_read_b64_tr_b16 a[238:239], v2 offset:14336
s_mov_b32 s46, 4278272
v_mfma_f32_16x16x32_bf16 v[132:135], a[216:219], a[140:143], v[132:135]
ds_read_b64_tr_b16 a[240:241], v3 offset:8192
v_mfma_f32_16x16x32_bf16 v[132:135], a[220:223], a[56:59], v[132:135]
v_mfma_f32_16x16x32_bf16 v[136:139], a[216:219], a[156:159], v[136:139]
v_mfma_f32_16x16x32_bf16 v[136:139], a[220:223], a[44:47], v[136:139]
buffer_load_dwordx4 v21, s[4:7], s46 offen offset:2048 lds
v_mfma_f32_16x16x32_bf16 v[140:143], a[216:219], a[160:163], v[140:143]
ds_read_b64_tr_b16 a[242:243], v3 offset:10240
s_waitcnt lgkmcnt(6)
v_mfma_f32_16x16x32_bf16 v[140:143], a[220:223], a[60:63], v[140:143]
ds_read_b64_tr_b16 a[244:245], v3 offset:12288
s_mov_b32 s46, 4287488
v_mfma_f32_16x16x32_bf16 v[144:147], a[224:227], a[136:139], v[144:147]
v_mfma_f32_16x16x32_bf16 v[144:147], a[228:231], a[176:179], v[144:147]
ds_read_b64_tr_b16 a[246:247], v3 offset:14336
v_mfma_f32_16x16x32_bf16 v[148:151], a[224:227], a[152:155], v[148:151]
buffer_load_dwordx4 v21, s[4:7], s46 offen offset:3072 lds
v_mfma_f32_16x16x32_bf16 v[148:151], a[228:231], a[40:43], v[148:151]
ds_read_b64_tr_b16 a[248:249], v4 offset:8192
s_mov_b32 s46, 3567616
v_mfma_f32_16x16x32_bf16 v[152:155], a[224:227], a[140:143], v[152:155]
v_mfma_f32_16x16x32_bf16 v[152:155], a[228:231], a[56:59], v[152:155]
v_mfma_f32_16x16x32_bf16 v[156:159], a[224:227], a[156:159], v[156:159]
ds_read_b64_tr_b16 a[250:251], v4 offset:10240
v_mfma_f32_16x16x32_bf16 v[156:159], a[228:231], a[44:47], v[156:159]
buffer_load_dwordx4 a[120:123], v18, s[8:11], s46 offen offset:0 sc1
v_mfma_f32_16x16x32_bf16 v[160:163], a[224:227], a[160:163], v[160:163]
ds_read_b64_tr_b16 a[252:253], v4 offset:12288
s_waitcnt lgkmcnt(7)
v_mfma_f32_16x16x32_bf16 v[160:163], a[228:231], a[60:63], v[160:163]
s_mov_b32 s46, 3686400
ds_read_b64_tr_b16 a[254:255], v4 offset:14336
v_mfma_f32_16x16x32_bf16 v[164:167], a[232:235], a[136:139], v[164:167]
v_mfma_f32_16x16x32_bf16 v[164:167], a[236:239], a[176:179], v[164:167]
v_mfma_f32_16x16x32_bf16 v[168:171], a[232:235], a[152:155], v[168:171]
buffer_load_dwordx4 v[224:227], v18, s[8:11], s46 offen offset:0 sc1
v_mfma_f32_16x16x32_bf16 v[168:171], a[236:239], a[40:43], v[168:171]
v_mfma_f32_16x16x32_bf16 v[172:175], a[232:235], a[140:143], v[172:175]
v_mfma_f32_16x16x32_bf16 v[172:175], a[236:239], a[56:59], v[172:175]
v_mfma_f32_16x16x32_bf16 v[176:179], a[232:235], a[156:159], v[176:179]
v_mfma_f32_16x16x32_bf16 v[176:179], a[236:239], a[44:47], v[176:179]
buffer_load_dwordx4 v[228:231], v18, s[8:11], s46 offen offset:1024 sc1
v_mfma_f32_16x16x32_bf16 v[180:183], a[232:235], a[160:163], v[180:183]
s_waitcnt lgkmcnt(4)
v_mfma_f32_16x16x32_bf16 v[180:183], a[236:239], a[60:63], v[180:183]
v_mfma_f32_16x16x32_bf16 v[184:187], a[240:243], a[136:139], v[184:187]
v_mfma_f32_16x16x32_bf16 v[184:187], a[244:247], a[176:179], v[184:187]
ds_read_b64_tr_b16 a[192:193], v1 offset:16384
v_mfma_f32_16x16x32_bf16 v[188:191], a[240:243], a[152:155], v[188:191]
buffer_load_dwordx4 v[232:235], v18, s[8:11], s46 offen offset:2048 sc1
v_mfma_f32_16x16x32_bf16 v[188:191], a[244:247], a[40:43], v[188:191]
ds_read_b64_tr_b16 a[194:195], v1 offset:18432
v_mfma_f32_16x16x32_bf16 v[192:195], a[240:243], a[140:143], v[192:195]
ds_read_b64_tr_b16 a[196:197], v1 offset:20480
v_mfma_f32_16x16x32_bf16 v[192:195], a[244:247], a[56:59], v[192:195]
ds_read_b64_tr_b16 a[198:199], v1 offset:22528
v_mfma_f32_16x16x32_bf16 v[196:199], a[240:243], a[156:159], v[196:199]
v_mfma_f32_16x16x32_bf16 v[196:199], a[244:247], a[44:47], v[196:199]
buffer_load_dwordx4 v[236:239], v18, s[8:11], s46 offen offset:3072 sc1
v_mfma_f32_16x16x32_bf16 v[200:203], a[240:243], a[160:163], v[200:203]
ds_read_b64_tr_b16 a[200:201], v2 offset:16384
s_waitcnt lgkmcnt(5)
v_mfma_f32_16x16x32_bf16 v[200:203], a[244:247], a[60:63], v[200:203]
ds_read_b64_tr_b16 a[202:203], v2 offset:18432
s_mov_b32 s46, 3690496
v_mfma_f32_16x16x32_bf16 v[204:207], a[248:251], a[136:139], v[204:207]
v_mfma_f32_16x16x32_bf16 v[204:207], a[252:255], a[176:179], v[204:207]
ds_read_b64_tr_b16 a[204:205], v2 offset:20480
v_mfma_f32_16x16x32_bf16 v[208:211], a[248:251], a[152:155], v[208:211]
buffer_load_dwordx4 v[240:243], v18, s[8:11], s46 offen offset:0 sc1
v_mfma_f32_16x16x32_bf16 v[208:211], a[252:255], a[40:43], v[208:211]
ds_read_b64_tr_b16 a[206:207], v2 offset:22528
s_mov_b32 s46, 3809280
v_mfma_f32_16x16x32_bf16 v[212:215], a[248:251], a[140:143], v[212:215]
v_mfma_f32_16x16x32_bf16 v[212:215], a[252:255], a[56:59], v[212:215]
v_mfma_f32_16x16x32_bf16 v[216:219], a[248:251], a[156:159], v[216:219]
v_mfma_f32_16x16x32_bf16 v[216:219], a[252:255], a[44:47], v[216:219]
buffer_load_dwordx4 v[244:247], v18, s[8:11], s46 offen offset:0 sc1
v_mfma_f32_16x16x32_bf16 v[220:223], a[248:251], a[160:163], v[220:223]
s_waitcnt vmcnt(20) lgkmcnt(4)
v_mfma_f32_16x16x32_bf16 v[220:223], a[252:255], a[60:63], v[220:223]
v_mfma_f32_16x16x32_bf16 v[64:67], a[192:195], a[64:67], v[64:67]
ds_read_b64_tr_b16 a[208:209], v3 offset:16384
s_mov_b32 s46, 3809280
v_mfma_f32_16x16x32_bf16 v[64:67], a[196:199], a[88:91], v[64:67]
ds_read_b64_tr_b16 a[210:211], v3 offset:18432
v_mfma_f32_16x16x32_bf16 v[68:71], a[192:195], a[80:83], v[68:71]
buffer_load_dwordx4 v[248:251], v18, s[8:11], s46 offen offset:1024 sc1
v_mfma_f32_16x16x32_bf16 v[68:71], a[196:199], a[164:167], v[68:71]
ds_read_b64_tr_b16 a[212:213], v3 offset:20480
v_mfma_f32_16x16x32_bf16 v[72:75], a[192:195], a[68:71], v[72:75]
v_mfma_f32_16x16x32_bf16 v[72:75], a[196:199], a[180:183], v[72:75]
ds_read_b64_tr_b16 a[214:215], v3 offset:22528
v_mfma_f32_16x16x32_bf16 v[76:79], a[192:195], a[84:87], v[76:79]
v_mfma_f32_16x16x32_bf16 v[76:79], a[196:199], a[168:171], v[76:79]
buffer_load_dwordx4 v[252:255], v18, s[8:11], s46 offen offset:2048 sc1
v_mfma_f32_16x16x32_bf16 v[80:83], a[192:195], a[72:75], v[80:83]
ds_read_b64_tr_b16 a[216:217], v4 offset:16384
s_waitcnt lgkmcnt(5)
v_mfma_f32_16x16x32_bf16 v[80:83], a[196:199], a[184:187], v[80:83]
v_mfma_f32_16x16x32_bf16 v[84:87], a[200:203], a[64:67], v[84:87]
ds_read_b64_tr_b16 a[218:219], v4 offset:18432
v_mfma_f32_16x16x32_bf16 v[84:87], a[204:207], a[88:91], v[84:87]
v_mfma_f32_16x16x32_bf16 v[88:91], a[200:203], a[80:83], v[88:91]
buffer_load_dwordx4 a[0:3], v18, s[8:11], s46 offen offset:3072 sc1
v_mfma_f32_16x16x32_bf16 v[88:91], a[204:207], a[164:167], v[88:91]
ds_read_b64_tr_b16 a[220:221], v4 offset:20480
s_mov_b32 s46, 3813376
v_mfma_f32_16x16x32_bf16 v[92:95], a[200:203], a[68:71], v[92:95]
ds_read_b64_tr_b16 a[222:223], v4 offset:22528
v_mfma_f32_16x16x32_bf16 v[92:95], a[204:207], a[180:183], v[92:95]
v_mfma_f32_16x16x32_bf16 v[96:99], a[200:203], a[84:87], v[96:99]
ds_read_b64_tr_b16 a[224:225], v1 offset:24576
v_mfma_f32_16x16x32_bf16 v[96:99], a[204:207], a[168:171], v[96:99]
buffer_load_dwordx4 a[16:19], v18, s[8:11], s46 offen offset:0 sc1
v_mfma_f32_16x16x32_bf16 v[100:103], a[200:203], a[72:75], v[100:103]
s_waitcnt lgkmcnt(5)
ds_read_b64_tr_b16 a[226:227], v1 offset:26624
v_mfma_f32_16x16x32_bf16 v[100:103], a[204:207], a[184:187], v[100:103]
s_mov_b32 s46, 3932160
ds_read_b64_tr_b16 a[228:229], v1 offset:28672
v_mfma_f32_16x16x32_bf16 v[104:107], a[208:211], a[64:67], v[104:107]
v_mfma_f32_16x16x32_bf16 v[104:107], a[212:215], a[88:91], v[104:107]
v_mfma_f32_16x16x32_bf16 v[108:111], a[208:211], a[80:83], v[108:111]
buffer_load_dwordx4 a[108:111], v18, s[8:11], s46 offen offset:0 sc1
v_mfma_f32_16x16x32_bf16 v[108:111], a[212:215], a[164:167], v[108:111]
ds_read_b64_tr_b16 a[230:231], v1 offset:30720
s_add_u32 m0, s41, 69632
v_mfma_f32_16x16x32_bf16 v[112:115], a[208:211], a[68:71], v[112:115]
s_mov_b32 s46, 4300800
ds_read_b64_tr_b16 a[232:233], v2 offset:24576
v_mfma_f32_16x16x32_bf16 v[112:115], a[212:215], a[180:183], v[112:115]
v_mfma_f32_16x16x32_bf16 v[116:119], a[208:211], a[84:87], v[116:119]
v_mfma_f32_16x16x32_bf16 v[116:119], a[212:215], a[168:171], v[116:119]
buffer_load_dwordx4 v21, s[4:7], s46 offen offset:0 lds
v_mfma_f32_16x16x32_bf16 v[120:123], a[208:211], a[72:75], v[120:123]
ds_read_b64_tr_b16 a[234:235], v2 offset:26624
s_waitcnt lgkmcnt(6)
v_mfma_f32_16x16x32_bf16 v[120:123], a[212:215], a[184:187], v[120:123]
s_mov_b32 s46, 4310016
ds_read_b64_tr_b16 a[236:237], v2 offset:28672
v_mfma_f32_16x16x32_bf16 v[124:127], a[216:219], a[64:67], v[124:127]
v_mfma_f32_16x16x32_bf16 v[124:127], a[220:223], a[88:91], v[124:127]
v_mfma_f32_16x16x32_bf16 v[128:131], a[216:219], a[80:83], v[128:131]
buffer_load_dwordx4 v21, s[4:7], s46 offen offset:1024 lds
v_mfma_f32_16x16x32_bf16 v[128:131], a[220:223], a[164:167], v[128:131]
ds_read_b64_tr_b16 a[238:239], v2 offset:30720
s_mov_b32 s46, 4319232
v_mfma_f32_16x16x32_bf16 v[132:135], a[216:219], a[68:71], v[132:135]
ds_read_b64_tr_b16 a[240:241], v3 offset:24576
v_mfma_f32_16x16x32_bf16 v[132:135], a[220:223], a[180:183], v[132:135]
v_mfma_f32_16x16x32_bf16 v[136:139], a[216:219], a[84:87], v[136:139]
v_mfma_f32_16x16x32_bf16 v[136:139], a[220:223], a[168:171], v[136:139]
buffer_load_dwordx4 v21, s[4:7], s46 offen offset:2048 lds
v_mfma_f32_16x16x32_bf16 v[140:143], a[216:219], a[72:75], v[140:143]
ds_read_b64_tr_b16 a[242:243], v3 offset:26624
s_waitcnt lgkmcnt(6)
v_mfma_f32_16x16x32_bf16 v[140:143], a[220:223], a[184:187], v[140:143]
ds_read_b64_tr_b16 a[244:245], v3 offset:28672
s_mov_b32 s46, 4328448
v_mfma_f32_16x16x32_bf16 v[144:147], a[224:227], a[64:67], v[144:147]
v_mfma_f32_16x16x32_bf16 v[144:147], a[228:231], a[88:91], v[144:147]
ds_read_b64_tr_b16 a[246:247], v3 offset:30720
v_mfma_f32_16x16x32_bf16 v[148:151], a[224:227], a[80:83], v[148:151]
buffer_load_dwordx4 v21, s[4:7], s46 offen offset:3072 lds
v_mfma_f32_16x16x32_bf16 v[148:151], a[228:231], a[164:167], v[148:151]
ds_read_b64_tr_b16 a[248:249], v4 offset:24576
s_mov_b32 s46, 3932160
v_mfma_f32_16x16x32_bf16 v[152:155], a[224:227], a[68:71], v[152:155]
v_mfma_f32_16x16x32_bf16 v[152:155], a[228:231], a[180:183], v[152:155]
v_mfma_f32_16x16x32_bf16 v[156:159], a[224:227], a[84:87], v[156:159]
ds_read_b64_tr_b16 a[250:251], v4 offset:26624
v_mfma_f32_16x16x32_bf16 v[156:159], a[228:231], a[168:171], v[156:159]
buffer_load_dwordx4 a[124:127], v18, s[8:11], s46 offen offset:1024 sc1
v_mfma_f32_16x16x32_bf16 v[160:163], a[224:227], a[72:75], v[160:163]
ds_read_b64_tr_b16 a[252:253], v4 offset:28672
s_waitcnt lgkmcnt(7)
v_mfma_f32_16x16x32_bf16 v[160:163], a[228:231], a[184:187], v[160:163]
v_mfma_f32_16x16x32_bf16 v[164:167], a[232:235], a[64:67], v[164:167]
ds_read_b64_tr_b16 a[254:255], v4 offset:30720
v_mfma_f32_16x16x32_bf16 v[164:167], a[236:239], a[88:91], v[164:167]
v_mfma_f32_16x16x32_bf16 v[168:171], a[232:235], a[80:83], v[168:171]
buffer_load_dwordx4 a[128:131], v18, s[8:11], s46 offen offset:2048 sc1
v_mfma_f32_16x16x32_bf16 v[168:171], a[236:239], a[164:167], v[168:171]
v_mfma_f32_16x16x32_bf16 v[172:175], a[232:235], a[68:71], v[172:175]
v_mfma_f32_16x16x32_bf16 v[172:175], a[236:239], a[180:183], v[172:175]
v_mfma_f32_16x16x32_bf16 v[176:179], a[232:235], a[84:87], v[176:179]
v_mfma_f32_16x16x32_bf16 v[176:179], a[236:239], a[168:171], v[176:179]
buffer_load_dwordx4 a[144:147], v18, s[8:11], s46 offen offset:3072 sc1
v_mfma_f32_16x16x32_bf16 v[180:183], a[232:235], a[72:75], v[180:183]
s_waitcnt lgkmcnt(4)
s_mov_b32 s46, 3936256
v_mfma_f32_16x16x32_bf16 v[180:183], a[236:239], a[184:187], v[180:183]
v_mfma_f32_16x16x32_bf16 v[184:187], a[240:243], a[64:67], v[184:187]
s_waitcnt vmcnt(35) lgkmcnt(0)
s_barrier
v_mfma_f32_16x16x32_bf16 v[184:187], a[244:247], a[88:91], v[184:187]
ds_read_b64_tr_b16 a[192:193], v1 offset:32768
v_mfma_f32_16x16x32_bf16 v[188:191], a[240:243], a[80:83], v[188:191]
buffer_load_dwordx4 a[132:135], v18, s[8:11], s46 offen offset:0 sc1
v_mfma_f32_16x16x32_bf16 v[188:191], a[244:247], a[164:167], v[188:191]
ds_read_b64_tr_b16 a[194:195], v1 offset:34816
s_mov_b32 s46, 4055040
v_mfma_f32_16x16x32_bf16 v[192:195], a[240:243], a[68:71], v[192:195]
ds_read_b64_tr_b16 a[196:197], v1 offset:36864
v_mfma_f32_16x16x32_bf16 v[192:195], a[244:247], a[180:183], v[192:195]
ds_read_b64_tr_b16 a[198:199], v1 offset:38912
v_mfma_f32_16x16x32_bf16 v[196:199], a[240:243], a[84:87], v[196:199]
v_mfma_f32_16x16x32_bf16 v[196:199], a[244:247], a[168:171], v[196:199]
buffer_load_dwordx4 a[148:151], v18, s[8:11], s46 offen offset:0 sc1
v_mfma_f32_16x16x32_bf16 v[200:203], a[240:243], a[72:75], v[200:203]
ds_read_b64_tr_b16 a[200:201], v2 offset:32768
v_mfma_f32_16x16x32_bf16 v[200:203], a[244:247], a[184:187], v[200:203]
ds_read_b64_tr_b16 a[202:203], v2 offset:34816
v_mfma_f32_16x16x32_bf16 v[204:207], a[248:251], a[64:67], v[204:207]
v_mfma_f32_16x16x32_bf16 v[204:207], a[252:255], a[88:91], v[204:207]
ds_read_b64_tr_b16 a[204:205], v2 offset:36864
v_mfma_f32_16x16x32_bf16 v[208:211], a[248:251], a[80:83], v[208:211]
buffer_load_dwordx4 a[4:7], v18, s[8:11], s46 offen offset:1024 sc1
v_mfma_f32_16x16x32_bf16 v[208:211], a[252:255], a[164:167], v[208:211]
ds_read_b64_tr_b16 a[206:207], v2 offset:38912
v_mfma_f32_16x16x32_bf16 v[212:215], a[248:251], a[68:71], v[212:215]
v_mfma_f32_16x16x32_bf16 v[212:215], a[252:255], a[180:183], v[212:215]
v_mfma_f32_16x16x32_bf16 v[216:219], a[248:251], a[84:87], v[216:219]
v_mfma_f32_16x16x32_bf16 v[216:219], a[252:255], a[168:171], v[216:219]
buffer_load_dwordx4 a[20:23], v18, s[8:11], s46 offen offset:2048 sc1
v_mfma_f32_16x16x32_bf16 v[220:223], a[248:251], a[72:75], v[220:223]
s_waitcnt vmcnt(22) lgkmcnt(4)
v_mfma_f32_16x16x32_bf16 v[220:223], a[252:255], a[184:187], v[220:223]
v_mfma_f32_16x16x32_bf16 v[64:67], a[192:195], a[172:175], v[64:67]
ds_read_b64_tr_b16 a[208:209], v3 offset:32768
s_mov_b32 s46, 4055040
v_mfma_f32_16x16x32_bf16 v[64:67], a[196:199], a[112:115], v[64:67]
ds_read_b64_tr_b16 a[210:211], v3 offset:34816
s_mov_b64 s[12:13], s[66:67]
v_mfma_f32_16x16x32_bf16 v[68:71], a[192:195], a[188:191], v[68:71]
buffer_load_dwordx4 a[8:11], v18, s[8:11], s46 offen offset:3072 sc1
v_mfma_f32_16x16x32_bf16 v[68:71], a[196:199], a[100:103], v[68:71]
ds_read_b64_tr_b16 a[212:213], v3 offset:36864
s_mov_b32 s14, 202304
v_mfma_f32_16x16x32_bf16 v[72:75], a[192:195], a[76:79], v[72:75]
ds_read_b64_tr_b16 a[214:215], v3 offset:38912
s_mov_b32 s15, 0x20000
v_mfma_f32_16x16x32_bf16 v[72:75], a[196:199], a[116:119], v[72:75]
s_add_u32 s20, s68, 49283072
s_addc_u32 s21, s69, 0
v_mfma_f32_16x16x32_bf16 v[76:79], a[192:195], a[92:95], v[76:79]
s_mov_b32 s46, 4059136
s_mov_b32 s22, 14745600
v_mfma_f32_16x16x32_bf16 v[76:79], a[196:199], a[104:107], v[76:79]
buffer_load_dwordx4 a[24:27], v18, s[8:11], s46 offen offset:0 sc1
v_mfma_f32_16x16x32_bf16 v[80:83], a[192:195], a[96:99], v[80:83]
ds_read_b64_tr_b16 a[216:217], v4 offset:32768
s_waitcnt lgkmcnt(5)
v_mfma_f32_16x16x32_bf16 v[80:83], a[196:199], a[120:123], v[80:83]
s_mov_b32 s23, 0x20000
s_lshl2_add_u32 s88, s53, s52
v_mfma_f32_16x16x32_bf16 v[84:87], a[200:203], a[172:175], v[84:87]
ds_read_b64_tr_b16 a[218:219], v4 offset:34816
s_mov_b32 s46, 4177920
v_mfma_f32_16x16x32_bf16 v[84:87], a[204:207], a[112:115], v[84:87]
s_mul_i32 s32, s88, 15360
ds_read_b64_tr_b16 a[220:221], v4 offset:36864
v_mfma_f32_16x16x32_bf16 v[88:91], a[200:203], a[188:191], v[88:91]
buffer_load_dwordx4 a[12:15], v18, s[8:11], s46 offen offset:0 sc1
v_mfma_f32_16x16x32_bf16 v[88:91], a[204:207], a[100:103], v[88:91]
s_xor_b32 s89, s88, 32
s_mul_i32 s33, s89, 15360
v_mfma_f32_16x16x32_bf16 v[92:95], a[200:203], a[76:79], v[92:95]
ds_read_b64_tr_b16 a[222:223], v4 offset:38912
s_xor_b32 s89, s88, 4
v_mfma_f32_16x16x32_bf16 v[92:95], a[204:207], a[116:119], v[92:95]
v_mfma_f32_16x16x32_bf16 v[96:99], a[200:203], a[92:95], v[96:99]
ds_read_b64_tr_b16 a[224:225], v1 offset:40960
s_mul_i32 s34, s89, 15360
v_mfma_f32_16x16x32_bf16 v[96:99], a[204:207], a[104:107], v[96:99]
buffer_load_dwordx4 a[28:31], v18, s[8:11], s46 offen offset:1024 sc1
v_mfma_f32_16x16x32_bf16 v[100:103], a[200:203], a[96:99], v[100:103]
s_xor_b32 s89, s88, 36
s_waitcnt lgkmcnt(5)
v_mfma_f32_16x16x32_bf16 v[100:103], a[204:207], a[120:123], v[100:103]
ds_read_b64_tr_b16 a[226:227], v1 offset:43008
s_mul_i32 s35, s89, 15360
v_mfma_f32_16x16x32_bf16 v[104:107], a[208:211], a[172:175], v[104:107]
s_mul_i32 s88, s52, 5120
ds_read_b64_tr_b16 a[228:229], v1 offset:45056
v_mfma_f32_16x16x32_bf16 v[104:107], a[212:215], a[112:115], v[104:107]
s_add_u32 s88, s88, 131072
ds_read_b64_tr_b16 a[230:231], v1 offset:47104
v_mfma_f32_16x16x32_bf16 v[108:111], a[208:211], a[188:191], v[108:111]
buffer_load_dwordx4 a[32:35], v18, s[8:11], s46 offen offset:2048 sc1
v_mfma_f32_16x16x32_bf16 v[108:111], a[212:215], a[100:103], v[108:111]
ds_read_b64_tr_b16 a[232:233], v2 offset:40960
v_add_u32 v12, s88, v18
v_mfma_f32_16x16x32_bf16 v[112:115], a[208:211], a[76:79], v[112:115]
s_add_u32 m0, s41, 0
v_and_b32 v5, 15, v0
v_mfma_f32_16x16x32_bf16 v[112:115], a[212:215], a[116:119], v[112:115]
s_mov_b32 s46, 4423680
v_lshrrev_b32 v6, 4, v0
v_mfma_f32_16x16x32_bf16 v[116:119], a[208:211], a[92:95], v[116:119]
ds_read_b64_tr_b16 a[234:235], v2 offset:43008
v_lshl_add_u32 v7, v5, 2, v6
v_mfma_f32_16x16x32_bf16 v[116:119], a[212:215], a[104:107], v[116:119]
buffer_load_dwordx4 v21, s[4:7], s46 offen offset:0 lds
v_mfma_f32_16x16x32_bf16 v[120:123], a[208:211], a[96:99], v[120:123]
s_waitcnt lgkmcnt(6)
v_lshlrev_b32 v7, 4, v7
v_mfma_f32_16x16x32_bf16 v[120:123], a[212:215], a[120:123], v[120:123]
s_mov_b32 s46, 4432896
v_add_u32 v17, s88, v7
v_mfma_f32_16x16x32_bf16 v[124:127], a[216:219], a[172:175], v[124:127]
ds_read_b64_tr_b16 a[236:237], v2 offset:45056
v_lshlrev_b32 v6, 2, v6
v_mfma_f32_16x16x32_bf16 v[124:127], a[220:223], a[112:115], v[124:127]
v_mfma_f32_16x16x32_bf16 v[128:131], a[216:219], a[188:191], v[128:131]
buffer_load_dwordx4 v21, s[4:7], s46 offen offset:1024 lds
v_mfma_f32_16x16x32_bf16 v[128:131], a[220:223], a[100:103], v[128:131]
ds_read_b64_tr_b16 a[238:239], v2 offset:47104
v_sub_u32 v5, v5, v6
v_mfma_f32_16x16x32_bf16 v[132:135], a[216:219], a[76:79], v[132:135]
ds_read_b64_tr_b16 a[240:241], v3 offset:40960
v_and_b32 v6, 1, v5
v_mfma_f32_16x16x32_bf16 v[132:135], a[220:223], a[116:119], v[132:135]
s_mov_b32 s46, 4442112
v_lshlrev_b32 v6, 4, v6
v_mfma_f32_16x16x32_bf16 v[136:139], a[216:219], a[92:95], v[136:139]
ds_read_b64_tr_b16 a[242:243], v3 offset:43008
v_mov_b32 v7, 0x3f80
v_mfma_f32_16x16x32_bf16 v[136:139], a[220:223], a[104:107], v[136:139]
buffer_load_dwordx4 v21, s[4:7], s46 offen offset:2048 lds
v_mfma_f32_16x16x32_bf16 v[140:143], a[216:219], a[96:99], v[140:143]
v_lshlrev_b32 v6, v6, v7
s_waitcnt lgkmcnt(6)
v_mfma_f32_16x16x32_bf16 v[140:143], a[220:223], a[120:123], v[140:143]
ds_read_b64_tr_b16 a[244:245], v3 offset:45056
v_lshrrev_b32 v5, 1, v5
v_mfma_f32_16x16x32_bf16 v[144:147], a[224:227], a[172:175], v[144:147]
s_mov_b32 s46, 4451328
v_cmp_eq_u32 s[84:85], 0, v5
v_mfma_f32_16x16x32_bf16 v[144:147], a[228:231], a[112:115], v[144:147]
ds_read_b64_tr_b16 a[246:247], v3 offset:47104
v_cmp_eq_u32 s[86:87], 1, v5
v_mfma_f32_16x16x32_bf16 v[148:151], a[224:227], a[188:191], v[148:151]
buffer_load_dwordx4 v21, s[4:7], s46 offen offset:3072 lds
v_mfma_f32_16x16x32_bf16 v[148:151], a[228:231], a[100:103], v[148:151]
ds_read_b64_tr_b16 a[248:249], v4 offset:40960
v_mov_b32 v34, 0
v_mfma_f32_16x16x32_bf16 v[152:155], a[224:227], a[76:79], v[152:155]
s_mov_b32 s46, 4177920
v_mov_b32 v35, 0
v_mfma_f32_16x16x32_bf16 v[152:155], a[228:231], a[116:119], v[152:155]
ds_read_b64_tr_b16 a[250:251], v4 offset:43008
v_cndmask_b32 v32, 0, v6, s[84:85]
v_mfma_f32_16x16x32_bf16 v[156:159], a[224:227], a[92:95], v[156:159]
ds_read_b64_tr_b16 a[252:253], v4 offset:45056
v_cndmask_b32 v33, 0, v6, s[86:87]
v_mfma_f32_16x16x32_bf16 v[156:159], a[228:231], a[104:107], v[156:159]
buffer_load_dwordx4 a[48:51], v18, s[8:11], s46 offen offset:3072 sc1
v_mfma_f32_16x16x32_bf16 v[160:163], a[224:227], a[96:99], v[160:163]
s_waitcnt lgkmcnt(7)
v_mov_b32 v36, 0
v_mfma_f32_16x16x32_bf16 v[160:163], a[228:231], a[120:123], v[160:163]
s_mov_b32 s46, 4182016
v_mov_b32 v37, 0
v_mfma_f32_16x16x32_bf16 v[164:167], a[232:235], a[172:175], v[164:167]
ds_read_b64_tr_b16 a[254:255], v4 offset:47104
v_mov_b32 v38, v32
v_mfma_f32_16x16x32_bf16 v[164:167], a[236:239], a[112:115], v[164:167]
v_mfma_f32_16x16x32_bf16 v[168:171], a[232:235], a[188:191], v[168:171]
buffer_load_dwordx4 a[36:39], v18, s[8:11], s46 offen offset:0 sc1
v_mfma_f32_16x16x32_bf16 v[168:171], a[236:239], a[100:103], v[168:171]
v_mov_b32 v39, v33
v_lshrrev_b32 v5, 2, v0
v_mfma_f32_16x16x32_bf16 v[172:175], a[232:235], a[76:79], v[172:175]
s_mov_b32 s46, 4300800
v_and_b32 v6, 3, v0
v_mfma_f32_16x16x32_bf16 v[172:175], a[236:239], a[116:119], v[172:175]
v_mfma_f32_16x16x32_bf16 v[176:179], a[232:235], a[92:95], v[176:179]
v_mul_u32_u24 v10, 2560, v5
v_lshl_add_u32 v10, v6, 4, v10
v_mfma_f32_16x16x32_bf16 v[176:179], a[236:239], a[104:107], v[176:179]
buffer_load_dwordx4 a[52:55], v18, s[8:11], s46 offen offset:0 sc1
v_mfma_f32_16x16x32_bf16 v[180:183], a[232:235], a[96:99], v[180:183]
s_waitcnt lgkmcnt(4)
v_min_u32 v6, 2, v0
v_mfma_f32_16x16x32_bf16 v[180:183], a[236:239], a[120:123], v[180:183]
v_mfma_f32_16x16x32_bf16 v[184:187], a[240:243], a[172:175], v[184:187]
v_add_u32 v6, 1, v6
v_and_b32 v5, 1, v6
v_mfma_f32_16x16x32_bf16 v[184:187], a[244:247], a[112:115], v[184:187]
ds_read_b64_tr_b16 a[192:193], v1 offset:49152
v_lshrrev_b32 v6, 1, v6
v_mfma_f32_16x16x32_bf16 v[188:191], a[240:243], a[188:191], v[188:191]
buffer_load_dwordx4 a[136:139], v18, s[8:11], s46 offen offset:1024 sc1
v_mfma_f32_16x16x32_bf16 v[188:191], a[244:247], a[100:103], v[188:191]
ds_read_b64_tr_b16 a[194:195], v1 offset:51200
v_lshl_or_b32 v5, v5, 3, v6
v_mfma_f32_16x16x32_bf16 v[192:195], a[240:243], a[76:79], v[192:195]
ds_read_b64_tr_b16 a[196:197], v1 offset:53248
v_xor_b32 v5, s53, v5
v_mfma_f32_16x16x32_bf16 v[192:195], a[244:247], a[116:119], v[192:195]
ds_read_b64_tr_b16 a[198:199], v1 offset:55296
v_lshlrev_b32 v11, 7, v5
v_mfma_f32_16x16x32_bf16 v[196:199], a[240:243], a[92:95], v[196:199]
v_mfma_f32_16x16x32_bf16 v[196:199], a[244:247], a[104:107], v[196:199]
buffer_load_dwordx4 a[152:155], v18, s[8:11], s46 offen offset:2048 sc1
v_mfma_f32_16x16x32_bf16 v[200:203], a[240:243], a[96:99], v[200:203]
ds_read_b64_tr_b16 a[200:201], v2 offset:49152
s_waitcnt lgkmcnt(5)
v_mfma_f32_16x16x32_bf16 v[200:203], a[244:247], a[120:123], v[200:203]
ds_read_b64_tr_b16 a[202:203], v2 offset:51200
v_min_u32 v6, 2, v0
v_mfma_f32_16x16x32_bf16 v[204:207], a[248:251], a[172:175], v[204:207]
v_lshl_add_u32 v11, v6, 2, v11
s_add_u32 s34, s34, 5120
v_mfma_f32_16x16x32_bf16 v[204:207], a[252:255], a[112:115], v[204:207]
ds_read_b64_tr_b16 a[204:205], v2 offset:53248
s_add_u32 s35, s35, 10240
v_mfma_f32_16x16x32_bf16 v[208:211], a[248:251], a[188:191], v[208:211]
buffer_load_dwordx4 a[140:143], v18, s[8:11], s46 offen offset:3072 sc1
v_mfma_f32_16x16x32_bf16 v[208:211], a[252:255], a[100:103], v[208:211]
ds_read_b64_tr_b16 a[206:207], v2 offset:55296
s_mov_b32 s40, 0
v_mfma_f32_16x16x32_bf16 v[212:215], a[248:251], a[76:79], v[212:215]
s_mov_b32 s46, 4304896
s_lshl_b32 s55, s53, 7
v_mfma_f32_16x16x32_bf16 v[212:215], a[252:255], a[116:119], v[212:215]
s_cmp_eq_u32 s52, 0
s_cselect_b32 s55, s55, 0x10000
v_mfma_f32_16x16x32_bf16 v[216:219], a[248:251], a[92:95], v[216:219]
v_mfma_f32_16x16x32_bf16 v[216:219], a[252:255], a[104:107], v[216:219]
buffer_load_dwordx4 a[156:159], v18, s[8:11], s46 offen offset:0 sc1
v_mfma_f32_16x16x32_bf16 v[220:223], a[248:251], a[96:99], v[220:223]
s_waitcnt vmcnt(28) lgkmcnt(4)
v_mfma_f32_16x16x32_bf16 v[220:223], a[252:255], a[120:123], v[220:223]
v_mfma_f32_16x16x32_bf16 v[64:67], a[192:195], v[224:227], v[64:67]
ds_read_b64_tr_b16 a[208:209], v3 offset:49152
v_mfma_f32_16x16x32_bf16 v[64:67], a[196:199], v[244:247], v[64:67]
ds_read_b64_tr_b16 a[210:211], v3 offset:51200
v_mfma_f32_16x16x32_bf16 v[68:71], a[192:195], v[228:231], v[68:71]
global_load_dword v30, v[28:29], off
v_mfma_f32_16x16x32_bf16 v[68:71], a[196:199], v[248:251], v[68:71]
ds_read_b64_tr_b16 a[212:213], v3 offset:53248
s_mov_b32 s46, 4423680
v_mfma_f32_16x16x32_bf16 v[72:75], a[192:195], v[232:235], v[72:75]
v_mfma_f32_16x16x32_bf16 v[72:75], a[196:199], v[252:255], v[72:75]
ds_read_b64_tr_b16 a[214:215], v3 offset:55296
v_mfma_f32_16x16x32_bf16 v[76:79], a[192:195], v[236:239], v[76:79]
v_mfma_f32_16x16x32_bf16 v[76:79], a[196:199], a[0:3], v[76:79]
buffer_load_dwordx4 a[160:163], v18, s[8:11], s46 offen offset:0 sc1
v_mfma_f32_16x16x32_bf16 v[80:83], a[192:195], v[240:243], v[80:83]
ds_read_b64_tr_b16 a[216:217], v4 offset:49152
s_waitcnt lgkmcnt(5)
v_mfma_f32_16x16x32_bf16 v[80:83], a[196:199], a[16:19], v[80:83]
v_mfma_f32_16x16x32_bf16 v[84:87], a[200:203], v[224:227], v[84:87]
ds_read_b64_tr_b16 a[218:219], v4 offset:51200
v_mfma_f32_16x16x32_bf16 v[84:87], a[204:207], v[244:247], v[84:87]
buffer_load_dwordx4 a[176:179], v18, s[8:11], s46 offen offset:1024 sc1
v_mfma_f32_16x16x32_bf16 v[88:91], a[200:203], v[228:231], v[88:91]
ds_read_b64_tr_b16 a[220:221], v4 offset:53248
v_mfma_f32_16x16x32_bf16 v[88:91], a[204:207], v[248:251], v[88:91]
v_mfma_f32_16x16x32_bf16 v[92:95], a[200:203], v[232:235], v[92:95]
ds_read_b64_tr_b16 a[222:223], v4 offset:55296
v_mfma_f32_16x16x32_bf16 v[92:95], a[204:207], v[252:255], v[92:95]
v_mfma_f32_16x16x32_bf16 v[96:99], a[200:203], v[236:239], v[96:99]
buffer_load_dwordx4 a[40:43], v18, s[8:11], s46 offen offset:2048 sc1
v_mfma_f32_16x16x32_bf16 v[96:99], a[204:207], a[0:3], v[96:99]
ds_read_b64_tr_b16 a[224:225], v1 offset:57344
s_waitcnt lgkmcnt(5)
v_mfma_f32_16x16x32_bf16 v[100:103], a[200:203], v[240:243], v[100:103]
v_mfma_f32_16x16x32_bf16 v[100:103], a[204:207], a[16:19], v[100:103]
ds_read_b64_tr_b16 a[226:227], v1 offset:59392
v_mfma_f32_16x16x32_bf16 v[104:107], a[208:211], v[224:227], v[104:107]
v_mfma_f32_16x16x32_bf16 v[104:107], a[212:215], v[244:247], v[104:107]
buffer_load_dwordx4 a[56:59], v18, s[8:11], s46 offen offset:3072 sc1
v_mfma_f32_16x16x32_bf16 v[108:111], a[208:211], v[228:231], v[108:111]
ds_read_b64_tr_b16 a[228:229], v1 offset:61440
s_mov_b32 s46, 4427776
v_mfma_f32_16x16x32_bf16 v[108:111], a[212:215], v[248:251], v[108:111]
ds_read_b64_tr_b16 a[230:231], v1 offset:63488
v_mfma_f32_16x16x32_bf16 v[112:115], a[208:211], v[232:235], v[112:115]
v_mfma_f32_16x16x32_bf16 v[112:115], a[212:215], v[252:255], v[112:115]
buffer_load_dwordx4 a[44:47], v18, s[8:11], s46 offen offset:0 sc1
v_mfma_f32_16x16x32_bf16 v[116:119], a[208:211], v[236:239], v[116:119]
ds_read_b64_tr_b16 a[232:233], v2 offset:57344
s_add_u32 m0, s41, 4096
v_mfma_f32_16x16x32_bf16 v[116:119], a[212:215], a[0:3], v[116:119]
s_mov_b32 s46, 4464640
s_waitcnt lgkmcnt(5)
v_mfma_f32_16x16x32_bf16 v[120:123], a[208:211], v[240:243], v[120:123]
ds_read_b64_tr_b16 a[234:235], v2 offset:59392
v_mfma_f32_16x16x32_bf16 v[120:123], a[212:215], a[16:19], v[120:123]
v_mfma_f32_16x16x32_bf16 v[124:127], a[216:219], v[224:227], v[124:127]
buffer_load_dwordx4 v21, s[4:7], s46 offen offset:0 lds
v_mfma_f32_16x16x32_bf16 v[124:127], a[220:223], v[244:247], v[124:127]
ds_read_b64_tr_b16 a[236:237], v2 offset:61440
s_mov_b32 s46, 4473856
v_mfma_f32_16x16x32_bf16 v[128:131], a[216:219], v[228:231], v[128:131]
ds_read_b64_tr_b16 a[238:239], v2 offset:63488
v_mfma_f32_16x16x32_bf16 v[128:131], a[220:223], v[248:251], v[128:131]
v_mfma_f32_16x16x32_bf16 v[132:135], a[216:219], v[232:235], v[132:135]
ds_read_b64_tr_b16 a[240:241], v3 offset:57344
v_mfma_f32_16x16x32_bf16 v[132:135], a[220:223], v[252:255], v[132:135]
buffer_load_dwordx4 v21, s[4:7], s46 offen offset:1024 lds
v_mfma_f32_16x16x32_bf16 v[136:139], a[216:219], v[236:239], v[136:139]
v_mfma_f32_16x16x32_bf16 v[136:139], a[220:223], a[0:3], v[136:139]
ds_read_b64_tr_b16 a[242:243], v3 offset:59392
s_mov_b32 s46, 4483072
v_mfma_f32_16x16x32_bf16 v[140:143], a[216:219], v[240:243], v[140:143]
s_waitcnt lgkmcnt(6)
ds_read_b64_tr_b16 a[244:245], v3 offset:61440
v_mfma_f32_16x16x32_bf16 v[140:143], a[220:223], a[16:19], v[140:143]
v_mfma_f32_16x16x32_bf16 v[144:147], a[224:227], v[224:227], v[144:147]
buffer_load_dwordx4 v21, s[4:7], s46 offen offset:2048 lds
v_mfma_f32_16x16x32_bf16 v[144:147], a[228:231], v[244:247], v[144:147]
ds_read_b64_tr_b16 a[246:247], v3 offset:63488
s_mov_b32 s46, 4492288
v_mfma_f32_16x16x32_bf16 v[148:151], a[224:227], v[228:231], v[148:151]
v_mfma_f32_16x16x32_bf16 v[148:151], a[228:231], v[248:251], v[148:151]
ds_read_b64_tr_b16 a[248:249], v4 offset:57344
v_mfma_f32_16x16x32_bf16 v[152:155], a[224:227], v[232:235], v[152:155]
buffer_load_dwordx4 v21, s[4:7], s46 offen offset:3072 lds
v_mfma_f32_16x16x32_bf16 v[152:155], a[228:231], v[252:255], v[152:155]
v_mfma_f32_16x16x32_bf16 v[156:159], a[224:227], v[236:239], v[156:159]
ds_read_b64_tr_b16 a[250:251], v4 offset:59392
s_mov_b32 s46, 4546560
v_mfma_f32_16x16x32_bf16 v[156:159], a[228:231], a[0:3], v[156:159]
s_waitcnt lgkmcnt(6)
ds_read_b64_tr_b16 a[252:253], v4 offset:61440
v_mfma_f32_16x16x32_bf16 v[160:163], a[224:227], v[240:243], v[160:163]
v_mfma_f32_16x16x32_bf16 v[160:163], a[228:231], a[16:19], v[160:163]
buffer_load_dwordx4 a[60:63], v18, s[8:11], s46 offen offset:0 sc1
v_mfma_f32_16x16x32_bf16 v[164:167], a[232:235], v[224:227], v[164:167]
ds_read_b64_tr_b16 a[254:255], v4 offset:63488
v_mfma_f32_16x16x32_bf16 v[164:167], a[236:239], v[244:247], v[164:167]
v_mfma_f32_16x16x32_bf16 v[168:171], a[232:235], v[228:231], v[168:171]
v_mfma_f32_16x16x32_bf16 v[168:171], a[236:239], v[248:251], v[168:171]
v_mfma_f32_16x16x32_bf16 v[172:175], a[232:235], v[232:235], v[172:175]
buffer_load_dwordx4 a[64:67], v18, s[8:11], s46 offen offset:1024 sc1
v_mfma_f32_16x16x32_bf16 v[172:175], a[236:239], v[252:255], v[172:175]
v_mfma_f32_16x16x32_bf16 v[176:179], a[232:235], v[236:239], v[176:179]
v_mfma_f32_16x16x32_bf16 v[176:179], a[236:239], a[0:3], v[176:179]
s_waitcnt lgkmcnt(4)
v_mfma_f32_16x16x32_bf16 v[180:183], a[232:235], v[240:243], v[180:183]
buffer_load_dwordx4 a[80:83], v18, s[8:11], s46 offen offset:2048 sc1
v_mfma_f32_16x16x32_bf16 v[180:183], a[236:239], a[16:19], v[180:183]
v_mfma_f32_16x16x32_bf16 v[184:187], a[240:243], v[224:227], v[184:187]
s_waitcnt vmcnt(36) lgkmcnt(0)
s_barrier
v_mfma_f32_16x16x32_bf16 v[184:187], a[244:247], v[244:247], v[184:187]
ds_read_b64_tr_b16 a[192:193], v13 offset:0
v_mfma_f32_16x16x32_bf16 v[188:191], a[240:243], v[228:231], v[188:191]
ds_read_b64_tr_b16 a[194:195], v13 offset:2048
v_mfma_f32_16x16x32_bf16 v[188:191], a[244:247], v[248:251], v[188:191]
buffer_load_dwordx4 a[68:71], v18, s[8:11], s46 offen offset:3072 sc1
v_mfma_f32_16x16x32_bf16 v[192:195], a[240:243], v[232:235], v[192:195]
ds_read_b64_tr_b16 a[196:197], v13 offset:4096
s_mov_b32 s46, 4550656
v_mfma_f32_16x16x32_bf16 v[192:195], a[244:247], v[252:255], v[192:195]
ds_read_b64_tr_b16 a[198:199], v13 offset:6144
v_mfma_f32_16x16x32_bf16 v[196:199], a[240:243], v[236:239], v[196:199]
v_mfma_f32_16x16x32_bf16 v[196:199], a[244:247], a[0:3], v[196:199]
ds_read_b64_tr_b16 a[200:201], v14 offset:0
v_mfma_f32_16x16x32_bf16 v[200:203], a[240:243], v[240:243], v[200:203]
buffer_load_dwordx4 a[84:87], v18, s[8:11], s46 offen offset:0 sc1
v_mfma_f32_16x16x32_bf16 v[200:203], a[244:247], a[16:19], v[200:203]
ds_read_b64_tr_b16 a[202:203], v14 offset:2048
s_mov_b32 s46, 4669440
v_mfma_f32_16x16x32_bf16 v[204:207], a[248:251], v[224:227], v[204:207]
v_mfma_f32_16x16x32_bf16 v[204:207], a[252:255], v[244:247], v[204:207]
ds_read_b64_tr_b16 a[204:205], v14 offset:4096
v_mfma_f32_16x16x32_bf16 v[208:211], a[248:251], v[228:231], v[208:211]
buffer_load_dwordx4 a[72:75], v18, s[8:11], s46 offen offset:0 sc1
v_mfma_f32_16x16x32_bf16 v[208:211], a[252:255], v[248:251], v[208:211]
ds_read_b64_tr_b16 a[206:207], v14 offset:6144
v_mfma_f32_16x16x32_bf16 v[212:215], a[248:251], v[232:235], v[212:215]
v_mfma_f32_16x16x32_bf16 v[212:215], a[252:255], v[252:255], v[212:215]
v_mfma_f32_16x16x32_bf16 v[216:219], a[248:251], v[236:239], v[216:219]
v_mfma_f32_16x16x32_bf16 v[216:219], a[252:255], a[0:3], v[216:219]
buffer_load_dwordx4 a[88:91], v18, s[8:11], s46 offen offset:1024 sc1
v_mfma_f32_16x16x32_bf16 v[220:223], a[248:251], v[240:243], v[220:223]
s_waitcnt vmcnt(31) lgkmcnt(4)
v_mfma_f32_16x16x32_bf16 v[220:223], a[252:255], a[16:19], v[220:223]
v_mfma_f32_16x16x32_bf16 v[64:67], a[192:195], a[108:111], v[64:67]
ds_read_b64_tr_b16 a[208:209], v15 offset:0
s_mov_b32 s46, 4669440
v_mfma_f32_16x16x32_bf16 v[64:67], a[196:199], a[148:151], v[64:67]
ds_read_b64_tr_b16 a[210:211], v15 offset:2048
v_mfma_f32_16x16x32_bf16 v[68:71], a[192:195], a[124:127], v[68:71]
buffer_load_dwordx4 a[164:167], v18, s[8:11], s46 offen offset:2048 sc1
v_mfma_f32_16x16x32_bf16 v[68:71], a[196:199], a[4:7], v[68:71]
ds_read_b64_tr_b16 a[212:213], v15 offset:4096
v_mfma_f32_16x16x32_bf16 v[72:75], a[192:195], a[128:131], v[72:75]
v_mfma_f32_16x16x32_bf16 v[72:75], a[196:199], a[20:23], v[72:75]
ds_read_b64_tr_b16 a[214:215], v15 offset:6144
v_mfma_f32_16x16x32_bf16 v[76:79], a[192:195], a[144:147], v[76:79]
v_mfma_f32_16x16x32_bf16 v[76:79], a[196:199], a[8:11], v[76:79]
buffer_load_dwordx4 a[180:183], v18, s[8:11], s46 offen offset:3072 sc1
v_mfma_f32_16x16x32_bf16 v[80:83], a[192:195], a[132:135], v[80:83]
ds_read_b64_tr_b16 a[216:217], v16 offset:0
s_waitcnt lgkmcnt(5)
v_mfma_f32_16x16x32_bf16 v[80:83], a[196:199], a[24:27], v[80:83]
s_mov_b32 s46, 4673536
ds_read_b64_tr_b16 a[218:219], v16 offset:2048
v_mfma_f32_16x16x32_bf16 v[84:87], a[200:203], a[108:111], v[84:87]
v_mfma_f32_16x16x32_bf16 v[84:87], a[204:207], a[148:151], v[84:87]
buffer_load_dwordx4 a[168:171], v18, s[8:11], s46 offen offset:0 sc1
v_mfma_f32_16x16x32_bf16 v[88:91], a[200:203], a[124:127], v[88:91]
ds_read_b64_tr_b16 a[220:221], v16 offset:4096
s_mov_b32 s46, 4792320
v_mfma_f32_16x16x32_bf16 v[88:91], a[204:207], a[4:7], v[88:91]
v_mfma_f32_16x16x32_bf16 v[92:95], a[200:203], a[128:131], v[92:95]
ds_read_b64_tr_b16 a[222:223], v16 offset:6144
v_mfma_f32_16x16x32_bf16 v[92:95], a[204:207], a[20:23], v[92:95]
v_mfma_f32_16x16x32_bf16 v[96:99], a[200:203], a[144:147], v[96:99]
buffer_load_dwordx4 a[184:187], v18, s[8:11], s46 offen offset:0 sc1
v_mfma_f32_16x16x32_bf16 v[96:99], a[204:207], a[8:11], v[96:99]
ds_read_b64_tr_b16 a[224:225], v13 offset:8192
s_waitcnt lgkmcnt(5)
v_mfma_f32_16x16x32_bf16 v[100:103], a[200:203], a[132:135], v[100:103]
v_mfma_f32_16x16x32_bf16 v[100:103], a[204:207], a[24:27], v[100:103]
ds_read_b64_tr_b16 a[226:227], v13 offset:10240
v_mfma_f32_16x16x32_bf16 v[104:107], a[208:211], a[108:111], v[104:107]
v_mfma_f32_16x16x32_bf16 v[104:107], a[212:215], a[148:151], v[104:107]
buffer_load_dwordx4 a[172:175], v18, s[8:11], s46 offen offset:1024 sc1
v_mfma_f32_16x16x32_bf16 v[108:111], a[208:211], a[124:127], v[108:111]
ds_read_b64_tr_b16 a[228:229], v13 offset:12288
s_add_u32 m0, s41, 32768
v_mfma_f32_16x16x32_bf16 v[108:111], a[212:215], a[4:7], v[108:111]
ds_read_b64_tr_b16 a[230:231], v13 offset:14336
s_mov_b32 s46, 4587520
v_mfma_f32_16x16x32_bf16 v[112:115], a[208:211], a[128:131], v[112:115]
v_mfma_f32_16x16x32_bf16 v[112:115], a[212:215], a[20:23], v[112:115]
buffer_load_dwordx4 v21, s[4:7], s46 offen offset:0 lds
v_mfma_f32_16x16x32_bf16 v[116:119], a[208:211], a[144:147], v[116:119]
ds_read_b64_tr_b16 a[232:233], v14 offset:8192
s_mov_b32 s46, 4596736
v_mfma_f32_16x16x32_bf16 v[116:119], a[212:215], a[8:11], v[116:119]
s_waitcnt lgkmcnt(5)
ds_read_b64_tr_b16 a[234:235], v14 offset:10240
v_mfma_f32_16x16x32_bf16 v[120:123], a[208:211], a[132:135], v[120:123]
v_mfma_f32_16x16x32_bf16 v[120:123], a[212:215], a[24:27], v[120:123]
v_mfma_f32_16x16x32_bf16 v[124:127], a[216:219], a[108:111], v[124:127]
buffer_load_dwordx4 v21, s[4:7], s46 offen offset:1024 lds
v_mfma_f32_16x16x32_bf16 v[124:127], a[220:223], a[148:151], v[124:127]
ds_read_b64_tr_b16 a[236:237], v14 offset:12288
s_mov_b32 s46, 4605952
v_mfma_f32_16x16x32_bf16 v[128:131], a[216:219], a[124:127], v[128:131]
ds_read_b64_tr_b16 a[238:239], v14 offset:14336
v_mfma_f32_16x16x32_bf16 v[128:131], a[220:223], a[4:7], v[128:131]
v_mfma_f32_16x16x32_bf16 v[132:135], a[216:219], a[128:131], v[132:135]
ds_read_b64_tr_b16 a[240:241], v15 offset:8192
v_mfma_f32_16x16x32_bf16 v[132:135], a[220:223], a[20:23], v[132:135]
buffer_load_dwordx4 v21, s[4:7], s46 offen offset:2048 lds
v_mfma_f32_16x16x32_bf16 v[136:139], a[216:219], a[144:147], v[136:139]
v_mfma_f32_16x16x32_bf16 v[136:139], a[220:223], a[8:11], v[136:139]
ds_read_b64_tr_b16 a[242:243], v15 offset:10240
s_mov_b32 s46, 4615168
v_mfma_f32_16x16x32_bf16 v[140:143], a[216:219], a[132:135], v[140:143]
s_waitcnt lgkmcnt(6)
ds_read_b64_tr_b16 a[244:245], v15 offset:12288
v_mfma_f32_16x16x32_bf16 v[140:143], a[220:223], a[24:27], v[140:143]
v_mfma_f32_16x16x32_bf16 v[144:147], a[224:227], a[108:111], v[144:147]
buffer_load_dwordx4 v21, s[4:7], s46 offen offset:3072 lds
v_mfma_f32_16x16x32_bf16 v[144:147], a[228:231], a[148:151], v[144:147]
ds_read_b64_tr_b16 a[246:247], v15 offset:14336
s_mov_b32 s46, 4792320
v_mfma_f32_16x16x32_bf16 v[148:151], a[224:227], a[124:127], v[148:151]
v_mfma_f32_16x16x32_bf16 v[148:151], a[228:231], a[4:7], v[148:151]
ds_read_b64_tr_b16 a[248:249], v16 offset:8192
v_mfma_f32_16x16x32_bf16 v[152:155], a[224:227], a[128:131], v[152:155]
buffer_load_dwordx4 a[188:191], v18, s[8:11], s46 offen offset:2048 sc1
v_mfma_f32_16x16x32_bf16 v[152:155], a[228:231], a[20:23], v[152:155]
v_mfma_f32_16x16x32_bf16 v[156:159], a[224:227], a[144:147], v[156:159]
ds_read_b64_tr_b16 a[250:251], v16 offset:10240
v_mfma_f32_16x16x32_bf16 v[156:159], a[228:231], a[8:11], v[156:159]
s_waitcnt lgkmcnt(6)
ds_read_b64_tr_b16 a[252:253], v16 offset:12288
v_mfma_f32_16x16x32_bf16 v[160:163], a[224:227], a[132:135], v[160:163]
v_mfma_f32_16x16x32_bf16 v[160:163], a[228:231], a[24:27], v[160:163]
buffer_load_dwordx4 a[76:79], v18, s[8:11], s46 offen offset:3072 sc1
v_mfma_f32_16x16x32_bf16 v[164:167], a[232:235], a[108:111], v[164:167]
ds_read_b64_tr_b16 a[254:255], v16 offset:14336
s_mov_b32 s46, 4796416
v_mfma_f32_16x16x32_bf16 v[164:167], a[236:239], a[148:151], v[164:167]
v_mfma_f32_16x16x32_bf16 v[168:171], a[232:235], a[124:127], v[168:171]
v_mfma_f32_16x16x32_bf16 v[168:171], a[236:239], a[4:7], v[168:171]
v_mfma_f32_16x16x32_bf16 v[172:175], a[232:235], a[128:131], v[172:175]
buffer_load_dwordx4 a[92:95], v18, s[8:11], s46 offen offset:0 sc1
v_mfma_f32_16x16x32_bf16 v[172:175], a[236:239], a[20:23], v[172:175]
s_mov_b32 s46, 4915200
v_mfma_f32_16x16x32_bf16 v[176:179], a[232:235], a[144:147], v[176:179]
v_mfma_f32_16x16x32_bf16 v[176:179], a[236:239], a[8:11], v[176:179]
s_waitcnt lgkmcnt(4)
v_mfma_f32_16x16x32_bf16 v[180:183], a[232:235], a[132:135], v[180:183]
buffer_load_dwordx4 a[96:99], v18, s[8:11], s46 offen offset:0 sc1
v_mfma_f32_16x16x32_bf16 v[180:183], a[236:239], a[24:27], v[180:183]
v_mfma_f32_16x16x32_bf16 v[184:187], a[240:243], a[108:111], v[184:187]
v_mfma_f32_16x16x32_bf16 v[184:187], a[244:247], a[148:151], v[184:187]
ds_read_b64_tr_b16 a[192:193], v13 offset:16384
v_mfma_f32_16x16x32_bf16 v[188:191], a[240:243], a[124:127], v[188:191]
ds_read_b64_tr_b16 a[194:195], v13 offset:18432
v_mfma_f32_16x16x32_bf16 v[188:191], a[244:247], a[4:7], v[188:191]
buffer_load_dwordx4 a[112:115], v18, s[8:11], s46 offen offset:1024 sc1
v_mfma_f32_16x16x32_bf16 v[192:195], a[240:243], a[128:131], v[192:195]
ds_read_b64_tr_b16 a[196:197], v13 offset:20480
v_mfma_f32_16x16x32_bf16 v[192:195], a[244:247], a[20:23], v[192:195]
ds_read_b64_tr_b16 a[198:199], v13 offset:22528
v_mfma_f32_16x16x32_bf16 v[196:199], a[240:243], a[144:147], v[196:199]
v_mfma_f32_16x16x32_bf16 v[196:199], a[244:247], a[8:11], v[196:199]
ds_read_b64_tr_b16 a[200:201], v14 offset:16384
s_waitcnt lgkmcnt(5)
v_mfma_f32_16x16x32_bf16 v[200:203], a[240:243], a[132:135], v[200:203]
buffer_load_dwordx4 a[100:103], v18, s[8:11], s46 offen offset:2048 sc1
v_mfma_f32_16x16x32_bf16 v[200:203], a[244:247], a[24:27], v[200:203]
ds_read_b64_tr_b16 a[202:203], v14 offset:18432
v_mfma_f32_16x16x32_bf16 v[204:207], a[248:251], a[108:111], v[204:207]
v_mfma_f32_16x16x32_bf16 v[204:207], a[252:255], a[148:151], v[204:207]
ds_read_b64_tr_b16 a[204:205], v14 offset:20480
v_mfma_f32_16x16x32_bf16 v[208:211], a[248:251], a[124:127], v[208:211]
buffer_load_dwordx4 a[116:119], v18, s[8:11], s46 offen offset:3072 sc1
v_mfma_f32_16x16x32_bf16 v[208:211], a[252:255], a[4:7], v[208:211]
ds_read_b64_tr_b16 a[206:207], v14 offset:22528
s_mov_b32 s46, 4919296
v_mfma_f32_16x16x32_bf16 v[212:215], a[248:251], a[128:131], v[212:215]
v_mfma_f32_16x16x32_bf16 v[212:215], a[252:255], a[20:23], v[212:215]
v_mfma_f32_16x16x32_bf16 v[216:219], a[248:251], a[144:147], v[216:219]
v_mfma_f32_16x16x32_bf16 v[216:219], a[252:255], a[8:11], v[216:219]
buffer_load_dwordx4 a[104:107], v18, s[8:11], s46 offen offset:0 sc1
v_mfma_f32_16x16x32_bf16 v[220:223], a[248:251], a[132:135], v[220:223]
s_waitcnt vmcnt(34) lgkmcnt(4)
v_mfma_f32_16x16x32_bf16 v[220:223], a[252:255], a[24:27], v[220:223]
v_mfma_f32_16x16x32_bf16 v[64:67], a[192:195], a[12:15], v[64:67]
ds_read_b64_tr_b16 a[208:209], v15 offset:16384
s_mov_b32 s46, 5038080
v_mfma_f32_16x16x32_bf16 v[64:67], a[196:199], a[52:55], v[64:67]
ds_read_b64_tr_b16 a[210:211], v15 offset:18432
v_mfma_f32_16x16x32_bf16 v[68:71], a[192:195], a[28:31], v[68:71]
buffer_load_dwordx4 a[120:123], v18, s[8:11], s46 offen offset:0 sc1
v_mfma_f32_16x16x32_bf16 v[68:71], a[196:199], a[136:139], v[68:71]
ds_read_b64_tr_b16 a[212:213], v15 offset:20480
v_mfma_f32_16x16x32_bf16 v[72:75], a[192:195], a[32:35], v[72:75]
v_mfma_f32_16x16x32_bf16 v[72:75], a[196:199], a[152:155], v[72:75]
ds_read_b64_tr_b16 a[214:215], v15 offset:22528
v_mfma_f32_16x16x32_bf16 v[76:79], a[192:195], a[48:51], v[76:79]
v_mfma_f32_16x16x32_bf16 v[76:79], a[196:199], a[140:143], v[76:79]
buffer_load_dwordx4 v[224:227], v18, s[8:11], s46 offen offset:1024 sc1
v_mfma_f32_16x16x32_bf16 v[80:83], a[192:195], a[36:39], v[80:83]
ds_read_b64_tr_b16 a[216:217], v16 offset:16384
s_waitcnt lgkmcnt(5)
v_mfma_f32_16x16x32_bf16 v[80:83], a[196:199], a[156:159], v[80:83]
v_mfma_f32_16x16x32_bf16 v[84:87], a[200:203], a[12:15], v[84:87]
ds_read_b64_tr_b16 a[218:219], v16 offset:18432
v_mfma_f32_16x16x32_bf16 v[84:87], a[204:207], a[52:55], v[84:87]
v_mfma_f32_16x16x32_bf16 v[88:91], a[200:203], a[28:31], v[88:91]
buffer_load_dwordx4 v[228:231], v18, s[8:11], s46 offen offset:2048 sc1
v_mfma_f32_16x16x32_bf16 v[88:91], a[204:207], a[136:139], v[88:91]
ds_read_b64_tr_b16 a[220:221], v16 offset:20480
v_mfma_f32_16x16x32_bf16 v[92:95], a[200:203], a[32:35], v[92:95]
ds_read_b64_tr_b16 a[222:223], v16 offset:22528
v_mfma_f32_16x16x32_bf16 v[92:95], a[204:207], a[152:155], v[92:95]
v_mfma_f32_16x16x32_bf16 v[96:99], a[200:203], a[48:51], v[96:99]
ds_read_b64_tr_b16 a[224:225], v13 offset:24576
v_mfma_f32_16x16x32_bf16 v[96:99], a[204:207], a[140:143], v[96:99]
buffer_load_dwordx4 v[232:235], v18, s[8:11], s46 offen offset:3072 sc1
v_mfma_f32_16x16x32_bf16 v[100:103], a[200:203], a[36:39], v[100:103]
s_waitcnt lgkmcnt(5)
ds_read_b64_tr_b16 a[226:227], v13 offset:26624
v_mfma_f32_16x16x32_bf16 v[100:103], a[204:207], a[156:159], v[100:103]
s_mov_b32 s46, 5042176
ds_read_b64_tr_b16 a[228:229], v13 offset:28672
v_mfma_f32_16x16x32_bf16 v[104:107], a[208:211], a[12:15], v[104:107]
v_mfma_f32_16x16x32_bf16 v[104:107], a[212:215], a[52:55], v[104:107]
v_mfma_f32_16x16x32_bf16 v[108:111], a[208:211], a[28:31], v[108:111]
buffer_load_dwordx4 v[236:239], v18, s[8:11], s46 offen offset:0 sc1
v_mfma_f32_16x16x32_bf16 v[108:111], a[212:215], a[136:139], v[108:111]
ds_read_b64_tr_b16 a[230:231], v13 offset:30720
s_add_u32 m0, s41, 36864
v_mfma_f32_16x16x32_bf16 v[112:115], a[208:211], a[32:35], v[112:115]
s_mov_b32 s46, 4628480
ds_read_b64_tr_b16 a[232:233], v14 offset:24576
v_mfma_f32_16x16x32_bf16 v[112:115], a[212:215], a[152:155], v[112:115]
v_mfma_f32_16x16x32_bf16 v[116:119], a[208:211], a[48:51], v[116:119]
v_mfma_f32_16x16x32_bf16 v[116:119], a[212:215], a[140:143], v[116:119]
buffer_load_dwordx4 v21, s[4:7], s46 offen offset:0 lds
v_mfma_f32_16x16x32_bf16 v[120:123], a[208:211], a[36:39], v[120:123]
ds_read_b64_tr_b16 a[234:235], v14 offset:26624
s_waitcnt lgkmcnt(6)
v_mfma_f32_16x16x32_bf16 v[120:123], a[212:215], a[156:159], v[120:123]
s_mov_b32 s46, 4637696
ds_read_b64_tr_b16 a[236:237], v14 offset:28672
v_mfma_f32_16x16x32_bf16 v[124:127], a[216:219], a[12:15], v[124:127]
v_mfma_f32_16x16x32_bf16 v[124:127], a[220:223], a[52:55], v[124:127]
v_mfma_f32_16x16x32_bf16 v[128:131], a[216:219], a[28:31], v[128:131]
buffer_load_dwordx4 v21, s[4:7], s46 offen offset:1024 lds
v_mfma_f32_16x16x32_bf16 v[128:131], a[220:223], a[136:139], v[128:131]
ds_read_b64_tr_b16 a[238:239], v14 offset:30720
s_mov_b32 s46, 4646912
v_mfma_f32_16x16x32_bf16 v[132:135], a[216:219], a[32:35], v[132:135]
ds_read_b64_tr_b16 a[240:241], v15 offset:24576
v_mfma_f32_16x16x32_bf16 v[132:135], a[220:223], a[152:155], v[132:135]
v_mfma_f32_16x16x32_bf16 v[136:139], a[216:219], a[48:51], v[136:139]
v_mfma_f32_16x16x32_bf16 v[136:139], a[220:223], a[140:143], v[136:139]
buffer_load_dwordx4 v21, s[4:7], s46 offen offset:2048 lds
v_mfma_f32_16x16x32_bf16 v[140:143], a[216:219], a[36:39], v[140:143]
ds_read_b64_tr_b16 a[242:243], v15 offset:26624
s_waitcnt lgkmcnt(6)
v_mfma_f32_16x16x32_bf16 v[140:143], a[220:223], a[156:159], v[140:143]
ds_read_b64_tr_b16 a[244:245], v15 offset:28672
s_mov_b32 s46, 4656128
v_mfma_f32_16x16x32_bf16 v[144:147], a[224:227], a[12:15], v[144:147]
v_mfma_f32_16x16x32_bf16 v[144:147], a[228:231], a[52:55], v[144:147]
ds_read_b64_tr_b16 a[246:247], v15 offset:30720
v_mfma_f32_16x16x32_bf16 v[148:151], a[224:227], a[28:31], v[148:151]
buffer_load_dwordx4 v21, s[4:7], s46 offen offset:3072 lds
v_mfma_f32_16x16x32_bf16 v[148:151], a[228:231], a[136:139], v[148:151]
ds_read_b64_tr_b16 a[248:249], v16 offset:24576
s_mov_b32 s46, 5160960
v_mfma_f32_16x16x32_bf16 v[152:155], a[224:227], a[32:35], v[152:155]
v_mfma_f32_16x16x32_bf16 v[152:155], a[228:231], a[152:155], v[152:155]
v_mfma_f32_16x16x32_bf16 v[156:159], a[224:227], a[48:51], v[156:159]
ds_read_b64_tr_b16 a[250:251], v16 offset:26624
v_mfma_f32_16x16x32_bf16 v[156:159], a[228:231], a[140:143], v[156:159]
buffer_load_dwordx4 v[240:243], v18, s[8:11], s46 offen offset:0 sc1
v_mfma_f32_16x16x32_bf16 v[160:163], a[224:227], a[36:39], v[160:163]
ds_read_b64_tr_b16 a[252:253], v16 offset:28672
s_waitcnt lgkmcnt(7)
v_mfma_f32_16x16x32_bf16 v[160:163], a[228:231], a[156:159], v[160:163]
v_mfma_f32_16x16x32_bf16 v[164:167], a[232:235], a[12:15], v[164:167]
ds_read_b64_tr_b16 a[254:255], v16 offset:30720
v_mfma_f32_16x16x32_bf16 v[164:167], a[236:239], a[52:55], v[164:167]
v_mfma_f32_16x16x32_bf16 v[168:171], a[232:235], a[28:31], v[168:171]
buffer_load_dwordx4 v[244:247], v18, s[8:11], s46 offen offset:1024 sc1
v_mfma_f32_16x16x32_bf16 v[168:171], a[236:239], a[136:139], v[168:171]
v_mfma_f32_16x16x32_bf16 v[172:175], a[232:235], a[32:35], v[172:175]
v_mfma_f32_16x16x32_bf16 v[172:175], a[236:239], a[152:155], v[172:175]
v_mfma_f32_16x16x32_bf16 v[176:179], a[232:235], a[48:51], v[176:179]
v_mfma_f32_16x16x32_bf16 v[176:179], a[236:239], a[140:143], v[176:179]
buffer_load_dwordx4 v[248:251], v18, s[8:11], s46 offen offset:2048 sc1
v_mfma_f32_16x16x32_bf16 v[180:183], a[232:235], a[36:39], v[180:183]
s_waitcnt lgkmcnt(4)
v_mfma_f32_16x16x32_bf16 v[180:183], a[236:239], a[156:159], v[180:183]
v_mfma_f32_16x16x32_bf16 v[184:187], a[240:243], a[12:15], v[184:187]
s_waitcnt vmcnt(36) lgkmcnt(0)
s_barrier
v_mfma_f32_16x16x32_bf16 v[184:187], a[244:247], a[52:55], v[184:187]
ds_read_b64_tr_b16 a[192:193], v1 offset:0
v_mfma_f32_16x16x32_bf16 v[188:191], a[240:243], a[28:31], v[188:191]
buffer_load_dwordx4 v[252:255], v18, s[8:11], s46 offen offset:3072 sc1
v_mfma_f32_16x16x32_bf16 v[188:191], a[244:247], a[136:139], v[188:191]
ds_read_b64_tr_b16 a[194:195], v1 offset:2048
s_mov_b32 s46, 5165056
v_mfma_f32_16x16x32_bf16 v[192:195], a[240:243], a[32:35], v[192:195]
ds_read_b64_tr_b16 a[196:197], v1 offset:4096
v_mfma_f32_16x16x32_bf16 v[192:195], a[244:247], a[152:155], v[192:195]
ds_read_b64_tr_b16 a[198:199], v1 offset:6144
v_mfma_f32_16x16x32_bf16 v[196:199], a[240:243], a[48:51], v[196:199]
v_mfma_f32_16x16x32_bf16 v[196:199], a[244:247], a[140:143], v[196:199]
buffer_load_dwordx4 a[0:3], v18, s[8:11], s46 offen offset:0 sc1
v_mfma_f32_16x16x32_bf16 v[200:203], a[240:243], a[36:39], v[200:203]
ds_read_b64_tr_b16 a[200:201], v2 offset:0
s_mov_b32 s46, 5283840
v_mfma_f32_16x16x32_bf16 v[200:203], a[244:247], a[156:159], v[200:203]
ds_read_b64_tr_b16 a[202:203], v2 offset:2048
v_mfma_f32_16x16x32_bf16 v[204:207], a[248:251], a[12:15], v[204:207]
v_mfma_f32_16x16x32_bf16 v[204:207], a[252:255], a[52:55], v[204:207]
ds_read_b64_tr_b16 a[204:205], v2 offset:4096
v_mfma_f32_16x16x32_bf16 v[208:211], a[248:251], a[28:31], v[208:211]
buffer_load_dwordx4 a[16:19], v18, s[8:11], s46 offen offset:0 sc1
v_mfma_f32_16x16x32_bf16 v[208:211], a[252:255], a[136:139], v[208:211]
ds_read_b64_tr_b16 a[206:207], v2 offset:6144
v_mfma_f32_16x16x32_bf16 v[212:215], a[248:251], a[32:35], v[212:215]
v_mfma_f32_16x16x32_bf16 v[212:215], a[252:255], a[152:155], v[212:215]
v_mfma_f32_16x16x32_bf16 v[216:219], a[248:251], a[48:51], v[216:219]
v_mfma_f32_16x16x32_bf16 v[216:219], a[252:255], a[140:143], v[216:219]
buffer_load_dwordx4 a[108:111], v18, s[8:11], s46 offen offset:1024 sc1
v_mfma_f32_16x16x32_bf16 v[220:223], a[248:251], a[36:39], v[220:223]
s_waitcnt vmcnt(35) lgkmcnt(4)
v_mfma_f32_16x16x32_bf16 v[220:223], a[252:255], a[156:159], v[220:223]
v_mfma_f32_16x16x32_bf16 v[64:67], a[192:195], a[160:163], v[64:67]
ds_read_b64_tr_b16 a[208:209], v3 offset:0
s_mov_b32 s46, 5283840
v_mfma_f32_16x16x32_bf16 v[64:67], a[196:199], a[60:63], v[64:67]
ds_read_b64_tr_b16 a[210:211], v3 offset:2048
v_mfma_f32_16x16x32_bf16 v[68:71], a[192:195], a[176:179], v[68:71]
buffer_load_dwordx4 a[124:127], v18, s[8:11], s46 offen offset:2048 sc1
v_mfma_f32_16x16x32_bf16 v[68:71], a[196:199], a[64:67], v[68:71]
ds_read_b64_tr_b16 a[212:213], v3 offset:4096
v_mfma_f32_16x16x32_bf16 v[72:75], a[192:195], a[40:43], v[72:75]
v_mfma_f32_16x16x32_bf16 v[72:75], a[196:199], a[80:83], v[72:75]
ds_read_b64_tr_b16 a[214:215], v3 offset:6144
v_mfma_f32_16x16x32_bf16 v[76:79], a[192:195], a[56:59], v[76:79]
v_mfma_f32_16x16x32_bf16 v[76:79], a[196:199], a[68:71], v[76:79]
buffer_load_dwordx4 a[128:131], v18, s[8:11], s46 offen offset:3072 sc1
v_mfma_f32_16x16x32_bf16 v[80:83], a[192:195], a[44:47], v[80:83]
ds_read_b64_tr_b16 a[216:217], v4 offset:0
s_waitcnt lgkmcnt(5)
v_mfma_f32_16x16x32_bf16 v[80:83], a[196:199], a[84:87], v[80:83]
s_mov_b32 s46, 5287936
ds_read_b64_tr_b16 a[218:219], v4 offset:2048
v_mfma_f32_16x16x32_bf16 v[84:87], a[200:203], a[160:163], v[84:87]
v_mfma_f32_16x16x32_bf16 v[84:87], a[204:207], a[60:63], v[84:87]
v_mfma_f32_16x16x32_bf16 v[88:91], a[200:203], a[176:179], v[88:91]
buffer_load_dwordx4 a[144:147], v18, s[8:11], s46 offen offset:0 sc1
v_mfma_f32_16x16x32_bf16 v[88:91], a[204:207], a[64:67], v[88:91]
ds_read_b64_tr_b16 a[220:221], v4 offset:4096
s_mov_b32 s46, 5406720
v_mfma_f32_16x16x32_bf16 v[92:95], a[200:203], a[40:43], v[92:95]
ds_read_b64_tr_b16 a[222:223], v4 offset:6144
v_mfma_f32_16x16x32_bf16 v[92:95], a[204:207], a[80:83], v[92:95]
v_mfma_f32_16x16x32_bf16 v[96:99], a[200:203], a[56:59], v[96:99]
ds_read_b64_tr_b16 a[224:225], v1 offset:8192
v_mfma_f32_16x16x32_bf16 v[96:99], a[204:207], a[68:71], v[96:99]
buffer_load_dwordx4 a[132:135], v18, s[8:11], s46 offen offset:0 sc1
v_mfma_f32_16x16x32_bf16 v[100:103], a[200:203], a[44:47], v[100:103]
s_waitcnt lgkmcnt(5)
ds_read_b64_tr_b16 a[226:227], v1 offset:10240
v_mfma_f32_16x16x32_bf16 v[100:103], a[204:207], a[84:87], v[100:103]
v_mfma_f32_16x16x32_bf16 v[104:107], a[208:211], a[160:163], v[104:107]
v_mfma_f32_16x16x32_bf16 v[104:107], a[212:215], a[60:63], v[104:107]
ds_read_b64_tr_b16 a[228:229], v1 offset:12288
v_mfma_f32_16x16x32_bf16 v[108:111], a[208:211], a[176:179], v[108:111]
buffer_load_dwordx4 a[148:151], v18, s[8:11], s46 offen offset:1024 sc1
v_mfma_f32_16x16x32_bf16 v[108:111], a[212:215], a[64:67], v[108:111]
ds_read_b64_tr_b16 a[230:231], v1 offset:14336
s_add_u32 m0, s41, 65536
v_mfma_f32_16x16x32_bf16 v[112:115], a[208:211], a[40:43], v[112:115]
s_mov_b32 s46, 4751360
ds_read_b64_tr_b16 a[232:233], v2 offset:8192
v_mfma_f32_16x16x32_bf16 v[112:115], a[212:215], a[80:83], v[112:115]
v_mfma_f32_16x16x32_bf16 v[116:119], a[208:211], a[56:59], v[116:119]
v_mfma_f32_16x16x32_bf16 v[116:119], a[212:215], a[68:71], v[116:119]
buffer_load_dwordx4 v21, s[4:7], s46 offen offset:0 lds
v_mfma_f32_16x16x32_bf16 v[120:123], a[208:211], a[44:47], v[120:123]
ds_read_b64_tr_b16 a[234:235], v2 offset:10240
s_waitcnt lgkmcnt(6)
v_mfma_f32_16x16x32_bf16 v[120:123], a[212:215], a[84:87], v[120:123]
s_mov_b32 s46, 4760576
ds_read_b64_tr_b16 a[236:237], v2 offset:12288
v_mfma_f32_16x16x32_bf16 v[124:127], a[216:219], a[160:163], v[124:127]
v_mfma_f32_16x16x32_bf16 v[124:127], a[220:223], a[60:63], v[124:127]
v_mfma_f32_16x16x32_bf16 v[128:131], a[216:219], a[176:179], v[128:131]
buffer_load_dwordx4 v21, s[4:7], s46 offen offset:1024 lds
v_mfma_f32_16x16x32_bf16 v[128:131], a[220:223], a[64:67], v[128:131]
ds_read_b64_tr_b16 a[238:239], v2 offset:14336
s_mov_b32 s46, 4769792
v_mfma_f32_16x16x32_bf16 v[132:135], a[216:219], a[40:43], v[132:135]
ds_read_b64_tr_b16 a[240:241], v3 offset:8192
v_mfma_f32_16x16x32_bf16 v[132:135], a[220:223], a[80:83], v[132:135]
v_mfma_f32_16x16x32_bf16 v[136:139], a[216:219], a[56:59], v[136:139]
v_mfma_f32_16x16x32_bf16 v[136:139], a[220:223], a[68:71], v[136:139]
buffer_load_dwordx4 v21, s[4:7], s46 offen offset:2048 lds
v_mfma_f32_16x16x32_bf16 v[140:143], a[216:219], a[44:47], v[140:143]
ds_read_b64_tr_b16 a[242:243], v3 offset:10240
s_waitcnt lgkmcnt(6)
v_mfma_f32_16x16x32_bf16 v[140:143], a[220:223], a[84:87], v[140:143]
ds_read_b64_tr_b16 a[244:245], v3 offset:12288
s_mov_b32 s46, 4779008
v_mfma_f32_16x16x32_bf16 v[144:147], a[224:227], a[160:163], v[144:147]
v_mfma_f32_16x16x32_bf16 v[144:147], a[228:231], a[60:63], v[144:147]
ds_read_b64_tr_b16 a[246:247], v3 offset:14336
v_mfma_f32_16x16x32_bf16 v[148:151], a[224:227], a[176:179], v[148:151]
buffer_load_dwordx4 v21, s[4:7], s46 offen offset:3072 lds
v_mfma_f32_16x16x32_bf16 v[148:151], a[228:231], a[64:67], v[148:151]
ds_read_b64_tr_b16 a[248:249], v4 offset:8192
s_mov_b32 s46, 5406720
v_mfma_f32_16x16x32_bf16 v[152:155], a[224:227], a[40:43], v[152:155]
v_mfma_f32_16x16x32_bf16 v[152:155], a[228:231], a[80:83], v[152:155]
v_mfma_f32_16x16x32_bf16 v[156:159], a[224:227], a[56:59], v[156:159]
ds_read_b64_tr_b16 a[250:251], v4 offset:10240
v_mfma_f32_16x16x32_bf16 v[156:159], a[228:231], a[68:71], v[156:159]
buffer_load_dwordx4 a[4:7], v18, s[8:11], s46 offen offset:2048 sc1
v_mfma_f32_16x16x32_bf16 v[160:163], a[224:227], a[44:47], v[160:163]
ds_read_b64_tr_b16 a[252:253], v4 offset:12288
s_waitcnt lgkmcnt(7)
v_mfma_f32_16x16x32_bf16 v[160:163], a[228:231], a[84:87], v[160:163]
v_mfma_f32_16x16x32_bf16 v[164:167], a[232:235], a[160:163], v[164:167]
ds_read_b64_tr_b16 a[254:255], v4 offset:14336
v_mfma_f32_16x16x32_bf16 v[164:167], a[236:239], a[60:63], v[164:167]
v_mfma_f32_16x16x32_bf16 v[168:171], a[232:235], a[176:179], v[168:171]
buffer_load_dwordx4 a[20:23], v18, s[8:11], s46 offen offset:3072 sc1
v_mfma_f32_16x16x32_bf16 v[168:171], a[236:239], a[64:67], v[168:171]
v_mfma_f32_16x16x32_bf16 v[172:175], a[232:235], a[40:43], v[172:175]
s_mov_b32 s46, 5410816
v_mfma_f32_16x16x32_bf16 v[172:175], a[236:239], a[80:83], v[172:175]
v_mfma_f32_16x16x32_bf16 v[176:179], a[232:235], a[56:59], v[176:179]
v_mfma_f32_16x16x32_bf16 v[176:179], a[236:239], a[68:71], v[176:179]
buffer_load_dwordx4 a[8:11], v18, s[8:11], s46 offen offset:0 sc1
v_mfma_f32_16x16x32_bf16 v[180:183], a[232:235], a[44:47], v[180:183]
s_waitcnt lgkmcnt(4)
s_mov_b32 s46, 5529600
v_mfma_f32_16x16x32_bf16 v[180:183], a[236:239], a[84:87], v[180:183]
v_mfma_f32_16x16x32_bf16 v[184:187], a[240:243], a[160:163], v[184:187]
v_mfma_f32_16x16x32_bf16 v[184:187], a[244:247], a[60:63], v[184:187]
ds_read_b64_tr_b16 a[192:193], v1 offset:16384
v_mfma_f32_16x16x32_bf16 v[188:191], a[240:243], a[176:179], v[188:191]
buffer_load_dwordx4 a[24:27], v18, s[8:11], s46 offen offset:0 sc1
v_mfma_f32_16x16x32_bf16 v[188:191], a[244:247], a[64:67], v[188:191]
ds_read_b64_tr_b16 a[194:195], v1 offset:18432
v_mfma_f32_16x16x32_bf16 v[192:195], a[240:243], a[40:43], v[192:195]
ds_read_b64_tr_b16 a[196:197], v1 offset:20480
v_mfma_f32_16x16x32_bf16 v[192:195], a[244:247], a[80:83], v[192:195]
ds_read_b64_tr_b16 a[198:199], v1 offset:22528
v_mfma_f32_16x16x32_bf16 v[196:199], a[240:243], a[56:59], v[196:199]
v_mfma_f32_16x16x32_bf16 v[196:199], a[244:247], a[68:71], v[196:199]
buffer_load_dwordx4 a[12:15], v18, s[8:11], s46 offen offset:1024 sc1
v_mfma_f32_16x16x32_bf16 v[200:203], a[240:243], a[44:47], v[200:203]
ds_read_b64_tr_b16 a[200:201], v2 offset:16384
s_waitcnt lgkmcnt(5)
v_mfma_f32_16x16x32_bf16 v[200:203], a[244:247], a[84:87], v[200:203]
ds_read_b64_tr_b16 a[202:203], v2 offset:18432
v_mfma_f32_16x16x32_bf16 v[204:207], a[248:251], a[160:163], v[204:207]
v_mfma_f32_16x16x32_bf16 v[204:207], a[252:255], a[60:63], v[204:207]
ds_read_b64_tr_b16 a[204:205], v2 offset:20480
v_mfma_f32_16x16x32_bf16 v[208:211], a[248:251], a[176:179], v[208:211]
buffer_load_dwordx4 a[28:31], v18, s[8:11], s46 offen offset:2048 sc1
v_mfma_f32_16x16x32_bf16 v[208:211], a[252:255], a[64:67], v[208:211]
ds_read_b64_tr_b16 a[206:207], v2 offset:22528
v_mfma_f32_16x16x32_bf16 v[212:215], a[248:251], a[40:43], v[212:215]
v_mfma_f32_16x16x32_bf16 v[212:215], a[252:255], a[80:83], v[212:215]
v_mfma_f32_16x16x32_bf16 v[216:219], a[248:251], a[56:59], v[216:219]
v_mfma_f32_16x16x32_bf16 v[216:219], a[252:255], a[68:71], v[216:219]
buffer_load_dwordx4 a[32:35], v18, s[8:11], s46 offen offset:3072 sc1
v_mfma_f32_16x16x32_bf16 v[220:223], a[248:251], a[44:47], v[220:223]
s_waitcnt vmcnt(37) lgkmcnt(4)
v_mfma_f32_16x16x32_bf16 v[220:223], a[252:255], a[84:87], v[220:223]
v_mfma_f32_16x16x32_bf16 v[64:67], a[192:195], a[72:75], v[64:67]
ds_read_b64_tr_b16 a[208:209], v3 offset:16384
v_mfma_f32_16x16x32_bf16 v[64:67], a[196:199], a[184:187], v[64:67]
ds_read_b64_tr_b16 a[210:211], v3 offset:18432
v_mfma_f32_16x16x32_bf16 v[68:71], a[192:195], a[88:91], v[68:71]
buffer_load_dword v9, off, s[28:31], s51 offset:128 sc1
v_mfma_f32_16x16x32_bf16 v[68:71], a[196:199], a[172:175], v[68:71]
ds_read_b64_tr_b16 a[212:213], v3 offset:20480
v_mfma_f32_16x16x32_bf16 v[72:75], a[192:195], a[164:167], v[72:75]
v_mfma_f32_16x16x32_bf16 v[72:75], a[196:199], a[188:191], v[72:75]
ds_read_b64_tr_b16 a[214:215], v3 offset:22528
v_mfma_f32_16x16x32_bf16 v[76:79], a[192:195], a[180:183], v[76:79]
global_load_dword v30, v[28:29], off
v_mfma_f32_16x16x32_bf16 v[76:79], a[196:199], a[76:79], v[76:79]
ds_read_b64_tr_b16 a[216:217], v4 offset:16384
s_mov_b32 s46, 5533696
v_mfma_f32_16x16x32_bf16 v[80:83], a[192:195], a[168:171], v[80:83]
s_waitcnt lgkmcnt(5)
ds_read_b64_tr_b16 a[218:219], v4 offset:18432
v_mfma_f32_16x16x32_bf16 v[80:83], a[196:199], a[92:95], v[80:83]
v_mfma_f32_16x16x32_bf16 v[84:87], a[200:203], a[72:75], v[84:87]
buffer_load_dwordx4 a[48:51], v18, s[8:11], s46 offen offset:0 sc1
v_mfma_f32_16x16x32_bf16 v[84:87], a[204:207], a[184:187], v[84:87]
s_mov_b32 s46, 5652480
ds_read_b64_tr_b16 a[220:221], v4 offset:20480
v_mfma_f32_16x16x32_bf16 v[88:91], a[200:203], a[88:91], v[88:91]
v_mfma_f32_16x16x32_bf16 v[88:91], a[204:207], a[172:175], v[88:91]
v_mfma_f32_16x16x32_bf16 v[92:95], a[200:203], a[164:167], v[92:95]
buffer_load_dwordx4 a[36:39], v18, s[8:11], s46 offen offset:0 sc1
v_mfma_f32_16x16x32_bf16 v[92:95], a[204:207], a[188:191], v[92:95]
ds_read_b64_tr_b16 a[222:223], v4 offset:22528
v_mfma_f32_16x16x32_bf16 v[96:99], a[200:203], a[180:183], v[96:99]
ds_read_b64_tr_b16 a[224:225], v1 offset:24576
v_mfma_f32_16x16x32_bf16 v[96:99], a[204:207], a[76:79], v[96:99]
s_waitcnt lgkmcnt(5)
ds_read_b64_tr_b16 a[226:227], v1 offset:26624
v_mfma_f32_16x16x32_bf16 v[100:103], a[200:203], a[168:171], v[100:103]
buffer_load_dwordx4 a[52:55], v18, s[8:11], s46 offen offset:1024 sc1
v_mfma_f32_16x16x32_bf16 v[100:103], a[204:207], a[92:95], v[100:103]
v_mfma_f32_16x16x32_bf16 v[104:107], a[208:211], a[72:75], v[104:107]
v_mfma_f32_16x16x32_bf16 v[104:107], a[212:215], a[184:187], v[104:107]
ds_read_b64_tr_b16 a[228:229], v1 offset:28672
v_mfma_f32_16x16x32_bf16 v[108:111], a[208:211], a[88:91], v[108:111]
buffer_load_dwordx4 a[136:139], v18, s[8:11], s46 offen offset:2048 sc1
v_mfma_f32_16x16x32_bf16 v[108:111], a[212:215], a[172:175], v[108:111]
ds_read_b64_tr_b16 a[230:231], v1 offset:30720
v_mfma_f32_16x16x32_bf16 v[112:115], a[208:211], a[164:167], v[112:115]
v_mfma_f32_16x16x32_bf16 v[112:115], a[212:215], a[188:191], v[112:115]
ds_read_b64_tr_b16 a[232:233], v2 offset:24576
v_mfma_f32_16x16x32_bf16 v[116:119], a[208:211], a[180:183], v[116:119]
buffer_load_dwordx4 a[152:155], v18, s[8:11], s46 offen offset:3072 sc1
v_mfma_f32_16x16x32_bf16 v[116:119], a[212:215], a[76:79], v[116:119]
s_add_u32 m0, s41, 69632
s_mov_b32 s46, 4792320
v_mfma_f32_16x16x32_bf16 v[120:123], a[208:211], a[168:171], v[120:123]
ds_read_b64_tr_b16 a[234:235], v2 offset:26624
s_waitcnt lgkmcnt(6)
v_mfma_f32_16x16x32_bf16 v[120:123], a[212:215], a[92:95], v[120:123]
v_mfma_f32_16x16x32_bf16 v[124:127], a[216:219], a[72:75], v[124:127]
buffer_load_dwordx4 v21, s[4:7], s46 offen offset:0 lds
v_mfma_f32_16x16x32_bf16 v[124:127], a[220:223], a[184:187], v[124:127]
ds_read_b64_tr_b16 a[236:237], v2 offset:28672
s_mov_b32 s46, 4801536
v_mfma_f32_16x16x32_bf16 v[128:131], a[216:219], a[88:91], v[128:131]
ds_read_b64_tr_b16 a[238:239], v2 offset:30720
v_mfma_f32_16x16x32_bf16 v[128:131], a[220:223], a[172:175], v[128:131]
v_mfma_f32_16x16x32_bf16 v[132:135], a[216:219], a[164:167], v[132:135]
buffer_load_dwordx4 v21, s[4:7], s46 offen offset:1024 lds
v_mfma_f32_16x16x32_bf16 v[132:135], a[220:223], a[188:191], v[132:135]
ds_read_b64_tr_b16 a[240:241], v3 offset:24576
s_mov_b32 s46, 4810752
v_mfma_f32_16x16x32_bf16 v[136:139], a[216:219], a[180:183], v[136:139]
v_mfma_f32_16x16x32_bf16 v[136:139], a[220:223], a[76:79], v[136:139]
ds_read_b64_tr_b16 a[242:243], v3 offset:26624
s_waitcnt lgkmcnt(6)
v_mfma_f32_16x16x32_bf16 v[140:143], a[216:219], a[168:171], v[140:143]
buffer_load_dwordx4 v21, s[4:7], s46 offen offset:2048 lds
v_mfma_f32_16x16x32_bf16 v[140:143], a[220:223], a[92:95], v[140:143]
ds_read_b64_tr_b16 a[244:245], v3 offset:28672
s_mov_b32 s46, 4819968
v_mfma_f32_16x16x32_bf16 v[144:147], a[224:227], a[72:75], v[144:147]
v_mfma_f32_16x16x32_bf16 v[144:147], a[228:231], a[184:187], v[144:147]
ds_read_b64_tr_b16 a[246:247], v3 offset:30720
v_mfma_f32_16x16x32_bf16 v[148:151], a[224:227], a[88:91], v[148:151]
buffer_load_dwordx4 v21, s[4:7], s46 offen offset:3072 lds
v_mfma_f32_16x16x32_bf16 v[148:151], a[228:231], a[172:175], v[148:151]
ds_read_b64_tr_b16 a[248:249], v4 offset:24576
s_mov_b32 s46, 5656576
v_mfma_f32_16x16x32_bf16 v[152:155], a[224:227], a[164:167], v[152:155]
v_mfma_f32_16x16x32_bf16 v[152:155], a[228:231], a[188:191], v[152:155]
v_mfma_f32_16x16x32_bf16 v[156:159], a[224:227], a[180:183], v[156:159]
buffer_load_dwordx4 a[140:143], v18, s[8:11], s46 offen offset:0 sc1
v_mfma_f32_16x16x32_bf16 v[156:159], a[228:231], a[76:79], v[156:159]
ds_read_b64_tr_b16 a[250:251], v4 offset:26624
s_mov_b32 s46, 5775360
v_mfma_f32_16x16x32_bf16 v[160:163], a[224:227], a[168:171], v[160:163]
ds_read_b64_tr_b16 a[252:253], v4 offset:28672
s_waitcnt lgkmcnt(7)
v_mfma_f32_16x16x32_bf16 v[160:163], a[228:231], a[92:95], v[160:163]
v_mfma_f32_16x16x32_bf16 v[164:167], a[232:235], a[72:75], v[164:167]
buffer_load_dwordx4 a[156:159], v18, s[8:11], s46 offen offset:0 sc1
v_mfma_f32_16x16x32_bf16 v[164:167], a[236:239], a[184:187], v[164:167]
ds_read_b64_tr_b16 a[254:255], v4 offset:30720
v_mfma_f32_16x16x32_bf16 v[168:171], a[232:235], a[88:91], v[168:171]
v_mfma_f32_16x16x32_bf16 v[168:171], a[236:239], a[172:175], v[168:171]
v_mfma_f32_16x16x32_bf16 v[172:175], a[232:235], a[164:167], v[172:175]
buffer_load_dwordx4 a[160:163], v18, s[8:11], s46 offen offset:1024 sc1
v_mfma_f32_16x16x32_bf16 v[172:175], a[236:239], a[188:191], v[172:175]
v_mfma_f32_16x16x32_bf16 v[176:179], a[232:235], a[180:183], v[176:179]
v_mfma_f32_16x16x32_bf16 v[176:179], a[236:239], a[76:79], v[176:179]
s_waitcnt lgkmcnt(4)
v_mfma_f32_16x16x32_bf16 v[180:183], a[232:235], a[168:171], v[180:183]
buffer_load_dwordx4 a[176:179], v18, s[8:11], s46 offen offset:2048 sc1
v_mfma_f32_16x16x32_bf16 v[180:183], a[236:239], a[92:95], v[180:183]
v_mfma_f32_16x16x32_bf16 v[184:187], a[240:243], a[72:75], v[184:187]
s_waitcnt vmcnt(38) lgkmcnt(0)
s_barrier
v_mfma_f32_16x16x32_bf16 v[184:187], a[244:247], a[184:187], v[184:187]
ds_read_b64_tr_b16 a[192:193], v1 offset:32768
v_mfma_f32_16x16x32_bf16 v[188:191], a[240:243], a[88:91], v[188:191]
buffer_load_dwordx4 a[40:43], v18, s[8:11], s46 offen offset:3072 sc1
v_mfma_f32_16x16x32_bf16 v[188:191], a[244:247], a[172:175], v[188:191]
ds_read_b64_tr_b16 a[194:195], v1 offset:34816
s_mov_b32 s46, 5779456
v_mfma_f32_16x16x32_bf16 v[192:195], a[240:243], a[164:167], v[192:195]
ds_read_b64_tr_b16 a[196:197], v1 offset:36864
v_mfma_f32_16x16x32_bf16 v[192:195], a[244:247], a[188:191], v[192:195]
ds_read_b64_tr_b16 a[198:199], v1 offset:38912
v_mfma_f32_16x16x32_bf16 v[196:199], a[240:243], a[180:183], v[196:199]
buffer_load_dwordx4 a[56:59], v18, s[8:11], s46 offen offset:0 sc1
v_mfma_f32_16x16x32_bf16 v[196:199], a[244:247], a[76:79], v[196:199]
ds_read_b64_tr_b16 a[200:201], v2 offset:32768
v_mfma_f32_16x16x32_bf16 v[200:203], a[240:243], a[168:171], v[200:203]
v_mfma_f32_16x16x32_bf16 v[200:203], a[244:247], a[92:95], v[200:203]
ds_read_b64_tr_b16 a[202:203], v2 offset:34816
s_waitcnt vmcnt(16)
v_mfma_f32_16x16x32_bf16 v[204:207], a[248:251], a[72:75], v[204:207]
ds_read_b64_tr_b16 a[204:205], v2 offset:36864
v_readfirstlane_b32 s88, v9
v_mfma_f32_16x16x32_bf16 v[204:207], a[252:255], a[184:187], v[204:207]
v_mfma_f32_16x16x32_bf16 v[208:211], a[248:251], a[88:91], v[208:211]
v_mfma_f32_16x16x32_bf16 v[208:211], a[252:255], a[172:175], v[208:211]
s_cmp_lt_u32 s88, 32
s_cbranch_scc1 K2_SPIN24e
K2_RET24e:
v_mfma_f32_16x16x32_bf16 v[212:215], a[248:251], a[164:167], v[212:215]
ds_read_b64_tr_b16 a[206:207], v2 offset:38912
s_mov_b32 s46, 17203200
v_mfma_f32_16x16x32_bf16 v[212:215], a[252:255], a[188:191], v[212:215]
v_mfma_f32_16x16x32_bf16 v[216:219], a[248:251], a[180:183], v[216:219]
v_mfma_f32_16x16x32_bf16 v[216:219], a[252:255], a[76:79], v[216:219]
buffer_load_dwordx4 a[44:47], v18, s[8:11], s46 offen offset:0 sc1
v_mfma_f32_16x16x32_bf16 v[220:223], a[248:251], a[168:171], v[220:223]
s_waitcnt vmcnt(45) lgkmcnt(4)
v_mfma_f32_16x16x32_bf16 v[220:223], a[252:255], a[92:95], v[220:223]
v_mfma_f32_16x16x32_bf16 v[64:67], a[192:195], a[96:99], v[64:67]
ds_read_b64_tr_b16 a[208:209], v3 offset:32768
s_mov_b32 s46, 17203200
v_mfma_f32_16x16x32_bf16 v[64:67], a[196:199], a[120:123], v[64:67]
ds_read_b64_tr_b16 a[210:211], v3 offset:34816
v_mfma_f32_16x16x32_bf16 v[68:71], a[192:195], a[112:115], v[68:71]
buffer_load_dwordx4 a[60:63], v18, s[8:11], s46 offen offset:1024 sc1
v_mfma_f32_16x16x32_bf16 v[68:71], a[196:199], v[224:227], v[68:71]
ds_read_b64_tr_b16 a[212:213], v3 offset:36864
v_mfma_f32_16x16x32_bf16 v[72:75], a[192:195], a[100:103], v[72:75]
v_mfma_f32_16x16x32_bf16 v[72:75], a[196:199], v[228:231], v[72:75]
ds_read_b64_tr_b16 a[214:215], v3 offset:38912
v_mfma_f32_16x16x32_bf16 v[76:79], a[192:195], a[116:119], v[76:79]
buffer_load_dwordx4 a[64:67], v18, s[8:11], s46 offen offset:2048 sc1
v_mfma_f32_16x16x32_bf16 v[76:79], a[196:199], v[232:235], v[76:79]
ds_read_b64_tr_b16 a[216:217], v4 offset:32768
s_waitcnt lgkmcnt(5)
v_mfma_f32_16x16x32_bf16 v[80:83], a[192:195], a[104:107], v[80:83]
v_mfma_f32_16x16x32_bf16 v[80:83], a[196:199], v[236:239], v[80:83]
v_mfma_f32_16x16x32_bf16 v[84:87], a[200:203], a[96:99], v[84:87]
buffer_load_dwordx4 a[80:83], v18, s[8:11], s46 offen offset:3072 sc1
v_mfma_f32_16x16x32_bf16 v[84:87], a[204:207], a[120:123], v[84:87]
ds_read_b64_tr_b16 a[218:219], v4 offset:34816
s_mov_b32 s46, 17207296
v_mfma_f32_16x16x32_bf16 v[88:91], a[200:203], a[112:115], v[88:91]
ds_read_b64_tr_b16 a[220:221], v4 offset:36864
v_mfma_f32_16x16x32_bf16 v[88:91], a[204:207], v[224:227], v[88:91]
v_mfma_f32_16x16x32_bf16 v[92:95], a[200:203], a[100:103], v[92:95]
buffer_load_dwordx4 a[68:71], v18, s[8:11], s46 offen offset:0 sc1
v_mfma_f32_16x16x32_bf16 v[92:95], a[204:207], v[228:231], v[92:95]
ds_read_b64_tr_b16 a[222:223], v4 offset:38912
s_mov_b32 s46, 17326080
v_mfma_f32_16x16x32_bf16 v[96:99], a[200:203], a[116:119], v[96:99]
ds_read_b64_tr_b16 a[224:225], v1 offset:40960
v_mfma_f32_16x16x32_bf16 v[96:99], a[204:207], v[232:235], v[96:99]
s_waitcnt lgkmcnt(5)
ds_read_b64_tr_b16 a[226:227], v1 offset:43008
v_mfma_f32_16x16x32_bf16 v[100:103], a[200:203], a[104:107], v[100:103]
buffer_load_dwordx4 a[84:87], v18, s[8:11], s46 offen offset:0 sc1
v_mfma_f32_16x16x32_bf16 v[100:103], a[204:207], v[236:239], v[100:103]
s_add_u32 m0, s41, 0
s_mov_b32 s46, 6717440
v_mfma_f32_16x16x32_bf16 v[104:107], a[208:211], a[96:99], v[104:107]
v_mfma_f32_16x16x32_bf16 v[104:107], a[212:215], a[120:123], v[104:107]
ds_read_b64_tr_b16 a[228:229], v1 offset:45056
v_mfma_f32_16x16x32_bf16 v[108:111], a[208:211], a[112:115], v[108:111]
buffer_load_dwordx4 v21, s[4:7], s46 offen offset:0 lds
v_mfma_f32_16x16x32_bf16 v[108:111], a[212:215], v[224:227], v[108:111]
ds_read_b64_tr_b16 a[230:231], v1 offset:47104
s_mov_b32 s46, 6726656
v_mfma_f32_16x16x32_bf16 v[112:115], a[208:211], a[100:103], v[112:115]
v_mfma_f32_16x16x32_bf16 v[112:115], a[212:215], v[228:231], v[112:115]
ds_read_b64_tr_b16 a[232:233], v2 offset:40960
v_mfma_f32_16x16x32_bf16 v[116:119], a[208:211], a[116:119], v[116:119]
buffer_load_dwordx4 v21, s[4:7], s46 offen offset:1024 lds
v_mfma_f32_16x16x32_bf16 v[116:119], a[212:215], v[232:235], v[116:119]
s_mov_b32 s46, 6735872
s_waitcnt lgkmcnt(5)
v_mfma_f32_16x16x32_bf16 v[120:123], a[208:211], a[104:107], v[120:123]
ds_read_b64_tr_b16 a[234:235], v2 offset:43008
v_mfma_f32_16x16x32_bf16 v[120:123], a[212:215], v[236:239], v[120:123]
v_mfma_f32_16x16x32_bf16 v[124:127], a[216:219], a[96:99], v[124:127]
buffer_load_dwordx4 v21, s[4:7], s46 offen offset:2048 lds
v_mfma_f32_16x16x32_bf16 v[124:127], a[220:223], a[120:123], v[124:127]
ds_read_b64_tr_b16 a[236:237], v2 offset:45056
s_mov_b32 s46, 6745088
v_mfma_f32_16x16x32_bf16 v[128:131], a[216:219], a[112:115], v[128:131]
ds_read_b64_tr_b16 a[238:239], v2 offset:47104
v_mfma_f32_16x16x32_bf16 v[128:131], a[220:223], v[224:227], v[128:131]
v_mfma_f32_16x16x32_bf16 v[132:135], a[216:219], a[100:103], v[132:135]
buffer_load_dwordx4 v21, s[4:7], s46 offen offset:3072 lds
v_mfma_f32_16x16x32_bf16 v[132:135], a[220:223], v[228:231], v[132:135]
ds_read_b64_tr_b16 a[240:241], v3 offset:40960
s_add_u32 m0, s41, 4096
v_mfma_f32_16x16x32_bf16 v[136:139], a[216:219], a[116:119], v[136:139]
s_mov_b32 s46, 6758400
ds_read_b64_tr_b16 a[242:243], v3 offset:43008
v_mfma_f32_16x16x32_bf16 v[136:139], a[220:223], v[232:235], v[136:139]
s_waitcnt lgkmcnt(6)
ds_read_b64_tr_b16 a[244:245], v3 offset:45056
v_mfma_f32_16x16x32_bf16 v[140:143], a[216:219], a[104:107], v[140:143]
buffer_load_dwordx4 v21, s[4:7], s46 offen offset:0 lds
v_mfma_f32_16x16x32_bf16 v[140:143], a[220:223], v[236:239], v[140:143]
s_mov_b32 s46, 6767616
ds_read_b64_tr_b16 a[246:247], v3 offset:47104
v_mfma_f32_16x16x32_bf16 v[144:147], a[224:227], a[96:99], v[144:147]
v_mfma_f32_16x16x32_bf16 v[144:147], a[228:231], a[120:123], v[144:147]
v_mfma_f32_16x16x32_bf16 v[148:151], a[224:227], a[112:115], v[148:151]
buffer_load_dwordx4 v21, s[4:7], s46 offen offset:1024 lds
v_mfma_f32_16x16x32_bf16 v[148:151], a[228:231], v[224:227], v[148:151]
ds_read_b64_tr_b16 a[248:249], v4 offset:40960
s_mov_b32 s46, 6776832
v_mfma_f32_16x16x32_bf16 v[152:155], a[224:227], a[100:103], v[152:155]
v_mfma_f32_16x16x32_bf16 v[152:155], a[228:231], v[228:231], v[152:155]
v_mfma_f32_16x16x32_bf16 v[156:159], a[224:227], a[116:119], v[156:159]
buffer_load_dwordx4 v21, s[4:7], s46 offen offset:2048 lds
v_mfma_f32_16x16x32_bf16 v[156:159], a[228:231], v[232:235], v[156:159]
ds_read_b64_tr_b16 a[250:251], v4 offset:43008
s_mov_b32 s46, 6786048
v_mfma_f32_16x16x32_bf16 v[160:163], a[224:227], a[104:107], v[160:163]
ds_read_b64_tr_b16 a[252:253], v4 offset:45056
s_waitcnt lgkmcnt(7)
v_mfma_f32_16x16x32_bf16 v[160:163], a[228:231], v[236:239], v[160:163]
v_mfma_f32_16x16x32_bf16 v[164:167], a[232:235], a[96:99], v[164:167]
buffer_load_dwordx4 v21, s[4:7], s46 offen offset:3072 lds
v_mfma_f32_16x16x32_bf16 v[164:167], a[236:239], a[120:123], v[164:167]
ds_read_b64_tr_b16 a[254:255], v4 offset:47104
s_mov_b32 s46, 17326080
v_mfma_f32_16x16x32_bf16 v[168:171], a[232:235], a[112:115], v[168:171]
v_mfma_f32_16x16x32_bf16 v[168:171], a[236:239], v[224:227], v[168:171]
v_mfma_f32_16x16x32_bf16 v[172:175], a[232:235], a[100:103], v[172:175]
buffer_load_dwordx4 a[72:75], v18, s[8:11], s46 offen offset:1024 sc1
v_mfma_f32_16x16x32_bf16 v[172:175], a[236:239], v[228:231], v[172:175]
v_mfma_f32_16x16x32_bf16 v[176:179], a[232:235], a[116:119], v[176:179]
v_mfma_f32_16x16x32_bf16 v[176:179], a[236:239], v[232:235], v[176:179]
s_waitcnt lgkmcnt(4)
v_mfma_f32_16x16x32_bf16 v[180:183], a[232:235], a[104:107], v[180:183]
buffer_load_dwordx4 a[88:91], v18, s[8:11], s46 offen offset:2048 sc1
v_mfma_f32_16x16x32_bf16 v[180:183], a[236:239], v[236:239], v[180:183]
v_mfma_f32_16x16x32_bf16 v[184:187], a[240:243], a[96:99], v[184:187]
v_mfma_f32_16x16x32_bf16 v[184:187], a[244:247], a[120:123], v[184:187]
ds_read_b64_tr_b16 a[192:193], v1 offset:49152
v_mfma_f32_16x16x32_bf16 v[188:191], a[240:243], a[112:115], v[188:191]
buffer_load_dwordx4 a[164:167], v18, s[8:11], s46 offen offset:3072 sc1
v_mfma_f32_16x16x32_bf16 v[188:191], a[244:247], v[224:227], v[188:191]
ds_read_b64_tr_b16 a[194:195], v1 offset:51200
s_mov_b32 s46, 17330176
v_mfma_f32_16x16x32_bf16 v[192:195], a[240:243], a[100:103], v[192:195]
ds_read_b64_tr_b16 a[196:197], v1 offset:53248
v_mfma_f32_16x16x32_bf16 v[192:195], a[244:247], v[228:231], v[192:195]
ds_read_b64_tr_b16 a[198:199], v1 offset:55296
v_mfma_f32_16x16x32_bf16 v[196:199], a[240:243], a[116:119], v[196:199]
buffer_load_dwordx4 a[180:183], v18, s[8:11], s46 offen offset:0 sc1
v_mfma_f32_16x16x32_bf16 v[196:199], a[244:247], v[232:235], v[196:199]
ds_read_b64_tr_b16 a[200:201], v2 offset:49152
s_mov_b32 s46, 17448960
v_mfma_f32_16x16x32_bf16 v[200:203], a[240:243], a[104:107], v[200:203]
s_waitcnt lgkmcnt(5)
ds_read_b64_tr_b16 a[202:203], v2 offset:51200
v_mfma_f32_16x16x32_bf16 v[200:203], a[244:247], v[236:239], v[200:203]
v_mfma_f32_16x16x32_bf16 v[204:207], a[248:251], a[96:99], v[204:207]
buffer_load_dwordx4 a[168:171], v18, s[8:11], s46 offen offset:0 sc1
v_mfma_f32_16x16x32_bf16 v[204:207], a[252:255], a[120:123], v[204:207]
ds_read_b64_tr_b16 a[204:205], v2 offset:53248
v_mfma_f32_16x16x32_bf16 v[208:211], a[248:251], a[112:115], v[208:211]
v_mfma_f32_16x16x32_bf16 v[208:211], a[252:255], v[224:227], v[208:211]
ds_read_b64_tr_b16 a[206:207], v2 offset:55296
v_mfma_f32_16x16x32_bf16 v[212:215], a[248:251], a[100:103], v[212:215]
buffer_load_dwordx4 a[184:187], v18, s[8:11], s46 offen offset:1024 sc1
v_mfma_f32_16x16x32_bf16 v[212:215], a[252:255], v[228:231], v[212:215]
v_mfma_f32_16x16x32_bf16 v[216:219], a[248:251], a[116:119], v[216:219]
v_mfma_f32_16x16x32_bf16 v[216:219], a[252:255], v[232:235], v[216:219]
v_mfma_f32_16x16x32_bf16 v[220:223], a[248:251], a[104:107], v[220:223]
buffer_load_dwordx4 a[172:175], v18, s[8:11], s46 offen offset:2048 sc1
v_mfma_f32_16x16x32_bf16 v[220:223], a[252:255], v[236:239], v[220:223]
s_waitcnt vmcnt(51) lgkmcnt(4)
v_mfma_f32_16x16x32_bf16 v[64:67], a[192:195], v[240:243], v[64:67]
ds_read_b64_tr_b16 a[208:209], v3 offset:49152
v_mfma_f32_16x16x32_bf16 v[64:67], a[196:199], a[16:19], v[64:67]
ds_read_b64_tr_b16 a[210:211], v3 offset:51200
v_mfma_f32_16x16x32_bf16 v[68:71], a[192:195], v[244:247], v[68:71]
global_load_dword v30, v[28:29], off
v_mfma_f32_16x16x32_bf16 v[68:71], a[196:199], a[108:111], v[68:71]
ds_read_b64_tr_b16 a[212:213], v3 offset:53248
s_mov_b32 s46, 17448960
v_mfma_f32_16x16x32_bf16 v[72:75], a[192:195], v[248:251], v[72:75]
v_mfma_f32_16x16x32_bf16 v[72:75], a[196:199], a[124:127], v[72:75]
ds_read_b64_tr_b16 a[214:215], v3 offset:55296
v_mfma_f32_16x16x32_bf16 v[76:79], a[192:195], v[252:255], v[76:79]
v_mfma_f32_16x16x32_bf16 v[76:79], a[196:199], a[128:131], v[76:79]
ds_read_b64_tr_b16 a[216:217], v4 offset:49152
s_waitcnt lgkmcnt(5)
v_mfma_f32_16x16x32_bf16 v[80:83], a[192:195], a[0:3], v[80:83]
buffer_load_dwordx4 a[188:191], v18, s[8:11], s46 offen offset:3072 sc1
v_mfma_f32_16x16x32_bf16 v[80:83], a[196:199], a[144:147], v[80:83]
ds_read_b64_tr_b16 a[218:219], v4 offset:51200
s_mov_b32 s46, 17453056
v_mfma_f32_16x16x32_bf16 v[84:87], a[200:203], v[240:243], v[84:87]
v_mfma_f32_16x16x32_bf16 v[84:87], a[204:207], a[16:19], v[84:87]
ds_read_b64_tr_b16 a[220:221], v4 offset:53248
v_mfma_f32_16x16x32_bf16 v[88:91], a[200:203], v[244:247], v[88:91]
v_mfma_f32_16x16x32_bf16 v[88:91], a[204:207], a[108:111], v[88:91]
buffer_load_dwordx4 a[76:79], v18, s[8:11], s46 offen offset:0 sc1
v_mfma_f32_16x16x32_bf16 v[92:95], a[200:203], v[248:251], v[92:95]
ds_read_b64_tr_b16 a[222:223], v4 offset:55296
s_mov_b32 s46, 17571840
v_mfma_f32_16x16x32_bf16 v[92:95], a[204:207], a[124:127], v[92:95]
ds_read_b64_tr_b16 a[224:225], v1 offset:57344
v_mfma_f32_16x16x32_bf16 v[96:99], a[200:203], v[252:255], v[96:99]
v_mfma_f32_16x16x32_bf16 v[96:99], a[204:207], a[128:131], v[96:99]
ds_read_b64_tr_b16 a[226:227], v1 offset:59392
s_waitcnt lgkmcnt(6)
v_mfma_f32_16x16x32_bf16 v[100:103], a[200:203], a[0:3], v[100:103]
v_mfma_f32_16x16x32_bf16 v[100:103], a[204:207], a[144:147], v[100:103]
buffer_load_dwordx4 a[92:95], v18, s[8:11], s46 offen offset:0 sc1
v_mfma_f32_16x16x32_bf16 v[104:107], a[208:211], v[240:243], v[104:107]
ds_read_b64_tr_b16 a[228:229], v1 offset:61440
v_mfma_f32_16x16x32_bf16 v[104:107], a[212:215], a[16:19], v[104:107]
ds_read_b64_tr_b16 a[230:231], v1 offset:63488
v_mfma_f32_16x16x32_bf16 v[108:111], a[208:211], v[244:247], v[108:111]
v_mfma_f32_16x16x32_bf16 v[108:111], a[212:215], a[108:111], v[108:111]
ds_read_b64_tr_b16 a[232:233], v2 offset:57344
v_mfma_f32_16x16x32_bf16 v[112:115], a[208:211], v[248:251], v[112:115]
buffer_load_dwordx4 a[96:99], v18, s[8:11], s46 offen offset:1024 sc1
v_mfma_f32_16x16x32_bf16 v[112:115], a[212:215], a[124:127], v[112:115]
ds_read_b64_tr_b16 a[234:235], v2 offset:59392
v_mfma_f32_16x16x32_bf16 v[116:119], a[208:211], v[252:255], v[116:119]
v_mfma_f32_16x16x32_bf16 v[116:119], a[212:215], a[128:131], v[116:119]
ds_read_b64_tr_b16 a[236:237], v2 offset:61440
s_waitcnt lgkmcnt(7)
v_mfma_f32_16x16x32_bf16 v[120:123], a[208:211], a[0:3], v[120:123]
v_mfma_f32_16x16x32_bf16 v[120:123], a[212:215], a[144:147], v[120:123]
ds_read_b64_tr_b16 a[238:239], v2 offset:63488
v_mfma_f32_16x16x32_bf16 v[124:127], a[216:219], v[240:243], v[124:127]
buffer_load_dwordx4 a[112:115], v18, s[8:11], s46 offen offset:2048 sc1
v_mfma_f32_16x16x32_bf16 v[124:127], a[220:223], a[16:19], v[124:127]
ds_read_b64_tr_b16 a[240:241], v3 offset:57344
s_mov_b32 s46, 17571840
v_mfma_f32_16x16x32_bf16 v[128:131], a[216:219], v[244:247], v[128:131]
v_mfma_f32_16x16x32_bf16 v[128:131], a[220:223], a[108:111], v[128:131]
ds_read_b64_tr_b16 a[242:243], v3 offset:59392
v_mfma_f32_16x16x32_bf16 v[132:135], a[216:219], v[248:251], v[132:135]
v_mfma_f32_16x16x32_bf16 v[132:135], a[220:223], a[124:127], v[132:135]
buffer_load_dwordx4 a[100:103], v18, s[8:11], s46 offen offset:3072 sc1
v_mfma_f32_16x16x32_bf16 v[136:139], a[216:219], v[252:255], v[136:139]
ds_read_b64_tr_b16 a[244:245], v3 offset:61440
s_mov_b32 s46, 17575936
v_mfma_f32_16x16x32_bf16 v[136:139], a[220:223], a[128:131], v[136:139]
ds_read_b64_tr_b16 a[246:247], v3 offset:63488
s_waitcnt lgkmcnt(8)
v_mfma_f32_16x16x32_bf16 v[140:143], a[216:219], a[0:3], v[140:143]
v_mfma_f32_16x16x32_bf16 v[140:143], a[220:223], a[144:147], v[140:143]
ds_read_b64_tr_b16 a[248:249], v4 offset:57344
v_mfma_f32_16x16x32_bf16 v[144:147], a[224:227], v[240:243], v[144:147]
v_mfma_f32_16x16x32_bf16 v[144:147], a[228:231], a[16:19], v[144:147]
buffer_load_dwordx4 a[116:119], v18, s[8:11], s46 offen offset:0 sc1
v_mfma_f32_16x16x32_bf16 v[148:151], a[224:227], v[244:247], v[148:151]
ds_read_b64_tr_b16 a[250:251], v4 offset:59392
v_mfma_f32_16x16x32_bf16 v[148:151], a[228:231], a[108:111], v[148:151]
ds_read_b64_tr_b16 a[252:253], v4 offset:61440
v_mfma_f32_16x16x32_bf16 v[152:155], a[224:227], v[248:251], v[152:155]
v_mfma_f32_16x16x32_bf16 v[152:155], a[228:231], a[124:127], v[152:155]
ds_read_b64_tr_b16 a[254:255], v4 offset:63488
v_mfma_f32_16x16x32_bf16 v[156:159], a[224:227], v[252:255], v[156:159]
v_mfma_f32_16x16x32_bf16 v[156:159], a[228:231], a[128:131], v[156:159]
s_waitcnt lgkmcnt(8)
v_mfma_f32_16x16x32_bf16 v[160:163], a[224:227], a[0:3], v[160:163]
v_mfma_f32_16x16x32_bf16 v[160:163], a[228:231], a[144:147], v[160:163]
v_mfma_f32_16x16x32_bf16 v[164:167], a[232:235], v[240:243], v[164:167]
v_mfma_f32_16x16x32_bf16 v[164:167], a[236:239], a[16:19], v[164:167]
v_mfma_f32_16x16x32_bf16 v[168:171], a[232:235], v[244:247], v[168:171]
v_mfma_f32_16x16x32_bf16 v[168:171], a[236:239], a[108:111], v[168:171]
v_mfma_f32_16x16x32_bf16 v[172:175], a[232:235], v[248:251], v[172:175]
s_waitcnt vmcnt(15) lgkmcnt(0)
s_barrier
v_mfma_f32_16x16x32_bf16 v[172:175], a[236:239], a[124:127], v[172:175]
ds_read_b64_tr_b16 a[192:193], v13 offset:0
v_mfma_f32_16x16x32_bf16 v[176:179], a[232:235], v[252:255], v[176:179]
ds_read_b64_tr_b16 a[194:195], v13 offset:2048
v_mfma_f32_16x16x32_bf16 v[176:179], a[236:239], a[128:131], v[176:179]
ds_read_b64_tr_b16 a[196:197], v13 offset:4096
s_waitcnt lgkmcnt(7)
v_mfma_f32_16x16x32_bf16 v[180:183], a[232:235], a[0:3], v[180:183]
ds_read_b64_tr_b16 a[198:199], v13 offset:6144
v_mfma_f32_16x16x32_bf16 v[180:183], a[236:239], a[144:147], v[180:183]
ds_read_b64_tr_b16 a[200:201], v13 offset:16384
v_mfma_f32_16x16x32_bf16 v[184:187], a[240:243], v[240:243], v[184:187]
ds_read_b64_tr_b16 a[202:203], v13 offset:18432
v_mfma_f32_16x16x32_bf16 v[184:187], a[244:247], a[16:19], v[184:187]
ds_read_b64_tr_b16 a[204:205], v13 offset:20480
v_mfma_f32_16x16x32_bf16 v[188:191], a[240:243], v[244:247], v[188:191]
ds_read_b64_tr_b16 a[206:207], v13 offset:22528
v_mfma_f32_16x16x32_bf16 v[188:191], a[244:247], a[108:111], v[188:191]
ds_read_b64_tr_b16 a[208:209], v1 offset:0
v_mfma_f32_16x16x32_bf16 v[192:195], a[240:243], v[248:251], v[192:195]
v_mfma_f32_16x16x32_bf16 v[192:195], a[244:247], a[124:127], v[192:195]
ds_read_b64_tr_b16 a[210:211], v1 offset:2048
v_mfma_f32_16x16x32_bf16 v[196:199], a[240:243], v[252:255], v[196:199]
ds_read_b64_tr_b16 a[212:213], v1 offset:4096
v_mfma_f32_16x16x32_bf16 v[196:199], a[244:247], a[128:131], v[196:199]
ds_read_b64_tr_b16 a[214:215], v1 offset:6144
v_mfma_f32_16x16x32_bf16 v[200:203], a[240:243], a[0:3], v[200:203]
ds_read_b64_tr_b16 a[216:217], v1 offset:16384
v_mfma_f32_16x16x32_bf16 v[200:203], a[244:247], a[144:147], v[200:203]
ds_read_b64_tr_b16 a[218:219], v1 offset:18432
v_mfma_f32_16x16x32_bf16 v[204:207], a[248:251], v[240:243], v[204:207]
ds_read_b64_tr_b16 a[220:221], v1 offset:20480
v_mfma_f32_16x16x32_bf16 v[204:207], a[252:255], a[16:19], v[204:207]
ds_read_b64_tr_b16 a[222:223], v1 offset:22528
v_mfma_f32_16x16x32_bf16 v[208:211], a[248:251], v[244:247], v[208:211]
v_mfma_f32_16x16x32_bf16 v[208:211], a[252:255], a[108:111], v[208:211]
v_mfma_f32_16x16x32_bf16 v[212:215], a[248:251], v[248:251], v[212:215]
v_mfma_f32_16x16x32_bf16 v[212:215], a[252:255], a[124:127], v[212:215]
v_mfma_f32_16x16x32_bf16 v[216:219], a[248:251], v[252:255], v[216:219]
v_mfma_f32_16x16x32_bf16 v[216:219], a[252:255], a[128:131], v[216:219]
v_mfma_f32_16x16x32_bf16 v[220:223], a[248:251], a[0:3], v[220:223]
s_waitcnt vmcnt(0) lgkmcnt(0)
v_mfma_f32_16x16x32_bf16 v[220:223], a[252:255], a[144:147], v[220:223]
v_mfma_f32_16x16x32_bf16 v[64:67], a[192:195], a[132:135], v[64:67]
ds_read_b64_tr_b16 a[224:225], v14 offset:0
v_mfma_f32_16x16x32_bf16 v[64:67], a[196:199], a[24:27], v[64:67]
ds_read_b64_tr_b16 a[226:227], v14 offset:2048
v_mfma_f32_16x16x32_bf16 v[64:67], a[200:203], a[36:39], v[64:67]
ds_read_b64_tr_b16 a[228:229], v14 offset:4096
v_mfma_f32_16x16x32_bf16 v[64:67], a[204:207], a[156:159], v[64:67]
ds_read_b64_tr_b16 a[230:231], v14 offset:6144
v_mfma_f32_16x16x32_bf16 v[64:67], a[208:211], a[44:47], v[64:67]
v_mfma_f32_16x16x32_bf16 v[64:67], a[212:215], a[84:87], v[64:67]
ds_read_b64_tr_b16 a[232:233], v14 offset:16384
v_mfma_f32_16x16x32_bf16 v[64:67], a[216:219], a[168:171], v[64:67]
ds_read_b64_tr_b16 a[234:235], v14 offset:18432
v_mfma_f32_16x16x32_bf16 v[64:67], a[220:223], a[92:95], v[64:67]
v_mfma_f32_16x16x32_bf16 v[68:71], a[220:223], a[96:99], v[68:71]
v_mfma_f32_16x16x32_bf16 v[68:71], a[216:219], a[184:187], v[68:71]
ds_read_b64_tr_b16 a[236:237], v14 offset:20480
v_mfma_f32_16x16x32_bf16 v[68:71], a[212:215], a[72:75], v[68:71]
ds_read_b64_tr_b16 a[238:239], v14 offset:22528
v_mfma_f32_16x16x32_bf16 v[68:71], a[208:211], a[60:63], v[68:71]
v_mfma_f32_16x16x32_bf16 v[68:71], a[204:207], a[160:163], v[68:71]
v_mfma_f32_16x16x32_bf16 v[68:71], a[200:203], a[52:55], v[68:71]
ds_read_b64_tr_b16 a[240:241], v2 offset:0
v_mfma_f32_16x16x32_bf16 v[68:71], a[196:199], a[12:15], v[68:71]
ds_read_b64_tr_b16 a[242:243], v2 offset:2048
v_mfma_f32_16x16x32_bf16 v[68:71], a[192:195], a[148:151], v[68:71]
v_mfma_f32_16x16x32_bf16 v[72:75], a[192:195], a[4:7], v[72:75]
v_mfma_f32_16x16x32_bf16 v[72:75], a[196:199], a[28:31], v[72:75]
ds_read_b64_tr_b16 a[244:245], v2 offset:4096
v_mfma_f32_16x16x32_bf16 v[72:75], a[200:203], a[136:139], v[72:75]
ds_read_b64_tr_b16 a[246:247], v2 offset:6144
v_mfma_f32_16x16x32_bf16 v[72:75], a[204:207], a[176:179], v[72:75]
v_mfma_f32_16x16x32_bf16 v[72:75], a[208:211], a[64:67], v[72:75]
v_mfma_f32_16x16x32_bf16 v[72:75], a[212:215], a[88:91], v[72:75]
ds_read_b64_tr_b16 a[248:249], v2 offset:16384
v_mfma_f32_16x16x32_bf16 v[72:75], a[216:219], a[172:175], v[72:75]
ds_read_b64_tr_b16 a[250:251], v2 offset:18432
v_mfma_f32_16x16x32_bf16 v[72:75], a[220:223], a[112:115], v[72:75]
v_mfma_f32_16x16x32_bf16 v[76:79], a[220:223], a[100:103], v[76:79]
v_mfma_f32_16x16x32_bf16 v[76:79], a[216:219], a[188:191], v[76:79]
ds_read_b64_tr_b16 a[252:253], v2 offset:20480
v_mfma_f32_16x16x32_bf16 v[76:79], a[212:215], a[164:167], v[76:79]
ds_read_b64_tr_b16 a[254:255], v2 offset:22528
v_mfma_f32_16x16x32_bf16 v[76:79], a[208:211], a[80:83], v[76:79]
v_mfma_f32_16x16x32_bf16 v[76:79], a[204:207], a[40:43], v[76:79]
v_mfma_f32_16x16x32_bf16 v[76:79], a[200:203], a[152:155], v[76:79]
v_mfma_f32_16x16x32_bf16 v[76:79], a[196:199], a[32:35], v[76:79]
v_mfma_f32_16x16x32_bf16 v[76:79], a[192:195], a[20:23], v[76:79]
v_mfma_f32_16x16x32_bf16 v[80:83], a[192:195], a[8:11], v[80:83]
v_mfma_f32_16x16x32_bf16 v[80:83], a[196:199], a[48:51], v[80:83]
v_mfma_f32_16x16x32_bf16 v[80:83], a[200:203], a[140:143], v[80:83]
v_mfma_f32_16x16x32_bf16 v[80:83], a[204:207], a[56:59], v[80:83]
v_mfma_f32_16x16x32_bf16 v[80:83], a[208:211], a[68:71], v[80:83]
v_mfma_f32_16x16x32_bf16 v[80:83], a[212:215], a[180:183], v[80:83]
ds_read_b64_tr_b16 a[192:193], v15 offset:0
s_waitcnt lgkmcnt(1)
v_mfma_f32_16x16x32_bf16 v[80:83], a[216:219], a[76:79], v[80:83]
ds_read_b64_tr_b16 a[194:195], v15 offset:2048
v_mfma_f32_16x16x32_bf16 v[80:83], a[220:223], a[116:119], v[80:83]
v_mfma_f32_16x16x32_bf16 v[84:87], a[224:227], a[132:135], v[84:87]
v_mfma_f32_16x16x32_bf16 v[84:87], a[228:231], a[24:27], v[84:87]
ds_read_b64_tr_b16 a[196:197], v15 offset:4096
v_mfma_f32_16x16x32_bf16 v[84:87], a[232:235], a[36:39], v[84:87]
ds_read_b64_tr_b16 a[198:199], v15 offset:6144
v_mfma_f32_16x16x32_bf16 v[84:87], a[236:239], a[156:159], v[84:87]
v_mfma_f32_16x16x32_bf16 v[84:87], a[240:243], a[44:47], v[84:87]
v_mfma_f32_16x16x32_bf16 v[84:87], a[244:247], a[84:87], v[84:87]
ds_read_b64_tr_b16 a[200:201], v15 offset:16384
v_mfma_f32_16x16x32_bf16 v[84:87], a[248:251], a[168:171], v[84:87]
ds_read_b64_tr_b16 a[202:203], v15 offset:18432
v_mfma_f32_16x16x32_bf16 v[84:87], a[252:255], a[92:95], v[84:87]
v_mfma_f32_16x16x32_bf16 v[88:91], a[252:255], a[96:99], v[88:91]
v_mfma_f32_16x16x32_bf16 v[88:91], a[248:251], a[184:187], v[88:91]
ds_read_b64_tr_b16 a[204:205], v15 offset:20480
v_cvt_pk_bf16_f32 v64, v64, v65
v_mfma_f32_16x16x32_bf16 v[88:91], a[244:247], a[72:75], v[88:91]
ds_read_b64_tr_b16 a[206:207], v15 offset:22528
v_cvt_pk_bf16_f32 v65, v66, v67
v_mfma_f32_16x16x32_bf16 v[88:91], a[240:243], a[60:63], v[88:91]
v_mfma_f32_16x16x32_bf16 v[88:91], a[236:239], a[160:163], v[88:91]
v_mfma_f32_16x16x32_bf16 v[88:91], a[232:235], a[52:55], v[88:91]
ds_read_b64_tr_b16 a[208:209], v3 offset:0
v_mfma_f32_16x16x32_bf16 v[88:91], a[228:231], a[12:15], v[88:91]
ds_read_b64_tr_b16 a[210:211], v3 offset:2048
v_mfma_f32_16x16x32_bf16 v[88:91], a[224:227], a[148:151], v[88:91]
v_cvt_pk_bf16_f32 v66, v84, v85
v_cvt_pk_bf16_f32 v67, v86, v87
v_mfma_f32_16x16x32_bf16 v[92:95], a[224:227], a[4:7], v[92:95]
s_add_u32 s39, s32, 10240
ds_read_b64_tr_b16 a[212:213], v3 offset:4096
v_mfma_f32_16x16x32_bf16 v[92:95], a[228:231], a[28:31], v[92:95]
buffer_store_dwordx4 v[64:67], v18, s[20:23], s39 offen offset:0 sc1
v_mfma_f32_16x16x32_bf16 v[92:95], a[232:235], a[136:139], v[92:95]
ds_read_b64_tr_b16 a[214:215], v3 offset:6144
v_cvt_pk_bf16_f32 v68, v68, v69
v_mfma_f32_16x16x32_bf16 v[92:95], a[236:239], a[176:179], v[92:95]
v_mfma_f32_16x16x32_bf16 v[92:95], a[240:243], a[64:67], v[92:95]
v_mfma_f32_16x16x32_bf16 v[92:95], a[244:247], a[88:91], v[92:95]
ds_read_b64_tr_b16 a[216:217], v3 offset:16384
v_cvt_pk_bf16_f32 v69, v70, v71
v_mfma_f32_16x16x32_bf16 v[92:95], a[248:251], a[172:175], v[92:95]
ds_read_b64_tr_b16 a[218:219], v3 offset:18432
v_mfma_f32_16x16x32_bf16 v[92:95], a[252:255], a[112:115], v[92:95]
v_cvt_pk_bf16_f32 v70, v88, v89
v_cvt_pk_bf16_f32 v71, v90, v91
v_mfma_f32_16x16x32_bf16 v[96:99], a[252:255], a[100:103], v[96:99]
buffer_store_dwordx4 v[68:71], v18, s[20:23], s39 offen offset:1024 sc1
v_mfma_f32_16x16x32_bf16 v[96:99], a[248:251], a[188:191], v[96:99]
ds_read_b64_tr_b16 a[220:221], v3 offset:20480
v_cvt_pk_bf16_f32 v72, v72, v73
v_mfma_f32_16x16x32_bf16 v[96:99], a[244:247], a[164:167], v[96:99]
ds_read_b64_tr_b16 a[222:223], v3 offset:22528
v_cvt_pk_bf16_f32 v73, v74, v75
v_mfma_f32_16x16x32_bf16 v[96:99], a[240:243], a[80:83], v[96:99]
v_mfma_f32_16x16x32_bf16 v[96:99], a[236:239], a[40:43], v[96:99]
v_mfma_f32_16x16x32_bf16 v[96:99], a[232:235], a[152:155], v[96:99]
v_mfma_f32_16x16x32_bf16 v[96:99], a[228:231], a[32:35], v[96:99]
v_mfma_f32_16x16x32_bf16 v[96:99], a[224:227], a[20:23], v[96:99]
v_cvt_pk_bf16_f32 v74, v92, v93
v_cvt_pk_bf16_f32 v75, v94, v95
v_mfma_f32_16x16x32_bf16 v[100:103], a[224:227], a[8:11], v[100:103]
buffer_store_dwordx4 v[72:75], v18, s[20:23], s39 offen offset:2048 sc1
v_mfma_f32_16x16x32_bf16 v[100:103], a[228:231], a[48:51], v[100:103]
v_mfma_f32_16x16x32_bf16 v[100:103], a[232:235], a[140:143], v[100:103]
v_mfma_f32_16x16x32_bf16 v[100:103], a[236:239], a[56:59], v[100:103]
v_mfma_f32_16x16x32_bf16 v[100:103], a[240:243], a[68:71], v[100:103]
v_mfma_f32_16x16x32_bf16 v[100:103], a[244:247], a[180:183], v[100:103]
ds_read_b64_tr_b16 a[224:225], v16 offset:0
s_waitcnt lgkmcnt(1)
v_mfma_f32_16x16x32_bf16 v[100:103], a[248:251], a[76:79], v[100:103]
ds_read_b64_tr_b16 a[226:227], v16 offset:2048
v_cvt_pk_bf16_f32 v76, v76, v77
v_mfma_f32_16x16x32_bf16 v[100:103], a[252:255], a[116:119], v[100:103]
v_cvt_pk_bf16_f32 v77, v78, v79
v_cvt_pk_bf16_f32 v78, v96, v97
v_mfma_f32_16x16x32_bf16 v[104:107], a[192:195], a[132:135], v[104:107]
ds_read_b64_tr_b16 a[228:229], v16 offset:4096
v_cvt_pk_bf16_f32 v79, v98, v99
v_mfma_f32_16x16x32_bf16 v[104:107], a[196:199], a[24:27], v[104:107]
buffer_store_dwordx4 v[76:79], v18, s[20:23], s39 offen offset:3072 sc1
v_mfma_f32_16x16x32_bf16 v[104:107], a[200:203], a[36:39], v[104:107]
ds_read_b64_tr_b16 a[230:231], v16 offset:6144
v_cvt_pk_bf16_f32 v80, v80, v81
v_mfma_f32_16x16x32_bf16 v[104:107], a[204:207], a[156:159], v[104:107]
v_mfma_f32_16x16x32_bf16 v[104:107], a[208:211], a[44:47], v[104:107]
v_mfma_f32_16x16x32_bf16 v[104:107], a[212:215], a[84:87], v[104:107]
ds_read_b64_tr_b16 a[232:233], v16 offset:16384
v_cvt_pk_bf16_f32 v81, v82, v83
v_mfma_f32_16x16x32_bf16 v[104:107], a[216:219], a[168:171], v[104:107]
ds_read_b64_tr_b16 a[234:235], v16 offset:18432
v_mfma_f32_16x16x32_bf16 v[104:107], a[220:223], a[92:95], v[104:107]
v_cvt_pk_bf16_f32 v82, v100, v101
v_cvt_pk_bf16_f32 v83, v102, v103
v_mfma_f32_16x16x32_bf16 v[108:111], a[220:223], a[96:99], v[108:111]
s_add_u32 s39, s32, 14336
ds_read_b64_tr_b16 a[236:237], v16 offset:20480
v_mfma_f32_16x16x32_bf16 v[108:111], a[216:219], a[184:187], v[108:111]
buffer_store_dwordx4 v[80:83], v18, s[20:23], s39 offen offset:0 sc1
v_mfma_f32_16x16x32_bf16 v[108:111], a[212:215], a[72:75], v[108:111]
ds_read_b64_tr_b16 a[238:239], v16 offset:22528
v_mfma_f32_16x16x32_bf16 v[108:111], a[208:211], a[60:63], v[108:111]
v_mfma_f32_16x16x32_bf16 v[108:111], a[204:207], a[160:163], v[108:111]
v_mfma_f32_16x16x32_bf16 v[108:111], a[200:203], a[52:55], v[108:111]
ds_read_b64_tr_b16 a[240:241], v4 offset:0
v_mfma_f32_16x16x32_bf16 v[108:111], a[196:199], a[12:15], v[108:111]
ds_read_b64_tr_b16 a[242:243], v4 offset:2048
v_mfma_f32_16x16x32_bf16 v[108:111], a[192:195], a[148:151], v[108:111]
v_mfma_f32_16x16x32_bf16 v[112:115], a[192:195], a[4:7], v[112:115]
v_mfma_f32_16x16x32_bf16 v[112:115], a[196:199], a[28:31], v[112:115]
ds_read_b64_tr_b16 a[244:245], v4 offset:4096
v_mfma_f32_16x16x32_bf16 v[112:115], a[200:203], a[136:139], v[112:115]
ds_read_b64_tr_b16 a[246:247], v4 offset:6144
v_mfma_f32_16x16x32_bf16 v[112:115], a[204:207], a[176:179], v[112:115]
v_mfma_f32_16x16x32_bf16 v[112:115], a[208:211], a[64:67], v[112:115]
v_mfma_f32_16x16x32_bf16 v[112:115], a[212:215], a[88:91], v[112:115]
ds_read_b64_tr_b16 a[248:249], v4 offset:16384
v_mfma_f32_16x16x32_bf16 v[112:115], a[216:219], a[172:175], v[112:115]
ds_read_b64_tr_b16 a[250:251], v4 offset:18432
v_mfma_f32_16x16x32_bf16 v[112:115], a[220:223], a[112:115], v[112:115]
v_mfma_f32_16x16x32_bf16 v[116:119], a[220:223], a[100:103], v[116:119]
v_mfma_f32_16x16x32_bf16 v[116:119], a[216:219], a[188:191], v[116:119]
ds_read_b64_tr_b16 a[252:253], v4 offset:20480
v_mfma_f32_16x16x32_bf16 v[116:119], a[212:215], a[164:167], v[116:119]
ds_read_b64_tr_b16 a[254:255], v4 offset:22528
v_mfma_f32_16x16x32_bf16 v[116:119], a[208:211], a[80:83], v[116:119]
v_mfma_f32_16x16x32_bf16 v[116:119], a[204:207], a[40:43], v[116:119]
v_mfma_f32_16x16x32_bf16 v[116:119], a[200:203], a[152:155], v[116:119]
v_mfma_f32_16x16x32_bf16 v[116:119], a[196:199], a[32:35], v[116:119]
v_mfma_f32_16x16x32_bf16 v[116:119], a[192:195], a[20:23], v[116:119]
v_mfma_f32_16x16x32_bf16 v[120:123], a[192:195], a[8:11], v[120:123]
v_mfma_f32_16x16x32_bf16 v[120:123], a[196:199], a[48:51], v[120:123]
v_mfma_f32_16x16x32_bf16 v[120:123], a[200:203], a[140:143], v[120:123]
v_mfma_f32_16x16x32_bf16 v[120:123], a[204:207], a[56:59], v[120:123]
v_mfma_f32_16x16x32_bf16 v[120:123], a[208:211], a[68:71], v[120:123]
v_mfma_f32_16x16x32_bf16 v[120:123], a[212:215], a[180:183], v[120:123]
ds_read_b64_tr_b16 a[192:193], v13 offset:8192
s_waitcnt lgkmcnt(1)
v_mfma_f32_16x16x32_bf16 v[120:123], a[216:219], a[76:79], v[120:123]
ds_read_b64_tr_b16 a[194:195], v13 offset:10240
v_mfma_f32_16x16x32_bf16 v[120:123], a[220:223], a[116:119], v[120:123]
v_mfma_f32_16x16x32_bf16 v[124:127], a[224:227], a[132:135], v[124:127]
v_mfma_f32_16x16x32_bf16 v[124:127], a[228:231], a[24:27], v[124:127]
ds_read_b64_tr_b16 a[196:197], v13 offset:12288
v_mfma_f32_16x16x32_bf16 v[124:127], a[232:235], a[36:39], v[124:127]
ds_read_b64_tr_b16 a[198:199], v13 offset:14336
v_mfma_f32_16x16x32_bf16 v[124:127], a[236:239], a[156:159], v[124:127]
v_mfma_f32_16x16x32_bf16 v[124:127], a[240:243], a[44:47], v[124:127]
v_mfma_f32_16x16x32_bf16 v[124:127], a[244:247], a[84:87], v[124:127]
ds_read_b64_tr_b16 a[200:201], v13 offset:24576
v_mfma_f32_16x16x32_bf16 v[124:127], a[248:251], a[168:171], v[124:127]
ds_read_b64_tr_b16 a[202:203], v13 offset:26624
v_mfma_f32_16x16x32_bf16 v[124:127], a[252:255], a[92:95], v[124:127]
v_mfma_f32_16x16x32_bf16 v[128:131], a[252:255], a[96:99], v[128:131]
v_mfma_f32_16x16x32_bf16 v[128:131], a[248:251], a[184:187], v[128:131]
ds_read_b64_tr_b16 a[204:205], v13 offset:28672
v_cvt_pk_bf16_f32 v104, v104, v105
v_mfma_f32_16x16x32_bf16 v[128:131], a[244:247], a[72:75], v[128:131]
ds_read_b64_tr_b16 a[206:207], v13 offset:30720
v_cvt_pk_bf16_f32 v105, v106, v107
v_mfma_f32_16x16x32_bf16 v[128:131], a[240:243], a[60:63], v[128:131]
v_mfma_f32_16x16x32_bf16 v[128:131], a[236:239], a[160:163], v[128:131]
v_mfma_f32_16x16x32_bf16 v[128:131], a[232:235], a[52:55], v[128:131]
ds_read_b64_tr_b16 a[208:209], v1 offset:8192
v_mfma_f32_16x16x32_bf16 v[128:131], a[228:231], a[12:15], v[128:131]
ds_read_b64_tr_b16 a[210:211], v1 offset:10240
v_mfma_f32_16x16x32_bf16 v[128:131], a[224:227], a[148:151], v[128:131]
v_cvt_pk_bf16_f32 v106, v124, v125
v_cvt_pk_bf16_f32 v107, v126, v127
v_mfma_f32_16x16x32_bf16 v[132:135], a[224:227], a[4:7], v[132:135]
s_add_u32 s39, s32, 5120
ds_read_b64_tr_b16 a[212:213], v1 offset:12288
v_mfma_f32_16x16x32_bf16 v[132:135], a[228:231], a[28:31], v[132:135]
buffer_store_dwordx4 v[104:107], v18, s[20:23], s39 offen offset:0 sc1
v_mfma_f32_16x16x32_bf16 v[132:135], a[232:235], a[136:139], v[132:135]
ds_read_b64_tr_b16 a[214:215], v1 offset:14336
v_cvt_pk_bf16_f32 v108, v108, v109
v_mfma_f32_16x16x32_bf16 v[132:135], a[236:239], a[176:179], v[132:135]
v_mfma_f32_16x16x32_bf16 v[132:135], a[240:243], a[64:67], v[132:135]
v_mfma_f32_16x16x32_bf16 v[132:135], a[244:247], a[88:91], v[132:135]
ds_read_b64_tr_b16 a[216:217], v1 offset:24576
v_cvt_pk_bf16_f32 v109, v110, v111
v_mfma_f32_16x16x32_bf16 v[132:135], a[248:251], a[172:175], v[132:135]
ds_read_b64_tr_b16 a[218:219], v1 offset:26624
v_mfma_f32_16x16x32_bf16 v[132:135], a[252:255], a[112:115], v[132:135]
v_cvt_pk_bf16_f32 v110, v128, v129
v_cvt_pk_bf16_f32 v111, v130, v131
v_mfma_f32_16x16x32_bf16 v[136:139], a[252:255], a[100:103], v[136:139]
buffer_store_dwordx4 v[108:111], v18, s[20:23], s39 offen offset:1024 sc1
v_mfma_f32_16x16x32_bf16 v[136:139], a[248:251], a[188:191], v[136:139]
ds_read_b64_tr_b16 a[220:221], v1 offset:28672
v_cvt_pk_bf16_f32 v112, v112, v113
v_mfma_f32_16x16x32_bf16 v[136:139], a[244:247], a[164:167], v[136:139]
ds_read_b64_tr_b16 a[222:223], v1 offset:30720
v_cvt_pk_bf16_f32 v113, v114, v115
v_mfma_f32_16x16x32_bf16 v[136:139], a[240:243], a[80:83], v[136:139]
v_mfma_f32_16x16x32_bf16 v[136:139], a[236:239], a[40:43], v[136:139]
v_mfma_f32_16x16x32_bf16 v[136:139], a[232:235], a[152:155], v[136:139]
v_mfma_f32_16x16x32_bf16 v[136:139], a[228:231], a[32:35], v[136:139]
v_mfma_f32_16x16x32_bf16 v[136:139], a[224:227], a[20:23], v[136:139]
v_cvt_pk_bf16_f32 v114, v132, v133
v_cvt_pk_bf16_f32 v115, v134, v135
v_mfma_f32_16x16x32_bf16 v[140:143], a[224:227], a[8:11], v[140:143]
buffer_store_dwordx4 v[112:115], v18, s[20:23], s39 offen offset:2048 sc1
v_mfma_f32_16x16x32_bf16 v[140:143], a[228:231], a[48:51], v[140:143]
v_mfma_f32_16x16x32_bf16 v[140:143], a[232:235], a[140:143], v[140:143]
s_waitcnt vmcnt(3)
s_barrier
v_mfma_f32_16x16x32_bf16 v[140:143], a[236:239], a[56:59], v[140:143]
s_mov_b64 exec, 1
buffer_store_dword v20, off, s[28:31], s55 offset:8 sc1
s_mov_b64 exec, -1
v_mfma_f32_16x16x32_bf16 v[140:143], a[240:243], a[68:71], v[140:143]
v_mfma_f32_16x16x32_bf16 v[140:143], a[244:247], a[180:183], v[140:143]
ds_read_b64_tr_b16 a[224:225], v14 offset:8192
s_waitcnt lgkmcnt(1)
v_mfma_f32_16x16x32_bf16 v[140:143], a[248:251], a[76:79], v[140:143]
ds_read_b64_tr_b16 a[226:227], v14 offset:10240
v_mfma_f32_16x16x32_bf16 v[140:143], a[252:255], a[116:119], v[140:143]
v_mfma_f32_16x16x32_bf16 v[144:147], a[192:195], a[132:135], v[144:147]
v_mfma_f32_16x16x32_bf16 v[144:147], a[196:199], a[24:27], v[144:147]
ds_read_b64_tr_b16 a[228:229], v14 offset:12288
v_mfma_f32_16x16x32_bf16 v[144:147], a[200:203], a[36:39], v[144:147]
ds_read_b64_tr_b16 a[230:231], v14 offset:14336
v_mfma_f32_16x16x32_bf16 v[144:147], a[204:207], a[156:159], v[144:147]
ds_read_b64_tr_b16 a[232:233], v14 offset:24576
v_cvt_pk_bf16_f32 v116, v116, v117
v_mfma_f32_16x16x32_bf16 v[144:147], a[208:211], a[44:47], v[144:147]
ds_read_b64_tr_b16 a[234:235], v14 offset:26624
v_cvt_pk_bf16_f32 v117, v118, v119
v_mfma_f32_16x16x32_bf16 v[144:147], a[212:215], a[84:87], v[144:147]
v_cvt_pk_bf16_f32 v118, v136, v137
v_cvt_pk_bf16_f32 v119, v138, v139
v_mfma_f32_16x16x32_bf16 v[144:147], a[216:219], a[168:171], v[144:147]
buffer_store_dwordx4 v[116:119], v18, s[20:23], s39 offen offset:3072 sc1
v_mfma_f32_16x16x32_bf16 v[144:147], a[220:223], a[92:95], v[144:147]
v_cvt_pk_bf16_f32 v120, v120, v121
v_cvt_pk_bf16_f32 v121, v122, v123
v_mfma_f32_16x16x32_bf16 v[148:151], a[220:223], a[96:99], v[148:151]
v_cvt_pk_bf16_f32 v122, v140, v141
v_cvt_pk_bf16_f32 v123, v142, v143
v_mfma_f32_16x16x32_bf16 v[148:151], a[216:219], a[184:187], v[148:151]
ds_read_b64_tr_b16 a[236:237], v14 offset:28672
s_add_u32 s39, s32, 9216
v_mfma_f32_16x16x32_bf16 v[148:151], a[212:215], a[72:75], v[148:151]
buffer_store_dwordx4 v[120:123], v18, s[20:23], s39 offen offset:0 sc1
v_mfma_f32_16x16x32_bf16 v[148:151], a[208:211], a[60:63], v[148:151]
ds_read_b64_tr_b16 a[238:239], v14 offset:30720
v_mfma_f32_16x16x32_bf16 v[148:151], a[204:207], a[160:163], v[148:151]
v_mfma_f32_16x16x32_bf16 v[148:151], a[200:203], a[52:55], v[148:151]
ds_read_b64_tr_b16 a[240:241], v2 offset:8192
v_mfma_f32_16x16x32_bf16 v[148:151], a[196:199], a[12:15], v[148:151]
ds_read_b64_tr_b16 a[242:243], v2 offset:10240
v_mfma_f32_16x16x32_bf16 v[148:151], a[192:195], a[148:151], v[148:151]
v_mfma_f32_16x16x32_bf16 v[152:155], a[192:195], a[4:7], v[152:155]
v_mfma_f32_16x16x32_bf16 v[152:155], a[196:199], a[28:31], v[152:155]
ds_read_b64_tr_b16 a[244:245], v2 offset:12288
v_mfma_f32_16x16x32_bf16 v[152:155], a[200:203], a[136:139], v[152:155]
ds_read_b64_tr_b16 a[246:247], v2 offset:14336
v_mfma_f32_16x16x32_bf16 v[152:155], a[204:207], a[176:179], v[152:155]
v_mfma_f32_16x16x32_bf16 v[152:155], a[208:211], a[64:67], v[152:155]
v_mfma_f32_16x16x32_bf16 v[152:155], a[212:215], a[88:91], v[152:155]
ds_read_b64_tr_b16 a[248:249], v2 offset:24576
v_mfma_f32_16x16x32_bf16 v[152:155], a[216:219], a[172:175], v[152:155]
ds_read_b64_tr_b16 a[250:251], v2 offset:26624
v_mfma_f32_16x16x32_bf16 v[152:155], a[220:223], a[112:115], v[152:155]
v_mfma_f32_16x16x32_bf16 v[156:159], a[220:223], a[100:103], v[156:159]
v_mfma_f32_16x16x32_bf16 v[156:159], a[216:219], a[188:191], v[156:159]
ds_read_b64_tr_b16 a[252:253], v2 offset:28672
v_mfma_f32_16x16x32_bf16 v[156:159], a[212:215], a[164:167], v[156:159]
ds_read_b64_tr_b16 a[254:255], v2 offset:30720
v_mfma_f32_16x16x32_bf16 v[156:159], a[208:211], a[80:83], v[156:159]
v_mfma_f32_16x16x32_bf16 v[156:159], a[204:207], a[40:43], v[156:159]
v_mfma_f32_16x16x32_bf16 v[156:159], a[200:203], a[152:155], v[156:159]
v_mfma_f32_16x16x32_bf16 v[156:159], a[196:199], a[32:35], v[156:159]
v_mfma_f32_16x16x32_bf16 v[156:159], a[192:195], a[20:23], v[156:159]
v_mfma_f32_16x16x32_bf16 v[160:163], a[192:195], a[8:11], v[160:163]
v_mfma_f32_16x16x32_bf16 v[160:163], a[196:199], a[48:51], v[160:163]
v_mfma_f32_16x16x32_bf16 v[160:163], a[200:203], a[140:143], v[160:163]
v_mfma_f32_16x16x32_bf16 v[160:163], a[204:207], a[56:59], v[160:163]
v_mfma_f32_16x16x32_bf16 v[160:163], a[208:211], a[68:71], v[160:163]
v_mfma_f32_16x16x32_bf16 v[160:163], a[212:215], a[180:183], v[160:163]
ds_read_b64_tr_b16 a[192:193], v15 offset:8192
s_waitcnt lgkmcnt(1)
v_mfma_f32_16x16x32_bf16 v[160:163], a[216:219], a[76:79], v[160:163]
ds_read_b64_tr_b16 a[194:195], v15 offset:10240
v_mfma_f32_16x16x32_bf16 v[160:163], a[220:223], a[116:119], v[160:163]
v_mfma_f32_16x16x32_bf16 v[164:167], a[224:227], a[132:135], v[164:167]
v_mfma_f32_16x16x32_bf16 v[164:167], a[228:231], a[24:27], v[164:167]
ds_read_b64_tr_b16 a[196:197], v15 offset:12288
v_mfma_f32_16x16x32_bf16 v[164:167], a[232:235], a[36:39], v[164:167]
ds_read_b64_tr_b16 a[198:199], v15 offset:14336
v_mfma_f32_16x16x32_bf16 v[164:167], a[236:239], a[156:159], v[164:167]
v_mfma_f32_16x16x32_bf16 v[164:167], a[240:243], a[44:47], v[164:167]
v_mfma_f32_16x16x32_bf16 v[164:167], a[244:247], a[84:87], v[164:167]
ds_read_b64_tr_b16 a[200:201], v15 offset:24576
v_mfma_f32_16x16x32_bf16 v[164:167], a[248:251], a[168:171], v[164:167]
ds_read_b64_tr_b16 a[202:203], v15 offset:26624
v_mfma_f32_16x16x32_bf16 v[164:167], a[252:255], a[92:95], v[164:167]
v_mfma_f32_16x16x32_bf16 v[168:171], a[252:255], a[96:99], v[168:171]
v_mfma_f32_16x16x32_bf16 v[168:171], a[248:251], a[184:187], v[168:171]
ds_read_b64_tr_b16 a[204:205], v15 offset:28672
v_cvt_pk_bf16_f32 v144, v144, v145
v_mfma_f32_16x16x32_bf16 v[168:171], a[244:247], a[72:75], v[168:171]
ds_read_b64_tr_b16 a[206:207], v15 offset:30720
v_cvt_pk_bf16_f32 v145, v146, v147
v_mfma_f32_16x16x32_bf16 v[168:171], a[240:243], a[60:63], v[168:171]
v_mfma_f32_16x16x32_bf16 v[168:171], a[236:239], a[160:163], v[168:171]
v_mfma_f32_16x16x32_bf16 v[168:171], a[232:235], a[52:55], v[168:171]
ds_read_b64_tr_b16 a[208:209], v3 offset:8192
v_mfma_f32_16x16x32_bf16 v[168:171], a[228:231], a[12:15], v[168:171]
ds_read_b64_tr_b16 a[210:211], v3 offset:10240
v_mfma_f32_16x16x32_bf16 v[168:171], a[224:227], a[148:151], v[168:171]
v_cvt_pk_bf16_f32 v146, v164, v165
v_cvt_pk_bf16_f32 v147, v166, v167
v_mfma_f32_16x16x32_bf16 v[172:175], a[224:227], a[4:7], v[172:175]
s_add_u32 s39, s32, 0
ds_read_b64_tr_b16 a[212:213], v3 offset:12288
v_mfma_f32_16x16x32_bf16 v[172:175], a[228:231], a[28:31], v[172:175]
buffer_store_dwordx4 v[144:147], v18, s[20:23], s39 offen offset:0 sc1
v_mfma_f32_16x16x32_bf16 v[172:175], a[232:235], a[136:139], v[172:175]
ds_read_b64_tr_b16 a[214:215], v3 offset:14336
v_cvt_pk_bf16_f32 v148, v148, v149
v_mfma_f32_16x16x32_bf16 v[172:175], a[236:239], a[176:179], v[172:175]
v_mfma_f32_16x16x32_bf16 v[172:175], a[240:243], a[64:67], v[172:175]
v_mfma_f32_16x16x32_bf16 v[172:175], a[244:247], a[88:91], v[172:175]
ds_read_b64_tr_b16 a[216:217], v3 offset:24576
v_cvt_pk_bf16_f32 v149, v150, v151
v_mfma_f32_16x16x32_bf16 v[172:175], a[248:251], a[172:175], v[172:175]
ds_read_b64_tr_b16 a[218:219], v3 offset:26624
v_mfma_f32_16x16x32_bf16 v[172:175], a[252:255], a[112:115], v[172:175]
v_cvt_pk_bf16_f32 v150, v168, v169
v_cvt_pk_bf16_f32 v151, v170, v171
v_mfma_f32_16x16x32_bf16 v[176:179], a[252:255], a[100:103], v[176:179]
buffer_store_dwordx4 v[148:151], v18, s[20:23], s39 offen offset:1024 sc1
v_mfma_f32_16x16x32_bf16 v[176:179], a[248:251], a[188:191], v[176:179]
ds_read_b64_tr_b16 a[220:221], v3 offset:28672
v_cvt_pk_bf16_f32 v152, v152, v153
v_mfma_f32_16x16x32_bf16 v[176:179], a[244:247], a[164:167], v[176:179]
ds_read_b64_tr_b16 a[222:223], v3 offset:30720
v_cvt_pk_bf16_f32 v153, v154, v155
v_mfma_f32_16x16x32_bf16 v[176:179], a[240:243], a[80:83], v[176:179]
v_mfma_f32_16x16x32_bf16 v[176:179], a[236:239], a[40:43], v[176:179]
v_mfma_f32_16x16x32_bf16 v[176:179], a[232:235], a[152:155], v[176:179]
v_mfma_f32_16x16x32_bf16 v[176:179], a[228:231], a[32:35], v[176:179]
v_mfma_f32_16x16x32_bf16 v[176:179], a[224:227], a[20:23], v[176:179]
v_cvt_pk_bf16_f32 v154, v172, v173
v_cvt_pk_bf16_f32 v155, v174, v175
v_mfma_f32_16x16x32_bf16 v[180:183], a[224:227], a[8:11], v[180:183]
buffer_store_dwordx4 v[152:155], v18, s[20:23], s39 offen offset:2048 sc1
v_mfma_f32_16x16x32_bf16 v[180:183], a[228:231], a[48:51], v[180:183]
v_mfma_f32_16x16x32_bf16 v[180:183], a[232:235], a[140:143], v[180:183]
s_waitcnt vmcnt(3)
s_barrier
v_mfma_f32_16x16x32_bf16 v[180:183], a[236:239], a[56:59], v[180:183]
s_mov_b64 exec, 1
buffer_store_dword v20, off, s[28:31], s55 offset:4 sc1
s_mov_b64 exec, -1
v_mfma_f32_16x16x32_bf16 v[180:183], a[240:243], a[68:71], v[180:183]
v_mfma_f32_16x16x32_bf16 v[180:183], a[244:247], a[180:183], v[180:183]
ds_read_b64_tr_b16 a[224:225], v16 offset:8192
s_waitcnt lgkmcnt(1)
v_mfma_f32_16x16x32_bf16 v[180:183], a[248:251], a[76:79], v[180:183]
ds_read_b64_tr_b16 a[226:227], v16 offset:10240
v_mfma_f32_16x16x32_bf16 v[180:183], a[252:255], a[116:119], v[180:183]
v_mfma_f32_16x16x32_bf16 v[184:187], a[192:195], a[132:135], v[184:187]
v_mfma_f32_16x16x32_bf16 v[184:187], a[196:199], a[24:27], v[184:187]
ds_read_b64_tr_b16 a[228:229], v16 offset:12288
v_mfma_f32_16x16x32_bf16 v[184:187], a[200:203], a[36:39], v[184:187]
ds_read_b64_tr_b16 a[230:231], v16 offset:14336
v_mfma_f32_16x16x32_bf16 v[184:187], a[204:207], a[156:159], v[184:187]
ds_read_b64_tr_b16 a[232:233], v16 offset:24576
v_cvt_pk_bf16_f32 v156, v156, v157
v_mfma_f32_16x16x32_bf16 v[184:187], a[208:211], a[44:47], v[184:187]
ds_read_b64_tr_b16 a[234:235], v16 offset:26624
v_cvt_pk_bf16_f32 v157, v158, v159
v_mfma_f32_16x16x32_bf16 v[184:187], a[212:215], a[84:87], v[184:187]
v_cvt_pk_bf16_f32 v158, v176, v177
v_cvt_pk_bf16_f32 v159, v178, v179
v_mfma_f32_16x16x32_bf16 v[184:187], a[216:219], a[168:171], v[184:187]
buffer_store_dwordx4 v[156:159], v18, s[20:23], s39 offen offset:3072 sc1
v_mfma_f32_16x16x32_bf16 v[184:187], a[220:223], a[92:95], v[184:187]
v_cvt_pk_bf16_f32 v160, v160, v161
v_cvt_pk_bf16_f32 v161, v162, v163
v_mfma_f32_16x16x32_bf16 v[188:191], a[220:223], a[96:99], v[188:191]
v_cvt_pk_bf16_f32 v162, v180, v181
v_cvt_pk_bf16_f32 v163, v182, v183
v_mfma_f32_16x16x32_bf16 v[188:191], a[216:219], a[184:187], v[188:191]
ds_read_b64_tr_b16 a[236:237], v16 offset:28672
s_add_u32 s39, s32, 4096
v_mfma_f32_16x16x32_bf16 v[188:191], a[212:215], a[72:75], v[188:191]
buffer_store_dwordx4 v[160:163], v18, s[20:23], s39 offen offset:0 sc1
v_mfma_f32_16x16x32_bf16 v[188:191], a[208:211], a[60:63], v[188:191]
ds_read_b64_tr_b16 a[238:239], v16 offset:30720
v_mfma_f32_16x16x32_bf16 v[188:191], a[204:207], a[160:163], v[188:191]
v_mfma_f32_16x16x32_bf16 v[188:191], a[200:203], a[52:55], v[188:191]
ds_read_b64_tr_b16 a[240:241], v4 offset:8192
v_mfma_f32_16x16x32_bf16 v[188:191], a[196:199], a[12:15], v[188:191]
ds_read_b64_tr_b16 a[242:243], v4 offset:10240
v_mfma_f32_16x16x32_bf16 v[188:191], a[192:195], a[148:151], v[188:191]
v_mfma_f32_16x16x32_bf16 v[192:195], a[192:195], a[4:7], v[192:195]
v_mfma_f32_16x16x32_bf16 v[192:195], a[196:199], a[28:31], v[192:195]
ds_read_b64_tr_b16 a[244:245], v4 offset:12288
v_mfma_f32_16x16x32_bf16 v[192:195], a[200:203], a[136:139], v[192:195]
ds_read_b64_tr_b16 a[246:247], v4 offset:14336
v_mfma_f32_16x16x32_bf16 v[192:195], a[204:207], a[176:179], v[192:195]
v_mfma_f32_16x16x32_bf16 v[192:195], a[208:211], a[64:67], v[192:195]
v_mfma_f32_16x16x32_bf16 v[192:195], a[212:215], a[88:91], v[192:195]
ds_read_b64_tr_b16 a[248:249], v4 offset:24576
v_mfma_f32_16x16x32_bf16 v[192:195], a[216:219], a[172:175], v[192:195]
ds_read_b64_tr_b16 a[250:251], v4 offset:26624
v_mfma_f32_16x16x32_bf16 v[192:195], a[220:223], a[112:115], v[192:195]
v_mfma_f32_16x16x32_bf16 v[196:199], a[220:223], a[100:103], v[196:199]
v_mfma_f32_16x16x32_bf16 v[196:199], a[216:219], a[188:191], v[196:199]
ds_read_b64_tr_b16 a[252:253], v4 offset:28672
v_mfma_f32_16x16x32_bf16 v[196:199], a[212:215], a[164:167], v[196:199]
ds_read_b64_tr_b16 a[254:255], v4 offset:30720
v_mfma_f32_16x16x32_bf16 v[196:199], a[208:211], a[80:83], v[196:199]
v_mfma_f32_16x16x32_bf16 v[196:199], a[204:207], a[40:43], v[196:199]
v_mfma_f32_16x16x32_bf16 v[196:199], a[200:203], a[152:155], v[196:199]
v_mfma_f32_16x16x32_bf16 v[196:199], a[196:199], a[32:35], v[196:199]
v_mfma_f32_16x16x32_bf16 v[196:199], a[192:195], a[20:23], v[196:199]
v_mfma_f32_16x16x32_bf16 v[200:203], a[192:195], a[8:11], v[200:203]
v_mfma_f32_16x16x32_bf16 v[200:203], a[196:199], a[48:51], v[200:203]
v_mfma_f32_16x16x32_bf16 v[200:203], a[200:203], a[140:143], v[200:203]
v_mfma_f32_16x16x32_bf16 v[200:203], a[204:207], a[56:59], v[200:203]
buffer_load_dword v7, v11, s[28:31], 0 offen sc1
v_mfma_f32_16x16x32_bf16 v[200:203], a[208:211], a[68:71], v[200:203]
v_mfma_f32_16x16x32_bf16 v[200:203], a[212:215], a[180:183], v[200:203]
s_waitcnt lgkmcnt(0)
v_mfma_f32_16x16x32_bf16 v[200:203], a[216:219], a[76:79], v[200:203]
v_mfma_f32_16x16x32_bf16 v[200:203], a[220:223], a[116:119], v[200:203]
v_mfma_f32_16x16x32_bf16 v[204:207], a[224:227], a[132:135], v[204:207]
v_mfma_f32_16x16x32_bf16 v[204:207], a[228:231], a[24:27], v[204:207]
v_mfma_f32_16x16x32_bf16 v[204:207], a[232:235], a[36:39], v[204:207]
v_mfma_f32_16x16x32_bf16 v[204:207], a[236:239], a[156:159], v[204:207]
v_mfma_f32_16x16x32_bf16 v[204:207], a[240:243], a[44:47], v[204:207]
v_mfma_f32_16x16x32_bf16 v[204:207], a[244:247], a[84:87], v[204:207]
v_mfma_f32_16x16x32_bf16 v[204:207], a[248:251], a[168:171], v[204:207]
v_mfma_f32_16x16x32_bf16 v[204:207], a[252:255], a[92:95], v[204:207]
v_mfma_f32_16x16x32_bf16 v[208:211], a[252:255], a[96:99], v[208:211]
v_mfma_f32_16x16x32_bf16 v[208:211], a[248:251], a[184:187], v[208:211]
v_mfma_f32_16x16x32_bf16 v[208:211], a[244:247], a[72:75], v[208:211]
v_mfma_f32_16x16x32_bf16 v[208:211], a[240:243], a[60:63], v[208:211]
v_mfma_f32_16x16x32_bf16 v[208:211], a[236:239], a[160:163], v[208:211]
v_mfma_f32_16x16x32_bf16 v[208:211], a[232:235], a[52:55], v[208:211]
v_mfma_f32_16x16x32_bf16 v[208:211], a[228:231], a[12:15], v[208:211]
v_mfma_f32_16x16x32_bf16 v[208:211], a[224:227], a[148:151], v[208:211]
v_mfma_f32_16x16x32_bf16 v[212:215], a[224:227], a[4:7], v[212:215]
v_mfma_f32_16x16x32_bf16 v[212:215], a[228:231], a[28:31], v[212:215]
v_mfma_f32_16x16x32_bf16 v[212:215], a[232:235], a[136:139], v[212:215]
v_mfma_f32_16x16x32_bf16 v[212:215], a[236:239], a[176:179], v[212:215]
v_mfma_f32_16x16x32_bf16 v[212:215], a[240:243], a[64:67], v[212:215]
v_mfma_f32_16x16x32_bf16 v[212:215], a[244:247], a[88:91], v[212:215]
v_mfma_f32_16x16x32_bf16 v[212:215], a[248:251], a[172:175], v[212:215]
v_mfma_f32_16x16x32_bf16 v[212:215], a[252:255], a[112:115], v[212:215]
v_mfma_f32_16x16x32_bf16 v[216:219], a[252:255], a[100:103], v[216:219]
v_mfma_f32_16x16x32_bf16 v[216:219], a[248:251], a[188:191], v[216:219]
v_mfma_f32_16x16x32_bf16 v[216:219], a[244:247], a[164:167], v[216:219]
v_mfma_f32_16x16x32_bf16 v[216:219], a[240:243], a[80:83], v[216:219]
v_mfma_f32_16x16x32_bf16 v[216:219], a[236:239], a[40:43], v[216:219]
s_waitcnt vmcnt(1)
s_barrier
v_mfma_f32_16x16x32_bf16 v[216:219], a[232:235], a[152:155], v[216:219]
s_mov_b64 exec, 1
buffer_store_dword v20, off, s[28:31], s55 offset:0 sc1
s_mov_b64 exec, -1
v_mfma_f32_16x16x32_bf16 v[216:219], a[228:231], a[32:35], v[216:219]
v_mfma_f32_16x16x32_bf16 v[216:219], a[224:227], a[20:23], v[216:219]
v_mfma_f32_16x16x32_bf16 v[220:223], a[224:227], a[8:11], v[220:223]
v_mfma_f32_16x16x32_bf16 v[220:223], a[228:231], a[48:51], v[220:223]
v_mfma_f32_16x16x32_bf16 v[220:223], a[232:235], a[140:143], v[220:223]
v_mfma_f32_16x16x32_bf16 v[220:223], a[236:239], a[56:59], v[220:223]
v_mfma_f32_16x16x32_bf16 v[220:223], a[240:243], a[68:71], v[220:223]
v_mfma_f32_16x16x32_bf16 v[220:223], a[244:247], a[180:183], v[220:223]
v_mfma_f32_16x16x32_bf16 v[220:223], a[248:251], a[76:79], v[220:223]
v_mfma_f32_16x16x32_bf16 v[220:223], a[252:255], a[116:119], v[220:223]
s_waitcnt vmcnt(1)
K2_PSe:
v_cmp_eq_u32 s[84:85], 1, v7
s_add_u32 s78, s78, 1
s_cmp_gt_u32 s78, 0x40000
s_nop 0
s_cselect_b32 s84, 7, s84
s_andn2_b32 s85, s84, s40
s_or_b32 s40, s40, s84
s_and_b32 s40, s40, 7
s_bitcmp0_b32 s85, 2
s_cbranch_scc1 K2_W3e
buffer_load_dwordx4 v[224:227], v18, s[20:23], s35 offen offset:0 sc1
buffer_load_dwordx4 v[236:239], v18, s[20:23], s35 offen offset:1024 sc1
buffer_load_dwordx4 v[248:251], v18, s[20:23], s35 offen offset:2048 sc1
buffer_load_dwordx4 a[16:19], v18, s[20:23], s35 offen offset:3072 sc1
s_add_u32 s46, s35, 4096
buffer_load_dwordx4 a[128:131], v18, s[20:23], s46 offen offset:0 sc1
K2_W3e:
s_bitcmp0_b32 s85, 1
s_cbranch_scc1 K2_W2e
buffer_load_dwordx4 a[120:123], v18, s[20:23], s34 offen offset:0 sc1
buffer_load_dwordx4 v[232:235], v18, s[20:23], s34 offen offset:1024 sc1
buffer_load_dwordx4 v[244:247], v18, s[20:23], s34 offen offset:2048 sc1
buffer_load_dwordx4 a[0:3], v18, s[20:23], s34 offen offset:3072 sc1
s_add_u32 s46, s34, 4096
buffer_load_dwordx4 a[124:127], v18, s[20:23], s46 offen offset:0 sc1
K2_W2e:
s_bitcmp0_b32 s85, 0
s_cbranch_scc1 K2_W1e
buffer_load_dwordx4 a[104:107], v18, s[20:23], s33 offen offset:0 sc1
buffer_load_dwordx4 v[228:231], v18, s[20:23], s33 offen offset:1024 sc1
buffer_load_dwordx4 v[240:243], v18, s[20:23], s33 offen offset:2048 sc1
buffer_load_dwordx4 v[252:255], v18, s[20:23], s33 offen offset:3072 sc1
s_add_u32 s46, s33, 4096
buffer_load_dwordx4 a[108:111], v18, s[20:23], s46 offen offset:0 sc1
K2_W1e:
s_cmp_lg_u32 s40, 7
s_cbranch_scc1 K2_WXe
K2_GOe:
s_waitcnt vmcnt(4)
v_mfma_f32_16x16x32_bf16 v[184:187], v[32:35], v[224:227], v[184:187]
v_mfma_f32_16x16x32_bf16 v[184:187], v[32:35], a[120:123], v[184:187]
v_mfma_f32_16x16x32_bf16 v[184:187], v[32:35], a[104:107], v[184:187]
v_mfma_f32_16x16x32_bf16 v[204:207], v[36:39], v[224:227], v[204:207]
v_mfma_f32_16x16x32_bf16 v[204:207], v[36:39], a[120:123], v[204:207]
v_mfma_f32_16x16x32_bf16 v[204:207], v[36:39], a[104:107], v[204:207]
s_waitcnt vmcnt(3)
v_mfma_f32_16x16x32_bf16 v[188:191], v[32:35], v[236:239], v[188:191]
v_mfma_f32_16x16x32_bf16 v[188:191], v[32:35], v[232:235], v[188:191]
v_mfma_f32_16x16x32_bf16 v[188:191], v[32:35], v[228:231], v[188:191]
v_mfma_f32_16x16x32_bf16 v[208:211], v[36:39], v[236:239], v[208:211]
v_mfma_f32_16x16x32_bf16 v[208:211], v[36:39], v[232:235], v[208:211]
v_mfma_f32_16x16x32_bf16 v[208:211], v[36:39], v[228:231], v[208:211]
v_cvt_pk_bf16_f32 v184, v184, v185
v_cvt_pk_bf16_f32 v185, v186, v187
v_cvt_pk_bf16_f32 v186, v204, v205
v_cvt_pk_bf16_f32 v187, v206, v207
s_nop 1
v_permlane16_swap_b32 v184, v186
v_permlane16_swap_b32 v185, v187
ds_write_b128 v17, v[184:187] offset:0
ds_read_b128 v[144:147], v12 offset:0
s_waitcnt vmcnt(2)
v_mfma_f32_16x16x32_bf16 v[192:195], v[32:35], v[248:251], v[192:195]
v_mfma_f32_16x16x32_bf16 v[192:195], v[32:35], v[244:247], v[192:195]
v_mfma_f32_16x16x32_bf16 v[192:195], v[32:35], v[240:243], v[192:195]
v_mfma_f32_16x16x32_bf16 v[212:215], v[36:39], v[248:251], v[212:215]
v_mfma_f32_16x16x32_bf16 v[212:215], v[36:39], v[244:247], v[212:215]
v_mfma_f32_16x16x32_bf16 v[212:215], v[36:39], v[240:243], v[212:215]
v_cvt_pk_bf16_f32 v188, v188, v189
v_cvt_pk_bf16_f32 v189, v190, v191
v_cvt_pk_bf16_f32 v190, v208, v209
v_cvt_pk_bf16_f32 v191, v210, v211
s_nop 1
v_permlane16_swap_b32 v188, v190
v_permlane16_swap_b32 v189, v191
ds_write_b128 v17, v[188:191] offset:1024
ds_read_b128 v[148:151], v12 offset:1024
s_waitcnt vmcnt(1)
v_mfma_f32_16x16x32_bf16 v[196:199], v[32:35], a[16:19], v[196:199]
v_mfma_f32_16x16x32_bf16 v[196:199], v[32:35], a[0:3], v[196:199]
v_mfma_f32_16x16x32_bf16 v[196:199], v[32:35], v[252:255], v[196:199]
v_mfma_f32_16x16x32_bf16 v[216:219], v[36:39], a[16:19], v[216:219]
v_mfma_f32_16x16x32_bf16 v[216:219], v[36:39], a[0:3], v[216:219]
v_mfma_f32_16x16x32_bf16 v[216:219], v[36:39], v[252:255], v[216:219]
v_cvt_pk_bf16_f32 v192, v192, v193
v_cvt_pk_bf16_f32 v193, v194, v195
v_cvt_pk_bf16_f32 v194, v212, v213
v_cvt_pk_bf16_f32 v195, v214, v215
s_nop 1
v_permlane16_swap_b32 v192, v194
v_permlane16_swap_b32 v193, v195
ds_write_b128 v17, v[192:195] offset:2048
ds_read_b128 v[152:155], v12 offset:2048
s_waitcnt vmcnt(0)
v_mfma_f32_16x16x32_bf16 v[200:203], v[32:35], a[128:131], v[200:203]
v_mfma_f32_16x16x32_bf16 v[200:203], v[32:35], a[124:127], v[200:203]
v_mfma_f32_16x16x32_bf16 v[200:203], v[32:35], a[108:111], v[200:203]
v_mfma_f32_16x16x32_bf16 v[220:223], v[36:39], a[128:131], v[220:223]
v_mfma_f32_16x16x32_bf16 v[220:223], v[36:39], a[124:127], v[220:223]
v_mfma_f32_16x16x32_bf16 v[220:223], v[36:39], a[108:111], v[220:223]
v_cvt_pk_bf16_f32 v196, v196, v197
v_cvt_pk_bf16_f32 v197, v198, v199
v_cvt_pk_bf16_f32 v198, v216, v217
v_cvt_pk_bf16_f32 v199, v218, v219
s_nop 1
v_permlane16_swap_b32 v196, v198
v_permlane16_swap_b32 v197, v199
ds_write_b128 v17, v[196:199] offset:3072
ds_read_b128 v[156:159], v12 offset:3072
s_mov_b32 s87, 0
s_waitcnt lgkmcnt(6)
buffer_store_dwordx4 v[144:147], v10, s[12:15], s87 offen sc1
s_mov_b32 s87, 40960
s_waitcnt lgkmcnt(4)
buffer_store_dwordx4 v[148:151], v10, s[12:15], s87 offen sc1
s_mov_b32 s87, 81920
s_waitcnt lgkmcnt(2)
buffer_store_dwordx4 v[152:155], v10, s[12:15], s87 offen sc1
v_cvt_pk_bf16_f32 v200, v200, v201
v_cvt_pk_bf16_f32 v201, v202, v203
v_cvt_pk_bf16_f32 v202, v220, v221
v_cvt_pk_bf16_f32 v203, v222, v223
s_nop 1
v_permlane16_swap_b32 v200, v202
v_permlane16_swap_b32 v201, v203
ds_write_b128 v17, v[200:203] offset:4096
ds_read_b128 v[160:163], v12 offset:4096
s_mov_b32 s87, 122880
s_waitcnt lgkmcnt(2)
buffer_store_dwordx4 v[156:159], v10, s[12:15], s87 offen sc1
s_mov_b32 s87, 163840
s_waitcnt lgkmcnt(0)
buffer_store_dwordx4 v[160:163], v10, s[12:15], s87 offen sc1
s_endpgm
K2_WXe:
buffer_load_dword v7, v11, s[28:31], 0 offen sc1
s_waitcnt vmcnt(0)
s_branch K2_PSe
K2_SPIN12e:
s_add_u32 s78, s78, 1
s_cmp_gt_u32 s78, 0x40000
s_cbranch_scc1 K2_RET12e
s_sleep 4
buffer_load_dword v9, off, s[28:31], s51 sc1
s_waitcnt vmcnt(0)
v_readfirstlane_b32 s88, v9
s_nop 3
s_cmp_lt_u32 s88, 32
s_cbranch_scc1 K2_SPIN12e
s_branch K2_RET12e
K2_SPIN24e:
s_add_u32 s78, s78, 1
s_cmp_gt_u32 s78, 0x40000
s_cbranch_scc1 K2_RET24e
s_sleep 4
buffer_load_dword v9, off, s[28:31], s51 offset:128 sc1
s_waitcnt vmcnt(0)
v_readfirstlane_b32 s88, v9
s_nop 3
s_cmp_lt_u32 s88, 32
s_cbranch_scc1 K2_SPIN24e
s_branch K2_RET24e
K1_DONE:
K1_END:
s_endpgm
.p2align 6
K1_LA:
v_exp_f32 v100, v100
v_exp_f32 v101, v101
v_exp_f32 v102, v102
v_exp_f32 v103, v103
v_cvt_pk_bf16_f32 v100, v100, v101
v_exp_f32 v144, v144
v_exp_f32 v145, v145
v_cvt_pk_bf16_f32 v101, v102, v103
v_exp_f32 v146, v146
v_exp_f32 v147, v147
v_cvt_pk_bf16_f32 v102, v144, v145
v_exp_f32 v108, v108
v_exp_f32 v109, v109
v_cvt_pk_bf16_f32 v103, v146, v147
v_exp_f32 v110, v110
v_exp_f32 v111, v111
v_cvt_pk_bf16_f32 v108, v108, v109
v_exp_f32 v148, v148
v_exp_f32 v149, v149
v_cvt_pk_bf16_f32 v109, v110, v111
v_exp_f32 v150, v150
v_exp_f32 v151, v151
v_cvt_pk_bf16_f32 v110, v148, v149
v_exp_f32 v116, v116
v_exp_f32 v117, v117
v_cvt_pk_bf16_f32 v111, v150, v151
v_exp_f32 v118, v118
v_exp_f32 v119, v119
v_cvt_pk_bf16_f32 v116, v116, v117
v_exp_f32 v152, v152
v_exp_f32 v153, v153
v_cvt_pk_bf16_f32 v117, v118, v119
v_exp_f32 v154, v154
v_exp_f32 v155, v155
v_cvt_pk_bf16_f32 v118, v152, v153
s_nop 0
v_cvt_pk_bf16_f32 v119, v154, v155
v_mfma_f32_16x16x32_bf16 v[64:67], a[224:227], v[160:163], v[48:51]
v_exp_f32 v124, v124
v_mfma_f32_16x16x32_bf16 v[64:67], a[228:231], v[164:167], v[64:67]
ds_read_b128 a[248:251], v1 offset:38912
v_mfma_f32_16x16x32_bf16 v[64:67], a[232:235], v[168:171], v[64:67]
global_load_dword v30, v[28:29], off
v_mfma_f32_16x16x32_bf16 v[64:67], a[236:239], v[172:175], v[64:67]
ds_read_b128 a[252:255], v2 offset:38912
v_mfma_f32_16x16x32_bf16 v[64:67], a[240:243], v[176:179], v[64:67]
ds_read_b128 a[192:195], v1 offset:39936
s_add_u32 m0, s40, 107392
v_mfma_f32_16x16x32_bf16 v[64:67], a[244:247], v[180:183], v[64:67]
v_mfma_f32_16x16x32_bf16 v[72:75], a[244:247], v[204:207], v[52:55]
v_mfma_f32_16x16x32_bf16 v[72:75], a[240:243], v[200:203], v[72:75]
ds_read_b128 a[196:199], v2 offset:39936
v_mfma_f32_16x16x32_bf16 v[72:75], a[236:239], v[196:199], v[72:75]
v_exp_f32 v125, v125
v_mfma_f32_16x16x32_bf16 v[72:75], a[232:235], v[192:195], v[72:75]
ds_read_b128 a[200:203], v1 offset:40960
v_cvt_pk_bf16_f32 v124, v124, v125
v_mfma_f32_16x16x32_bf16 v[72:75], a[228:231], v[188:191], v[72:75]
v_mfma_f32_16x16x32_bf16 v[72:75], a[224:227], v[184:187], v[72:75]
v_mfma_f32_16x16x32_bf16 v[80:83], a[224:227], v[208:211], v[56:59]
ds_read_b128 a[204:207], v2 offset:40960
v_mfma_f32_16x16x32_bf16 v[80:83], a[228:231], v[212:215], v[80:83]
v_mfma_f32_16x16x32_bf16 v[80:83], a[232:235], v[216:219], v[80:83]
v_mfma_f32_16x16x32_bf16 v[80:83], a[236:239], v[220:223], v[80:83]
v_mfma_f32_16x16x32_bf16 v[80:83], a[240:243], v[224:227], v[80:83]
buffer_load_dwordx4 v19, s[12:15], s35 offen offset:128 nt lds
v_mfma_f32_16x16x32_bf16 v[80:83], a[244:247], v[228:231], v[80:83]
v_exp_f32 v126, v126
v_mfma_f32_16x16x32_bf16 v[88:91], a[244:247], v[252:255], v[60:63]
v_mfma_f32_16x16x32_bf16 v[88:91], a[240:243], v[248:251], v[88:91]
v_mfma_f32_16x16x32_bf16 v[88:91], a[236:239], v[244:247], v[88:91]
v_mfma_f32_16x16x32_bf16 v[88:91], a[232:235], v[240:243], v[88:91]
s_waitcnt lgkmcnt(0)
ds_read_b128 a[208:211], v1 offset:45056
v_mfma_f32_16x16x32_bf16 v[88:91], a[228:231], v[236:239], v[88:91]
v_mfma_f32_16x16x32_bf16 v[88:91], a[224:227], v[232:235], v[88:91]
v_mfma_f32_16x16x32_bf16 v[128:131], a[248:251], v[160:163], v[48:51]
v_mfma_f32_16x16x32_bf16 v[128:131], a[252:255], v[164:167], v[128:131]
v_mfma_f32_16x16x32_bf16 v[128:131], a[192:195], v[168:171], v[128:131]
ds_read_b128 a[212:215], v2 offset:45056
v_mfma_f32_16x16x32_bf16 v[128:131], a[196:199], v[172:175], v[128:131]
v_exp_f32 v127, v127
v_mfma_f32_16x16x32_bf16 v[128:131], a[200:203], v[176:179], v[128:131]
buffer_load_dwordx4 v19, s[12:15], s35 offen offset:3200 nt lds
v_mfma_f32_16x16x32_bf16 v[128:131], a[204:207], v[180:183], v[128:131]
ds_read_b128 a[216:219], v1 offset:46080
v_cvt_pk_bf16_f32 v125, v126, v127
v_mfma_f32_16x16x32_bf16 v[132:135], a[204:207], v[204:207], v[52:55]
v_mfma_f32_16x16x32_bf16 v[132:135], a[200:203], v[200:203], v[132:135]
ds_read_b128 a[220:223], v2 offset:46080
v_mfma_f32_16x16x32_bf16 v[132:135], a[196:199], v[196:199], v[132:135]
v_mfma_f32_16x16x32_bf16 v[132:135], a[192:195], v[192:195], v[132:135]
ds_read_b128 a[224:227], v1 offset:47104
s_add_u32 m0, s40, 108288
v_mfma_f32_16x16x32_bf16 v[132:135], a[252:255], v[188:191], v[132:135]
v_mfma_f32_16x16x32_bf16 v[132:135], a[248:251], v[184:187], v[132:135]
v_exp_f32 v156, v156
v_mfma_f32_16x16x32_bf16 v[136:139], a[248:251], v[208:211], v[56:59]
ds_read_b128 a[228:231], v2 offset:47104
v_mfma_f32_16x16x32_bf16 v[136:139], a[252:255], v[212:215], v[136:139]
v_mfma_f32_16x16x32_bf16 v[136:139], a[192:195], v[216:219], v[136:139]
v_mfma_f32_16x16x32_bf16 v[136:139], a[196:199], v[220:223], v[136:139]
v_mfma_f32_16x16x32_bf16 v[136:139], a[200:203], v[224:227], v[136:139]
v_mfma_f32_16x16x32_bf16 v[136:139], a[204:207], v[228:231], v[136:139]
v_mfma_f32_16x16x32_bf16 v[140:143], a[204:207], v[252:255], v[60:63]
v_mfma_f32_16x16x32_bf16 v[140:143], a[200:203], v[248:251], v[140:143]
buffer_load_dwordx4 v19, s[12:15], s35 offen offset:256 nt lds
v_mfma_f32_16x16x32_bf16 v[140:143], a[196:199], v[244:247], v[140:143]
v_mfma_f32_16x16x32_bf16 v[140:143], a[192:195], v[240:243], v[140:143]
v_exp_f32 v157, v157
v_mfma_f32_16x16x32_bf16 v[140:143], a[252:255], v[236:239], v[140:143]
s_waitcnt lgkmcnt(0)
ds_read_b128 a[232:235], v1 offset:51200
v_mfma_f32_16x16x32_bf16 v[140:143], a[248:251], v[232:235], v[140:143]
ds_read_b128 a[236:239], v2 offset:51200
v_cvt_pk_bf16_f32 v126, v156, v157
v_mfma_f32_16x16x32_bf16 v[68:71], a[208:211], v[160:163], v[48:51]
v_mfma_f32_16x16x32_bf16 v[68:71], a[212:215], v[164:167], v[68:71]
v_mfma_f32_16x16x32_bf16 v[68:71], a[216:219], v[168:171], v[68:71]
v_mfma_f32_16x16x32_bf16 v[68:71], a[220:223], v[172:175], v[68:71]
v_mfma_f32_16x16x32_bf16 v[68:71], a[224:227], v[176:179], v[68:71]
ds_read_b128 a[240:243], v1 offset:52224
v_mfma_f32_16x16x32_bf16 v[68:71], a[228:231], v[180:183], v[68:71]
v_mfma_f32_16x16x32_bf16 v[76:79], a[228:231], v[204:207], v[52:55]
v_exp_f32 v158, v158
v_mfma_f32_16x16x32_bf16 v[76:79], a[224:227], v[200:203], v[76:79]
buffer_load_dwordx4 v19, s[12:15], s35 offen offset:3328 nt lds
v_mfma_f32_16x16x32_bf16 v[76:79], a[220:223], v[196:199], v[76:79]
ds_read_b128 a[244:247], v2 offset:52224
v_mfma_f32_16x16x32_bf16 v[76:79], a[216:219], v[192:195], v[76:79]
ds_read_b128 a[248:251], v1 offset:53248
v_mfma_f32_16x16x32_bf16 v[76:79], a[212:215], v[188:191], v[76:79]
v_mfma_f32_16x16x32_bf16 v[76:79], a[208:211], v[184:187], v[76:79]
v_mfma_f32_16x16x32_bf16 v[84:87], a[208:211], v[208:211], v[56:59]
ds_read_b128 a[252:255], v2 offset:53248
s_add_u32 s35, s35, 24576
v_mfma_f32_16x16x32_bf16 v[84:87], a[212:215], v[212:215], v[84:87]
v_mfma_f32_16x16x32_bf16 v[84:87], a[216:219], v[216:219], v[84:87]
v_mfma_f32_16x16x32_bf16 v[84:87], a[220:223], v[220:223], v[84:87]
v_exp_f32 v159, v159
v_mfma_f32_16x16x32_bf16 v[84:87], a[224:227], v[224:227], v[84:87]
v_mfma_f32_16x16x32_bf16 v[84:87], a[228:231], v[228:231], v[84:87]
v_cvt_pk_bf16_f32 v127, v158, v159
v_mfma_f32_16x16x32_bf16 v[92:95], a[228:231], v[252:255], v[60:63]
v_mfma_f32_16x16x32_bf16 v[92:95], a[224:227], v[248:251], v[92:95]
v_mfma_f32_16x16x32_bf16 v[92:95], a[220:223], v[244:247], v[92:95]
v_mfma_f32_16x16x32_bf16 v[92:95], a[216:219], v[240:243], v[92:95]
s_waitcnt lgkmcnt(0)
v_mfma_f32_16x16x32_bf16 v[92:95], a[212:215], v[236:239], v[92:95]
v_mfma_f32_16x16x32_bf16 v[92:95], a[208:211], v[232:235], v[92:95]
v_mfma_f32_16x16x32_bf16 v[144:147], a[232:235], v[160:163], v[48:51]
v_mfma_f32_16x16x32_bf16 v[144:147], a[236:239], v[164:167], v[144:147]
v_mfma_f32_16x16x32_bf16 v[144:147], a[240:243], v[168:171], v[144:147]
v_mfma_f32_16x16x32_bf16 v[144:147], a[244:247], v[172:175], v[144:147]
s_add_u32 m0, s40, 32768
v_mfma_f32_16x16x32_bf16 v[144:147], a[248:251], v[176:179], v[144:147]
s_waitcnt vmcnt(13) lgkmcnt(0)
s_barrier
v_mfma_f32_16x16x32_bf16 v[144:147], a[252:255], v[180:183], v[144:147]
ds_read_b64_tr_b16 a[192:193], v5 offset:24576
v_mfma_f32_16x16x32_bf16 v[148:151], a[252:255], v[204:207], v[52:55]
buffer_load_dwordx4 v19, s[8:11], s34 offen offset:0 nt lds
v_mfma_f32_16x16x32_bf16 v[148:151], a[248:251], v[200:203], v[148:151]
ds_read_b64_tr_b16 a[194:195], v5 offset:30720
v_mfma_f32_16x16x32_bf16 v[148:151], a[244:247], v[196:199], v[148:151]
ds_read_b64_tr_b16 a[196:197], v5 offset:36864
v_mfma_f32_16x16x32_bf16 v[148:151], a[240:243], v[192:195], v[148:151]
ds_read_b64_tr_b16 a[198:199], v5 offset:43008
v_mfma_f32_16x16x32_bf16 v[148:151], a[236:239], v[188:191], v[148:151]
v_mfma_f32_16x16x32_bf16 v[148:151], a[232:235], v[184:187], v[148:151]
ds_read_b64_tr_b16 a[200:201], v6 offset:24576
v_mfma_f32_16x16x32_bf16 v[152:155], a[232:235], v[208:211], v[56:59]
ds_read_b64_tr_b16 a[202:203], v6 offset:30720
v_mfma_f32_16x16x32_bf16 v[152:155], a[236:239], v[212:215], v[152:155]
buffer_load_dwordx4 v19, s[8:11], s34 offen offset:3072 nt lds
v_mfma_f32_16x16x32_bf16 v[152:155], a[240:243], v[216:219], v[152:155]
ds_read_b64_tr_b16 a[204:205], v6 offset:36864
v_mfma_f32_16x16x32_bf16 v[152:155], a[244:247], v[220:223], v[152:155]
v_mfma_f32_16x16x32_bf16 v[152:155], a[248:251], v[224:227], v[152:155]
ds_read_b64_tr_b16 a[206:207], v6 offset:43008
v_mfma_f32_16x16x32_bf16 v[152:155], a[252:255], v[228:231], v[152:155]
v_mfma_f32_16x16x32_bf16 v[156:159], a[252:255], v[252:255], v[60:63]
ds_read_b64_tr_b16 a[208:209], v7 offset:24576
v_mfma_f32_16x16x32_bf16 v[156:159], a[248:251], v[248:251], v[156:159]
v_mfma_f32_16x16x32_bf16 v[156:159], a[244:247], v[244:247], v[156:159]
ds_read_b64_tr_b16 a[210:211], v7 offset:30720
v_mfma_f32_16x16x32_bf16 v[156:159], a[240:243], v[240:243], v[156:159]
v_mfma_f32_16x16x32_bf16 v[156:159], a[236:239], v[236:239], v[156:159]
s_waitcnt lgkmcnt(6)
v_mfma_f32_16x16x32_bf16 v[156:159], a[232:235], v[232:235], v[156:159]
v_exp_f32 v64, v64
v_exp_f32 v65, v65
v_exp_f32 v66, v66
v_exp_f32 v67, v67
v_cvt_pk_bf16_f32 v64, v64, v65
v_exp_f32 v128, v128
v_exp_f32 v129, v129
v_cvt_pk_bf16_f32 v65, v66, v67
v_exp_f32 v130, v130
v_exp_f32 v131, v131
v_cvt_pk_bf16_f32 v66, v128, v129
v_exp_f32 v72, v72
v_exp_f32 v73, v73
v_cvt_pk_bf16_f32 v67, v130, v131
v_exp_f32 v74, v74
v_exp_f32 v75, v75
v_cvt_pk_bf16_f32 v72, v72, v73
v_exp_f32 v132, v132
v_exp_f32 v133, v133
v_cvt_pk_bf16_f32 v73, v74, v75
v_exp_f32 v134, v134
v_exp_f32 v135, v135
v_cvt_pk_bf16_f32 v74, v132, v133
s_nop 0
v_cvt_pk_bf16_f32 v75, v134, v135
v_mfma_f32_16x16x32_bf16 a[0:3], a[192:195], v[96:99], a[0:3]
ds_read_b64_tr_b16 a[212:213], v7 offset:36864
v_mfma_f32_16x16x32_bf16 a[0:3], a[196:199], v[100:103], a[0:3]
v_exp_f32 v80, v80
v_mfma_f32_16x16x32_bf16 a[4:7], a[192:195], v[104:107], a[4:7]
ds_read_b64_tr_b16 a[214:215], v7 offset:43008
s_add_u32 m0, s40, 33664
v_mfma_f32_16x16x32_bf16 a[4:7], a[196:199], v[108:111], a[4:7]
ds_read_b64_tr_b16 a[216:217], v8 offset:24576
v_mfma_f32_16x16x32_bf16 a[8:11], a[192:195], v[112:115], a[8:11]
v_exp_f32 v81, v81
v_mfma_f32_16x16x32_bf16 a[8:11], a[196:199], v[116:119], a[8:11]
ds_read_b64_tr_b16 a[218:219], v8 offset:30720
s_waitcnt lgkmcnt(6)
v_mfma_f32_16x16x32_bf16 a[12:15], a[192:195], v[120:123], a[12:15]
buffer_load_dwordx4 v19, s[8:11], s34 offen offset:128 nt lds
v_mfma_f32_16x16x32_bf16 a[12:15], a[196:199], v[124:127], a[12:15]
ds_read_b64_tr_b16 a[220:221], v8 offset:36864
v_cvt_pk_bf16_f32 v80, v80, v81
v_mfma_f32_16x16x32_bf16 a[16:19], a[200:203], v[96:99], a[16:19]
ds_read_b64_tr_b16 a[222:223], v8 offset:43008
v_mfma_f32_16x16x32_bf16 a[16:19], a[204:207], v[100:103], a[16:19]
v_exp_f32 v82, v82
v_mfma_f32_16x16x32_bf16 a[20:23], a[200:203], v[104:107], a[20:23]
ds_read_b64_tr_b16 a[224:225], v5 offset:25600
v_mfma_f32_16x16x32_bf16 a[20:23], a[204:207], v[108:111], a[20:23]
ds_read_b64_tr_b16 a[226:227], v5 offset:31744
v_mfma_f32_16x16x32_bf16 a[24:27], a[200:203], v[112:115], a[24:27]
ds_read_b64_tr_b16 a[228:229], v5 offset:37888
v_mfma_f32_16x16x32_bf16 a[24:27], a[204:207], v[116:119], a[24:27]
s_waitcnt lgkmcnt(7)
ds_read_b64_tr_b16 a[230:231], v5 offset:44032
v_mfma_f32_16x16x32_bf16 a[28:31], a[200:203], v[120:123], a[28:31]
buffer_load_dwordx4 v19, s[8:11], s34 offen offset:3200 nt lds
v_mfma_f32_16x16x32_bf16 a[28:31], a[204:207], v[124:127], a[28:31]
v_exp_f32 v83, v83
v_mfma_f32_16x16x32_bf16 a[32:35], a[208:211], v[96:99], a[32:35]
ds_read_b64_tr_b16 a[232:233], v6 offset:25600
v_cvt_pk_bf16_f32 v81, v82, v83
v_mfma_f32_16x16x32_bf16 a[32:35], a[212:215], v[100:103], a[32:35]
v_mfma_f32_16x16x32_bf16 a[36:39], a[208:211], v[104:107], a[36:39]
ds_read_b64_tr_b16 a[234:235], v6 offset:31744
v_mfma_f32_16x16x32_bf16 a[36:39], a[212:215], v[108:111], a[36:39]
v_exp_f32 v136, v136
v_mfma_f32_16x16x32_bf16 a[40:43], a[208:211], v[112:115], a[40:43]
ds_read_b64_tr_b16 a[236:237], v6 offset:37888
s_add_u32 m0, s40, 34560
v_mfma_f32_16x16x32_bf16 a[40:43], a[212:215], v[116:119], a[40:43]
ds_read_b64_tr_b16 a[238:239], v6 offset:44032
s_waitcnt lgkmcnt(8)
v_mfma_f32_16x16x32_bf16 a[44:47], a[208:211], v[120:123], a[44:47]
v_mfma_f32_16x16x32_bf16 a[44:47], a[212:215], v[124:127], a[44:47]
ds_read_b64_tr_b16 a[240:241], v7 offset:25600
v_mfma_f32_16x16x32_bf16 a[48:51], a[216:219], v[96:99], a[48:51]
v_mfma_f32_16x16x32_bf16 a[48:51], a[220:223], v[100:103], a[48:51]
v_exp_f32 v137, v137
v_mfma_f32_16x16x32_bf16 a[52:55], a[216:219], v[104:107], a[52:55]
ds_read_b64_tr_b16 a[242:243], v7 offset:31744
v_cvt_pk_bf16_f32 v82, v136, v137
v_mfma_f32_16x16x32_bf16 a[52:55], a[220:223], v[108:111], a[52:55]
ds_read_b64_tr_b16 a[244:245], v7 offset:37888
v_mfma_f32_16x16x32_bf16 a[56:59], a[216:219], v[112:115], a[56:59]
v_mfma_f32_16x16x32_bf16 a[56:59], a[220:223], v[116:119], a[56:59]
ds_read_b64_tr_b16 a[246:247], v7 offset:44032
s_waitcnt lgkmcnt(8)
v_mfma_f32_16x16x32_bf16 a[60:63], a[216:219], v[120:123], a[60:63]
buffer_load_dwordx4 v19, s[8:11], s34 offen offset:256 nt lds
v_mfma_f32_16x16x32_bf16 a[60:63], a[220:223], v[124:127], a[60:63]
v_exp_f32 v138, v138
v_mfma_f32_16x16x32_bf16 a[64:67], a[224:227], v[96:99], a[64:67]
ds_read_b64_tr_b16 a[248:249], v8 offset:25600
v_mfma_f32_16x16x32_bf16 a[64:67], a[228:231], v[100:103], a[64:67]
ds_read_b64_tr_b16 a[250:251], v8 offset:31744
v_mfma_f32_16x16x32_bf16 a[68:71], a[224:227], v[104:107], a[68:71]
ds_read_b64_tr_b16 a[252:253], v8 offset:37888
v_mfma_f32_16x16x32_bf16 a[68:71], a[228:231], v[108:111], a[68:71]
v_mfma_f32_16x16x32_bf16 a[72:75], a[224:227], v[112:115], a[72:75]
v_exp_f32 v139, v139
v_mfma_f32_16x16x32_bf16 a[72:75], a[228:231], v[116:119], a[72:75]
ds_read_b64_tr_b16 a[254:255], v8 offset:44032
s_waitcnt lgkmcnt(8)
v_mfma_f32_16x16x32_bf16 a[76:79], a[224:227], v[120:123], a[76:79]
ds_read_b64_tr_b16 a[192:193], v5 offset:26624
v_cvt_pk_bf16_f32 v83, v138, v139
v_mfma_f32_16x16x32_bf16 a[76:79], a[228:231], v[124:127], a[76:79]
buffer_load_dwordx4 v19, s[8:11], s34 offen offset:3328 nt lds
v_mfma_f32_16x16x32_bf16 a[80:83], a[232:235], v[96:99], a[80:83]
ds_read_b64_tr_b16 a[194:195], v5 offset:32768
v_mfma_f32_16x16x32_bf16 a[80:83], a[236:239], v[100:103], a[80:83]
v_exp_f32 v88, v88
v_mfma_f32_16x16x32_bf16 a[84:87], a[232:235], v[104:107], a[84:87]
ds_read_b64_tr_b16 a[196:197], v5 offset:38912
v_mfma_f32_16x16x32_bf16 a[84:87], a[236:239], v[108:111], a[84:87]
v_mfma_f32_16x16x32_bf16 a[88:91], a[232:235], v[112:115], a[88:91]
ds_read_b64_tr_b16 a[198:199], v5 offset:45056
s_add_u32 s34, s34, 24576
v_mfma_f32_16x16x32_bf16 a[88:91], a[236:239], v[116:119], a[88:91]
ds_read_b64_tr_b16 a[200:201], v6 offset:26624
s_waitcnt lgkmcnt(9)
v_mfma_f32_16x16x32_bf16 a[92:95], a[232:235], v[120:123], a[92:95]
v_mfma_f32_16x16x32_bf16 a[92:95], a[236:239], v[124:127], a[92:95]
v_exp_f32 v89, v89
v_mfma_f32_16x16x32_bf16 a[96:99], a[240:243], v[96:99], a[96:99]
ds_read_b64_tr_b16 a[202:203], v6 offset:32768
v_cvt_pk_bf16_f32 v88, v88, v89
v_mfma_f32_16x16x32_bf16 a[96:99], a[244:247], v[100:103], a[96:99]
ds_read_b64_tr_b16 a[204:205], v6 offset:38912
s_getreg_b32 s80, hwreg(HW_REG_IB_STS, 0, 4)
v_mfma_f32_16x16x32_bf16 a[100:103], a[240:243], v[104:107], a[100:103]
v_mfma_f32_16x16x32_bf16 a[100:103], a[244:247], v[108:111], a[100:103]
ds_read_b64_tr_b16 a[206:207], v6 offset:45056
v_mfma_f32_16x16x32_bf16 a[104:107], a[240:243], v[112:115], a[104:107]
v_exp_f32 v90, v90
v_mfma_f32_16x16x32_bf16 a[104:107], a[244:247], v[116:119], a[104:107]
ds_read_b64_tr_b16 a[208:209], v7 offset:26624
s_waitcnt lgkmcnt(9)
v_mfma_f32_16x16x32_bf16 a[108:111], a[240:243], v[120:123], a[108:111]
v_mfma_f32_16x16x32_bf16 a[108:111], a[244:247], v[124:127], a[108:111]
ds_read_b64_tr_b16 a[210:211], v7 offset:32768
s_cmp_ge_u32 s80, 9
v_mfma_f32_16x16x32_bf16 a[112:115], a[248:251], v[96:99], a[112:115]
ds_read_b64_tr_b16 a[212:213], v7 offset:38912
v_mfma_f32_16x16x32_bf16 a[112:115], a[252:255], v[100:103], a[112:115]
v_mfma_f32_16x16x32_bf16 a[116:119], a[248:251], v[104:107], a[116:119]
v_exp_f32 v91, v91
v_mfma_f32_16x16x32_bf16 a[116:119], a[252:255], v[108:111], a[116:119]
ds_read_b64_tr_b16 a[214:215], v7 offset:45056
v_cvt_pk_bf16_f32 v89, v90, v91
v_mfma_f32_16x16x32_bf16 a[120:123], a[248:251], v[112:115], a[120:123]
ds_read_b64_tr_b16 a[216:217], v8 offset:26624
s_addc_u32 s3, s3, 0
v_mfma_f32_16x16x32_bf16 a[120:123], a[252:255], v[116:119], a[120:123]
s_waitcnt lgkmcnt(9)
ds_read_b64_tr_b16 a[218:219], v8 offset:32768
v_mfma_f32_16x16x32_bf16 a[124:127], a[248:251], v[120:123], a[124:127]
v_mfma_f32_16x16x32_bf16 a[124:127], a[252:255], v[124:127], a[124:127]
v_exp_f32 v140, v140
v_mfma_f32_16x16x32_bf16 a[128:131], a[192:195], v[96:99], a[128:131]
ds_read_b64_tr_b16 a[220:221], v8 offset:38912
v_mfma_f32_16x16x32_bf16 a[128:131], a[196:199], v[100:103], a[128:131]
v_mfma_f32_16x16x32_bf16 a[132:135], a[192:195], v[104:107], a[132:135]
ds_read_b64_tr_b16 a[222:223], v8 offset:45056
v_mfma_f32_16x16x32_bf16 a[132:135], a[196:199], v[108:111], a[132:135]
v_mfma_f32_16x16x32_bf16 a[136:139], a[192:195], v[112:115], a[136:139]
v_mfma_f32_16x16x32_bf16 a[136:139], a[196:199], v[116:119], a[136:139]
v_exp_f32 v141, v141
v_mfma_f32_16x16x32_bf16 a[140:143], a[192:195], v[120:123], a[140:143]
s_waitcnt lgkmcnt(8)
v_cvt_pk_bf16_f32 v90, v140, v141
v_mfma_f32_16x16x32_bf16 a[140:143], a[196:199], v[124:127], a[140:143]
v_mfma_f32_16x16x32_bf16 a[144:147], a[200:203], v[96:99], a[144:147]
v_mfma_f32_16x16x32_bf16 a[144:147], a[204:207], v[100:103], a[144:147]
v_mfma_f32_16x16x32_bf16 a[148:151], a[200:203], v[104:107], a[148:151]
v_mfma_f32_16x16x32_bf16 a[148:151], a[204:207], v[108:111], a[148:151]
s_add_u32 m0, s40, 57344
v_mfma_f32_16x16x32_bf16 a[152:155], a[200:203], v[112:115], a[152:155]
s_waitcnt vmcnt(13) lgkmcnt(0)
s_barrier
v_mfma_f32_16x16x32_bf16 a[152:155], a[204:207], v[116:119], a[152:155]
ds_read_b128 a[224:227], v3 offset:16384
v_mfma_f32_16x16x32_bf16 a[156:159], a[200:203], v[120:123], a[156:159]
buffer_load_dwordx4 v19, s[12:15], s35 offen offset:0 nt lds
v_mfma_f32_16x16x32_bf16 a[156:159], a[204:207], v[124:127], a[156:159]
ds_read_b128 a[228:231], v4 offset:16384
v_mfma_f32_16x16x32_bf16 a[160:163], a[208:211], v[96:99], a[160:163]
ds_read_b128 a[232:235], v3 offset:17408
v_mfma_f32_16x16x32_bf16 a[160:163], a[212:215], v[100:103], a[160:163]
ds_read_b128 a[236:239], v4 offset:17408
v_mfma_f32_16x16x32_bf16 a[164:167], a[208:211], v[104:107], a[164:167]
ds_read_b128 a[240:243], v3 offset:18432
v_mfma_f32_16x16x32_bf16 a[164:167], a[212:215], v[108:111], a[164:167]
ds_read_b128 a[244:247], v4 offset:18432
v_mfma_f32_16x16x32_bf16 a[168:171], a[208:211], v[112:115], a[168:171]
v_mfma_f32_16x16x32_bf16 a[168:171], a[212:215], v[116:119], a[168:171]
v_exp_f32 v142, v142
v_mfma_f32_16x16x32_bf16 a[172:175], a[208:211], v[120:123], a[172:175]
buffer_load_dwordx4 v19, s[12:15], s35 offen offset:3072 nt lds
v_mfma_f32_16x16x32_bf16 a[172:175], a[212:215], v[124:127], a[172:175]
v_mfma_f32_16x16x32_bf16 a[176:179], a[216:219], v[96:99], a[176:179]
v_mfma_f32_16x16x32_bf16 a[176:179], a[220:223], v[100:103], a[176:179]
v_exp_f32 v143, v143
v_mfma_f32_16x16x32_bf16 a[180:183], a[216:219], v[104:107], a[180:183]
v_mfma_f32_16x16x32_bf16 a[180:183], a[220:223], v[108:111], a[180:183]
v_mfma_f32_16x16x32_bf16 a[184:187], a[216:219], v[112:115], a[184:187]
v_cvt_pk_bf16_f32 v91, v142, v143
v_mfma_f32_16x16x32_bf16 a[184:187], a[220:223], v[116:119], a[184:187]
v_mfma_f32_16x16x32_bf16 a[188:191], a[216:219], v[120:123], a[188:191]
v_mfma_f32_16x16x32_bf16 a[188:191], a[220:223], v[124:127], a[188:191]
v_smfmac_f32_16x16x64_bf16 v[24:27], v[32:35], v[96:103], v17
v_smfmac_f32_16x16x64_bf16 v[24:27], v[36:39], v[104:111], v17
v_smfmac_f32_16x16x64_bf16 v[24:27], v[40:43], v[112:119], v17
s_waitcnt lgkmcnt(0)
v_smfmac_f32_16x16x64_bf16 v[24:27], v[44:47], v[120:127], v17
v_exp_f32 v68, v68
v_exp_f32 v69, v69
v_exp_f32 v70, v70
v_exp_f32 v71, v71
v_cvt_pk_bf16_f32 v68, v68, v69
v_exp_f32 v144, v144
v_exp_f32 v145, v145
v_cvt_pk_bf16_f32 v69, v70, v71
v_exp_f32 v146, v146
v_exp_f32 v147, v147
v_cvt_pk_bf16_f32 v70, v144, v145
v_exp_f32 v76, v76
v_exp_f32 v77, v77
v_cvt_pk_bf16_f32 v71, v146, v147
v_exp_f32 v78, v78
v_exp_f32 v79, v79
v_cvt_pk_bf16_f32 v76, v76, v77
v_exp_f32 v148, v148
v_exp_f32 v149, v149
v_cvt_pk_bf16_f32 v77, v78, v79
v_exp_f32 v150, v150
v_exp_f32 v151, v151
v_cvt_pk_bf16_f32 v78, v148, v149
v_exp_f32 v84, v84
v_exp_f32 v85, v85
v_cvt_pk_bf16_f32 v79, v150, v151
v_exp_f32 v86, v86
v_exp_f32 v87, v87
v_cvt_pk_bf16_f32 v84, v84, v85
v_exp_f32 v152, v152
v_exp_f32 v153, v153
v_cvt_pk_bf16_f32 v85, v86, v87
v_exp_f32 v154, v154
v_exp_f32 v155, v155
v_cvt_pk_bf16_f32 v86, v152, v153
s_nop 0
v_cvt_pk_bf16_f32 v87, v154, v155
v_mfma_f32_16x16x32_bf16 v[96:99], a[224:227], v[160:163], v[48:51]
v_exp_f32 v92, v92
v_mfma_f32_16x16x32_bf16 v[96:99], a[228:231], v[164:167], v[96:99]
ds_read_b128 a[248:251], v3 offset:22528
s_add_u32 m0, s40, 58240
v_mfma_f32_16x16x32_bf16 v[96:99], a[232:235], v[168:171], v[96:99]
v_mfma_f32_16x16x32_bf16 v[96:99], a[236:239], v[172:175], v[96:99]
ds_read_b128 a[252:255], v4 offset:22528
v_mfma_f32_16x16x32_bf16 v[96:99], a[240:243], v[176:179], v[96:99]
v_mfma_f32_16x16x32_bf16 v[96:99], a[244:247], v[180:183], v[96:99]
ds_read_b128 a[192:195], v3 offset:23552
v_mfma_f32_16x16x32_bf16 v[104:107], a[244:247], v[204:207], v[52:55]
v_mfma_f32_16x16x32_bf16 v[104:107], a[240:243], v[200:203], v[104:107]
buffer_load_dwordx4 v19, s[12:15], s35 offen offset:128 nt lds
v_mfma_f32_16x16x32_bf16 v[104:107], a[236:239], v[196:199], v[104:107]
ds_read_b128 a[196:199], v4 offset:23552
v_mfma_f32_16x16x32_bf16 v[104:107], a[232:235], v[192:195], v[104:107]
v_exp_f32 v93, v93
v_mfma_f32_16x16x32_bf16 v[104:107], a[228:231], v[188:191], v[104:107]
ds_read_b128 a[200:203], v3 offset:24576
v_cvt_pk_bf16_f32 v92, v92, v93
v_mfma_f32_16x16x32_bf16 v[104:107], a[224:227], v[184:187], v[104:107]
v_mfma_f32_16x16x32_bf16 v[112:115], a[224:227], v[208:211], v[56:59]
v_mfma_f32_16x16x32_bf16 v[112:115], a[228:231], v[212:215], v[112:115]
ds_read_b128 a[204:207], v4 offset:24576
v_mfma_f32_16x16x32_bf16 v[112:115], a[232:235], v[216:219], v[112:115]
v_mfma_f32_16x16x32_bf16 v[112:115], a[236:239], v[220:223], v[112:115]
v_mfma_f32_16x16x32_bf16 v[112:115], a[240:243], v[224:227], v[112:115]
v_mfma_f32_16x16x32_bf16 v[112:115], a[244:247], v[228:231], v[112:115]
v_mfma_f32_16x16x32_bf16 v[120:123], a[244:247], v[252:255], v[60:63]
v_exp_f32 v94, v94
v_mfma_f32_16x16x32_bf16 v[120:123], a[240:243], v[248:251], v[120:123]
v_mfma_f32_16x16x32_bf16 v[120:123], a[236:239], v[244:247], v[120:123]
buffer_load_dwordx4 v19, s[12:15], s35 offen offset:3200 nt lds
v_mfma_f32_16x16x32_bf16 v[120:123], a[232:235], v[240:243], v[120:123]
s_waitcnt lgkmcnt(0)
ds_read_b128 a[208:211], v3 offset:28672
v_mfma_f32_16x16x32_bf16 v[120:123], a[228:231], v[236:239], v[120:123]
v_mfma_f32_16x16x32_bf16 v[120:123], a[224:227], v[232:235], v[120:123]
v_mfma_f32_16x16x32_bf16 v[128:131], a[248:251], v[160:163], v[48:51]
v_mfma_f32_16x16x32_bf16 v[128:131], a[252:255], v[164:167], v[128:131]
v_mfma_f32_16x16x32_bf16 v[128:131], a[192:195], v[168:171], v[128:131]
v_mfma_f32_16x16x32_bf16 v[128:131], a[196:199], v[172:175], v[128:131]
ds_read_b128 a[212:215], v4 offset:28672
s_add_u32 m0, s40, 59136
v_mfma_f32_16x16x32_bf16 v[128:131], a[200:203], v[176:179], v[128:131]
v_exp_f32 v95, v95
v_mfma_f32_16x16x32_bf16 v[128:131], a[204:207], v[180:183], v[128:131]
ds_read_b128 a[216:219], v3 offset:29696
v_cvt_pk_bf16_f32 v93, v94, v95
v_mfma_f32_16x16x32_bf16 v[132:135], a[204:207], v[204:207], v[52:55]
v_mfma_f32_16x16x32_bf16 v[132:135], a[200:203], v[200:203], v[132:135]
v_mfma_f32_16x16x32_bf16 v[132:135], a[196:199], v[196:199], v[132:135]
ds_read_b128 a[220:223], v4 offset:29696
v_mfma_f32_16x16x32_bf16 v[132:135], a[192:195], v[192:195], v[132:135]
v_mfma_f32_16x16x32_bf16 v[132:135], a[252:255], v[188:191], v[132:135]
ds_read_b128 a[224:227], v3 offset:30720
v_mfma_f32_16x16x32_bf16 v[132:135], a[248:251], v[184:187], v[132:135]
v_mfma_f32_16x16x32_bf16 v[136:139], a[248:251], v[208:211], v[56:59]
v_exp_f32 v156, v156
v_mfma_f32_16x16x32_bf16 v[136:139], a[252:255], v[212:215], v[136:139]
ds_read_b128 a[228:231], v4 offset:30720
v_mfma_f32_16x16x32_bf16 v[136:139], a[192:195], v[216:219], v[136:139]
v_mfma_f32_16x16x32_bf16 v[136:139], a[196:199], v[220:223], v[136:139]
buffer_load_dwordx4 v19, s[12:15], s35 offen offset:256 nt lds
v_mfma_f32_16x16x32_bf16 v[136:139], a[200:203], v[224:227], v[136:139]
v_mfma_f32_16x16x32_bf16 v[136:139], a[204:207], v[228:231], v[136:139]
v_mfma_f32_16x16x32_bf16 v[140:143], a[204:207], v[252:255], v[60:63]
v_mfma_f32_16x16x32_bf16 v[140:143], a[200:203], v[248:251], v[140:143]
v_mfma_f32_16x16x32_bf16 v[140:143], a[196:199], v[244:247], v[140:143]
v_mfma_f32_16x16x32_bf16 v[140:143], a[192:195], v[240:243], v[140:143]
s_waitcnt lgkmcnt(0)
ds_read_b128 a[232:235], v3 offset:34816
v_mfma_f32_16x16x32_bf16 v[140:143], a[252:255], v[236:239], v[140:143]
v_exp_f32 v157, v157
v_mfma_f32_16x16x32_bf16 v[140:143], a[248:251], v[232:235], v[140:143]
v_cvt_pk_bf16_f32 v94, v156, v157
v_mfma_f32_16x16x32_bf16 v[100:103], a[208:211], v[160:163], v[48:51]
v_mfma_f32_16x16x32_bf16 v[100:103], a[212:215], v[164:167], v[100:103]
v_mfma_f32_16x16x32_bf16 v[100:103], a[216:219], v[168:171], v[100:103]
v_mfma_f32_16x16x32_bf16 v[100:103], a[220:223], v[172:175], v[100:103]
ds_read_b128 a[236:239], v4 offset:34816
v_mfma_f32_16x16x32_bf16 v[100:103], a[224:227], v[176:179], v[100:103]
buffer_load_dwordx4 v19, s[12:15], s35 offen offset:3328 nt lds
v_mfma_f32_16x16x32_bf16 v[100:103], a[228:231], v[180:183], v[100:103]
ds_read_b128 a[240:243], v3 offset:35840
v_mfma_f32_16x16x32_bf16 v[108:111], a[228:231], v[204:207], v[52:55]
v_mfma_f32_16x16x32_bf16 v[108:111], a[224:227], v[200:203], v[108:111]
v_exp_f32 v158, v158
v_mfma_f32_16x16x32_bf16 v[108:111], a[220:223], v[196:199], v[108:111]
ds_read_b128 a[244:247], v4 offset:35840
v_mfma_f32_16x16x32_bf16 v[108:111], a[216:219], v[192:195], v[108:111]
v_mfma_f32_16x16x32_bf16 v[108:111], a[212:215], v[188:191], v[108:111]
ds_read_b128 a[248:251], v3 offset:36864
s_add_u32 s35, s35, 24576
v_mfma_f32_16x16x32_bf16 v[108:111], a[208:211], v[184:187], v[108:111]
v_mfma_f32_16x16x32_bf16 v[116:119], a[208:211], v[208:211], v[56:59]
v_mfma_f32_16x16x32_bf16 v[116:119], a[212:215], v[212:215], v[116:119]
ds_read_b128 a[252:255], v4 offset:36864
v_mfma_f32_16x16x32_bf16 v[116:119], a[216:219], v[216:219], v[116:119]
v_mfma_f32_16x16x32_bf16 v[116:119], a[220:223], v[220:223], v[116:119]
v_mfma_f32_16x16x32_bf16 v[116:119], a[224:227], v[224:227], v[116:119]
v_exp_f32 v159, v159
v_mfma_f32_16x16x32_bf16 v[116:119], a[228:231], v[228:231], v[116:119]
v_cvt_pk_bf16_f32 v95, v158, v159
v_mfma_f32_16x16x32_bf16 v[124:127], a[228:231], v[252:255], v[60:63]
v_mfma_f32_16x16x32_bf16 v[124:127], a[224:227], v[248:251], v[124:127]
v_mfma_f32_16x16x32_bf16 v[124:127], a[220:223], v[244:247], v[124:127]
v_mfma_f32_16x16x32_bf16 v[124:127], a[216:219], v[240:243], v[124:127]
s_waitcnt lgkmcnt(0)
v_mfma_f32_16x16x32_bf16 v[124:127], a[212:215], v[236:239], v[124:127]
v_mfma_f32_16x16x32_bf16 v[124:127], a[208:211], v[232:235], v[124:127]
v_mfma_f32_16x16x32_bf16 v[144:147], a[232:235], v[160:163], v[48:51]
v_mfma_f32_16x16x32_bf16 v[144:147], a[236:239], v[164:167], v[144:147]
v_mfma_f32_16x16x32_bf16 v[144:147], a[240:243], v[168:171], v[144:147]
v_mfma_f32_16x16x32_bf16 v[144:147], a[244:247], v[172:175], v[144:147]
s_add_u32 m0, s40, 81920
v_mfma_f32_16x16x32_bf16 v[144:147], a[248:251], v[176:179], v[144:147]
s_waitcnt vmcnt(12) lgkmcnt(0)
s_barrier
v_mfma_f32_16x16x32_bf16 v[144:147], a[252:255], v[180:183], v[144:147]
ds_read_b64_tr_b16 a[192:193], v9 offset:8192
v_mfma_f32_16x16x32_bf16 v[148:151], a[252:255], v[204:207], v[52:55]
buffer_load_dwordx4 v19, s[8:11], s34 offen offset:0 nt lds
v_mfma_f32_16x16x32_bf16 v[148:151], a[248:251], v[200:203], v[148:151]
ds_read_b64_tr_b16 a[194:195], v9 offset:14336
v_mfma_f32_16x16x32_bf16 v[148:151], a[244:247], v[196:199], v[148:151]
ds_read_b64_tr_b16 a[196:197], v9 offset:20480
v_mfma_f32_16x16x32_bf16 v[148:151], a[240:243], v[192:195], v[148:151]
v_mfma_f32_16x16x32_bf16 v[148:151], a[236:239], v[188:191], v[148:151]
ds_read_b64_tr_b16 a[198:199], v9 offset:26624
v_mfma_f32_16x16x32_bf16 v[148:151], a[232:235], v[184:187], v[148:151]
v_mfma_f32_16x16x32_bf16 v[152:155], a[232:235], v[208:211], v[56:59]
ds_read_b64_tr_b16 a[200:201], v10 offset:8192
v_mfma_f32_16x16x32_bf16 v[152:155], a[236:239], v[212:215], v[152:155]
ds_read_b64_tr_b16 a[202:203], v10 offset:14336
v_mfma_f32_16x16x32_bf16 v[152:155], a[240:243], v[216:219], v[152:155]
buffer_load_dwordx4 v19, s[8:11], s34 offen offset:3072 nt lds
v_mfma_f32_16x16x32_bf16 v[152:155], a[244:247], v[220:223], v[152:155]
ds_read_b64_tr_b16 a[204:205], v10 offset:20480
v_mfma_f32_16x16x32_bf16 v[152:155], a[248:251], v[224:227], v[152:155]
v_mfma_f32_16x16x32_bf16 v[152:155], a[252:255], v[228:231], v[152:155]
ds_read_b64_tr_b16 a[206:207], v10 offset:26624
v_mfma_f32_16x16x32_bf16 v[156:159], a[252:255], v[252:255], v[60:63]
v_mfma_f32_16x16x32_bf16 v[156:159], a[248:251], v[248:251], v[156:159]
ds_read_b64_tr_b16 a[208:209], v11 offset:8192
v_mfma_f32_16x16x32_bf16 v[156:159], a[244:247], v[244:247], v[156:159]
v_mfma_f32_16x16x32_bf16 v[156:159], a[240:243], v[240:243], v[156:159]
ds_read_b64_tr_b16 a[210:211], v11 offset:14336
v_mfma_f32_16x16x32_bf16 v[156:159], a[236:239], v[236:239], v[156:159]
s_waitcnt lgkmcnt(6)
v_mfma_f32_16x16x32_bf16 v[156:159], a[232:235], v[232:235], v[156:159]
v_exp_f32 v96, v96
v_exp_f32 v97, v97
v_exp_f32 v98, v98
v_exp_f32 v99, v99
v_cvt_pk_bf16_f32 v96, v96, v97
v_exp_f32 v128, v128
v_exp_f32 v129, v129
v_cvt_pk_bf16_f32 v97, v98, v99
v_exp_f32 v130, v130
v_exp_f32 v131, v131
v_cvt_pk_bf16_f32 v98, v128, v129
v_exp_f32 v104, v104
v_exp_f32 v105, v105
v_cvt_pk_bf16_f32 v99, v130, v131
v_exp_f32 v106, v106
v_exp_f32 v107, v107
v_cvt_pk_bf16_f32 v104, v104, v105
v_exp_f32 v132, v132
v_exp_f32 v133, v133
v_cvt_pk_bf16_f32 v105, v106, v107
v_exp_f32 v134, v134
v_exp_f32 v135, v135
v_cvt_pk_bf16_f32 v106, v132, v133
s_nop 0
v_cvt_pk_bf16_f32 v107, v134, v135
v_mfma_f32_16x16x32_bf16 a[0:3], a[192:195], v[64:67], a[0:3]
ds_read_b64_tr_b16 a[212:213], v11 offset:20480
v_mfma_f32_16x16x32_bf16 a[0:3], a[196:199], v[68:71], a[0:3]
v_exp_f32 v112, v112
v_mfma_f32_16x16x32_bf16 a[4:7], a[192:195], v[72:75], a[4:7]
ds_read_b64_tr_b16 a[214:215], v11 offset:26624
s_add_u32 m0, s40, 82816
v_mfma_f32_16x16x32_bf16 a[4:7], a[196:199], v[76:79], a[4:7]
ds_read_b64_tr_b16 a[216:217], v12 offset:8192
v_mfma_f32_16x16x32_bf16 a[8:11], a[192:195], v[80:83], a[8:11]
v_exp_f32 v113, v113
v_mfma_f32_16x16x32_bf16 a[8:11], a[196:199], v[84:87], a[8:11]
ds_read_b64_tr_b16 a[218:219], v12 offset:14336
s_waitcnt lgkmcnt(6)
v_mfma_f32_16x16x32_bf16 a[12:15], a[192:195], v[88:91], a[12:15]
buffer_load_dwordx4 v19, s[8:11], s34 offen offset:128 nt lds
v_mfma_f32_16x16x32_bf16 a[12:15], a[196:199], v[92:95], a[12:15]
ds_read_b64_tr_b16 a[220:221], v12 offset:20480
v_cvt_pk_bf16_f32 v112, v112, v113
v_mfma_f32_16x16x32_bf16 a[16:19], a[200:203], v[64:67], a[16:19]
ds_read_b64_tr_b16 a[222:223], v12 offset:26624
v_mfma_f32_16x16x32_bf16 a[16:19], a[204:207], v[68:71], a[16:19]
v_exp_f32 v114, v114
v_mfma_f32_16x16x32_bf16 a[20:23], a[200:203], v[72:75], a[20:23]
ds_read_b64_tr_b16 a[224:225], v9 offset:9216
v_mfma_f32_16x16x32_bf16 a[20:23], a[204:207], v[76:79], a[20:23]
ds_read_b64_tr_b16 a[226:227], v9 offset:15360
v_mfma_f32_16x16x32_bf16 a[24:27], a[200:203], v[80:83], a[24:27]
ds_read_b64_tr_b16 a[228:229], v9 offset:21504
v_mfma_f32_16x16x32_bf16 a[24:27], a[204:207], v[84:87], a[24:27]
s_waitcnt lgkmcnt(7)
ds_read_b64_tr_b16 a[230:231], v9 offset:27648
v_mfma_f32_16x16x32_bf16 a[28:31], a[200:203], v[88:91], a[28:31]
buffer_load_dwordx4 v19, s[8:11], s34 offen offset:3200 nt lds
v_mfma_f32_16x16x32_bf16 a[28:31], a[204:207], v[92:95], a[28:31]
v_exp_f32 v115, v115
v_mfma_f32_16x16x32_bf16 a[32:35], a[208:211], v[64:67], a[32:35]
ds_read_b64_tr_b16 a[232:233], v10 offset:9216
v_cvt_pk_bf16_f32 v113, v114, v115
v_mfma_f32_16x16x32_bf16 a[32:35], a[212:215], v[68:71], a[32:35]
v_mfma_f32_16x16x32_bf16 a[36:39], a[208:211], v[72:75], a[36:39]
ds_read_b64_tr_b16 a[234:235], v10 offset:15360
v_mfma_f32_16x16x32_bf16 a[36:39], a[212:215], v[76:79], a[36:39]
v_exp_f32 v136, v136
v_mfma_f32_16x16x32_bf16 a[40:43], a[208:211], v[80:83], a[40:43]
ds_read_b64_tr_b16 a[236:237], v10 offset:21504
s_add_u32 m0, s40, 83712
v_mfma_f32_16x16x32_bf16 a[40:43], a[212:215], v[84:87], a[40:43]
ds_read_b64_tr_b16 a[238:239], v10 offset:27648
s_waitcnt lgkmcnt(8)
v_mfma_f32_16x16x32_bf16 a[44:47], a[208:211], v[88:91], a[44:47]
v_mfma_f32_16x16x32_bf16 a[44:47], a[212:215], v[92:95], a[44:47]
ds_read_b64_tr_b16 a[240:241], v11 offset:9216
v_mfma_f32_16x16x32_bf16 a[48:51], a[216:219], v[64:67], a[48:51]
v_mfma_f32_16x16x32_bf16 a[48:51], a[220:223], v[68:71], a[48:51]
v_exp_f32 v137, v137
v_mfma_f32_16x16x32_bf16 a[52:55], a[216:219], v[72:75], a[52:55]
ds_read_b64_tr_b16 a[242:243], v11 offset:15360
v_cvt_pk_bf16_f32 v114, v136, v137
v_mfma_f32_16x16x32_bf16 a[52:55], a[220:223], v[76:79], a[52:55]
ds_read_b64_tr_b16 a[244:245], v11 offset:21504
v_mfma_f32_16x16x32_bf16 a[56:59], a[216:219], v[80:83], a[56:59]
v_mfma_f32_16x16x32_bf16 a[56:59], a[220:223], v[84:87], a[56:59]
ds_read_b64_tr_b16 a[246:247], v11 offset:27648
s_waitcnt lgkmcnt(8)
v_mfma_f32_16x16x32_bf16 a[60:63], a[216:219], v[88:91], a[60:63]
buffer_load_dwordx4 v19, s[8:11], s34 offen offset:256 nt lds
v_mfma_f32_16x16x32_bf16 a[60:63], a[220:223], v[92:95], a[60:63]
v_exp_f32 v138, v138
v_mfma_f32_16x16x32_bf16 a[64:67], a[224:227], v[64:67], a[64:67]
ds_read_b64_tr_b16 a[248:249], v12 offset:9216
v_mfma_f32_16x16x32_bf16 a[64:67], a[228:231], v[68:71], a[64:67]
ds_read_b64_tr_b16 a[250:251], v12 offset:15360
v_mfma_f32_16x16x32_bf16 a[68:71], a[224:227], v[72:75], a[68:71]
ds_read_b64_tr_b16 a[252:253], v12 offset:21504
v_mfma_f32_16x16x32_bf16 a[68:71], a[228:231], v[76:79], a[68:71]
v_mfma_f32_16x16x32_bf16 a[72:75], a[224:227], v[80:83], a[72:75]
v_exp_f32 v139, v139
v_mfma_f32_16x16x32_bf16 a[72:75], a[228:231], v[84:87], a[72:75]
ds_read_b64_tr_b16 a[254:255], v12 offset:27648
s_waitcnt lgkmcnt(8)
v_mfma_f32_16x16x32_bf16 a[76:79], a[224:227], v[88:91], a[76:79]
ds_read_b64_tr_b16 a[192:193], v9 offset:10240
v_cvt_pk_bf16_f32 v115, v138, v139
v_mfma_f32_16x16x32_bf16 a[76:79], a[228:231], v[92:95], a[76:79]
buffer_load_dwordx4 v19, s[8:11], s34 offen offset:3328 nt lds
v_mfma_f32_16x16x32_bf16 a[80:83], a[232:235], v[64:67], a[80:83]
ds_read_b64_tr_b16 a[194:195], v9 offset:16384
v_mfma_f32_16x16x32_bf16 a[80:83], a[236:239], v[68:71], a[80:83]
v_exp_f32 v120, v120
v_mfma_f32_16x16x32_bf16 a[84:87], a[232:235], v[72:75], a[84:87]
ds_read_b64_tr_b16 a[196:197], v9 offset:22528
v_mfma_f32_16x16x32_bf16 a[84:87], a[236:239], v[76:79], a[84:87]
v_mfma_f32_16x16x32_bf16 a[88:91], a[232:235], v[80:83], a[88:91]
ds_read_b64_tr_b16 a[198:199], v9 offset:28672
s_add_u32 s34, s34, 24576
v_mfma_f32_16x16x32_bf16 a[88:91], a[236:239], v[84:87], a[88:91]
ds_read_b64_tr_b16 a[200:201], v10 offset:10240
s_waitcnt lgkmcnt(9)
v_mfma_f32_16x16x32_bf16 a[92:95], a[232:235], v[88:91], a[92:95]
v_mfma_f32_16x16x32_bf16 a[92:95], a[236:239], v[92:95], a[92:95]
v_exp_f32 v121, v121
v_mfma_f32_16x16x32_bf16 a[96:99], a[240:243], v[64:67], a[96:99]
ds_read_b64_tr_b16 a[202:203], v10 offset:16384
v_cvt_pk_bf16_f32 v120, v120, v121
v_mfma_f32_16x16x32_bf16 a[96:99], a[244:247], v[68:71], a[96:99]
ds_read_b64_tr_b16 a[204:205], v10 offset:22528
s_getreg_b32 s80, hwreg(HW_REG_IB_STS, 0, 4)
v_mfma_f32_16x16x32_bf16 a[100:103], a[240:243], v[72:75], a[100:103]
v_mfma_f32_16x16x32_bf16 a[100:103], a[244:247], v[76:79], a[100:103]
ds_read_b64_tr_b16 a[206:207], v10 offset:28672
v_mfma_f32_16x16x32_bf16 a[104:107], a[240:243], v[80:83], a[104:107]
v_exp_f32 v122, v122
v_mfma_f32_16x16x32_bf16 a[104:107], a[244:247], v[84:87], a[104:107]
ds_read_b64_tr_b16 a[208:209], v11 offset:10240
s_waitcnt lgkmcnt(9)
v_mfma_f32_16x16x32_bf16 a[108:111], a[240:243], v[88:91], a[108:111]
v_mfma_f32_16x16x32_bf16 a[108:111], a[244:247], v[92:95], a[108:111]
ds_read_b64_tr_b16 a[210:211], v11 offset:16384
s_cmp_ge_u32 s80, 9
v_mfma_f32_16x16x32_bf16 a[112:115], a[248:251], v[64:67], a[112:115]
ds_read_b64_tr_b16 a[212:213], v11 offset:22528
v_mfma_f32_16x16x32_bf16 a[112:115], a[252:255], v[68:71], a[112:115]
v_mfma_f32_16x16x32_bf16 a[116:119], a[248:251], v[72:75], a[116:119]
v_exp_f32 v123, v123
v_mfma_f32_16x16x32_bf16 a[116:119], a[252:255], v[76:79], a[116:119]
ds_read_b64_tr_b16 a[214:215], v11 offset:28672
v_cvt_pk_bf16_f32 v121, v122, v123
v_mfma_f32_16x16x32_bf16 a[120:123], a[248:251], v[80:83], a[120:123]
ds_read_b64_tr_b16 a[216:217], v12 offset:10240
s_addc_u32 s3, s3, 0
v_mfma_f32_16x16x32_bf16 a[120:123], a[252:255], v[84:87], a[120:123]
s_waitcnt lgkmcnt(9)
ds_read_b64_tr_b16 a[218:219], v12 offset:16384
v_mfma_f32_16x16x32_bf16 a[124:127], a[248:251], v[88:91], a[124:127]
v_mfma_f32_16x16x32_bf16 a[124:127], a[252:255], v[92:95], a[124:127]
v_exp_f32 v140, v140
v_mfma_f32_16x16x32_bf16 a[128:131], a[192:195], v[64:67], a[128:131]
ds_read_b64_tr_b16 a[220:221], v12 offset:22528
v_mfma_f32_16x16x32_bf16 a[128:131], a[196:199], v[68:71], a[128:131]
v_mfma_f32_16x16x32_bf16 a[132:135], a[192:195], v[72:75], a[132:135]
ds_read_b64_tr_b16 a[222:223], v12 offset:28672
v_mfma_f32_16x16x32_bf16 a[132:135], a[196:199], v[76:79], a[132:135]
v_mfma_f32_16x16x32_bf16 a[136:139], a[192:195], v[80:83], a[136:139]
v_mfma_f32_16x16x32_bf16 a[136:139], a[196:199], v[84:87], a[136:139]
v_exp_f32 v141, v141
v_mfma_f32_16x16x32_bf16 a[140:143], a[192:195], v[88:91], a[140:143]
s_waitcnt lgkmcnt(8)
v_cvt_pk_bf16_f32 v122, v140, v141
v_mfma_f32_16x16x32_bf16 a[140:143], a[196:199], v[92:95], a[140:143]
v_mfma_f32_16x16x32_bf16 a[144:147], a[200:203], v[64:67], a[144:147]
v_mfma_f32_16x16x32_bf16 a[144:147], a[204:207], v[68:71], a[144:147]
v_mfma_f32_16x16x32_bf16 a[148:151], a[200:203], v[72:75], a[148:151]
v_mfma_f32_16x16x32_bf16 a[148:151], a[204:207], v[76:79], a[148:151]
s_add_u32 m0, s40, 106496
v_mfma_f32_16x16x32_bf16 a[152:155], a[200:203], v[80:83], a[152:155]
s_waitcnt vmcnt(12) lgkmcnt(0)
s_barrier
v_mfma_f32_16x16x32_bf16 a[152:155], a[204:207], v[84:87], a[152:155]
ds_read_b128 a[224:227], v1 offset:32768
v_mfma_f32_16x16x32_bf16 a[156:159], a[200:203], v[88:91], a[156:159]
buffer_load_dwordx4 v19, s[12:15], s35 offen offset:0 nt lds
v_mfma_f32_16x16x32_bf16 a[156:159], a[204:207], v[92:95], a[156:159]
ds_read_b128 a[228:231], v2 offset:32768
v_mfma_f32_16x16x32_bf16 a[160:163], a[208:211], v[64:67], a[160:163]
ds_read_b128 a[232:235], v1 offset:33792
v_mfma_f32_16x16x32_bf16 a[160:163], a[212:215], v[68:71], a[160:163]
ds_read_b128 a[236:239], v2 offset:33792
v_mfma_f32_16x16x32_bf16 a[164:167], a[208:211], v[72:75], a[164:167]
ds_read_b128 a[240:243], v1 offset:34816
v_mfma_f32_16x16x32_bf16 a[164:167], a[212:215], v[76:79], a[164:167]
ds_read_b128 a[244:247], v2 offset:34816
v_mfma_f32_16x16x32_bf16 a[168:171], a[208:211], v[80:83], a[168:171]
v_mfma_f32_16x16x32_bf16 a[168:171], a[212:215], v[84:87], a[168:171]
v_exp_f32 v142, v142
v_mfma_f32_16x16x32_bf16 a[172:175], a[208:211], v[88:91], a[172:175]
buffer_load_dwordx4 v19, s[12:15], s35 offen offset:3072 nt lds
v_mfma_f32_16x16x32_bf16 a[172:175], a[212:215], v[92:95], a[172:175]
v_mfma_f32_16x16x32_bf16 a[176:179], a[216:219], v[64:67], a[176:179]
v_mfma_f32_16x16x32_bf16 a[176:179], a[220:223], v[68:71], a[176:179]
v_exp_f32 v143, v143
v_mfma_f32_16x16x32_bf16 a[180:183], a[216:219], v[72:75], a[180:183]
v_mfma_f32_16x16x32_bf16 a[180:183], a[220:223], v[76:79], a[180:183]
v_mfma_f32_16x16x32_bf16 a[184:187], a[216:219], v[80:83], a[184:187]
s_add_u32 s39, s39, 1
v_cvt_pk_bf16_f32 v123, v142, v143
v_mfma_f32_16x16x32_bf16 a[184:187], a[220:223], v[84:87], a[184:187]
s_or_b32 s80, s1, 0x40
s_bitcmp0_b32 s80, s39
v_mfma_f32_16x16x32_bf16 a[188:191], a[216:219], v[88:91], a[188:191]
v_mfma_f32_16x16x32_bf16 a[188:191], a[220:223], v[92:95], a[188:191]
v_smfmac_f32_16x16x64_bf16 v[24:27], v[32:35], v[64:71], v17
v_smfmac_f32_16x16x64_bf16 v[24:27], v[36:39], v[72:79], v17
v_smfmac_f32_16x16x64_bf16 v[24:27], v[40:43], v[80:87], v17
s_waitcnt lgkmcnt(0)
v_smfmac_f32_16x16x64_bf16 v[24:27], v[44:47], v[88:95], v17
s_cbranch_scc1 K1_L
s_cmp_lg_u32 s39, 6
s_cbranch_scc1 K1_LA
s_cmp_lg_u32 s47, 0
s_cbranch_scc1 K1_LASTB
K1_LASTA:
v_mfma_f32_16x16x32_bf16 v[64:67], a[224:227], v[160:163], v[48:51]
v_exp_f32 v100, v100
v_mfma_f32_16x16x32_bf16 v[64:67], a[228:231], v[164:167], v[64:67]
ds_read_b128 a[248:251], v1 offset:38912
s_add_u32 m0, s40, 107392
v_mfma_f32_16x16x32_bf16 v[64:67], a[232:235], v[168:171], v[64:67]
v_exp_f32 v101, v101
v_mfma_f32_16x16x32_bf16 v[64:67], a[236:239], v[172:175], v[64:67]
ds_read_b128 a[252:255], v2 offset:38912
v_cvt_pk_bf16_f32 v100, v100, v101
v_mfma_f32_16x16x32_bf16 v[64:67], a[240:243], v[176:179], v[64:67]
v_exp_f32 v102, v102
v_mfma_f32_16x16x32_bf16 v[64:67], a[244:247], v[180:183], v[64:67]
buffer_load_dwordx4 v19, s[12:15], s35 offen offset:128 nt lds
v_mfma_f32_16x16x32_bf16 v[72:75], a[244:247], v[204:207], v[52:55]
ds_read_b128 a[192:195], v1 offset:39936
v_mfma_f32_16x16x32_bf16 v[72:75], a[240:243], v[200:203], v[72:75]
v_exp_f32 v103, v103
v_mfma_f32_16x16x32_bf16 v[72:75], a[236:239], v[196:199], v[72:75]
v_exp_f32 v144, v144
v_mfma_f32_16x16x32_bf16 v[72:75], a[232:235], v[192:195], v[72:75]
ds_read_b128 a[196:199], v2 offset:39936
v_cvt_pk_bf16_f32 v101, v102, v103
v_mfma_f32_16x16x32_bf16 v[72:75], a[228:231], v[188:191], v[72:75]
v_exp_f32 v145, v145
v_mfma_f32_16x16x32_bf16 v[72:75], a[224:227], v[184:187], v[72:75]
ds_read_b128 a[200:203], v1 offset:40960
v_cvt_pk_bf16_f32 v102, v144, v145
v_mfma_f32_16x16x32_bf16 v[80:83], a[224:227], v[208:211], v[56:59]
v_exp_f32 v146, v146
v_mfma_f32_16x16x32_bf16 v[80:83], a[228:231], v[212:215], v[80:83]
buffer_load_dwordx4 v19, s[12:15], s35 offen offset:3200 nt lds
v_mfma_f32_16x16x32_bf16 v[80:83], a[232:235], v[216:219], v[80:83]
ds_read_b128 a[204:207], v2 offset:40960
s_add_u32 m0, s40, 108288
v_mfma_f32_16x16x32_bf16 v[80:83], a[236:239], v[220:223], v[80:83]
v_exp_f32 v147, v147
v_mfma_f32_16x16x32_bf16 v[80:83], a[240:243], v[224:227], v[80:83]
v_exp_f32 v108, v108
v_mfma_f32_16x16x32_bf16 v[80:83], a[244:247], v[228:231], v[80:83]
v_cvt_pk_bf16_f32 v103, v146, v147
v_mfma_f32_16x16x32_bf16 v[88:91], a[244:247], v[252:255], v[60:63]
v_exp_f32 v109, v109
v_mfma_f32_16x16x32_bf16 v[88:91], a[240:243], v[248:251], v[88:91]
v_exp_f32 v110, v110
v_mfma_f32_16x16x32_bf16 v[88:91], a[236:239], v[244:247], v[88:91]
ds_read_b128 a[208:211], v1 offset:45056
v_cvt_pk_bf16_f32 v108, v108, v109
v_mfma_f32_16x16x32_bf16 v[88:91], a[232:235], v[240:243], v[88:91]
s_waitcnt lgkmcnt(1)
v_mfma_f32_16x16x32_bf16 v[88:91], a[228:231], v[236:239], v[88:91]
v_exp_f32 v111, v111
v_mfma_f32_16x16x32_bf16 v[88:91], a[224:227], v[232:235], v[88:91]
buffer_load_dwordx4 v19, s[12:15], s35 offen offset:256 nt lds
v_mfma_f32_16x16x32_bf16 v[128:131], a[248:251], v[160:163], v[48:51]
v_exp_f32 v148, v148
v_mfma_f32_16x16x32_bf16 v[128:131], a[252:255], v[164:167], v[128:131]
ds_read_b128 a[212:215], v2 offset:45056
v_cvt_pk_bf16_f32 v109, v110, v111
v_mfma_f32_16x16x32_bf16 v[128:131], a[192:195], v[168:171], v[128:131]
v_exp_f32 v149, v149
v_mfma_f32_16x16x32_bf16 v[128:131], a[196:199], v[172:175], v[128:131]
v_mfma_f32_16x16x32_bf16 v[128:131], a[200:203], v[176:179], v[128:131]
v_exp_f32 v150, v150
v_mfma_f32_16x16x32_bf16 v[128:131], a[204:207], v[180:183], v[128:131]
ds_read_b128 a[216:219], v1 offset:46080
v_cvt_pk_bf16_f32 v110, v148, v149
v_mfma_f32_16x16x32_bf16 v[132:135], a[204:207], v[204:207], v[52:55]
v_exp_f32 v151, v151
v_mfma_f32_16x16x32_bf16 v[132:135], a[200:203], v[200:203], v[132:135]
ds_read_b128 a[220:223], v2 offset:46080
v_cvt_pk_bf16_f32 v111, v150, v151
v_mfma_f32_16x16x32_bf16 v[132:135], a[196:199], v[196:199], v[132:135]
buffer_load_dwordx4 v19, s[12:15], s35 offen offset:3328 nt lds
v_mfma_f32_16x16x32_bf16 v[132:135], a[192:195], v[192:195], v[132:135]
v_exp_f32 v116, v116
v_mfma_f32_16x16x32_bf16 v[132:135], a[252:255], v[188:191], v[132:135]
ds_read_b128 a[224:227], v1 offset:47104
v_mfma_f32_16x16x32_bf16 v[132:135], a[248:251], v[184:187], v[132:135]
v_exp_f32 v117, v117
v_mfma_f32_16x16x32_bf16 v[136:139], a[248:251], v[208:211], v[56:59]
ds_read_b128 a[228:231], v2 offset:47104
v_cvt_pk_bf16_f32 v116, v116, v117
v_mfma_f32_16x16x32_bf16 v[136:139], a[252:255], v[212:215], v[136:139]
v_exp_f32 v118, v118
v_mfma_f32_16x16x32_bf16 v[136:139], a[192:195], v[216:219], v[136:139]
v_exp_f32 v119, v119
v_mfma_f32_16x16x32_bf16 v[136:139], a[196:199], v[220:223], v[136:139]
global_load_dword v30, v[28:29], off
v_mfma_f32_16x16x32_bf16 v[136:139], a[200:203], v[224:227], v[136:139]
v_exp_f32 v152, v152
v_mfma_f32_16x16x32_bf16 v[136:139], a[204:207], v[228:231], v[136:139]
s_cmp_ge_u32 s3, 2
v_cvt_pk_bf16_f32 v117, v118, v119
v_mfma_f32_16x16x32_bf16 v[140:143], a[204:207], v[252:255], v[60:63]
v_mfma_f32_16x16x32_bf16 v[140:143], a[200:203], v[248:251], v[140:143]
v_exp_f32 v153, v153
v_mfma_f32_16x16x32_bf16 v[140:143], a[196:199], v[244:247], v[140:143]
v_mfma_f32_16x16x32_bf16 v[140:143], a[192:195], v[240:243], v[140:143]
v_exp_f32 v154, v154
v_mfma_f32_16x16x32_bf16 v[140:143], a[252:255], v[236:239], v[140:143]
v_cvt_pk_bf16_f32 v118, v152, v153
s_waitcnt lgkmcnt(0)
v_mfma_f32_16x16x32_bf16 v[140:143], a[248:251], v[232:235], v[140:143]
v_exp_f32 v155, v155
v_mfma_f32_16x16x32_bf16 v[68:71], a[208:211], v[160:163], v[48:51]
ds_read_b128 a[232:235], v1 offset:51200
v_cvt_pk_bf16_f32 v119, v154, v155
v_mfma_f32_16x16x32_bf16 v[68:71], a[212:215], v[164:167], v[68:71]
v_exp_f32 v124, v124
v_mfma_f32_16x16x32_bf16 v[68:71], a[216:219], v[168:171], v[68:71]
ds_read_b128 a[236:239], v2 offset:51200
s_cselect_b32 s1, 63, 0
v_mfma_f32_16x16x32_bf16 v[68:71], a[220:223], v[172:175], v[68:71]
v_exp_f32 v125, v125
v_mfma_f32_16x16x32_bf16 v[68:71], a[224:227], v[176:179], v[68:71]
ds_read_b128 a[240:243], v1 offset:52224
v_cvt_pk_bf16_f32 v124, v124, v125
v_mfma_f32_16x16x32_bf16 v[68:71], a[228:231], v[180:183], v[68:71]
v_exp_f32 v126, v126
v_mfma_f32_16x16x32_bf16 v[76:79], a[228:231], v[204:207], v[52:55]
v_mfma_f32_16x16x32_bf16 v[76:79], a[224:227], v[200:203], v[76:79]
ds_read_b128 a[244:247], v2 offset:52224
s_add_u32 s20, s20, 6291456
v_mfma_f32_16x16x32_bf16 v[76:79], a[220:223], v[196:199], v[76:79]
v_exp_f32 v127, v127
v_mfma_f32_16x16x32_bf16 v[76:79], a[216:219], v[192:195], v[76:79]
v_exp_f32 v156, v156
v_mfma_f32_16x16x32_bf16 v[76:79], a[212:215], v[188:191], v[76:79]
ds_read_b128 a[248:251], v1 offset:53248
v_cvt_pk_bf16_f32 v125, v126, v127
v_mfma_f32_16x16x32_bf16 v[76:79], a[208:211], v[184:187], v[76:79]
v_exp_f32 v157, v157
v_mfma_f32_16x16x32_bf16 v[84:87], a[208:211], v[208:211], v[56:59]
ds_read_b128 a[252:255], v2 offset:53248
s_addc_u32 s21, s21, 0
v_mfma_f32_16x16x32_bf16 v[84:87], a[212:215], v[212:215], v[84:87]
v_exp_f32 v158, v158
v_mfma_f32_16x16x32_bf16 v[84:87], a[216:219], v[216:219], v[84:87]
s_add_u32 s22, s22, 6291456
v_cvt_pk_bf16_f32 v126, v156, v157
v_mfma_f32_16x16x32_bf16 v[84:87], a[220:223], v[220:223], v[84:87]
v_mfma_f32_16x16x32_bf16 v[84:87], a[224:227], v[224:227], v[84:87]
v_exp_f32 v159, v159
v_mfma_f32_16x16x32_bf16 v[84:87], a[228:231], v[228:231], v[84:87]
v_mfma_f32_16x16x32_bf16 v[92:95], a[228:231], v[252:255], v[60:63]
v_exp_f32 v64, v64
v_mfma_f32_16x16x32_bf16 v[92:95], a[224:227], v[248:251], v[92:95]
s_addc_u32 s23, s23, 0
v_cvt_pk_bf16_f32 v127, v158, v159
v_mfma_f32_16x16x32_bf16 v[92:95], a[220:223], v[244:247], v[92:95]
v_exp_f32 v65, v65
v_mfma_f32_16x16x32_bf16 v[92:95], a[216:219], v[240:243], v[92:95]
s_waitcnt lgkmcnt(0)
v_cvt_pk_bf16_f32 v64, v64, v65
v_mfma_f32_16x16x32_bf16 v[92:95], a[212:215], v[236:239], v[92:95]
v_exp_f32 v66, v66
v_mfma_f32_16x16x32_bf16 v[92:95], a[208:211], v[232:235], v[92:95]
v_mfma_f32_16x16x32_bf16 v[144:147], a[232:235], v[160:163], v[48:51]
v_exp_f32 v67, v67
v_mfma_f32_16x16x32_bf16 v[144:147], a[236:239], v[164:167], v[144:147]
v_mfma_f32_16x16x32_bf16 v[144:147], a[240:243], v[168:171], v[144:147]
v_exp_f32 v128, v128
v_mfma_f32_16x16x32_bf16 v[144:147], a[244:247], v[172:175], v[144:147]
s_mov_b32 s54, 368640
v_cvt_pk_bf16_f32 v65, v66, v67
v_mfma_f32_16x16x32_bf16 v[144:147], a[248:251], v[176:179], v[144:147]
s_waitcnt vmcnt(13) lgkmcnt(0)
s_barrier
v_mfma_f32_16x16x32_bf16 v[144:147], a[252:255], v[180:183], v[144:147]
ds_read_b64_tr_b16 a[192:193], v5 offset:24576
s_add_u32 m0, s40, 131072
v_mfma_f32_16x16x32_bf16 v[148:151], a[252:255], v[204:207], v[52:55]
buffer_load_dwordx4 v19, s[12:15], s54 offen offset:0 nt lds
v_mfma_f32_16x16x32_bf16 v[148:151], a[248:251], v[200:203], v[148:151]
ds_read_b64_tr_b16 a[194:195], v5 offset:30720
v_mfma_f32_16x16x32_bf16 v[148:151], a[244:247], v[196:199], v[148:151]
ds_read_b64_tr_b16 a[196:197], v5 offset:36864
v_mfma_f32_16x16x32_bf16 v[148:151], a[240:243], v[192:195], v[148:151]
ds_read_b64_tr_b16 a[198:199], v5 offset:43008
v_mfma_f32_16x16x32_bf16 v[148:151], a[236:239], v[188:191], v[148:151]
v_mfma_f32_16x16x32_bf16 v[148:151], a[232:235], v[184:187], v[148:151]
ds_read_b64_tr_b16 a[200:201], v6 offset:24576
v_mfma_f32_16x16x32_bf16 v[152:155], a[232:235], v[208:211], v[56:59]
ds_read_b64_tr_b16 a[202:203], v6 offset:30720
v_mfma_f32_16x16x32_bf16 v[152:155], a[236:239], v[212:215], v[152:155]
buffer_load_dwordx4 v19, s[12:15], s54 offen offset:3072 nt lds
v_mfma_f32_16x16x32_bf16 v[152:155], a[240:243], v[216:219], v[152:155]
v_exp_f32 v129, v129
v_mfma_f32_16x16x32_bf16 v[152:155], a[244:247], v[220:223], v[152:155]
ds_read_b64_tr_b16 a[204:205], v6 offset:36864
v_cvt_pk_bf16_f32 v66, v128, v129
v_mfma_f32_16x16x32_bf16 v[152:155], a[248:251], v[224:227], v[152:155]
v_exp_f32 v130, v130
v_mfma_f32_16x16x32_bf16 v[152:155], a[252:255], v[228:231], v[152:155]
ds_read_b64_tr_b16 a[206:207], v6 offset:43008
v_mfma_f32_16x16x32_bf16 v[156:159], a[252:255], v[252:255], v[60:63]
v_exp_f32 v131, v131
v_mfma_f32_16x16x32_bf16 v[156:159], a[248:251], v[248:251], v[156:159]
ds_read_b64_tr_b16 a[208:209], v7 offset:24576
v_cvt_pk_bf16_f32 v67, v130, v131
v_mfma_f32_16x16x32_bf16 v[156:159], a[244:247], v[244:247], v[156:159]
ds_read_b64_tr_b16 a[210:211], v7 offset:30720
v_mfma_f32_16x16x32_bf16 v[156:159], a[240:243], v[240:243], v[156:159]
v_mfma_f32_16x16x32_bf16 v[156:159], a[236:239], v[236:239], v[156:159]
s_waitcnt lgkmcnt(6)
v_mfma_f32_16x16x32_bf16 v[156:159], a[232:235], v[232:235], v[156:159]
v_mfma_f32_16x16x32_bf16 a[0:3], a[192:195], v[96:99], a[0:3]
ds_read_b64_tr_b16 a[212:213], v7 offset:36864
v_mfma_f32_16x16x32_bf16 a[0:3], a[196:199], v[100:103], a[0:3]
v_exp_f32 v72, v72
v_mfma_f32_16x16x32_bf16 a[4:7], a[192:195], v[104:107], a[4:7]
ds_read_b64_tr_b16 a[214:215], v7 offset:43008
s_add_u32 m0, s40, 131968
v_mfma_f32_16x16x32_bf16 a[4:7], a[196:199], v[108:111], a[4:7]
v_exp_f32 v73, v73
v_mfma_f32_16x16x32_bf16 a[8:11], a[192:195], v[112:115], a[8:11]
ds_read_b64_tr_b16 a[216:217], v8 offset:24576
v_cvt_pk_bf16_f32 v72, v72, v73
v_mfma_f32_16x16x32_bf16 a[8:11], a[196:199], v[116:119], a[8:11]
v_exp_f32 v74, v74
v_mfma_f32_16x16x32_bf16 a[12:15], a[192:195], v[120:123], a[12:15]
ds_read_b64_tr_b16 a[218:219], v8 offset:30720
s_waitcnt lgkmcnt(6)
v_mfma_f32_16x16x32_bf16 a[12:15], a[196:199], v[124:127], a[12:15]
v_exp_f32 v75, v75
v_mfma_f32_16x16x32_bf16 a[16:19], a[200:203], v[96:99], a[16:19]
buffer_load_dwordx4 v19, s[12:15], s54 offen offset:128 nt lds
v_mfma_f32_16x16x32_bf16 a[16:19], a[204:207], v[100:103], a[16:19]
ds_read_b64_tr_b16 a[220:221], v8 offset:36864
v_cvt_pk_bf16_f32 v73, v74, v75
v_mfma_f32_16x16x32_bf16 a[20:23], a[200:203], v[104:107], a[20:23]
v_exp_f32 v132, v132
v_mfma_f32_16x16x32_bf16 a[20:23], a[204:207], v[108:111], a[20:23]
ds_read_b64_tr_b16 a[222:223], v8 offset:43008
v_mfma_f32_16x16x32_bf16 a[24:27], a[200:203], v[112:115], a[24:27]
v_exp_f32 v133, v133
v_mfma_f32_16x16x32_bf16 a[24:27], a[204:207], v[116:119], a[24:27]
ds_read_b64_tr_b16 a[224:225], v5 offset:25600
v_cvt_pk_bf16_f32 v74, v132, v133
v_mfma_f32_16x16x32_bf16 a[28:31], a[200:203], v[120:123], a[28:31]
ds_read_b64_tr_b16 a[226:227], v5 offset:31744
s_waitcnt lgkmcnt(6)
v_mfma_f32_16x16x32_bf16 a[28:31], a[204:207], v[124:127], a[28:31]
v_exp_f32 v134, v134
v_mfma_f32_16x16x32_bf16 a[32:35], a[208:211], v[96:99], a[32:35]
ds_read_b64_tr_b16 a[228:229], v5 offset:37888
v_mfma_f32_16x16x32_bf16 a[32:35], a[212:215], v[100:103], a[32:35]
v_exp_f32 v135, v135
v_mfma_f32_16x16x32_bf16 a[36:39], a[208:211], v[104:107], a[36:39]
ds_read_b64_tr_b16 a[230:231], v5 offset:44032
v_cvt_pk_bf16_f32 v75, v134, v135
v_mfma_f32_16x16x32_bf16 a[36:39], a[212:215], v[108:111], a[36:39]
v_exp_f32 v80, v80
v_mfma_f32_16x16x32_bf16 a[40:43], a[208:211], v[112:115], a[40:43]
ds_read_b64_tr_b16 a[232:233], v6 offset:25600
v_mfma_f32_16x16x32_bf16 a[40:43], a[212:215], v[116:119], a[40:43]
buffer_load_dwordx4 v19, s[12:15], s54 offen offset:3200 nt lds
v_mfma_f32_16x16x32_bf16 a[44:47], a[208:211], v[120:123], a[44:47]
v_exp_f32 v81, v81
v_mfma_f32_16x16x32_bf16 a[44:47], a[212:215], v[124:127], a[44:47]
s_waitcnt lgkmcnt(5)
v_cvt_pk_bf16_f32 v80, v80, v81
v_mfma_f32_16x16x32_bf16 a[48:51], a[216:219], v[96:99], a[48:51]
ds_read_b64_tr_b16 a[234:235], v6 offset:31744
s_add_u32 m0, s40, 132864
v_mfma_f32_16x16x32_bf16 a[48:51], a[220:223], v[100:103], a[48:51]
v_exp_f32 v82, v82
v_mfma_f32_16x16x32_bf16 a[52:55], a[216:219], v[104:107], a[52:55]
ds_read_b64_tr_b16 a[236:237], v6 offset:37888
v_mfma_f32_16x16x32_bf16 a[52:55], a[220:223], v[108:111], a[52:55]
ds_read_b64_tr_b16 a[238:239], v6 offset:44032
v_mfma_f32_16x16x32_bf16 a[56:59], a[216:219], v[112:115], a[56:59]
v_exp_f32 v83, v83
v_mfma_f32_16x16x32_bf16 a[56:59], a[220:223], v[116:119], a[56:59]
ds_read_b64_tr_b16 a[240:241], v7 offset:25600
v_cvt_pk_bf16_f32 v81, v82, v83
v_mfma_f32_16x16x32_bf16 a[60:63], a[216:219], v[120:123], a[60:63]
v_exp_f32 v136, v136
v_mfma_f32_16x16x32_bf16 a[60:63], a[220:223], v[124:127], a[60:63]
s_waitcnt lgkmcnt(5)
ds_read_b64_tr_b16 a[242:243], v7 offset:31744
v_mfma_f32_16x16x32_bf16 a[64:67], a[224:227], v[96:99], a[64:67]
v_exp_f32 v137, v137
v_mfma_f32_16x16x32_bf16 a[64:67], a[228:231], v[100:103], a[64:67]
ds_read_b64_tr_b16 a[244:245], v7 offset:37888
v_cvt_pk_bf16_f32 v82, v136, v137
v_mfma_f32_16x16x32_bf16 a[68:71], a[224:227], v[104:107], a[68:71]
v_exp_f32 v138, v138
v_mfma_f32_16x16x32_bf16 a[68:71], a[228:231], v[108:111], a[68:71]
ds_read_b64_tr_b16 a[246:247], v7 offset:44032
v_mfma_f32_16x16x32_bf16 a[72:75], a[224:227], v[112:115], a[72:75]
v_exp_f32 v139, v139
v_mfma_f32_16x16x32_bf16 a[72:75], a[228:231], v[116:119], a[72:75]
ds_read_b64_tr_b16 a[248:249], v8 offset:25600
v_cvt_pk_bf16_f32 v83, v138, v139
v_mfma_f32_16x16x32_bf16 a[76:79], a[224:227], v[120:123], a[76:79]
ds_read_b64_tr_b16 a[250:251], v8 offset:31744
s_waitcnt lgkmcnt(6)
v_mfma_f32_16x16x32_bf16 a[76:79], a[228:231], v[124:127], a[76:79]
v_exp_f32 v88, v88
v_mfma_f32_16x16x32_bf16 a[80:83], a[232:235], v[96:99], a[80:83]
buffer_load_dwordx4 v19, s[12:15], s54 offen offset:256 nt lds
v_mfma_f32_16x16x32_bf16 a[80:83], a[236:239], v[100:103], a[80:83]
ds_read_b64_tr_b16 a[252:253], v8 offset:37888
v_mfma_f32_16x16x32_bf16 a[84:87], a[232:235], v[104:107], a[84:87]
v_exp_f32 v89, v89
v_mfma_f32_16x16x32_bf16 a[84:87], a[236:239], v[108:111], a[84:87]
ds_read_b64_tr_b16 a[254:255], v8 offset:44032
v_cvt_pk_bf16_f32 v88, v88, v89
v_mfma_f32_16x16x32_bf16 a[88:91], a[232:235], v[112:115], a[88:91]
v_exp_f32 v90, v90
v_mfma_f32_16x16x32_bf16 a[88:91], a[236:239], v[116:119], a[88:91]
ds_read_b64_tr_b16 a[192:193], v5 offset:26624
s_waitcnt lgkmcnt(5)
v_mfma_f32_16x16x32_bf16 a[92:95], a[232:235], v[120:123], a[92:95]
v_exp_f32 v91, v91
v_mfma_f32_16x16x32_bf16 a[92:95], a[236:239], v[124:127], a[92:95]
ds_read_b64_tr_b16 a[194:195], v5 offset:32768
v_cvt_pk_bf16_f32 v89, v90, v91
v_mfma_f32_16x16x32_bf16 a[96:99], a[240:243], v[96:99], a[96:99]
v_exp_f32 v140, v140
v_mfma_f32_16x16x32_bf16 a[96:99], a[244:247], v[100:103], a[96:99]
ds_read_b64_tr_b16 a[196:197], v5 offset:38912
v_mfma_f32_16x16x32_bf16 a[100:103], a[240:243], v[104:107], a[100:103]
ds_read_b64_tr_b16 a[198:199], v5 offset:45056
v_mfma_f32_16x16x32_bf16 a[100:103], a[244:247], v[108:111], a[100:103]
v_exp_f32 v141, v141
v_mfma_f32_16x16x32_bf16 a[104:107], a[240:243], v[112:115], a[104:107]
ds_read_b64_tr_b16 a[200:201], v6 offset:26624
v_cvt_pk_bf16_f32 v90, v140, v141
v_mfma_f32_16x16x32_bf16 a[104:107], a[244:247], v[116:119], a[104:107]
buffer_load_dwordx4 v19, s[12:15], s54 offen offset:3328 nt lds
v_mfma_f32_16x16x32_bf16 a[108:111], a[240:243], v[120:123], a[108:111]
v_exp_f32 v142, v142
v_mfma_f32_16x16x32_bf16 a[108:111], a[244:247], v[124:127], a[108:111]
s_waitcnt lgkmcnt(5)
ds_read_b64_tr_b16 a[202:203], v6 offset:32768
v_mfma_f32_16x16x32_bf16 a[112:115], a[248:251], v[96:99], a[112:115]
v_exp_f32 v143, v143
v_mfma_f32_16x16x32_bf16 a[112:115], a[252:255], v[100:103], a[112:115]
ds_read_b64_tr_b16 a[204:205], v6 offset:38912
v_cvt_pk_bf16_f32 v91, v142, v143
v_mfma_f32_16x16x32_bf16 a[116:119], a[248:251], v[104:107], a[116:119]
v_exp_f32 v68, v68
v_mfma_f32_16x16x32_bf16 a[116:119], a[252:255], v[108:111], a[116:119]
ds_read_b64_tr_b16 a[206:207], v6 offset:45056
s_mov_b64 s[8:9], s[24:25]
v_mfma_f32_16x16x32_bf16 a[120:123], a[248:251], v[112:115], a[120:123]
v_exp_f32 v69, v69
v_mfma_f32_16x16x32_bf16 a[120:123], a[252:255], v[116:119], a[120:123]
ds_read_b64_tr_b16 a[208:209], v7 offset:26624
v_cvt_pk_bf16_f32 v68, v68, v69
v_mfma_f32_16x16x32_bf16 a[124:127], a[248:251], v[120:123], a[124:127]
ds_read_b64_tr_b16 a[210:211], v7 offset:32768
s_waitcnt lgkmcnt(6)
v_mfma_f32_16x16x32_bf16 a[124:127], a[252:255], v[124:127], a[124:127]
v_exp_f32 v70, v70
v_mfma_f32_16x16x32_bf16 a[128:131], a[192:195], v[96:99], a[128:131]
ds_read_b64_tr_b16 a[212:213], v7 offset:38912
s_mov_b32 s10, s26
v_mfma_f32_16x16x32_bf16 a[128:131], a[196:199], v[100:103], a[128:131]
v_exp_f32 v71, v71
v_mfma_f32_16x16x32_bf16 a[132:135], a[192:195], v[104:107], a[132:135]
ds_read_b64_tr_b16 a[214:215], v7 offset:45056
v_cvt_pk_bf16_f32 v69, v70, v71
v_mfma_f32_16x16x32_bf16 a[132:135], a[196:199], v[108:111], a[132:135]
v_exp_f32 v144, v144
v_mfma_f32_16x16x32_bf16 a[136:139], a[192:195], v[112:115], a[136:139]
ds_read_b64_tr_b16 a[216:217], v8 offset:26624
v_mfma_f32_16x16x32_bf16 a[136:139], a[196:199], v[116:119], a[136:139]
v_exp_f32 v145, v145
v_mfma_f32_16x16x32_bf16 a[140:143], a[192:195], v[120:123], a[140:143]
ds_read_b64_tr_b16 a[218:219], v8 offset:32768
s_waitcnt lgkmcnt(6)
v_mfma_f32_16x16x32_bf16 a[140:143], a[196:199], v[124:127], a[140:143]
ds_read_b64_tr_b16 a[220:221], v8 offset:38912
ds_read_b64_tr_b16 a[222:223], v8 offset:45056
v_mfma_f32_16x16x32_bf16 a[144:147], a[200:203], v[96:99], a[144:147]
v_exp_f32 v146, v146
v_mfma_f32_16x16x32_bf16 a[144:147], a[204:207], v[100:103], a[144:147]
v_exp_f32 v147, v147
v_mfma_f32_16x16x32_bf16 a[148:151], a[200:203], v[104:107], a[148:151]
v_exp_f32 v76, v76
v_mfma_f32_16x16x32_bf16 a[148:151], a[204:207], v[108:111], a[148:151]
v_exp_f32 v77, v77
v_mfma_f32_16x16x32_bf16 a[152:155], a[200:203], v[112:115], a[152:155]
s_waitcnt vmcnt(13) lgkmcnt(0)
s_barrier
v_mfma_f32_16x16x32_bf16 a[152:155], a[204:207], v[116:119], a[152:155]
ds_read_b128 a[224:227], v3 offset:16384
s_mov_b32 s54, 0
v_mfma_f32_16x16x32_bf16 a[156:159], a[200:203], v[120:123], a[156:159]
ds_read_b128 a[228:231], v4 offset:16384
s_add_u32 m0, s40, 32768
v_mfma_f32_16x16x32_bf16 a[156:159], a[204:207], v[124:127], a[156:159]
buffer_load_dwordx4 v20, s[8:11], s54 offen offset:0 lds
v_mfma_f32_16x16x32_bf16 a[160:163], a[208:211], v[96:99], a[160:163]
ds_read_b128 a[232:235], v3 offset:17408
v_mfma_f32_16x16x32_bf16 a[160:163], a[212:215], v[100:103], a[160:163]
ds_read_b128 a[236:239], v4 offset:17408
v_mfma_f32_16x16x32_bf16 a[164:167], a[208:211], v[104:107], a[164:167]
v_mfma_f32_16x16x32_bf16 a[164:167], a[212:215], v[108:111], a[164:167]
ds_read_b128 a[240:243], v3 offset:18432
v_mfma_f32_16x16x32_bf16 a[168:171], a[208:211], v[112:115], a[168:171]
ds_read_b128 a[244:247], v4 offset:18432
v_mfma_f32_16x16x32_bf16 a[168:171], a[212:215], v[116:119], a[168:171]
v_cvt_pk_bf16_f32 v70, v144, v145
v_cvt_pk_bf16_f32 v71, v146, v147
v_mfma_f32_16x16x32_bf16 a[172:175], a[208:211], v[120:123], a[172:175]
v_cvt_pk_bf16_f32 v76, v76, v77
v_mfma_f32_16x16x32_bf16 a[172:175], a[212:215], v[124:127], a[172:175]
v_exp_f32 v78, v78
v_mfma_f32_16x16x32_bf16 a[176:179], a[216:219], v[96:99], a[176:179]
v_exp_f32 v79, v79
v_mfma_f32_16x16x32_bf16 a[176:179], a[220:223], v[100:103], a[176:179]
v_exp_f32 v148, v148
v_mfma_f32_16x16x32_bf16 a[180:183], a[216:219], v[104:107], a[180:183]
buffer_load_dwordx4 v18, s[8:11], s54 offen offset:3072 lds
v_mfma_f32_16x16x32_bf16 a[180:183], a[220:223], v[108:111], a[180:183]
v_exp_f32 v149, v149
v_mfma_f32_16x16x32_bf16 a[184:187], a[216:219], v[112:115], a[184:187]
v_cvt_pk_bf16_f32 v77, v78, v79
v_cvt_pk_bf16_f32 v78, v148, v149
v_mfma_f32_16x16x32_bf16 a[184:187], a[220:223], v[116:119], a[184:187]
v_exp_f32 v150, v150
v_mfma_f32_16x16x32_bf16 a[188:191], a[216:219], v[120:123], a[188:191]
v_mfma_f32_16x16x32_bf16 a[188:191], a[220:223], v[124:127], a[188:191]
v_exp_f32 v151, v151
v_smfmac_f32_16x16x64_bf16 v[24:27], v[32:35], v[96:103], v17
v_cvt_pk_bf16_f32 v79, v150, v151
v_smfmac_f32_16x16x64_bf16 v[24:27], v[36:39], v[104:111], v17
v_smfmac_f32_16x16x64_bf16 v[24:27], v[40:43], v[112:119], v17
s_waitcnt lgkmcnt(0)
v_smfmac_f32_16x16x64_bf16 v[24:27], v[44:47], v[120:127], v17
v_mfma_f32_16x16x32_bf16 v[96:99], a[224:227], v[160:163], v[48:51]
v_exp_f32 v84, v84
v_mfma_f32_16x16x32_bf16 v[96:99], a[228:231], v[164:167], v[96:99]
ds_read_b128 a[248:251], v3 offset:22528
s_add_u32 m0, s40, 33664
v_mfma_f32_16x16x32_bf16 v[96:99], a[232:235], v[168:171], v[96:99]
v_exp_f32 v85, v85
v_mfma_f32_16x16x32_bf16 v[96:99], a[236:239], v[172:175], v[96:99]
buffer_load_dwordx4 v20, s[8:11], s54 offen offset:128 lds
v_mfma_f32_16x16x32_bf16 v[96:99], a[240:243], v[176:179], v[96:99]
ds_read_b128 a[252:255], v4 offset:22528
v_cvt_pk_bf16_f32 v84, v84, v85
v_mfma_f32_16x16x32_bf16 v[96:99], a[244:247], v[180:183], v[96:99]
v_exp_f32 v86, v86
v_mfma_f32_16x16x32_bf16 v[104:107], a[244:247], v[204:207], v[52:55]
ds_read_b128 a[192:195], v3 offset:23552
v_mfma_f32_16x16x32_bf16 v[104:107], a[240:243], v[200:203], v[104:107]
v_exp_f32 v87, v87
v_mfma_f32_16x16x32_bf16 v[104:107], a[236:239], v[196:199], v[104:107]
buffer_load_dwordx4 v18, s[8:11], s54 offen offset:3200 lds
v_mfma_f32_16x16x32_bf16 v[104:107], a[232:235], v[192:195], v[104:107]
ds_read_b128 a[196:199], v4 offset:23552
v_cvt_pk_bf16_f32 v85, v86, v87
v_mfma_f32_16x16x32_bf16 v[104:107], a[228:231], v[188:191], v[104:107]
v_exp_f32 v152, v152
v_mfma_f32_16x16x32_bf16 v[104:107], a[224:227], v[184:187], v[104:107]
v_exp_f32 v153, v153
v_mfma_f32_16x16x32_bf16 v[112:115], a[224:227], v[208:211], v[56:59]
ds_read_b128 a[200:203], v3 offset:24576
s_add_u32 m0, s40, 34560
v_mfma_f32_16x16x32_bf16 v[112:115], a[228:231], v[212:215], v[112:115]
ds_read_b128 a[204:207], v4 offset:24576
v_cvt_pk_bf16_f32 v86, v152, v153
v_mfma_f32_16x16x32_bf16 v[112:115], a[232:235], v[216:219], v[112:115]
v_exp_f32 v154, v154
v_mfma_f32_16x16x32_bf16 v[112:115], a[236:239], v[220:223], v[112:115]
buffer_load_dwordx4 v20, s[8:11], s54 offen offset:256 lds
v_mfma_f32_16x16x32_bf16 v[112:115], a[240:243], v[224:227], v[112:115]
v_exp_f32 v155, v155
v_mfma_f32_16x16x32_bf16 v[112:115], a[244:247], v[228:231], v[112:115]
v_cvt_pk_bf16_f32 v87, v154, v155
v_mfma_f32_16x16x32_bf16 v[120:123], a[244:247], v[252:255], v[60:63]
buffer_load_dwordx4 v18, s[8:11], s54 offen offset:3328 lds
v_mfma_f32_16x16x32_bf16 v[120:123], a[240:243], v[248:251], v[120:123]
v_exp_f32 v92, v92
v_mfma_f32_16x16x32_bf16 v[120:123], a[236:239], v[244:247], v[120:123]
v_exp_f32 v93, v93
v_mfma_f32_16x16x32_bf16 v[120:123], a[232:235], v[240:243], v[120:123]
s_add_u32 m0, s41, 0
v_cvt_pk_bf16_f32 v92, v92, v93
v_mfma_f32_16x16x32_bf16 v[120:123], a[228:231], v[236:239], v[120:123]
v_exp_f32 v94, v94
v_mfma_f32_16x16x32_bf16 v[120:123], a[224:227], v[232:235], v[120:123]
s_waitcnt lgkmcnt(0)
s_mov_b32 s46, 0
v_mfma_f32_16x16x32_bf16 v[128:131], a[248:251], v[160:163], v[48:51]
v_exp_f32 v95, v95
v_mfma_f32_16x16x32_bf16 v[128:131], a[252:255], v[164:167], v[128:131]
buffer_load_dwordx4 v21, s[4:7], s46 offen offset:0 lds
v_mfma_f32_16x16x32_bf16 v[128:131], a[192:195], v[168:171], v[128:131]
ds_read_b128 a[208:211], v3 offset:28672
v_cvt_pk_bf16_f32 v93, v94, v95
v_mfma_f32_16x16x32_bf16 v[128:131], a[196:199], v[172:175], v[128:131]
v_exp_f32 v156, v156
v_mfma_f32_16x16x32_bf16 v[128:131], a[200:203], v[176:179], v[128:131]
v_exp_f32 v157, v157
v_mfma_f32_16x16x32_bf16 v[128:131], a[204:207], v[180:183], v[128:131]
ds_read_b128 a[212:215], v4 offset:28672
v_cvt_pk_bf16_f32 v94, v156, v157
v_mfma_f32_16x16x32_bf16 v[132:135], a[204:207], v[204:207], v[52:55]
ds_read_b128 a[216:219], v3 offset:29696
s_mov_b32 s46, 9216
v_mfma_f32_16x16x32_bf16 v[132:135], a[200:203], v[200:203], v[132:135]
v_exp_f32 v158, v158
v_mfma_f32_16x16x32_bf16 v[132:135], a[196:199], v[196:199], v[132:135]
buffer_load_dwordx4 v21, s[4:7], s46 offen offset:1024 lds
v_mfma_f32_16x16x32_bf16 v[132:135], a[192:195], v[192:195], v[132:135]
v_exp_f32 v159, v159
v_mfma_f32_16x16x32_bf16 v[132:135], a[252:255], v[188:191], v[132:135]
ds_read_b128 a[220:223], v4 offset:29696
v_cvt_pk_bf16_f32 v95, v158, v159
v_mfma_f32_16x16x32_bf16 v[132:135], a[248:251], v[184:187], v[132:135]
v_exp_f32 v96, v96
v_mfma_f32_16x16x32_bf16 v[136:139], a[248:251], v[208:211], v[56:59]
ds_read_b128 a[224:227], v3 offset:30720
s_mov_b32 s46, 18432
v_mfma_f32_16x16x32_bf16 v[136:139], a[252:255], v[212:215], v[136:139]
v_exp_f32 v97, v97
v_mfma_f32_16x16x32_bf16 v[136:139], a[192:195], v[216:219], v[136:139]
ds_read_b128 a[228:231], v4 offset:30720
v_cvt_pk_bf16_f32 v96, v96, v97
v_mfma_f32_16x16x32_bf16 v[136:139], a[196:199], v[220:223], v[136:139]
buffer_load_dwordx4 v21, s[4:7], s46 offen offset:2048 lds
v_mfma_f32_16x16x32_bf16 v[136:139], a[200:203], v[224:227], v[136:139]
v_exp_f32 v98, v98
v_mfma_f32_16x16x32_bf16 v[136:139], a[204:207], v[228:231], v[136:139]
v_exp_f32 v99, v99
v_mfma_f32_16x16x32_bf16 v[140:143], a[204:207], v[252:255], v[60:63]
s_mov_b32 s46, 27648
v_cvt_pk_bf16_f32 v97, v98, v99
v_mfma_f32_16x16x32_bf16 v[140:143], a[200:203], v[248:251], v[140:143]
v_exp_f32 v128, v128
v_mfma_f32_16x16x32_bf16 v[140:143], a[196:199], v[244:247], v[140:143]
buffer_load_dwordx4 v21, s[4:7], s46 offen offset:3072 lds
v_mfma_f32_16x16x32_bf16 v[140:143], a[192:195], v[240:243], v[140:143]
v_exp_f32 v129, v129
v_mfma_f32_16x16x32_bf16 v[140:143], a[252:255], v[236:239], v[140:143]
v_exp_f32 v130, v130
v_mfma_f32_16x16x32_bf16 v[140:143], a[248:251], v[232:235], v[140:143]
s_waitcnt lgkmcnt(0)
v_cvt_pk_bf16_f32 v98, v128, v129
v_mfma_f32_16x16x32_bf16 v[100:103], a[208:211], v[160:163], v[48:51]
ds_read_b128 a[232:235], v3 offset:34816
s_add_u32 m0, s41, 4096
v_mfma_f32_16x16x32_bf16 v[100:103], a[212:215], v[164:167], v[100:103]
v_exp_f32 v131, v131
v_mfma_f32_16x16x32_bf16 v[100:103], a[216:219], v[168:171], v[100:103]
ds_read_b128 a[236:239], v4 offset:34816
s_mov_b32 s46, 40960
v_mfma_f32_16x16x32_bf16 v[100:103], a[220:223], v[172:175], v[100:103]
ds_read_b128 a[240:243], v3 offset:35840
v_cvt_pk_bf16_f32 v99, v130, v131
v_mfma_f32_16x16x32_bf16 v[100:103], a[224:227], v[176:179], v[100:103]
buffer_load_dwordx4 v21, s[4:7], s46 offen offset:0 lds
v_mfma_f32_16x16x32_bf16 v[100:103], a[228:231], v[180:183], v[100:103]
v_exp_f32 v104, v104
v_mfma_f32_16x16x32_bf16 v[108:111], a[228:231], v[204:207], v[52:55]
v_exp_f32 v105, v105
v_mfma_f32_16x16x32_bf16 v[108:111], a[224:227], v[200:203], v[108:111]
ds_read_b128 a[244:247], v4 offset:35840
v_cvt_pk_bf16_f32 v104, v104, v105
v_mfma_f32_16x16x32_bf16 v[108:111], a[220:223], v[196:199], v[108:111]
ds_read_b128 a[248:251], v3 offset:36864
s_mov_b32 s46, 50176
v_mfma_f32_16x16x32_bf16 v[108:111], a[216:219], v[192:195], v[108:111]
v_exp_f32 v106, v106
v_mfma_f32_16x16x32_bf16 v[108:111], a[212:215], v[188:191], v[108:111]
buffer_load_dwordx4 v21, s[4:7], s46 offen offset:1024 lds
v_mfma_f32_16x16x32_bf16 v[108:111], a[208:211], v[184:187], v[108:111]
v_exp_f32 v107, v107
v_mfma_f32_16x16x32_bf16 v[116:119], a[208:211], v[208:211], v[56:59]
ds_read_b128 a[252:255], v4 offset:36864
v_cvt_pk_bf16_f32 v105, v106, v107
v_mfma_f32_16x16x32_bf16 v[116:119], a[212:215], v[212:215], v[116:119]
v_exp_f32 v132, v132
v_mfma_f32_16x16x32_bf16 v[116:119], a[216:219], v[216:219], v[116:119]
s_mov_b32 s46, 59392
v_mfma_f32_16x16x32_bf16 v[116:119], a[220:223], v[220:223], v[116:119]
v_exp_f32 v133, v133
v_mfma_f32_16x16x32_bf16 v[116:119], a[224:227], v[224:227], v[116:119]
v_cvt_pk_bf16_f32 v106, v132, v133
v_mfma_f32_16x16x32_bf16 v[116:119], a[228:231], v[228:231], v[116:119]
buffer_load_dwordx4 v21, s[4:7], s46 offen offset:2048 lds
v_mfma_f32_16x16x32_bf16 v[124:127], a[228:231], v[252:255], v[60:63]
v_exp_f32 v134, v134
v_mfma_f32_16x16x32_bf16 v[124:127], a[224:227], v[248:251], v[124:127]
v_exp_f32 v135, v135
v_mfma_f32_16x16x32_bf16 v[124:127], a[220:223], v[244:247], v[124:127]
s_mov_b32 s46, 68608
v_cvt_pk_bf16_f32 v107, v134, v135
v_mfma_f32_16x16x32_bf16 v[124:127], a[216:219], v[240:243], v[124:127]
v_exp_f32 v112, v112
v_mfma_f32_16x16x32_bf16 v[124:127], a[212:215], v[236:239], v[124:127]
buffer_load_dwordx4 v21, s[4:7], s46 offen offset:3072 lds
v_mfma_f32_16x16x32_bf16 v[124:127], a[208:211], v[232:235], v[124:127]
s_waitcnt lgkmcnt(0)
v_mfma_f32_16x16x32_bf16 v[144:147], a[232:235], v[160:163], v[48:51]
v_exp_f32 v113, v113
v_mfma_f32_16x16x32_bf16 v[144:147], a[236:239], v[164:167], v[144:147]
s_mov_b32 s54, 786432
v_cvt_pk_bf16_f32 v112, v112, v113
v_mfma_f32_16x16x32_bf16 v[144:147], a[240:243], v[168:171], v[144:147]
v_exp_f32 v114, v114
v_mfma_f32_16x16x32_bf16 v[144:147], a[244:247], v[172:175], v[144:147]
v_exp_f32 v115, v115
v_mfma_f32_16x16x32_bf16 v[144:147], a[248:251], v[176:179], v[144:147]
s_waitcnt vmcnt(21) lgkmcnt(0)
s_barrier
v_mfma_f32_16x16x32_bf16 v[144:147], a[252:255], v[180:183], v[144:147]
ds_read_b64_tr_b16 a[192:193], v9 offset:8192
s_add_u32 m0, s40, 57344
v_mfma_f32_16x16x32_bf16 v[148:151], a[252:255], v[204:207], v[52:55]
buffer_load_dwordx4 v20, s[8:11], s54 offen offset:0 lds
v_mfma_f32_16x16x32_bf16 v[148:151], a[248:251], v[200:203], v[148:151]
ds_read_b64_tr_b16 a[194:195], v9 offset:14336
v_mfma_f32_16x16x32_bf16 v[148:151], a[244:247], v[196:199], v[148:151]
ds_read_b64_tr_b16 a[196:197], v9 offset:20480
v_mfma_f32_16x16x32_bf16 v[148:151], a[240:243], v[192:195], v[148:151]
v_mfma_f32_16x16x32_bf16 v[148:151], a[236:239], v[188:191], v[148:151]
ds_read_b64_tr_b16 a[198:199], v9 offset:26624
v_mfma_f32_16x16x32_bf16 v[148:151], a[232:235], v[184:187], v[148:151]
v_mfma_f32_16x16x32_bf16 v[152:155], a[232:235], v[208:211], v[56:59]
ds_read_b64_tr_b16 a[200:201], v10 offset:8192
v_mfma_f32_16x16x32_bf16 v[152:155], a[236:239], v[212:215], v[152:155]
ds_read_b64_tr_b16 a[202:203], v10 offset:14336
v_cvt_pk_bf16_f32 v113, v114, v115
v_mfma_f32_16x16x32_bf16 v[152:155], a[240:243], v[216:219], v[152:155]
v_exp_f32 v136, v136
v_mfma_f32_16x16x32_bf16 v[152:155], a[244:247], v[220:223], v[152:155]
buffer_load_dwordx4 v18, s[8:11], s54 offen offset:3072 lds
v_mfma_f32_16x16x32_bf16 v[152:155], a[248:251], v[224:227], v[152:155]
v_exp_f32 v137, v137
v_mfma_f32_16x16x32_bf16 v[152:155], a[252:255], v[228:231], v[152:155]
ds_read_b64_tr_b16 a[204:205], v10 offset:20480
v_cvt_pk_bf16_f32 v114, v136, v137
v_mfma_f32_16x16x32_bf16 v[156:159], a[252:255], v[252:255], v[60:63]
v_exp_f32 v138, v138
v_mfma_f32_16x16x32_bf16 v[156:159], a[248:251], v[248:251], v[156:159]
ds_read_b64_tr_b16 a[206:207], v10 offset:26624
v_mfma_f32_16x16x32_bf16 v[156:159], a[244:247], v[244:247], v[156:159]
v_exp_f32 v139, v139
v_mfma_f32_16x16x32_bf16 v[156:159], a[240:243], v[240:243], v[156:159]
ds_read_b64_tr_b16 a[208:209], v11 offset:8192
v_cvt_pk_bf16_f32 v115, v138, v139
v_mfma_f32_16x16x32_bf16 v[156:159], a[236:239], v[236:239], v[156:159]
ds_read_b64_tr_b16 a[210:211], v11 offset:14336
s_waitcnt lgkmcnt(6)
v_mfma_f32_16x16x32_bf16 v[156:159], a[232:235], v[232:235], v[156:159]
v_mfma_f32_16x16x32_bf16 a[0:3], a[192:195], v[64:67], a[0:3]
ds_read_b64_tr_b16 a[212:213], v11 offset:20480
v_mfma_f32_16x16x32_bf16 a[0:3], a[196:199], v[68:71], a[0:3]
v_exp_f32 v120, v120
v_mfma_f32_16x16x32_bf16 a[4:7], a[192:195], v[72:75], a[4:7]
ds_read_b64_tr_b16 a[214:215], v11 offset:26624
s_add_u32 m0, s40, 58240
v_mfma_f32_16x16x32_bf16 a[4:7], a[196:199], v[76:79], a[4:7]
v_exp_f32 v121, v121
v_mfma_f32_16x16x32_bf16 a[8:11], a[192:195], v[80:83], a[8:11]
ds_read_b64_tr_b16 a[216:217], v12 offset:8192
v_cvt_pk_bf16_f32 v120, v120, v121
v_mfma_f32_16x16x32_bf16 a[8:11], a[196:199], v[84:87], a[8:11]
v_exp_f32 v122, v122
v_mfma_f32_16x16x32_bf16 a[12:15], a[192:195], v[88:91], a[12:15]
buffer_load_dwordx4 v20, s[8:11], s54 offen offset:128 lds
v_mfma_f32_16x16x32_bf16 a[12:15], a[196:199], v[92:95], a[12:15]
s_waitcnt lgkmcnt(5)
ds_read_b64_tr_b16 a[218:219], v12 offset:14336
v_mfma_f32_16x16x32_bf16 a[16:19], a[200:203], v[64:67], a[16:19]
v_exp_f32 v123, v123
v_mfma_f32_16x16x32_bf16 a[16:19], a[204:207], v[68:71], a[16:19]
ds_read_b64_tr_b16 a[220:221], v12 offset:20480
v_cvt_pk_bf16_f32 v121, v122, v123
v_mfma_f32_16x16x32_bf16 a[20:23], a[200:203], v[72:75], a[20:23]
v_exp_f32 v140, v140
v_mfma_f32_16x16x32_bf16 a[20:23], a[204:207], v[76:79], a[20:23]
ds_read_b64_tr_b16 a[222:223], v12 offset:26624
v_mfma_f32_16x16x32_bf16 a[24:27], a[200:203], v[80:83], a[24:27]
v_exp_f32 v141, v141
v_mfma_f32_16x16x32_bf16 a[24:27], a[204:207], v[84:87], a[24:27]
ds_read_b64_tr_b16 a[224:225], v9 offset:9216
v_cvt_pk_bf16_f32 v122, v140, v141
v_mfma_f32_16x16x32_bf16 a[28:31], a[200:203], v[88:91], a[28:31]
ds_read_b64_tr_b16 a[226:227], v9 offset:15360
s_waitcnt lgkmcnt(6)
v_mfma_f32_16x16x32_bf16 a[28:31], a[204:207], v[92:95], a[28:31]
v_exp_f32 v142, v142
v_mfma_f32_16x16x32_bf16 a[32:35], a[208:211], v[64:67], a[32:35]
buffer_load_dwordx4 v18, s[8:11], s54 offen offset:3200 lds
v_mfma_f32_16x16x32_bf16 a[32:35], a[212:215], v[68:71], a[32:35]
ds_read_b64_tr_b16 a[228:229], v9 offset:21504
s_add_u32 m0, s40, 59136
v_mfma_f32_16x16x32_bf16 a[36:39], a[208:211], v[72:75], a[36:39]
v_exp_f32 v143, v143
v_mfma_f32_16x16x32_bf16 a[36:39], a[212:215], v[76:79], a[36:39]
ds_read_b64_tr_b16 a[230:231], v9 offset:27648
v_cvt_pk_bf16_f32 v123, v142, v143
v_mfma_f32_16x16x32_bf16 a[40:43], a[208:211], v[80:83], a[40:43]
v_exp_f32 v100, v100
v_mfma_f32_16x16x32_bf16 a[40:43], a[212:215], v[84:87], a[40:43]
ds_read_b64_tr_b16 a[232:233], v10 offset:9216
s_waitcnt lgkmcnt(5)
v_mfma_f32_16x16x32_bf16 a[44:47], a[208:211], v[88:91], a[44:47]
v_exp_f32 v101, v101
v_mfma_f32_16x16x32_bf16 a[44:47], a[212:215], v[92:95], a[44:47]
ds_read_b64_tr_b16 a[234:235], v10 offset:15360
v_cvt_pk_bf16_f32 v100, v100, v101
v_mfma_f32_16x16x32_bf16 a[48:51], a[216:219], v[64:67], a[48:51]
v_exp_f32 v102, v102
v_mfma_f32_16x16x32_bf16 a[48:51], a[220:223], v[68:71], a[48:51]
ds_read_b64_tr_b16 a[236:237], v10 offset:21504
v_mfma_f32_16x16x32_bf16 a[52:55], a[216:219], v[72:75], a[52:55]
ds_read_b64_tr_b16 a[238:239], v10 offset:27648
v_mfma_f32_16x16x32_bf16 a[52:55], a[220:223], v[76:79], a[52:55]
v_exp_f32 v103, v103
v_mfma_f32_16x16x32_bf16 a[56:59], a[216:219], v[80:83], a[56:59]
ds_read_b64_tr_b16 a[240:241], v11 offset:9216
v_cvt_pk_bf16_f32 v101, v102, v103
v_mfma_f32_16x16x32_bf16 a[56:59], a[220:223], v[84:87], a[56:59]
buffer_load_dwordx4 v20, s[8:11], s54 offen offset:256 lds
v_mfma_f32_16x16x32_bf16 a[60:63], a[216:219], v[88:91], a[60:63]
v_exp_f32 v144, v144
v_mfma_f32_16x16x32_bf16 a[60:63], a[220:223], v[92:95], a[60:63]
s_waitcnt lgkmcnt(5)
ds_read_b64_tr_b16 a[242:243], v11 offset:15360
v_mfma_f32_16x16x32_bf16 a[64:67], a[224:227], v[64:67], a[64:67]
v_exp_f32 v145, v145
v_mfma_f32_16x16x32_bf16 a[64:67], a[228:231], v[68:71], a[64:67]
ds_read_b64_tr_b16 a[244:245], v11 offset:21504
v_cvt_pk_bf16_f32 v102, v144, v145
v_mfma_f32_16x16x32_bf16 a[68:71], a[224:227], v[72:75], a[68:71]
v_exp_f32 v146, v146
v_mfma_f32_16x16x32_bf16 a[68:71], a[228:231], v[76:79], a[68:71]
ds_read_b64_tr_b16 a[246:247], v11 offset:27648
v_mfma_f32_16x16x32_bf16 a[72:75], a[224:227], v[80:83], a[72:75]
v_exp_f32 v147, v147
v_mfma_f32_16x16x32_bf16 a[72:75], a[228:231], v[84:87], a[72:75]
ds_read_b64_tr_b16 a[248:249], v12 offset:9216
v_cvt_pk_bf16_f32 v103, v146, v147
v_mfma_f32_16x16x32_bf16 a[76:79], a[224:227], v[88:91], a[76:79]
buffer_load_dwordx4 v18, s[8:11], s54 offen offset:3328 lds
v_mfma_f32_16x16x32_bf16 a[76:79], a[228:231], v[92:95], a[76:79]
s_waitcnt lgkmcnt(5)
ds_read_b64_tr_b16 a[250:251], v12 offset:15360
v_mfma_f32_16x16x32_bf16 a[80:83], a[232:235], v[64:67], a[80:83]
v_exp_f32 v108, v108
v_mfma_f32_16x16x32_bf16 a[80:83], a[236:239], v[68:71], a[80:83]
ds_read_b64_tr_b16 a[252:253], v12 offset:21504
v_add_u32 v248, s41, v22
v_mfma_f32_16x16x32_bf16 a[84:87], a[232:235], v[72:75], a[84:87]
v_exp_f32 v109, v109
v_mfma_f32_16x16x32_bf16 a[84:87], a[236:239], v[76:79], a[84:87]
ds_read_b64_tr_b16 a[254:255], v12 offset:27648
v_cvt_pk_bf16_f32 v108, v108, v109
v_mfma_f32_16x16x32_bf16 a[88:91], a[232:235], v[80:83], a[88:91]
v_exp_f32 v110, v110
v_mfma_f32_16x16x32_bf16 a[88:91], a[236:239], v[84:87], a[88:91]
ds_read_b64_tr_b16 a[192:193], v9 offset:10240
s_waitcnt lgkmcnt(5)
v_mfma_f32_16x16x32_bf16 a[92:95], a[232:235], v[88:91], a[92:95]
v_exp_f32 v111, v111
v_mfma_f32_16x16x32_bf16 a[92:95], a[236:239], v[92:95], a[92:95]
ds_read_b64_tr_b16 a[194:195], v9 offset:16384
v_cvt_pk_bf16_f32 v109, v110, v111
v_mfma_f32_16x16x32_bf16 a[96:99], a[240:243], v[64:67], a[96:99]
v_exp_f32 v148, v148
v_mfma_f32_16x16x32_bf16 a[96:99], a[244:247], v[68:71], a[96:99]
ds_read_b64_tr_b16 a[196:197], v9 offset:22528
v_mfma_f32_16x16x32_bf16 a[100:103], a[240:243], v[72:75], a[100:103]
ds_read_b64_tr_b16 a[198:199], v9 offset:28672
v_mfma_f32_16x16x32_bf16 a[100:103], a[244:247], v[76:79], a[100:103]
v_exp_f32 v149, v149
v_mfma_f32_16x16x32_bf16 a[104:107], a[240:243], v[80:83], a[104:107]
buffer_load_dwordx4 v[252:255], v248, s[60:63], 0 offen offset:0
v_mfma_f32_16x16x32_bf16 a[104:107], a[244:247], v[84:87], a[104:107]
ds_read_b64_tr_b16 a[200:201], v10 offset:10240
v_cvt_pk_bf16_f32 v110, v148, v149
v_mfma_f32_16x16x32_bf16 a[108:111], a[240:243], v[88:91], a[108:111]
v_exp_f32 v150, v150
v_mfma_f32_16x16x32_bf16 a[108:111], a[244:247], v[92:95], a[108:111]
s_waitcnt lgkmcnt(5)
ds_read_b64_tr_b16 a[202:203], v10 offset:16384
v_mfma_f32_16x16x32_bf16 a[112:115], a[248:251], v[64:67], a[112:115]
v_exp_f32 v151, v151
v_mfma_f32_16x16x32_bf16 a[112:115], a[252:255], v[68:71], a[112:115]
ds_read_b64_tr_b16 a[204:205], v10 offset:22528
v_cvt_pk_bf16_f32 v111, v150, v151
v_mfma_f32_16x16x32_bf16 a[116:119], a[248:251], v[72:75], a[116:119]
v_exp_f32 v116, v116
v_mfma_f32_16x16x32_bf16 a[116:119], a[252:255], v[76:79], a[116:119]
ds_read_b64_tr_b16 a[206:207], v10 offset:28672
v_mfma_f32_16x16x32_bf16 a[120:123], a[248:251], v[80:83], a[120:123]
v_exp_f32 v117, v117
v_mfma_f32_16x16x32_bf16 a[120:123], a[252:255], v[84:87], a[120:123]
ds_read_b64_tr_b16 a[208:209], v11 offset:10240
v_cvt_pk_bf16_f32 v116, v116, v117
v_mfma_f32_16x16x32_bf16 a[124:127], a[248:251], v[88:91], a[124:127]
buffer_load_dwordx4 v[252:255], v248, s[60:63], 0 offen offset:1024
v_mfma_f32_16x16x32_bf16 a[124:127], a[252:255], v[92:95], a[124:127]
s_waitcnt lgkmcnt(5)
ds_read_b64_tr_b16 a[210:211], v11 offset:16384
v_mfma_f32_16x16x32_bf16 a[128:131], a[192:195], v[64:67], a[128:131]
v_exp_f32 v118, v118
v_mfma_f32_16x16x32_bf16 a[128:131], a[196:199], v[68:71], a[128:131]
ds_read_b64_tr_b16 a[212:213], v11 offset:22528
v_mfma_f32_16x16x32_bf16 a[132:135], a[192:195], v[72:75], a[132:135]
v_exp_f32 v119, v119
v_mfma_f32_16x16x32_bf16 a[132:135], a[196:199], v[76:79], a[132:135]
ds_read_b64_tr_b16 a[214:215], v11 offset:28672
v_cvt_pk_bf16_f32 v117, v118, v119
v_mfma_f32_16x16x32_bf16 a[136:139], a[192:195], v[80:83], a[136:139]
v_exp_f32 v152, v152
v_mfma_f32_16x16x32_bf16 a[136:139], a[196:199], v[84:87], a[136:139]
ds_read_b64_tr_b16 a[216:217], v12 offset:10240
s_waitcnt lgkmcnt(5)
v_mfma_f32_16x16x32_bf16 a[140:143], a[192:195], v[88:91], a[140:143]
ds_read_b64_tr_b16 a[218:219], v12 offset:16384
v_mfma_f32_16x16x32_bf16 a[140:143], a[196:199], v[92:95], a[140:143]
buffer_load_dwordx4 v[252:255], v248, s[60:63], 0 offen offset:2048
ds_read_b64_tr_b16 a[220:221], v12 offset:22528
ds_read_b64_tr_b16 a[222:223], v12 offset:28672
v_mfma_f32_16x16x32_bf16 a[144:147], a[200:203], v[64:67], a[144:147]
v_exp_f32 v153, v153
v_mfma_f32_16x16x32_bf16 a[144:147], a[204:207], v[68:71], a[144:147]
v_exp_f32 v154, v154
v_mfma_f32_16x16x32_bf16 a[148:151], a[200:203], v[72:75], a[148:151]
v_exp_f32 v155, v155
v_mfma_f32_16x16x32_bf16 a[148:151], a[204:207], v[76:79], a[148:151]
v_exp_f32 v124, v124
v_mfma_f32_16x16x32_bf16 a[152:155], a[200:203], v[80:83], a[152:155]
s_waitcnt vmcnt(23) lgkmcnt(0)
s_barrier
v_mfma_f32_16x16x32_bf16 a[152:155], a[204:207], v[84:87], a[152:155]
ds_read_b64_tr_b16 a[224:225], v9 offset:32768
s_mov_b32 s54, 1572864
v_mfma_f32_16x16x32_bf16 a[156:159], a[200:203], v[88:91], a[156:159]
ds_read_b64_tr_b16 a[226:227], v9 offset:38912
s_add_u32 m0, s40, 81920
v_mfma_f32_16x16x32_bf16 a[156:159], a[204:207], v[92:95], a[156:159]
buffer_load_dwordx4 v20, s[8:11], s54 offen offset:0 lds
v_mfma_f32_16x16x32_bf16 a[160:163], a[208:211], v[64:67], a[160:163]
ds_read_b64_tr_b16 a[228:229], v9 offset:45056
v_mfma_f32_16x16x32_bf16 a[160:163], a[212:215], v[68:71], a[160:163]
ds_read_b64_tr_b16 a[230:231], v9 offset:51200
v_mfma_f32_16x16x32_bf16 a[164:167], a[208:211], v[72:75], a[164:167]
buffer_load_dwordx4 v18, s[8:11], s54 offen offset:3072 lds
v_mfma_f32_16x16x32_bf16 a[164:167], a[212:215], v[76:79], a[164:167]
ds_read_b64_tr_b16 a[232:233], v10 offset:32768
v_mfma_f32_16x16x32_bf16 a[168:171], a[208:211], v[80:83], a[168:171]
ds_read_b64_tr_b16 a[234:235], v10 offset:38912
v_mfma_f32_16x16x32_bf16 a[168:171], a[212:215], v[84:87], a[168:171]
ds_read_b64_tr_b16 a[236:237], v10 offset:45056
v_cvt_pk_bf16_f32 v118, v152, v153
v_mfma_f32_16x16x32_bf16 a[172:175], a[208:211], v[88:91], a[172:175]
ds_read_b64_tr_b16 a[238:239], v10 offset:51200
v_cvt_pk_bf16_f32 v119, v154, v155
v_mfma_f32_16x16x32_bf16 a[172:175], a[212:215], v[92:95], a[172:175]
v_exp_f32 v125, v125
v_mfma_f32_16x16x32_bf16 a[176:179], a[216:219], v[64:67], a[176:179]
ds_read_b64_tr_b16 a[240:241], v11 offset:32768
v_cvt_pk_bf16_f32 v124, v124, v125
v_mfma_f32_16x16x32_bf16 a[176:179], a[220:223], v[68:71], a[176:179]
v_exp_f32 v126, v126
v_mfma_f32_16x16x32_bf16 a[180:183], a[216:219], v[72:75], a[180:183]
v_exp_f32 v127, v127
v_mfma_f32_16x16x32_bf16 a[180:183], a[220:223], v[76:79], a[180:183]
buffer_load_dwordx4 v[252:255], v248, s[60:63], 0 offen offset:3072
v_mfma_f32_16x16x32_bf16 a[184:187], a[216:219], v[80:83], a[184:187]
v_exp_f32 v156, v156
v_mfma_f32_16x16x32_bf16 a[184:187], a[220:223], v[84:87], a[184:187]
v_exp_f32 v157, v157
v_mfma_f32_16x16x32_bf16 a[188:191], a[216:219], v[88:91], a[188:191]
v_exp_f32 v158, v158
v_mfma_f32_16x16x32_bf16 a[188:191], a[220:223], v[92:95], a[188:191]
buffer_load_dwordx4 v[252:255], v248, s[60:63], s55 offen offset:0
v_smfmac_f32_16x16x64_bf16 v[24:27], v[32:35], v[64:71], v17
ds_read_b64_tr_b16 a[242:243], v11 offset:38912
v_cvt_pk_bf16_f32 v125, v126, v127
v_smfmac_f32_16x16x64_bf16 v[24:27], v[36:39], v[72:79], v17
v_exp_f32 v159, v159
v_smfmac_f32_16x16x64_bf16 v[24:27], v[40:43], v[80:87], v17
buffer_load_dwordx4 v[252:255], v248, s[60:63], s55 offen offset:1024
v_smfmac_f32_16x16x64_bf16 v[24:27], v[44:47], v[88:95], v17
v_cvt_pk_bf16_f32 v126, v156, v157
v_cvt_pk_bf16_f32 v127, v158, v159
v_smfmac_f32_16x16x64_bf16 v[24:27], v[32:35], v[96:103], v17
v_smfmac_f32_16x16x64_bf16 v[24:27], v[36:39], v[104:111], v17
v_smfmac_f32_16x16x64_bf16 v[24:27], v[40:43], v[112:119], v17
s_waitcnt lgkmcnt(6)
v_smfmac_f32_16x16x64_bf16 v[24:27], v[44:47], v[120:127], v17
v_mfma_f32_16x16x32_bf16 a[0:3], a[224:227], v[96:99], a[0:3]
ds_read_b64_tr_b16 a[244:245], v11 offset:45056
v_mfma_f32_16x16x32_bf16 a[0:3], a[228:231], v[100:103], a[0:3]
ds_read_b64_tr_b16 a[246:247], v11 offset:51200
v_mfma_f32_16x16x32_bf16 a[4:7], a[224:227], v[104:107], a[4:7]
ds_read_b64_tr_b16 a[248:249], v12 offset:32768
v_mfma_f32_16x16x32_bf16 a[4:7], a[228:231], v[108:111], a[4:7]
ds_read_b64_tr_b16 a[250:251], v12 offset:38912
v_mfma_f32_16x16x32_bf16 a[8:11], a[224:227], v[112:115], a[8:11]
ds_read_b64_tr_b16 a[252:253], v12 offset:45056
v_mfma_f32_16x16x32_bf16 a[8:11], a[228:231], v[116:119], a[8:11]
ds_read_b64_tr_b16 a[254:255], v12 offset:51200
s_waitcnt lgkmcnt(8)
v_mfma_f32_16x16x32_bf16 a[12:15], a[224:227], v[120:123], a[12:15]
ds_read_b64_tr_b16 a[192:193], v9 offset:33792
v_mfma_f32_16x16x32_bf16 a[12:15], a[228:231], v[124:127], a[12:15]
ds_read_b64_tr_b16 a[194:195], v9 offset:39936
v_mfma_f32_16x16x32_bf16 a[16:19], a[232:235], v[96:99], a[16:19]
v_mov_b32 v168, v24
v_mov_b32 v169, v25
v_mfma_f32_16x16x32_bf16 a[16:19], a[236:239], v[100:103], a[16:19]
ds_read_b64_tr_b16 a[196:197], v9 offset:46080
v_mov_b32 v170, v26
v_mfma_f32_16x16x32_bf16 a[20:23], a[232:235], v[104:107], a[20:23]
ds_read_b64_tr_b16 a[198:199], v9 offset:52224
v_mov_b32 v171, v27
v_mfma_f32_16x16x32_bf16 a[20:23], a[236:239], v[108:111], a[20:23]
v_permlane16_swap_b32 v24, v168
v_permlane16_swap_b32 v25, v169
v_mfma_f32_16x16x32_bf16 a[24:27], a[232:235], v[112:115], a[24:27]
ds_read_b64_tr_b16 a[200:201], v10 offset:33792
v_permlane16_swap_b32 v26, v170
v_mfma_f32_16x16x32_bf16 a[24:27], a[236:239], v[116:119], a[24:27]
ds_read_b64_tr_b16 a[202:203], v10 offset:39936
v_permlane16_swap_b32 v27, v171
v_mfma_f32_16x16x32_bf16 a[28:31], a[232:235], v[120:123], a[28:31]
v_add_f32 v24, v24, v168
s_waitcnt lgkmcnt(10)
v_mfma_f32_16x16x32_bf16 a[28:31], a[236:239], v[124:127], a[28:31]
ds_read_b64_tr_b16 a[204:205], v10 offset:46080
v_add_f32 v25, v25, v169
v_mfma_f32_16x16x32_bf16 a[32:35], a[240:243], v[96:99], a[32:35]
ds_read_b64_tr_b16 a[206:207], v10 offset:52224
v_add_f32 v26, v26, v170
v_mfma_f32_16x16x32_bf16 a[32:35], a[244:247], v[100:103], a[32:35]
ds_read_b64_tr_b16 a[208:209], v11 offset:33792
v_add_f32 v27, v27, v171
v_mfma_f32_16x16x32_bf16 a[36:39], a[240:243], v[104:107], a[36:39]
v_rcp_f32 v48, v24
v_mfma_f32_16x16x32_bf16 a[36:39], a[244:247], v[108:111], a[36:39]
v_rcp_f32 v50, v25
v_mfma_f32_16x16x32_bf16 a[40:43], a[240:243], v[112:115], a[40:43]
v_rcp_f32 v52, v26
v_mfma_f32_16x16x32_bf16 a[40:43], a[244:247], v[116:119], a[40:43]
v_rcp_f32 v54, v27
v_mfma_f32_16x16x32_bf16 a[44:47], a[240:243], v[120:123], a[44:47]
ds_read_b64_tr_b16 a[210:211], v11 offset:39936
s_waitcnt lgkmcnt(10)
v_mfma_f32_16x16x32_bf16 a[44:47], a[244:247], v[124:127], a[44:47]
ds_read_b64_tr_b16 a[212:213], v11 offset:46080
v_cmp_ngt_f32 s[80:81], s56, v24
v_mfma_f32_16x16x32_bf16 a[48:51], a[248:251], v[96:99], a[48:51]
ds_read_b64_tr_b16 a[214:215], v11 offset:52224
v_cmp_ngt_f32 s[82:83], s56, v25
v_mfma_f32_16x16x32_bf16 a[48:51], a[252:255], v[100:103], a[48:51]
ds_read_b64_tr_b16 a[216:217], v12 offset:33792
v_cmp_ngt_f32 s[84:85], s56, v26
v_mfma_f32_16x16x32_bf16 a[52:55], a[248:251], v[104:107], a[52:55]
ds_read_b64_tr_b16 a[218:219], v12 offset:39936
v_cmp_ngt_f32 s[86:87], s56, v27
v_mfma_f32_16x16x32_bf16 a[52:55], a[252:255], v[108:111], a[52:55]
ds_read_b64_tr_b16 a[220:221], v12 offset:46080
v_accvgpr_read_b32 v32, a0
v_mfma_f32_16x16x32_bf16 a[56:59], a[248:251], v[112:115], a[56:59]
ds_read_b64_tr_b16 a[222:223], v12 offset:52224
v_accvgpr_read_b32 v33, a1
v_mfma_f32_16x16x32_bf16 a[56:59], a[252:255], v[116:119], a[56:59]
ds_read_b64_tr_b16 a[224:225], v9 offset:34816
s_or_b64 s[80:81], s[80:81], s[82:83]
v_mfma_f32_16x16x32_bf16 a[60:63], a[248:251], v[120:123], a[60:63]
ds_read_b64_tr_b16 a[226:227], v9 offset:40960
s_waitcnt lgkmcnt(14)
v_accvgpr_read_b32 v34, a2
v_accvgpr_read_b32 v35, a3
v_mfma_f32_16x16x32_bf16 a[60:63], a[252:255], v[124:127], a[60:63]
ds_read_b64_tr_b16 a[228:229], v9 offset:47104
s_or_b64 s[84:85], s[84:85], s[86:87]
v_mul_f32 v32, v32, v48
v_mul_f32 v33, v33, v48
v_mfma_f32_16x16x32_bf16 a[64:67], a[192:195], v[96:99], a[64:67]
ds_read_b64_tr_b16 a[230:231], v9 offset:53248
s_or_b64 s[80:81], s[80:81], s[84:85]
v_mul_f32 v34, v34, v48
v_mul_f32 v35, v35, v48
v_mfma_f32_16x16x32_bf16 a[64:67], a[196:199], v[100:103], a[64:67]
ds_read_b64_tr_b16 a[232:233], v10 offset:34816
s_or_b32 s80, s80, s81
v_cvt_pk_bf16_f32 v32, v32, v33
v_cvt_pk_bf16_f32 v33, v34, v35
v_mfma_f32_16x16x32_bf16 a[68:71], a[192:195], v[104:107], a[68:71]
ds_read_b64_tr_b16 a[234:235], v10 offset:40960
s_or_b32 s49, s49, s80
v_accvgpr_read_b32 v36, a16
v_accvgpr_read_b32 v37, a17
v_mfma_f32_16x16x32_bf16 a[68:71], a[196:199], v[108:111], a[68:71]
ds_read_b64_tr_b16 a[236:237], v10 offset:47104
s_lshl_b32 s80, s52, 2
v_accvgpr_read_b32 v38, a18
v_accvgpr_read_b32 v39, a19
v_mfma_f32_16x16x32_bf16 a[72:75], a[192:195], v[112:115], a[72:75]
s_add_u32 s80, s80, 106496
v_mul_f32 v36, v36, v48
v_mul_f32 v37, v37, v48
v_mfma_f32_16x16x32_bf16 a[72:75], a[196:199], v[116:119], a[72:75]
v_mul_f32 v38, v38, v48
v_mul_f32 v39, v39, v48
v_mfma_f32_16x16x32_bf16 a[76:79], a[192:195], v[120:123], a[76:79]
v_cvt_pk_bf16_f32 v34, v36, v37
s_waitcnt lgkmcnt(15)
v_cvt_pk_bf16_f32 v35, v38, v39
v_mov_b32 v160, s80
v_mfma_f32_16x16x32_bf16 a[76:79], a[196:199], v[124:127], a[76:79]
buffer_store_dwordx4 v[32:35], v22, s[16:19], s42 offen offset:0 sc1
v_mfma_f32_16x16x32_bf16 a[80:83], a[200:203], v[96:99], a[80:83]
ds_read_b64_tr_b16 a[238:239], v10 offset:53248
v_accvgpr_read_b32 v40, a4
v_accvgpr_read_b32 v41, a5
v_mfma_f32_16x16x32_bf16 a[80:83], a[204:207], v[100:103], a[80:83]
ds_read_b64_tr_b16 a[240:241], v11 offset:34816
v_accvgpr_read_b32 v42, a6
v_accvgpr_read_b32 v43, a7
v_mfma_f32_16x16x32_bf16 a[84:87], a[200:203], v[104:107], a[84:87]
ds_read_b64_tr_b16 a[242:243], v11 offset:40960
v_mul_f32 v40, v40, v50
v_mul_f32 v41, v41, v50
v_mfma_f32_16x16x32_bf16 a[84:87], a[204:207], v[108:111], a[84:87]
ds_read_b64_tr_b16 a[244:245], v11 offset:47104
v_mul_f32 v42, v42, v50
v_mov_b32 v161, s49
v_mul_f32 v43, v43, v50
v_mfma_f32_16x16x32_bf16 a[88:91], a[200:203], v[112:115], a[88:91]
ds_read_b64_tr_b16 a[246:247], v11 offset:53248
v_cvt_pk_bf16_f32 v40, v40, v41
v_cvt_pk_bf16_f32 v41, v42, v43
v_mfma_f32_16x16x32_bf16 a[88:91], a[204:207], v[116:119], a[88:91]
v_accvgpr_read_b32 v44, a20
v_accvgpr_read_b32 v45, a21
v_mfma_f32_16x16x32_bf16 a[92:95], a[200:203], v[120:123], a[92:95]
ds_read_b64_tr_b16 a[248:249], v12 offset:34816
s_waitcnt lgkmcnt(15)
v_accvgpr_read_b32 v46, a22
v_accvgpr_read_b32 v47, a23
v_mfma_f32_16x16x32_bf16 a[92:95], a[204:207], v[124:127], a[92:95]
ds_read_b64_tr_b16 a[250:251], v12 offset:40960
v_mul_f32 v44, v44, v50
v_mul_f32 v45, v45, v50
v_mov_b32 v162, 106496
v_mfma_f32_16x16x32_bf16 a[96:99], a[208:211], v[96:99], a[96:99]
ds_write_b32 v160, v161
v_mul_f32 v46, v46, v50
v_mul_f32 v47, v47, v50
v_mfma_f32_16x16x32_bf16 a[96:99], a[212:215], v[100:103], a[96:99]
ds_read_b64_tr_b16 a[252:253], v12 offset:47104
v_cvt_pk_bf16_f32 v42, v44, v45
v_cvt_pk_bf16_f32 v43, v46, v47
v_mfma_f32_16x16x32_bf16 a[100:103], a[208:211], v[104:107], a[100:103]
buffer_store_dwordx4 v[40:43], v22, s[16:19], s42 offen offset:1024 sc1
v_mfma_f32_16x16x32_bf16 a[100:103], a[212:215], v[108:111], a[100:103]
ds_read_b64_tr_b16 a[254:255], v12 offset:53248
v_accvgpr_read_b32 v56, a8
v_accvgpr_read_b32 v57, a9
v_mfma_f32_16x16x32_bf16 a[104:107], a[208:211], v[112:115], a[104:107]
v_accvgpr_read_b32 v58, a10
v_accvgpr_read_b32 v59, a11
v_mfma_f32_16x16x32_bf16 a[104:107], a[212:215], v[116:119], a[104:107]
v_mul_f32 v56, v56, v52
v_mul_f32 v57, v57, v52
v_mfma_f32_16x16x32_bf16 a[108:111], a[208:211], v[120:123], a[108:111]
v_mul_f32 v58, v58, v52
s_waitcnt lgkmcnt(15)
v_mul_f32 v59, v59, v52
v_mfma_f32_16x16x32_bf16 a[108:111], a[212:215], v[124:127], a[108:111]
v_cvt_pk_bf16_f32 v56, v56, v57
v_cvt_pk_bf16_f32 v57, v58, v59
v_mfma_f32_16x16x32_bf16 a[112:115], a[216:219], v[96:99], a[112:115]
v_accvgpr_read_b32 v60, a24
v_accvgpr_read_b32 v61, a25
v_mfma_f32_16x16x32_bf16 a[112:115], a[220:223], v[100:103], a[112:115]
v_accvgpr_read_b32 v62, a26
v_accvgpr_read_b32 v63, a27
v_mfma_f32_16x16x32_bf16 a[116:119], a[216:219], v[104:107], a[116:119]
v_mul_f32 v60, v60, v52
v_mul_f32 v61, v61, v52
v_mfma_f32_16x16x32_bf16 a[116:119], a[220:223], v[108:111], a[116:119]
v_mul_f32 v62, v62, v52
v_mul_f32 v63, v63, v52
v_mfma_f32_16x16x32_bf16 a[120:123], a[216:219], v[112:115], a[120:123]
s_waitcnt vmcnt(16) lgkmcnt(0)
s_barrier
v_mfma_f32_16x16x32_bf16 a[120:123], a[220:223], v[116:119], a[120:123]
ds_read_b64_tr_b16 a[192:193], v5 offset:0
s_add_u32 m0, s41, 131072
v_mfma_f32_16x16x32_bf16 a[124:127], a[216:219], v[120:123], a[124:127]
ds_read_b128 a[0:3], v13 offset:0
s_mov_b32 s46, 128
v_mfma_f32_16x16x32_bf16 a[124:127], a[220:223], v[124:127], a[124:127]
buffer_load_dwordx4 v21, s[4:7], s46 offen offset:0 lds
v_mfma_f32_16x16x32_bf16 a[128:131], a[224:227], v[96:99], a[128:131]
ds_read_b64_tr_b16 a[194:195], v5 offset:6144
s_mov_b32 s46, 9344
v_mfma_f32_16x16x32_bf16 a[128:131], a[228:231], v[100:103], a[128:131]
ds_read_b128 v[164:167], v162
v_mfma_f32_16x16x32_bf16 a[132:135], a[224:227], v[104:107], a[132:135]
ds_read_b64_tr_b16 a[196:197], v5 offset:12288
v_mfma_f32_16x16x32_bf16 a[132:135], a[228:231], v[108:111], a[132:135]
ds_read_b128 a[16:19], v14 offset:0
v_mfma_f32_16x16x32_bf16 a[136:139], a[224:227], v[112:115], a[136:139]
buffer_load_dwordx4 v21, s[4:7], s46 offen offset:1024 lds
v_mfma_f32_16x16x32_bf16 a[136:139], a[228:231], v[116:119], a[136:139]
ds_read_b64_tr_b16 a[198:199], v5 offset:18432
v_cvt_pk_bf16_f32 v58, v60, v61
v_cvt_pk_bf16_f32 v59, v62, v63
v_mfma_f32_16x16x32_bf16 a[140:143], a[224:227], v[120:123], a[140:143]
buffer_store_dwordx4 v[56:59], v22, s[16:19], s42 offen offset:2048 sc1
v_accvgpr_read_b32 v32, a12
v_accvgpr_read_b32 v33, a13
v_accvgpr_read_b32 v34, a14
v_accvgpr_read_b32 v35, a15
v_mul_f32 v32, v32, v54
v_mul_f32 v33, v33, v54
v_mul_f32 v34, v34, v54
v_mul_f32 v35, v35, v54
v_cvt_pk_bf16_f32 v32, v32, v33
v_cvt_pk_bf16_f32 v33, v34, v35
v_mfma_f32_16x16x32_bf16 a[140:143], a[228:231], v[124:127], a[140:143]
ds_read_b64_tr_b16 a[200:201], v6 offset:0
s_mov_b32 s46, 18560
v_mfma_f32_16x16x32_bf16 a[144:147], a[232:235], v[96:99], a[144:147]
ds_read_b128 a[4:7], v13 offset:2048
v_accvgpr_read_b32 v36, a28
v_mfma_f32_16x16x32_bf16 a[144:147], a[236:239], v[100:103], a[144:147]
buffer_load_dwordx4 v21, s[4:7], s46 offen offset:2048 lds
v_mfma_f32_16x16x32_bf16 a[148:151], a[232:235], v[104:107], a[148:151]
ds_read_b64_tr_b16 a[202:203], v6 offset:6144
v_accvgpr_read_b32 v37, a29
v_mfma_f32_16x16x32_bf16 a[148:151], a[236:239], v[108:111], a[148:151]
ds_read_b128 a[20:23], v14 offset:2048
s_mov_b32 s46, 27776
v_mfma_f32_16x16x32_bf16 a[152:155], a[232:235], v[112:115], a[152:155]
ds_read_b64_tr_b16 a[204:205], v6 offset:12288
v_accvgpr_read_b32 v38, a30
v_mfma_f32_16x16x32_bf16 a[152:155], a[236:239], v[116:119], a[152:155]
buffer_load_dwordx4 v21, s[4:7], s46 offen offset:3072 lds
v_accvgpr_read_b32 v39, a31
v_mfma_f32_16x16x32_bf16 a[156:159], a[232:235], v[120:123], a[156:159]
ds_read_b64_tr_b16 a[206:207], v6 offset:18432
v_mul_f32 v36, v36, v54
v_mul_f32 v37, v37, v54
v_mfma_f32_16x16x32_bf16 a[156:159], a[236:239], v[124:127], a[156:159]
ds_read_b128 a[8:11], v13 offset:4096
v_mul_f32 v38, v38, v54
v_mul_f32 v39, v39, v54
v_mfma_f32_16x16x32_bf16 a[160:163], a[240:243], v[96:99], a[160:163]
ds_read_b64_tr_b16 a[208:209], v7 offset:0
s_add_u32 m0, s41, 135168
v_cvt_pk_bf16_f32 v34, v36, v37
v_cvt_pk_bf16_f32 v35, v38, v39
v_mfma_f32_16x16x32_bf16 a[160:163], a[244:247], v[100:103], a[160:163]
ds_read_b64_tr_b16 a[210:211], v7 offset:6144
s_mov_b32 s46, 41088
v_accvgpr_read_b32 v40, a32
v_accvgpr_read_b32 v41, a33
v_mfma_f32_16x16x32_bf16 a[164:167], a[240:243], v[104:107], a[164:167]
buffer_load_dwordx4 v21, s[4:7], s46 offen offset:0 lds
v_accvgpr_read_b32 v42, a34
v_accvgpr_read_b32 v43, a35
v_mfma_f32_16x16x32_bf16 a[164:167], a[244:247], v[108:111], a[164:167]
ds_read_b128 a[24:27], v14 offset:4096
v_mul_f32 v40, v40, v48
v_mul_f32 v41, v41, v48
v_mfma_f32_16x16x32_bf16 a[168:171], a[240:243], v[112:115], a[168:171]
ds_read_b128 a[12:15], v13 offset:6144
s_mov_b32 s46, 50304
v_mul_f32 v42, v42, v48
v_mul_f32 v43, v43, v48
v_mfma_f32_16x16x32_bf16 a[168:171], a[244:247], v[116:119], a[168:171]
buffer_load_dwordx4 v21, s[4:7], s46 offen offset:1024 lds
v_cvt_pk_bf16_f32 v40, v40, v41
v_cvt_pk_bf16_f32 v41, v42, v43
v_mfma_f32_16x16x32_bf16 a[172:175], a[240:243], v[120:123], a[172:175]
ds_read_b128 a[28:31], v14 offset:6144
v_accvgpr_read_b32 v44, a48
v_accvgpr_read_b32 v45, a49
v_mfma_f32_16x16x32_bf16 a[172:175], a[244:247], v[124:127], a[172:175]
s_mov_b32 s46, 59520
v_accvgpr_read_b32 v46, a50
v_accvgpr_read_b32 v47, a51
v_mfma_f32_16x16x32_bf16 a[176:179], a[248:251], v[96:99], a[176:179]
buffer_load_dwordx4 v21, s[4:7], s46 offen offset:2048 lds
v_mul_f32 v44, v44, v48
v_mul_f32 v45, v45, v48
v_mfma_f32_16x16x32_bf16 a[176:179], a[252:255], v[100:103], a[176:179]
s_waitcnt lgkmcnt(15)
v_or_b32 v164, v164, v165
v_or3_b32 v164, v164, v166, v167
v_mul_f32 v46, v46, v48
v_mul_f32 v47, v47, v48
v_mfma_f32_16x16x32_bf16 a[180:183], a[248:251], v[104:107], a[180:183]
v_readfirstlane_b32 s36, v164
v_cvt_pk_bf16_f32 v42, v44, v45
v_cvt_pk_bf16_f32 v43, v46, v47
v_mfma_f32_16x16x32_bf16 a[180:183], a[252:255], v[108:111], a[180:183]
s_mov_b32 s46, 68736
v_accvgpr_read_b32 v56, a36
v_accvgpr_read_b32 v57, a37
v_mfma_f32_16x16x32_bf16 a[184:187], a[248:251], v[112:115], a[184:187]
buffer_load_dwordx4 v21, s[4:7], s46 offen offset:3072 lds
v_accvgpr_read_b32 v58, a38
v_accvgpr_read_b32 v59, a39
v_mfma_f32_16x16x32_bf16 a[184:187], a[252:255], v[116:119], a[184:187]
v_mul_f32 v56, v56, v50
v_mul_f32 v57, v57, v50
v_mul_f32 v58, v58, v50
v_mul_f32 v59, v59, v50
v_cvt_pk_bf16_f32 v56, v56, v57
v_cvt_pk_bf16_f32 v57, v58, v59
v_accvgpr_read_b32 v60, a52
v_accvgpr_read_b32 v61, a53
v_accvgpr_read_b32 v62, a54
v_accvgpr_read_b32 v63, a55
v_mul_f32 v60, v60, v50
v_mul_f32 v61, v61, v50
v_mul_f32 v62, v62, v50
v_mul_f32 v63, v63, v50
v_cvt_pk_bf16_f32 v58, v60, v61
v_cvt_pk_bf16_f32 v59, v62, v63
v_mfma_f32_16x16x32_bf16 a[188:191], a[248:251], v[120:123], a[188:191]
buffer_store_dwordx4 v[32:35], v23, s[16:19], s42 offen offset:3072 sc1
v_mfma_f32_16x16x32_bf16 a[188:191], a[252:255], v[124:127], a[188:191]
buffer_store_dwordx4 v[40:43], v22, s[16:19], s43 offen offset:0 sc1
buffer_store_dwordx4 v[56:59], v22, s[16:19], s43 offen offset:1024 sc1
s_waitcnt lgkmcnt(0)
s_cmp_lg_u32 s48, 0
s_cselect_b32 s36, 0, s36
s_mov_b32 s47, 1
v_mfma_f32_16x16x32_bf16 v[160:163], a[192:195], a[0:3], 0
ds_read_b64_tr_b16 a[212:213], v7 offset:12288
v_accvgpr_read_b32 v32, a40
v_mfma_f32_16x16x32_bf16 v[160:163], a[196:199], a[16:19], v[160:163]
ds_read_b64_tr_b16 a[214:215], v7 offset:18432
s_add_u32 m0, s40, 82816
v_mfma_f32_16x16x32_bf16 v[184:187], a[192:195], a[4:7], 0
buffer_load_dwordx4 v20, s[8:11], s54 offen offset:128 lds
v_mfma_f32_16x16x32_bf16 v[184:187], a[196:199], a[20:23], v[184:187]
ds_read_b64_tr_b16 a[216:217], v8 offset:0
v_accvgpr_read_b32 v33, a41
v_mfma_f32_16x16x32_bf16 v[208:211], a[192:195], a[8:11], 0
ds_read_b64_tr_b16 a[218:219], v8 offset:6144
v_accvgpr_read_b32 v34, a42
v_mfma_f32_16x16x32_bf16 v[208:211], a[196:199], a[24:27], v[208:211]
buffer_load_dwordx4 v18, s[8:11], s54 offen offset:3200 lds
v_mfma_f32_16x16x32_bf16 v[232:235], a[192:195], a[12:15], 0
ds_read_b64_tr_b16 a[220:221], v8 offset:12288
s_waitcnt lgkmcnt(11)
v_mfma_f32_16x16x32_bf16 v[232:235], a[196:199], a[28:31], v[232:235]
ds_read_b64_tr_b16 a[222:223], v8 offset:18432
v_accvgpr_read_b32 v35, a43
v_mfma_f32_16x16x32_bf16 v[64:67], a[200:203], a[0:3], 0
v_mul_f32 v32, v32, v52
v_mul_f32 v33, v33, v52
v_mfma_f32_16x16x32_bf16 v[64:67], a[204:207], a[16:19], v[64:67]
v_mfma_f32_16x16x32_bf16 v[88:91], a[200:203], a[4:7], 0
ds_read_b64_tr_b16 a[224:225], v5 offset:1024
v_mul_f32 v34, v34, v52
v_mfma_f32_16x16x32_bf16 v[88:91], a[204:207], a[20:23], v[88:91]
ds_read_b64_tr_b16 a[226:227], v5 offset:7168
s_add_u32 m0, s40, 83712
v_mfma_f32_16x16x32_bf16 v[112:115], a[200:203], a[8:11], 0
buffer_load_dwordx4 v20, s[8:11], s54 offen offset:256 lds
v_mfma_f32_16x16x32_bf16 v[112:115], a[204:207], a[24:27], v[112:115]
ds_read_b64_tr_b16 a[228:229], v5 offset:13312
v_mul_f32 v35, v35, v52
v_mfma_f32_16x16x32_bf16 v[136:139], a[200:203], a[12:15], 0
s_waitcnt lgkmcnt(7)
v_cvt_pk_bf16_f32 v32, v32, v33
v_mfma_f32_16x16x32_bf16 v[136:139], a[204:207], a[28:31], v[136:139]
buffer_load_dwordx4 v18, s[8:11], s54 offen offset:3328 lds
v_mfma_f32_16x16x32_bf16 v[164:167], a[208:211], a[0:3], 0
ds_read_b64_tr_b16 a[230:231], v5 offset:19456
v_cvt_pk_bf16_f32 v33, v34, v35
v_mfma_f32_16x16x32_bf16 v[164:167], a[212:215], a[16:19], v[164:167]
ds_read_b64_tr_b16 a[232:233], v6 offset:1024
v_accvgpr_read_b32 v36, a56
v_mfma_f32_16x16x32_bf16 v[188:191], a[208:211], a[4:7], 0
v_mfma_f32_16x16x32_bf16 v[188:191], a[212:215], a[20:23], v[188:191]
ds_read_b64_tr_b16 a[234:235], v6 offset:7168
v_accvgpr_read_b32 v37, a57
v_mfma_f32_16x16x32_bf16 v[212:215], a[208:211], a[8:11], 0
s_add_u32 m0, s41, 0
v_accvgpr_read_b32 v38, a58
v_mfma_f32_16x16x32_bf16 v[212:215], a[212:215], a[24:27], v[212:215]
ds_read_b64_tr_b16 a[236:237], v6 offset:13312
s_waitcnt lgkmcnt(7)
v_mfma_f32_16x16x32_bf16 v[236:239], a[208:211], a[12:15], 0
ds_read_b64_tr_b16 a[238:239], v6 offset:19456
s_mov_b32 s46, 256
v_mfma_f32_16x16x32_bf16 v[236:239], a[212:215], a[28:31], v[236:239]
buffer_load_dwordx4 v21, s[4:7], s46 offen offset:0 lds
v_mfma_f32_16x16x32_bf16 v[68:71], a[216:219], a[0:3], 0
ds_read_b64_tr_b16 a[240:241], v7 offset:1024
v_accvgpr_read_b32 v39, a59
v_mfma_f32_16x16x32_bf16 v[68:71], a[220:223], a[16:19], v[68:71]
ds_read_b64_tr_b16 a[242:243], v7 offset:7168
v_mul_f32 v36, v36, v52
v_mfma_f32_16x16x32_bf16 v[92:95], a[216:219], a[4:7], 0
ds_read_b64_tr_b16 a[244:245], v7 offset:13312
v_mul_f32 v37, v37, v52
v_mfma_f32_16x16x32_bf16 v[92:95], a[220:223], a[20:23], v[92:95]
s_mov_b32 s46, 9472
v_mul_f32 v38, v38, v52
v_mfma_f32_16x16x32_bf16 v[116:119], a[216:219], a[8:11], 0
buffer_load_dwordx4 v21, s[4:7], s46 offen offset:1024 lds
v_mfma_f32_16x16x32_bf16 v[116:119], a[220:223], a[24:27], v[116:119]
v_mul_f32 v39, v39, v52
s_waitcnt lgkmcnt(7)
v_mfma_f32_16x16x32_bf16 v[140:143], a[216:219], a[12:15], 0
ds_read_b64_tr_b16 a[246:247], v7 offset:19456
v_cvt_pk_bf16_f32 v34, v36, v37
v_mfma_f32_16x16x32_bf16 v[140:143], a[220:223], a[28:31], v[140:143]
v_mfma_f32_16x16x32_bf16 v[168:171], a[224:227], a[0:3], 0
ds_read_b64_tr_b16 a[248:249], v8 offset:1024
v_cvt_pk_bf16_f32 v35, v38, v39
v_mfma_f32_16x16x32_bf16 v[168:171], a[228:231], a[16:19], v[168:171]
ds_read_b64_tr_b16 a[250:251], v8 offset:7168
s_mov_b32 s46, 18688
v_mfma_f32_16x16x32_bf16 v[192:195], a[224:227], a[4:7], 0
buffer_load_dwordx4 v21, s[4:7], s46 offen offset:2048 lds
v_mfma_f32_16x16x32_bf16 v[192:195], a[228:231], a[20:23], v[192:195]
ds_read_b64_tr_b16 a[252:253], v8 offset:13312
v_accvgpr_read_b32 v40, a44
v_mfma_f32_16x16x32_bf16 v[216:219], a[224:227], a[8:11], 0
ds_read_b64_tr_b16 a[254:255], v8 offset:19456
v_accvgpr_read_b32 v41, a45
v_mfma_f32_16x16x32_bf16 v[216:219], a[228:231], a[24:27], v[216:219]
s_waitcnt lgkmcnt(8)
ds_read_b64_tr_b16 a[192:193], v5 offset:2048
v_mfma_f32_16x16x32_bf16 v[240:243], a[224:227], a[12:15], 0
ds_read_b64_tr_b16 a[194:195], v5 offset:8192
v_accvgpr_read_b32 v42, a46
v_mfma_f32_16x16x32_bf16 v[240:243], a[228:231], a[28:31], v[240:243]
s_mov_b32 s46, 27904
v_accvgpr_read_b32 v43, a47
v_mfma_f32_16x16x32_bf16 v[72:75], a[232:235], a[0:3], 0
buffer_load_dwordx4 v21, s[4:7], s46 offen offset:3072 lds
v_mfma_f32_16x16x32_bf16 v[72:75], a[236:239], a[16:19], v[72:75]
ds_read_b64_tr_b16 a[196:197], v5 offset:14336
v_mul_f32 v40, v40, v54
v_mfma_f32_16x16x32_bf16 v[96:99], a[232:235], a[4:7], 0
v_mfma_f32_16x16x32_bf16 v[96:99], a[236:239], a[20:23], v[96:99]
ds_read_b64_tr_b16 a[198:199], v5 offset:20480
v_mul_f32 v41, v41, v54
v_mfma_f32_16x16x32_bf16 v[120:123], a[232:235], a[8:11], 0
v_mfma_f32_16x16x32_bf16 v[120:123], a[236:239], a[24:27], v[120:123]
s_add_u32 m0, s41, 4096
v_mul_f32 v42, v42, v54
v_mfma_f32_16x16x32_bf16 v[144:147], a[232:235], a[12:15], 0
ds_read_b64_tr_b16 a[200:201], v6 offset:2048
s_waitcnt lgkmcnt(9)
v_mfma_f32_16x16x32_bf16 v[144:147], a[236:239], a[28:31], v[144:147]
s_waitcnt vmcnt(15)
s_mov_b32 s46, 41216
v_mfma_f32_16x16x32_bf16 v[172:175], a[240:243], a[0:3], 0
ds_read_b128 a[32:35], v15 offset:0
v_mul_f32 v43, v43, v54
v_mfma_f32_16x16x32_bf16 v[172:175], a[244:247], a[16:19], v[172:175]
buffer_load_dwordx4 v21, s[4:7], s46 offen offset:0 lds
v_mfma_f32_16x16x32_bf16 v[196:199], a[240:243], a[4:7], 0
ds_read_b64_tr_b16 a[202:203], v6 offset:8192
v_cvt_pk_bf16_f32 v40, v40, v41
v_mfma_f32_16x16x32_bf16 v[196:199], a[244:247], a[20:23], v[196:199]
ds_read_b128 a[48:51], v16 offset:0
v_cvt_pk_bf16_f32 v41, v42, v43
v_mfma_f32_16x16x32_bf16 v[220:223], a[240:243], a[8:11], 0
ds_read_b64_tr_b16 a[204:205], v6 offset:14336
v_accvgpr_read_b32 v44, a60
v_mfma_f32_16x16x32_bf16 v[220:223], a[244:247], a[24:27], v[220:223]
ds_read_b64_tr_b16 a[206:207], v6 offset:20480
s_mov_b32 s46, 50432
v_mfma_f32_16x16x32_bf16 v[244:247], a[240:243], a[12:15], 0
ds_read_b128 a[36:39], v15 offset:2048
s_waitcnt lgkmcnt(11)
v_mfma_f32_16x16x32_bf16 v[244:247], a[244:247], a[28:31], v[244:247]
buffer_load_dwordx4 v21, s[4:7], s46 offen offset:1024 lds
v_mfma_f32_16x16x32_bf16 v[76:79], a[248:251], a[0:3], 0
ds_read_b64_tr_b16 a[208:209], v7 offset:2048
v_accvgpr_read_b32 v45, a61
v_mfma_f32_16x16x32_bf16 v[76:79], a[252:255], a[16:19], v[76:79]
ds_read_b128 a[52:55], v16 offset:2048
v_accvgpr_read_b32 v46, a62
v_mfma_f32_16x16x32_bf16 v[100:103], a[248:251], a[4:7], 0
ds_read_b64_tr_b16 a[210:211], v7 offset:8192
v_accvgpr_read_b32 v47, a63
v_mfma_f32_16x16x32_bf16 v[100:103], a[252:255], a[20:23], v[100:103]
ds_read_b64_tr_b16 a[212:213], v7 offset:14336
s_mov_b32 s46, 59648
v_mfma_f32_16x16x32_bf16 v[124:127], a[248:251], a[8:11], 0
ds_read_b64_tr_b16 a[214:215], v7 offset:20480
s_waitcnt vmcnt(13)
v_mfma_f32_16x16x32_bf16 v[124:127], a[252:255], a[24:27], v[124:127]
ds_read_b64_tr_b16 a[216:217], v8 offset:2048
v_mul_f32 v44, v44, v54
v_mfma_f32_16x16x32_bf16 v[148:151], a[248:251], a[12:15], 0
buffer_load_dwordx4 v21, s[4:7], s46 offen offset:2048 lds
v_mfma_f32_16x16x32_bf16 v[148:151], a[252:255], a[28:31], v[148:151]
s_waitcnt lgkmcnt(13)
v_mul_f32 v45, v45, v54
v_mfma_f32_16x16x32_bf16 v[176:179], a[192:195], a[0:3], 0
ds_read_b128 a[40:43], v15 offset:4096
v_mul_f32 v46, v46, v54
v_mfma_f32_16x16x32_bf16 v[176:179], a[196:199], a[16:19], v[176:179]
ds_read_b128 a[56:59], v16 offset:4096
s_mov_b32 s46, 68864
v_mfma_f32_16x16x32_bf16 v[200:203], a[192:195], a[4:7], 0
ds_read_b64_tr_b16 a[218:219], v8 offset:8192
v_mul_f32 v47, v47, v54
v_mfma_f32_16x16x32_bf16 v[200:203], a[196:199], a[20:23], v[200:203]
ds_read_b128 a[44:47], v15 offset:6144
v_cvt_pk_bf16_f32 v42, v44, v45
v_mfma_f32_16x16x32_bf16 v[224:227], a[192:195], a[8:11], 0
buffer_load_dwordx4 v21, s[4:7], s46 offen offset:3072 lds
v_mfma_f32_16x16x32_bf16 v[224:227], a[196:199], a[24:27], v[224:227]
ds_read_b128 a[60:63], v16 offset:6144
v_cvt_pk_bf16_f32 v43, v46, v47
v_mfma_f32_16x16x32_bf16 v[248:251], a[192:195], a[12:15], 0
ds_read_b64_tr_b16 a[220:221], v8 offset:14336
s_waitcnt lgkmcnt(13)
v_mfma_f32_16x16x32_bf16 v[248:251], a[196:199], a[28:31], v[248:251]
ds_read_b64_tr_b16 a[222:223], v8 offset:20480
v_mfma_f32_16x16x32_bf16 v[80:83], a[200:203], a[0:3], 0
buffer_store_dwordx4 v[32:35], v22, s[16:19], s43 offen offset:2048 sc1
v_mfma_f32_16x16x32_bf16 v[80:83], a[204:207], a[16:19], v[80:83]
v_mfma_f32_16x16x32_bf16 v[104:107], a[200:203], a[4:7], 0
v_mfma_f32_16x16x32_bf16 v[104:107], a[204:207], a[20:23], v[104:107]
s_mov_b32 s54, 2359296
s_add_u32 m0, s40, 106496
v_mfma_f32_16x16x32_bf16 v[128:131], a[200:203], a[8:11], 0
s_waitcnt vmcnt(35) lgkmcnt(0)
s_barrier
v_mfma_f32_16x16x32_bf16 v[128:131], a[204:207], a[24:27], v[128:131]
ds_read_b64_tr_b16 a[224:225], v5 offset:24576
v_mfma_f32_16x16x32_bf16 v[152:155], a[200:203], a[12:15], 0
buffer_load_dwordx4 v20, s[8:11], s54 offen offset:0 lds
v_mfma_f32_16x16x32_bf16 v[152:155], a[204:207], a[28:31], v[152:155]
ds_read_b64_tr_b16 a[226:227], v5 offset:30720
v_mfma_f32_16x16x32_bf16 v[180:183], a[208:211], a[0:3], 0
ds_read_b64_tr_b16 a[228:229], v5 offset:36864
v_mfma_f32_16x16x32_bf16 v[180:183], a[212:215], a[16:19], v[180:183]
ds_read_b64_tr_b16 a[230:231], v5 offset:43008
v_mfma_f32_16x16x32_bf16 v[204:207], a[208:211], a[4:7], 0
v_mfma_f32_16x16x32_bf16 v[204:207], a[212:215], a[20:23], v[204:207]
ds_read_b64_tr_b16 a[232:233], v6 offset:24576
v_mfma_f32_16x16x32_bf16 v[228:231], a[208:211], a[8:11], 0
buffer_store_dwordx4 v[40:43], v23, s[16:19], s43 offen offset:3072 sc1
v_mfma_f32_16x16x32_bf16 v[228:231], a[212:215], a[24:27], v[228:231]
ds_read_b64_tr_b16 a[234:235], v6 offset:30720
v_mfma_f32_16x16x32_bf16 v[252:255], a[208:211], a[12:15], 0
buffer_load_dwordx4 v18, s[8:11], s54 offen offset:3072 lds
v_mfma_f32_16x16x32_bf16 v[252:255], a[212:215], a[28:31], v[252:255]
ds_read_b64_tr_b16 a[236:237], v6 offset:36864
v_mfma_f32_16x16x32_bf16 v[84:87], a[216:219], a[0:3], 0
ds_read_b64_tr_b16 a[238:239], v6 offset:43008
v_mfma_f32_16x16x32_bf16 v[84:87], a[220:223], a[16:19], v[84:87]
v_mfma_f32_16x16x32_bf16 v[108:111], a[216:219], a[4:7], 0
ds_read_b64_tr_b16 a[240:241], v7 offset:24576
v_mfma_f32_16x16x32_bf16 v[108:111], a[220:223], a[20:23], v[108:111]
v_mfma_f32_16x16x32_bf16 v[132:135], a[216:219], a[8:11], 0
ds_read_b64_tr_b16 a[242:243], v7 offset:30720
v_mfma_f32_16x16x32_bf16 v[132:135], a[220:223], a[24:27], v[132:135]
v_mfma_f32_16x16x32_bf16 v[156:159], a[216:219], a[12:15], 0
s_waitcnt lgkmcnt(6)
v_mfma_f32_16x16x32_bf16 v[156:159], a[220:223], a[28:31], v[156:159]
s_branch K1_W1
K1_REDO:
s_mov_b32 s48, 1
s_waitcnt vmcnt(0) lgkmcnt(0)
s_barrier
s_load_dwordx16 s[4:19], s[58:59], 0
s_load_dwordx8 s[20:27], s[58:59], 64
s_load_dwordx2 s[68:69], s[58:59], 96
s_branch K1_PRO
K2_SPIN0:
s_add_u32 s78, s78, 1
s_cmp_gt_u32 s78, 0x40000
s_cbranch_scc1 K2_RET0
s_sleep 4
buffer_load_dwordx2 v[14:15], off, s[72:75], s76 sc1
s_waitcnt vmcnt(0)
v_min_u32 v14, v14, v15
s_nop 0
v_readfirstlane_b32 s88, v14
s_nop 3
s_cmp_lt_u32 s88, 32
s_cbranch_scc1 K2_SPIN0
s_branch K2_RET0
K2_IDLE:
buffer_store_dwordx4 v[32:35], v22, s[16:19], s45 offen offset:0 sc1
buffer_store_dwordx4 v[40:43], v22, s[16:19], s45 offen offset:1024 sc1
buffer_store_dwordx4 v[56:59], v22, s[16:19], s45 offen offset:2048 sc1
v_mov_b32 v49, v48
v_mov_b32 v51, v50
v_mov_b32 v53, v52
v_mov_b32 v55, v54
v_accvgpr_read_b32 v32, a108
v_accvgpr_read_b32 v33, a109
v_accvgpr_read_b32 v34, a110
v_accvgpr_read_b32 v35, a111
v_pk_mul_f32 v[32:33], v[32:33], v[54:55]
v_pk_mul_f32 v[34:35], v[34:35], v[54:55]
v_cvt_pk_bf16_f32 v32, v32, v33
v_cvt_pk_bf16_f32 v33, v34, v35
v_accvgpr_read_b32 v36, a124
v_accvgpr_read_b32 v37, a125
v_accvgpr_read_b32 v38, a126
v_accvgpr_read_b32 v39, a127
v_pk_mul_f32 v[36:37], v[36:37], v[54:55]
v_pk_mul_f32 v[38:39], v[38:39], v[54:55]
v_cvt_pk_bf16_f32 v34, v36, v37
v_cvt_pk_bf16_f32 v35, v38, v39
buffer_store_dwordx4 v[32:35], v23, s[16:19], s45 offen offset:3072 sc1
v_accvgpr_read_b32 v40, a128
v_accvgpr_read_b32 v41, a129
v_accvgpr_read_b32 v42, a130
v_accvgpr_read_b32 v43, a131
v_pk_mul_f32 v[40:41], v[40:41], v[48:49]
v_pk_mul_f32 v[42:43], v[42:43], v[48:49]
v_cvt_pk_bf16_f32 v40, v40, v41
v_cvt_pk_bf16_f32 v41, v42, v43
v_accvgpr_read_b32 v44, a144
v_accvgpr_read_b32 v45, a145
v_accvgpr_read_b32 v46, a146
v_accvgpr_read_b32 v47, a147
v_pk_mul_f32 v[44:45], v[44:45], v[48:49]
v_pk_mul_f32 v[46:47], v[46:47], v[48:49]
v_cvt_pk_bf16_f32 v42, v44, v45
v_cvt_pk_bf16_f32 v43, v46, v47
buffer_store_dwordx4 v[40:43], v22, s[16:19], s37 offen offset:0 sc1
v_accvgpr_read_b32 v56, a132
v_accvgpr_read_b32 v57, a133
v_accvgpr_read_b32 v58, a134
v_accvgpr_read_b32 v59, a135
v_pk_mul_f32 v[56:57], v[56:57], v[50:51]
v_pk_mul_f32 v[58:59], v[58:59], v[50:51]
v_cvt_pk_bf16_f32 v56, v56, v57
v_cvt_pk_bf16_f32 v57, v58, v59
v_accvgpr_read_b32 v60, a148
v_accvgpr_read_b32 v61, a149
v_accvgpr_read_b32 v62, a150
v_accvgpr_read_b32 v63, a151
v_pk_mul_f32 v[60:61], v[60:61], v[50:51]
v_pk_mul_f32 v[62:63], v[62:63], v[50:51]
v_cvt_pk_bf16_f32 v58, v60, v61
v_cvt_pk_bf16_f32 v59, v62, v63
buffer_store_dwordx4 v[56:59], v22, s[16:19], s37 offen offset:1024 sc1
v_accvgpr_read_b32 v32, a136
v_accvgpr_read_b32 v33, a137
v_accvgpr_read_b32 v34, a138
v_accvgpr_read_b32 v35, a139
v_pk_mul_f32 v[32:33], v[32:33], v[52:53]
v_pk_mul_f32 v[34:35], v[34:35], v[52:53]
v_cvt_pk_bf16_f32 v32, v32, v33
v_cvt_pk_bf16_f32 v33, v34, v35
v_accvgpr_read_b32 v36, a152
v_accvgpr_read_b32 v37, a153
v_accvgpr_read_b32 v38, a154
v_accvgpr_read_b32 v39, a155
v_pk_mul_f32 v[36:37], v[36:37], v[52:53]
v_pk_mul_f32 v[38:39], v[38:39], v[52:53]
v_cvt_pk_bf16_f32 v34, v36, v37
v_cvt_pk_bf16_f32 v35, v38, v39
buffer_store_dwordx4 v[32:35], v22, s[16:19], s37 offen offset:2048 sc1
v_accvgpr_read_b32 v40, a140
v_accvgpr_read_b32 v41, a141
v_accvgpr_read_b32 v42, a142
v_accvgpr_read_b32 v43, a143
v_pk_mul_f32 v[40:41], v[40:41], v[54:55]
v_pk_mul_f32 v[42:43], v[42:43], v[54:55]
v_cvt_pk_bf16_f32 v40, v40, v41
v_cvt_pk_bf16_f32 v41, v42, v43
v_accvgpr_read_b32 v44, a156
v_accvgpr_read_b32 v45, a157
v_accvgpr_read_b32 v46, a158
v_accvgpr_read_b32 v47, a159
v_pk_mul_f32 v[44:45], v[44:45], v[54:55]
v_pk_mul_f32 v[46:47], v[46:47], v[54:55]
v_cvt_pk_bf16_f32 v42, v44, v45
v_cvt_pk_bf16_f32 v43, v46, v47
buffer_store_dwordx4 v[40:43], v23, s[16:19], s37 offen offset:3072 sc1
v_accvgpr_read_b32 v56, a160
v_accvgpr_read_b32 v57, a161
v_accvgpr_read_b32 v58, a162
v_accvgpr_read_b32 v59, a163
v_pk_mul_f32 v[56:57], v[56:57], v[48:49]
v_pk_mul_f32 v[58:59], v[58:59], v[48:49]
v_cvt_pk_bf16_f32 v56, v56, v57
v_cvt_pk_bf16_f32 v57, v58, v59
v_accvgpr_read_b32 v60, a176
v_accvgpr_read_b32 v61, a177
v_accvgpr_read_b32 v62, a178
v_accvgpr_read_b32 v63, a179
v_pk_mul_f32 v[60:61], v[60:61], v[48:49]
v_pk_mul_f32 v[62:63], v[62:63], v[48:49]
v_cvt_pk_bf16_f32 v58, v60, v61
v_cvt_pk_bf16_f32 v59, v62, v63
buffer_store_dwordx4 v[56:59], v22, s[16:19], s38 offen offset:0 sc1
v_accvgpr_read_b32 v32, a164
v_accvgpr_read_b32 v33, a165
v_accvgpr_read_b32 v34, a166
v_accvgpr_read_b32 v35, a167
v_pk_mul_f32 v[32:33], v[32:33], v[50:51]
v_pk_mul_f32 v[34:35], v[34:35], v[50:51]
v_cvt_pk_bf16_f32 v32, v32, v33
v_cvt_pk_bf16_f32 v33, v34, v35
v_accvgpr_read_b32 v36, a180
v_accvgpr_read_b32 v37, a181
v_accvgpr_read_b32 v38, a182
v_accvgpr_read_b32 v39, a183
v_pk_mul_f32 v[36:37], v[36:37], v[50:51]
v_pk_mul_f32 v[38:39], v[38:39], v[50:51]
v_cvt_pk_bf16_f32 v34, v36, v37
v_cvt_pk_bf16_f32 v35, v38, v39
buffer_store_dwordx4 v[32:35], v22, s[16:19], s38 offen offset:1024 sc1
v_accvgpr_read_b32 v40, a168
v_accvgpr_read_b32 v41, a169
v_accvgpr_read_b32 v42, a170
v_accvgpr_read_b32 v43, a171
v_pk_mul_f32 v[40:41], v[40:41], v[52:53]
v_pk_mul_f32 v[42:43], v[42:43], v[52:53]
v_cvt_pk_bf16_f32 v40, v40, v41
v_cvt_pk_bf16_f32 v41, v42, v43
v_accvgpr_read_b32 v44, a184
v_accvgpr_read_b32 v45, a185
v_accvgpr_read_b32 v46, a186
v_accvgpr_read_b32 v47, a187
v_pk_mul_f32 v[44:45], v[44:45], v[52:53]
v_pk_mul_f32 v[46:47], v[46:47], v[52:53]
v_cvt_pk_bf16_f32 v42, v44, v45
v_cvt_pk_bf16_f32 v43, v46, v47
buffer_store_dwordx4 v[40:43], v22, s[16:19], s38 offen offset:2048 sc1
v_accvgpr_read_b32 v56, a172
v_accvgpr_read_b32 v57, a173
v_accvgpr_read_b32 v58, a174
v_accvgpr_read_b32 v59, a175
v_pk_mul_f32 v[56:57], v[56:57], v[54:55]
v_pk_mul_f32 v[58:59], v[58:59], v[54:55]
v_cvt_pk_bf16_f32 v56, v56, v57
v_cvt_pk_bf16_f32 v57, v58, v59
v_accvgpr_read_b32 v60, a188
v_accvgpr_read_b32 v61, a189
v_accvgpr_read_b32 v62, a190
v_accvgpr_read_b32 v63, a191
v_pk_mul_f32 v[60:61], v[60:61], v[54:55]
v_pk_mul_f32 v[62:63], v[62:63], v[54:55]
v_cvt_pk_bf16_f32 v58, v60, v61
v_cvt_pk_bf16_f32 v59, v62, v63
buffer_store_dwordx4 v[56:59], v23, s[16:19], s38 offen offset:3072 sc1
s_add_u32 s81, s57, 0
buffer_load_dword v30, v22, s[24:27], s81 offen offset:0
buffer_load_dword v30, v22, s[24:27], s81 offen offset:1024
buffer_load_dword v30, v22, s[24:27], s81 offen offset:2048
buffer_load_dword v30, v22, s[24:27], s81 offen offset:3072
s_add_u32 s81, s57, 983040
buffer_load_dword v30, v22, s[24:27], s81 offen offset:0
buffer_load_dword v30, v22, s[24:27], s81 offen offset:1024
buffer_load_dword v30, v22, s[24:27], s81 offen offset:2048
buffer_load_dword v30, v22, s[24:27], s81 offen offset:3072
s_add_u32 s57, s57, 65536
s_add_u32 s81, s57, 0
buffer_load_dword v30, v22, s[24:27], s81 offen offset:0
buffer_load_dword v30, v22, s[24:27], s81 offen offset:1024
buffer_load_dword v30, v22, s[24:27], s81 offen offset:2048
buffer_load_dword v30, v22, s[24:27], s81 offen offset:3072
s_add_u32 s81, s57, 983040
buffer_load_dword v30, v22, s[24:27], s81 offen offset:0
buffer_load_dword v30, v22, s[24:27], s81 offen offset:1024
buffer_load_dword v30, v22, s[24:27], s81 offen offset:2048
buffer_load_dword v30, v22, s[24:27], s81 offen offset:3072
s_add_u32 s57, s57, 65536
s_waitcnt vmcnt(16)
s_barrier
s_mov_b64 exec, 1
buffer_atomic_add v20, off, s[28:31], s50
s_mov_b64 exec, -1
K2_PFL:
s_add_u32 s81, s57, 0
buffer_load_dword v30, v22, s[24:27], s81 offen offset:0
buffer_load_dword v30, v22, s[24:27], s81 offen offset:1024
buffer_load_dword v30, v22, s[24:27], s81 offen offset:2048
buffer_load_dword v30, v22, s[24:27], s81 offen offset:3072
s_add_u32 s81, s57, 983040
buffer_load_dword v30, v22, s[24:27], s81 offen offset:0
buffer_load_dword v30, v22, s[24:27], s81 offen offset:1024
buffer_load_dword v30, v22, s[24:27], s81 offen offset:2048
buffer_load_dword v30, v22, s[24:27], s81 offen offset:3072
s_add_u32 s57, s57, 65536
s_waitcnt vmcnt(24)
s_cmp_lt_u32 s57, 983040
s_cbranch_scc1 K2_PFL
s_branch K1_DONE
K1_MAXPASS:
v_and_b32 v32, 15, v0
v_lshrrev_b32 v33, 4, v0
v_mul_u32_u24 v32, 384, v32
v_lshl_add_u32 v32, v33, 4, v32
s_mov_b32 s46, 0
v_mov_b32 v40, 0xff800000
v_mov_b32 v41, 0xff800000
v_mov_b32 v42, 0xff800000
v_mov_b32 v43, 0xff800000
K1_MAXL:
buffer_load_dwordx4 v[64:67], v32, s[8:11], s46 offen offset:0
buffer_load_dwordx4 v[68:71], v32, s[8:11], s46 offen offset:64
buffer_load_dwordx4 v[72:75], v32, s[8:11], s46 offen offset:128
buffer_load_dwordx4 v[76:79], v32, s[8:11], s46 offen offset:192
buffer_load_dwordx4 v[80:83], v32, s[8:11], s46 offen offset:256
buffer_load_dwordx4 v[84:87], v32, s[8:11], s46 offen offset:320
s_waitcnt vmcnt(0)
v_mfma_f32_16x16x32_bf16 v[96:99], v[64:67], v[160:163], 0
v_mfma_f32_16x16x32_bf16 v[96:99], v[68:71], v[164:167], v[96:99]
v_mfma_f32_16x16x32_bf16 v[96:99], v[72:75], v[168:171], v[96:99]
v_mfma_f32_16x16x32_bf16 v[96:99], v[76:79], v[172:175], v[96:99]
v_mfma_f32_16x16x32_bf16 v[96:99], v[80:83], v[176:179], v[96:99]
v_mfma_f32_16x16x32_bf16 v[96:99], v[84:87], v[180:183], v[96:99]
v_mfma_f32_16x16x32_bf16 v[100:103], v[64:67], v[184:187], 0
v_mfma_f32_16x16x32_bf16 v[100:103], v[68:71], v[188:191], v[100:103]
v_mfma_f32_16x16x32_bf16 v[100:103], v[72:75], v[192:195], v[100:103]
v_mfma_f32_16x16x32_bf16 v[100:103], v[76:79], v[196:199], v[100:103]
v_mfma_f32_16x16x32_bf16 v[100:103], v[80:83], v[200:203], v[100:103]
v_mfma_f32_16x16x32_bf16 v[100:103], v[84:87], v[204:207], v[100:103]
v_mfma_f32_16x16x32_bf16 v[104:107], v[64:67], v[208:211], 0
v_mfma_f32_16x16x32_bf16 v[104:107], v[68:71], v[212:215], v[104:107]
v_mfma_f32_16x16x32_bf16 v[104:107], v[72:75], v[216:219], v[104:107]
v_mfma_f32_16x16x32_bf16 v[104:107], v[76:79], v[220:223], v[104:107]
v_mfma_f32_16x16x32_bf16 v[104:107], v[80:83], v[224:227], v[104:107]
v_mfma_f32_16x16x32_bf16 v[104:107], v[84:87], v[228:231], v[104:107]
v_mfma_f32_16x16x32_bf16 v[108:111], v[64:67], v[232:235], 0
v_mfma_f32_16x16x32_bf16 v[108:111], v[68:71], v[236:239], v[108:111]
v_mfma_f32_16x16x32_bf16 v[108:111], v[72:75], v[240:243], v[108:111]
v_mfma_f32_16x16x32_bf16 v[108:111], v[76:79], v[244:247], v[108:111]
v_mfma_f32_16x16x32_bf16 v[108:111], v[80:83], v[248:251], v[108:111]
v_mfma_f32_16x16x32_bf16 v[108:111], v[84:87], v[252:255], v[108:111]
s_nop 7
v_max3_f32 v40, v40, v96, v97
v_max3_f32 v40, v40, v98, v99
v_max3_f32 v41, v41, v100, v101
v_max3_f32 v41, v41, v102, v103
v_max3_f32 v42, v42, v104, v105
v_max3_f32 v42, v42, v106, v107
v_max3_f32 v43, v43, v108, v109
v_max3_f32 v43, v43, v110, v111
s_add_u32 s46, s46, 6144
s_cmp_lt_u32 s46, 393216
s_cbranch_scc1 K1_MAXL
s_branch K1_MAXRET
K_CODE_END:
s_endpgm
.section .rodata,"a"
.p2align 6
.amdhsa_kernel concat_heads__gqa_block_cached__gqa_block_cached__near_ridge_kernel
  .amdhsa_next_free_vgpr 512
  .amdhsa_next_free_sgpr 102
  .amdhsa_accum_offset 256
  .amdhsa_group_segment_fixed_size 0
  .amdhsa_kernarg_size 104
  .amdhsa_user_sgpr_count 2
  .amdhsa_user_sgpr_kernarg_segment_ptr 1
  .amdhsa_system_sgpr_workgroup_id_x 1
  .amdhsa_float_denorm_mode_32 3
.end_amdhsa_kernel
```
